```python
import torch

def _softmax(x, axis=-1):
    return torch.softmax(x, dim=axis)
def _gelu(x):
    return torch.nn.functional.gelu(x, approximate="tanh")
def _silu(x):
    return torch.nn.functional.silu(x)
def _sigmoid(x):
    return torch.sigmoid(x)
def _layernorm(x, axis=-1, eps=1e-5):
    m = x.mean(dim=axis, keepdim=True)
    v = x.var(dim=axis, keepdim=True, unbiased=False)
    return (x - m) / torch.sqrt(v + eps)
def _scatter_add(tgt, idx, src, axis=0):
    return tgt.clone().index_add_(axis, idx, src)
def _segment_sum(src, seg, n):
    out = torch.zeros((n,) + src.shape[1:], dtype=src.dtype)
    return out.index_add_(0, seg, src)
def _pad(x, pw):
    flat = tuple(v for pair in reversed(pw) for v in pair)
    return torch.nn.functional.pad(x, flat)

kernel_name = 'standalone__glu_gated_reglu__prompt'

def setup_inputs():

    _w = (lambda a: (lambda t: t.to(torch.bfloat16) if t.is_floating_point() else t)(torch.as_tensor(a)))
    B, S, D, F = 1, 2048, 640, 1536
    return {
        "x": _w((lambda *s: torch.randn(*s, dtype=torch.bfloat16) * 0.05)(B, S, D)),
        "W_gate": _w((lambda *s: torch.randn(*s, dtype=torch.bfloat16) * 0.05)(D, F) * (2.0 / D) ** 0.5),
        "W_up": _w((lambda *s: torch.randn(*s, dtype=torch.bfloat16) * 0.05)(D, F) * (2.0 / D) ** 0.5),
        "W_down": _w((lambda *s: torch.randn(*s, dtype=torch.bfloat16) * 0.05)(F, D) * (1.0 / F) ** 0.5),
    }

def reference(x, W_gate, W_up, W_down):
    gate = torch.einsum("bsd,df->bsf", x, W_gate)
    up = torch.einsum("bsd,df->bsf", x, W_up)
    gate = gate * (lambda x, dt: x.to(dt))(gate > 0, gate.dtype)
    h = gate * up
    return torch.einsum("bsf,fd->bsd", h, W_down)
```

```asm
; @launch grid=(256,1,1) block=(256,1,1) lds=163840
.amdgcn_target "amdgcn-amd-amdhsa--gfx950"
.text
.globl standalone__glu_gated_reglu__prompt_kernel
.p2align 8
.type standalone__glu_gated_reglu__prompt_kernel,@function
standalone__glu_gated_reglu__prompt_kernel:
    s_load_dwordx8 s[36:43], s[0:1], 0
    s_load_dwordx4 s[44:47], s[0:1], 32
    s_load_dwordx2 s[48:49], s[0:1], 48
    s_cmp_ge_u32 s2, 256
    s_cbranch_scc1 L_exit
    v_lshrrev_b32 v65, 6, v0
    v_and_b32 v0, 63, v0
    s_and_b32 s50, s2, 7
    v_readfirstlane_b32 s3, v65
    s_lshr_b32 s51, s2, 3
    s_mul_i32 s52, s51, 43
    s_lshr_b32 s52, s52, 8
    s_mul_i32 s53, s52, 6
    s_sub_u32 s53, s51, s53
    s_lshr_b32 s54, s50, 2
    s_and_b32 s55, s50, 3
    s_mul_i32 s56, s55, 6
    s_add_u32 s56, s56, s53
    s_lshl_b32 s57, s52, 3
    s_mov_b32 s4, 639307008
    s_mov_b32 s5, 51
    s_lshr_b64 s[4:5], s[4:5], s57
    s_and_b32 s57, s4, 0xff
    s_lshl_b32 s58, s54, 6
    s_add_u32 s57, s57, s58
    s_mul_i32 s58, s54, 5
    s_add_u32 s58, s58, s52
    s_add_u32 s59, s52, s53
    s_add_u32 s59, s59, s54
    s_lshl_b32 s59, s59, 2
    s_mov_b32 s4, 812844848
    s_mov_b32 s5, 120615687
    s_lshr_b64 s[4:5], s[4:5], s59
    s_and_b32 s59, s4, 15
    s_lshl_b32 s60, s59, 7
    s_lshl_b32 s70, s3, 10
    s_lshl_b32 s71, s3, 12
    s_lshl_b32 s7, s3, 11
    v_lshrrev_b32 v66, 3, v0
    v_and_b32 v67, 7, v0
    v_lshrrev_b32 v68, 4, v0
    v_lshl_add_u32 v69, v65, 3, v66
    v_mul_u32_u24 v69, 1280, v69
    v_lshl_add_u32 v70, v65, 2, v68
    v_and_b32 v70, 7, v70
    v_xor_b32 v70, v70, v67
    v_lshl_add_u32 v69, v70, 4, v69
    s_mul_i32 s4, s57, 20480
    v_add_u32 v8, s4, v69
    v_lshl_add_u32 v69, v65, 4, v66
    v_mul_u32_u24 v69, 3072, v69
    v_and_b32 v70, 1, v68
    v_lshlrev_b32 v71, 1, v70
    v_xor_b32 v71, v71, v67
    v_lshl_add_u32 v69, v71, 4, v69
    s_lshl_b32 s4, s56, 7
    v_add_u32 v9, s4, v69
    v_xor_b32 v10, 0, v9
    v_add_u32 v3, 122880, v8
    s_mov_b32 s10, 2621440
    s_mov_b32 s11, 0x20000
    s_mov_b32 s14, 1966080
    s_mov_b32 s15, 0x20000
    s_mov_b32 s18, 1966080
    s_mov_b32 s19, 0x20000
    s_mov_b32 s22, 1966080
    s_mov_b32 s23, 0x20000
    s_mov_b32 s26, 2621440
    s_mov_b32 s27, 0x20000
    s_mov_b32 s30, 67108864
    s_mov_b32 s31, 0x20000
    s_mov_b32 s34, 256
    s_mov_b32 s35, 0x20000
    v_xor_b32 v71, 64, v9
    v_add_u32 v42, 23552, v71
    v_xor_b32 v43, 0, v42
    v_add_u32 v1, 40960, v8
    v_add_u32 v2, 81920, v8
    s_mov_b32 s97, 0
    s_cmp_ge_u32 s51, 6
    s_cselect_b32 s97, 1, s97
    s_cmp_ge_u32 s51, 12
    s_cselect_b32 s97, 2, s97
    s_cmp_ge_u32 s51, 18
    s_cselect_b32 s97, 0, s97
    s_cmp_ge_u32 s51, 30
    s_cselect_b32 s97, 3, s97
    s_getpc_b64 s[0:1]
L_pc:
    s_lshl_b32 s4, s2, 7
    s_add_u32 s0, s0, s4
    s_addc_u32 s1, s1, 0
    s_add_u32 s0, s0, L_table-L_pc
    s_addc_u32 s1, s1, 0
    s_mov_b32 s5, s56
    s_mov_b32 s6, s57
    s_mov_b32 s50, s58
    v_mov_b32 v11, 0
    v_mov_b32 v44, 0
    v_mov_b32 v45, 0
    v_mov_b32 v46, 0
    v_mov_b32 v12, 0
    v_mov_b32 v13, 0
    v_mov_b32 v17, 0
    v_mov_b32 v18, 0
    v_mov_b32 v19, 0
    v_mov_b32 v50, 0
    v_mov_b32 v4, 0
    v_mov_b32 v5, 0
    v_mov_b32 v6, 0
    s_waitcnt lgkmcnt(0)
    s_mov_b64 s[12:13], s[38:39]
    s_mov_b64 s[16:17], s[40:41]
    s_mov_b64 s[8:9], s[36:37]
    s_mov_b64 s[20:21], s[42:43]
    s_mov_b64 s[24:25], s[44:45]
    s_mov_b64 s[32:33], s[46:47]
    s_mov_b64 s[28:29], s[48:49]
    s_cmp_ge_u32 s51, 30
    s_cbranch_scc1 L_idle
    s_add_u32 m0, s7, 0
    s_mul_i32 s4, s60, 1536
    buffer_load_dwordx4 v9, s[12:15], s4 offen lds
    s_add_u32 m0, s7, 8192
    s_nop 0
    buffer_load_dwordx4 v10, s[16:19], s4 offen lds
    s_add_u32 m0, s70, 16384
    s_nop 0
    buffer_load_dwordx4 v8, s[8:11], s60 offen lds
    s_add_u32 m0, s70, 28672
    s_nop 0
    buffer_load_dwordx4 v3, s[8:11], s60 offen lds
    s_add_u32 m0, s7, 0
    s_nop 0
    buffer_load_dwordx4 v42, s[12:15], s4 offen offset:1024 lds
L_hop:
    s_load_dwordx16 s[72:87], s[0:1], 0
    s_load_dwordx8 s[88:95], s[0:1], 64
    s_load_dwordx8 s[36:43], s[0:1], 96
    s_mov_b32 s44, s5
    s_mov_b32 s45, s6
    s_mov_b32 s46, s50
    s_add_u32 s52, s60, 128
    s_sub_u32 s53, s52, 1280
    s_min_u32 s61, s52, s53
    s_add_u32 s52, s61, 128
    s_sub_u32 s53, s52, 1280
    s_min_u32 s62, s52, s53
    s_add_u32 s52, s62, 128
    s_sub_u32 s53, s52, 1280
    s_min_u32 s63, s52, s53
    s_add_u32 s52, s63, 128
    s_sub_u32 s53, s52, 1280
    s_min_u32 s64, s52, s53
    s_add_u32 s52, s64, 128
    s_sub_u32 s53, s52, 1280
    s_min_u32 s65, s52, s53
    s_add_u32 s52, s65, 128
    s_sub_u32 s53, s52, 1280
    s_min_u32 s66, s52, s53
    s_add_u32 s52, s66, 128
    s_sub_u32 s53, s52, 1280
    s_min_u32 s67, s52, s53
    s_add_u32 s52, s67, 128
    s_sub_u32 s53, s52, 1280
    s_min_u32 s68, s52, s53
    s_add_u32 s52, s68, 128
    s_sub_u32 s53, s52, 1280
    s_min_u32 s69, s52, s53
    v_and_b32 v72, 15, v0
    v_bfe_u32 v74, v0, 1, 3
    v_xor_b32 v74, v74, v68
    v_lshlrev_b32 v74, 4, v74
    v_lshl_add_u32 v20, v72, 7, v74
    v_xor_b32 v21, 64, v20
    v_add_u32 v24, 0x10000, v20
    v_add_u32 v25, 0x10000, v21
    v_bfe_u32 v74, v0, 2, 2
    v_lshl_add_u32 v72, v68, 3, v74
    v_lshlrev_b32 v72, 7, v72
    v_bfe_u32 v74, v0, 3, 1
    v_lshl_add_u32 v74, v70, 1, v74
    v_xor_b32 v74, v74, v65
    v_lshl_add_u32 v72, v74, 5, v72
    v_and_b32 v74, 3, v0
    v_lshl_add_u32 v28, v74, 3, v72
    v_add_u32 v29, 0x10000, v28
    v_lshrrev_b32 v7, 4, v0
    v_and_b32 v14, 15, v0
    v_lshrrev_b32 v15, 5, v0
    v_and_b32 v16, 1, v7
    s_mul_i32 s52, s3, 491520
    v_lshrrev_b32 v39, 3, v0
    v_mul_u32_u24 v39, 1280, v39
    v_and_b32 v41, 7, v0
    v_lshlrev_b32 v49, 1, v7
    v_xor_b32 v41, v41, v49
    v_lshl_add_u32 v39, v41, 4, v39
    v_add_u32 v11, s52, v39
    v_bfe_u32 v39, v0, 2, 2
    v_lshl_add_u32 v39, v16, 2, v39
    v_lshl_add_u32 v39, v15, 4, v39
    v_lshlrev_b32 v39, 7, v39
    v_bfe_u32 v41, v0, 3, 1
    v_lshl_add_u32 v41, v16, 1, v41
    v_lshl_add_u32 v39, v41, 5, v39
    v_and_b32 v41, 3, v0
    v_lshl_add_u32 v39, v41, 3, v39
    v_add_u32 v39, s71, v39
    v_xor_b32 v41, 0, v39
    v_add_u32 v30, 0x18000, v41
    v_add_u32 v60, 0x8000, v41
    v_xor_b32 v41, 32, v39
    v_add_u32 v31, 0x18000, v41
    v_add_u32 v61, 0x8000, v41
    v_xor_b32 v41, 64, v39
    v_add_u32 v32, 0x18000, v41
    v_add_u32 v62, 0x8000, v41
    v_xor_b32 v41, 96, v39
    v_add_u32 v33, 0x18000, v41
    v_add_u32 v63, 0x8000, v41
    v_add_u32 v4, 163840, v8
    v_add_u32 v5, 204800, v8
    v_add_u32 v6, 245760, v8
    v_mul_u32_u24 v39, 49152, v15
    v_lshl_add_u32 v39, v16, 8, v39
    v_lshl_add_u32 v39, v14, 4, v39
    s_lshl_b32 s52, s3, 9
    s_mul_i32 s53, s45, 49152
    s_add_u32 s52, s52, s53
    s_lshl_b32 s53, s44, 11
    s_add_u32 s52, s52, s53
    s_add_u32 s52, s52, 131072
    v_add_u32 v12, s52, v39
    s_mul_i32 s52, s3, 12288
    s_add_u32 s52, s52, 131072
    v_lshlrev_b32 v39, 4, v0
    v_add_u32 v13, s52, v39
    s_mul_i32 s52, s46, 24
    s_add_u32 s52, s52, s44
    s_lshl_b32 s52, s52, 9
    s_add_u32 s52, s52, 0
    v_mov_b32 v18, s52
    s_mov_b32 s51, s52
    v_min_u32 v50, 5, v0
    v_lshlrev_b32 v50, 9, v50
    v_xor_b32 v39, v7, v14
    v_lshlrev_b32 v39, 4, v39
    v_lshl_add_u32 v39, v14, 8, v39
    v_add_u32 v34, s71, v39
    v_xor_b32 v35, 64, v34
    v_xor_b32 v36, 0x80, v34
    v_xor_b32 v37, 0xc0, v34
    v_lshl_add_u32 v39, s3, 2, v7
    v_xor_b32 v41, v39, v14
    v_lshlrev_b32 v41, 4, v41
    v_lshl_add_u32 v38, v39, 8, v41
    v_mul_u32_u24 v39, 1280, v39
    v_lshl_add_u32 v17, v14, 3, v39
    s_mul_i32 s52, s3, 3072
    v_add_u32 v50, s52, v50
    s_add_u32 s0, s28, s52
    s_addc_u32 s1, s29, 0
    s_cmp_eq_u32 s97, 3
    s_cbranch_scc1 L_latehop
    s_add_u32 m0, s7, 8192
    s_nop 0
    buffer_load_dwordx4 v43, s[16:19], s4 offen offset:1024 lds
    s_add_u32 m0, s70, 20480
    s_nop 0
    buffer_load_dwordx4 v1, s[8:11], s60 offen lds
    s_add_u32 m0, s70, 24576
    s_nop 0
    buffer_load_dwordx4 v2, s[8:11], s60 offen lds
    s_add_u32 m0, s7, 32768
    s_mul_i32 s4, s61, 1536
    buffer_load_dwordx4 v9, s[12:15], s4 offen lds
    s_add_u32 m0, s7, 32768
    s_nop 0
    buffer_load_dwordx4 v42, s[12:15], s4 offen offset:1024 lds
    s_add_u32 m0, s7, 40960
    s_nop 0
    buffer_load_dwordx4 v10, s[16:19], s4 offen lds
    s_add_u32 m0, s7, 40960
    s_nop 0
    buffer_load_dwordx4 v43, s[16:19], s4 offen offset:1024 lds
L_latehop:
    s_mov_b64 exec, 0
    s_cmp_eq_u32 s97, 1
    s_cbranch_scc1 L_B_hop
    s_cmp_eq_u32 s97, 2
    s_cbranch_scc1 L_C_hop
    s_cmp_eq_u32 s97, 3
    s_cbranch_scc1 L_D_hop
L_A_hop:
    s_cmp_eq_u32 s3, 1
    s_cbranch_scc1 L_A_w1_0
    s_cmp_eq_u32 s3, 2
    s_cbranch_scc1 L_A_w2_0
    s_cmp_eq_u32 s3, 3
    s_cbranch_scc1 L_A_w3_0
    s_branch L_A_w0_0
L_B_hop:
    s_cmp_eq_u32 s3, 1
    s_cbranch_scc1 L_B_w1_0
    s_cmp_eq_u32 s3, 2
    s_cbranch_scc1 L_B_w2_0
    s_cmp_eq_u32 s3, 3
    s_cbranch_scc1 L_B_w3_0
    s_branch L_B_w0_0
L_C_hop:
    s_cmp_eq_u32 s3, 1
    s_cbranch_scc1 L_C_w1_0
    s_cmp_eq_u32 s3, 2
    s_cbranch_scc1 L_C_w2_0
    s_cmp_eq_u32 s3, 3
    s_cbranch_scc1 L_C_w3_0
    s_branch L_C_w0_0
L_D_hop:
    s_cmp_eq_u32 s3, 1
    s_cbranch_scc1 L_D_w1_0
    s_cmp_eq_u32 s3, 2
    s_cbranch_scc1 L_hopped
    s_cmp_eq_u32 s3, 3
    s_cbranch_scc1 L_hopped
    s_branch L_D_w0_0
L_hopped:
    s_mov_b64 exec, -1
    s_cmp_eq_u32 s97, 3
    s_cbranch_scc1 L_no3
    s_add_u32 m0, s70, 49152
    s_nop 0
    buffer_load_dwordx4 v8, s[8:11], s61 offen lds
    s_add_u32 m0, s70, 53248
    s_nop 0
    buffer_load_dwordx4 v1, s[8:11], s61 offen lds
    s_add_u32 m0, s70, 57344
    s_nop 0
    buffer_load_dwordx4 v2, s[8:11], s61 offen lds
    s_add_u32 m0, s70, 61440
    s_nop 0
    buffer_load_dwordx4 v3, s[8:11], s61 offen lds
L_no3:
    s_waitcnt lgkmcnt(0)
    v_add_u32 v11, s42, v11
    v_add_u32 v17, s42, v17
    v_add_u32 v44, 9216, v11
    v_add_u32 v45, 18432, v11
    v_add_u32 v46, 27648, v11
    s_cmp_eq_u32 s97, 3
    s_cbranch_scc1 L_D_enter
    s_cmp_lg_u32 s3, 0
    s_cbranch_scc1 L_noold
    s_load_dword s100, s[28:29], s51 glc
    s_load_dword s101, s[28:29], s51 offset:128 glc
    s_load_dword s47, s[28:29], s51 offset:256 glc
    s_load_dword s5, s[28:29], s51 offset:384 glc
L_noold:
    s_cmp_eq_u32 s97, 1
    s_cbranch_scc1 L_B_enter
    s_cmp_eq_u32 s97, 2
    s_cbranch_scc1 L_C_enter
    s_branch L_A_enter
L_idle:
    s_cmp_lg_u32 s2, 240
    s_cbranch_scc1 L_hop
    s_cmp_lg_u32 s3, 0
    s_cbranch_scc1 L_hop
    buffer_load_dword v48, v19, s[28:31], 0 offen sc1
    s_waitcnt vmcnt(0)
    v_and_b32 v48, -8, v48
    v_add_u32 v48, 0x9e3779b9, v48
    s_mov_b64 exec, 1
    buffer_store_dword v48, v19, s[32:35], 0 offen sc1
    s_mov_b64 exec, -1
    s_branch L_hop
L_exit:
    s_endpgm
.p2align 12
L_A_enter:
L_A_w0_0:
    s_cbranch_execz L_A_w0_1
    s_waitcnt vmcnt(8)
    s_barrier
    ds_read_b64_tr_b16 v[128:129], v28 offset:0
    ds_read_b64_tr_b16 v[130:131], v28 offset:512
    ds_read_b64_tr_b16 v[132:133], v28 offset:8192
    ds_read_b64_tr_b16 v[134:135], v28 offset:8704
    ds_read_b128 a[192:195], v20 offset:16384
    ds_read_b128 a[196:199], v20 offset:18432
    ds_read_b128 a[200:203], v20 offset:20480
L_A_w0_1:
    s_cbranch_execz L_hopped
    ds_read_b128 a[204:207], v20 offset:22528
    ds_read_b128 a[208:211], v20 offset:24576
    ds_read_b128 a[212:215], v20 offset:26624
    ds_read_b128 a[216:219], v20 offset:28672
    s_waitcnt lgkmcnt(6)
    v_mfma_f32_16x16x32_bf16 v[64:67], v[128:131], a[192:195], 0
    ds_read_b128 a[220:223], v20 offset:30720
    s_add_u32 m0, s7, 98304
    v_mfma_f32_16x16x32_bf16 v[72:75], v[132:135], a[192:195], 0
    s_mul_i32 s4, s62, 1536
    buffer_load_dwordx4 v9, s[12:15], s4 offen lds
    s_waitcnt lgkmcnt(6)
    v_mfma_f32_16x16x32_bf16 v[68:71], v[128:131], a[196:199], 0
    ds_read_b64_tr_b16 v[136:137], v28 offset:4096
    v_mfma_f32_16x16x32_bf16 v[76:79], v[132:135], a[196:199], 0
    ds_read_b64_tr_b16 v[138:139], v28 offset:4608
    s_waitcnt lgkmcnt(6)
    v_mfma_f32_16x16x32_bf16 v[80:83], v[128:131], a[200:203], 0
    ds_read_b64_tr_b16 v[140:141], v28 offset:12288
    v_mfma_f32_16x16x32_bf16 v[88:91], v[132:135], a[200:203], 0
    ds_read_b64_tr_b16 v[142:143], v28 offset:12800
    v_mfma_f32_16x16x32_bf16 v[84:87], v[128:131], a[204:207], 0
    ds_read_b128 a[192:195], v21 offset:16384
    v_mfma_f32_16x16x32_bf16 v[92:95], v[132:135], a[204:207], 0
    buffer_load_dwordx4 v42, s[12:15], s4 offen offset:1024 lds
    s_add_u32 m0, s7, 106496
    s_waitcnt lgkmcnt(7)
    v_mfma_f32_16x16x32_bf16 v[96:99], v[128:131], a[208:211], 0
    buffer_load_dwordx4 v10, s[16:19], s4 offen lds
    ds_read_b128 a[196:199], v21 offset:18432
    v_mfma_f32_16x16x32_bf16 v[104:107], v[132:135], a[208:211], 0
    buffer_load_dwordx4 v43, s[16:19], s4 offen offset:1024 lds
    v_mfma_f32_16x16x32_bf16 v[100:103], v[128:131], a[212:215], 0
    ds_read_b128 a[200:203], v21 offset:20480
    v_mfma_f32_16x16x32_bf16 v[108:111], v[132:135], a[212:215], 0
    ds_read_b128 a[204:207], v21 offset:22528
    s_add_u32 m0, s70, 114688
    s_waitcnt lgkmcnt(8)
    v_mfma_f32_16x16x32_bf16 v[112:115], v[128:131], a[216:219], 0
    buffer_load_dwordx4 v8, s[8:11], s62 offen lds
    v_mfma_f32_16x16x32_bf16 v[120:123], v[132:135], a[216:219], 0
    ds_read_b128 a[208:211], v21 offset:24576
    s_add_u32 m0, s70, 118784
    v_mfma_f32_16x16x32_bf16 v[116:119], v[128:131], a[220:223], 0
    buffer_load_dwordx4 v1, s[8:11], s62 offen lds
    v_mfma_f32_16x16x32_bf16 v[124:127], v[132:135], a[220:223], 0
    ds_read_b128 a[212:215], v21 offset:26624
    s_add_u32 m0, s70, 122880
    s_waitcnt lgkmcnt(4)
    v_mfma_f32_16x16x32_bf16 v[64:67], v[136:139], a[192:195], v[64:67]
    buffer_load_dwordx4 v2, s[8:11], s62 offen lds
    v_mfma_f32_16x16x32_bf16 v[72:75], v[140:143], a[192:195], v[72:75]
    ds_read_b128 a[216:219], v21 offset:28672
    s_add_u32 m0, s70, 126976
    v_mfma_f32_16x16x32_bf16 v[68:71], v[136:139], a[196:199], v[68:71]
    buffer_load_dwordx4 v3, s[8:11], s62 offen lds
    v_mfma_f32_16x16x32_bf16 v[76:79], v[140:143], a[196:199], v[76:79]
    ds_read_b128 a[220:223], v21 offset:30720
    s_waitcnt lgkmcnt(4)
    v_mfma_f32_16x16x32_bf16 v[80:83], v[136:139], a[200:203], v[80:83]
    s_waitcnt vmcnt(8)
    s_barrier
    ds_read_b64_tr_b16 v[144:145], v28 offset:32768
    v_mfma_f32_16x16x32_bf16 v[88:91], v[140:143], a[200:203], v[88:91]
    ds_read_b64_tr_b16 v[146:147], v28 offset:33280
    v_mfma_f32_16x16x32_bf16 v[84:87], v[136:139], a[204:207], v[84:87]
    ds_read_b64_tr_b16 v[148:149], v28 offset:40960
    v_mfma_f32_16x16x32_bf16 v[92:95], v[140:143], a[204:207], v[92:95]
    ds_read_b64_tr_b16 v[150:151], v28 offset:41472
    s_waitcnt lgkmcnt(6)
    v_mfma_f32_16x16x32_bf16 v[96:99], v[136:139], a[208:211], v[96:99]
    ds_read_b128 a[192:195], v20 offset:49152
    v_mfma_f32_16x16x32_bf16 v[104:107], v[140:143], a[208:211], v[104:107]
    ds_read_b128 a[196:199], v20 offset:51200
    s_add_u32 m0, s7, 65536
    s_mul_i32 s4, s63, 1536
    v_mfma_f32_16x16x32_bf16 v[100:103], v[136:139], a[212:215], v[100:103]
    buffer_load_dwordx4 v9, s[12:15], s4 offen lds
    v_mfma_f32_16x16x32_bf16 v[108:111], v[140:143], a[212:215], v[108:111]
    ds_read_b128 a[200:203], v20 offset:53248
    s_waitcnt lgkmcnt(7)
    v_mfma_f32_16x16x32_bf16 v[112:115], v[136:139], a[216:219], v[112:115]
    buffer_load_dwordx4 v42, s[12:15], s4 offen offset:1024 lds
    ds_read_b128 a[204:207], v20 offset:55296
    v_mfma_f32_16x16x32_bf16 v[120:123], v[140:143], a[216:219], v[120:123]
    ds_read_b128 a[208:211], v20 offset:57344
    s_add_u32 m0, s7, 73728
    v_mfma_f32_16x16x32_bf16 v[116:119], v[136:139], a[220:223], v[116:119]
    buffer_load_dwordx4 v10, s[16:19], s4 offen lds
    v_mfma_f32_16x16x32_bf16 v[124:127], v[140:143], a[220:223], v[124:127]
    ds_read_b128 a[212:215], v20 offset:59392
    s_waitcnt lgkmcnt(5)
    v_mfma_f32_16x16x32_bf16 v[64:67], v[144:147], a[192:195], v[64:67]
    ds_read_b64_tr_b16 v[152:153], v28 offset:36864
    v_mfma_f32_16x16x32_bf16 v[72:75], v[148:151], a[192:195], v[72:75]
    ds_read_b128 a[216:219], v20 offset:61440
    s_waitcnt lgkmcnt(6)
    v_mfma_f32_16x16x32_bf16 v[68:71], v[144:147], a[196:199], v[68:71]
    buffer_load_dwordx4 v43, s[16:19], s4 offen offset:1024 lds
    v_mfma_f32_16x16x32_bf16 v[76:79], v[148:151], a[196:199], v[76:79]
    ds_read_b64_tr_b16 v[154:155], v28 offset:37376
    s_waitcnt lgkmcnt(5)
    v_mfma_f32_16x16x32_bf16 v[80:83], v[144:147], a[200:203], v[80:83]
    ds_read_b128 a[220:223], v20 offset:63488
    v_mfma_f32_16x16x32_bf16 v[88:91], v[148:151], a[200:203], v[88:91]
    ds_read_b64_tr_b16 v[156:157], v28 offset:45056
    v_mfma_f32_16x16x32_bf16 v[84:87], v[144:147], a[204:207], v[84:87]
    ds_read_b128 a[192:195], v21 offset:49152
    s_add_u32 m0, s70, 81920
    v_mfma_f32_16x16x32_bf16 v[92:95], v[148:151], a[204:207], v[92:95]
    buffer_load_dwordx4 v8, s[8:11], s63 offen lds
    s_waitcnt lgkmcnt(6)
    v_mfma_f32_16x16x32_bf16 v[96:99], v[144:147], a[208:211], v[96:99]
    ds_read_b64_tr_b16 v[158:159], v28 offset:45568
    ds_read_b128 a[196:199], v21 offset:51200
    v_mfma_f32_16x16x32_bf16 v[104:107], v[148:151], a[208:211], v[104:107]
    ds_read_b128 a[200:203], v21 offset:53248
    s_add_u32 m0, s70, 86016
    v_mfma_f32_16x16x32_bf16 v[100:103], v[144:147], a[212:215], v[100:103]
    buffer_load_dwordx4 v1, s[8:11], s63 offen lds
    v_mfma_f32_16x16x32_bf16 v[108:111], v[148:151], a[212:215], v[108:111]
    ds_read_b128 a[204:207], v21 offset:55296
    s_waitcnt lgkmcnt(6)
    v_mfma_f32_16x16x32_bf16 v[112:115], v[144:147], a[216:219], v[112:115]
    ds_read_b128 a[208:211], v21 offset:57344
    s_add_u32 m0, s70, 90112
    v_mfma_f32_16x16x32_bf16 v[120:123], v[148:151], a[216:219], v[120:123]
    buffer_load_dwordx4 v2, s[8:11], s63 offen lds
    v_mfma_f32_16x16x32_bf16 v[116:119], v[144:147], a[220:223], v[116:119]
    ds_read_b128 a[212:215], v21 offset:59392
    v_mfma_f32_16x16x32_bf16 v[124:127], v[148:151], a[220:223], v[124:127]
    ds_read_b128 a[216:219], v21 offset:61440
    s_add_u32 m0, s70, 94208
    s_waitcnt lgkmcnt(5)
    v_mfma_f32_16x16x32_bf16 v[64:67], v[152:155], a[192:195], v[64:67]
    buffer_load_dwordx4 v3, s[8:11], s63 offen lds
    v_mfma_f32_16x16x32_bf16 v[72:75], v[156:159], a[192:195], v[72:75]
    ds_read_b128 a[220:223], v21 offset:63488
    v_mfma_f32_16x16x32_bf16 v[68:71], v[152:155], a[196:199], v[68:71]
    v_mfma_f32_16x16x32_bf16 v[76:79], v[156:159], a[196:199], v[76:79]
    s_waitcnt lgkmcnt(4)
    v_mfma_f32_16x16x32_bf16 v[80:83], v[152:155], a[200:203], v[80:83]
    s_waitcnt vmcnt(8)
    s_barrier
    ds_read_b64_tr_b16 v[160:161], v29 offset:32768
    v_mfma_f32_16x16x32_bf16 v[88:91], v[156:159], a[200:203], v[88:91]
    ds_read_b64_tr_b16 v[162:163], v29 offset:33280
    v_mfma_f32_16x16x32_bf16 v[84:87], v[152:155], a[204:207], v[84:87]
    ds_read_b64_tr_b16 v[164:165], v29 offset:40960
    v_mfma_f32_16x16x32_bf16 v[92:95], v[156:159], a[204:207], v[92:95]
    ds_read_b64_tr_b16 v[166:167], v29 offset:41472
    s_waitcnt lgkmcnt(6)
    v_mfma_f32_16x16x32_bf16 v[96:99], v[152:155], a[208:211], v[96:99]
    ds_read_b128 a[192:195], v24 offset:49152
    v_mfma_f32_16x16x32_bf16 v[104:107], v[156:159], a[208:211], v[104:107]
    ds_read_b128 a[196:199], v24 offset:51200
    s_add_u32 m0, s7, 0
    s_mul_i32 s4, s64, 1536
    v_mfma_f32_16x16x32_bf16 v[100:103], v[152:155], a[212:215], v[100:103]
    buffer_load_dwordx4 v9, s[12:15], s4 offen lds
    v_mfma_f32_16x16x32_bf16 v[108:111], v[156:159], a[212:215], v[108:111]
    ds_read_b128 a[200:203], v24 offset:53248
    s_waitcnt lgkmcnt(7)
    v_mfma_f32_16x16x32_bf16 v[112:115], v[152:155], a[216:219], v[112:115]
    buffer_load_dwordx4 v42, s[12:15], s4 offen offset:1024 lds
    ds_read_b128 a[204:207], v24 offset:55296
    v_mfma_f32_16x16x32_bf16 v[120:123], v[156:159], a[216:219], v[120:123]
    s_lshr_b32 s53, s3, 1
    ds_read_b128 a[208:211], v24 offset:57344
    s_mul_i32 s52, s53, 20480
    v_mfma_f32_16x16x32_bf16 v[116:119], v[152:155], a[220:223], v[116:119]
    s_add_u32 m0, s7, 8192
    s_nop 0
    buffer_load_dwordx4 v10, s[16:19], s4 offen lds
    v_mfma_f32_16x16x32_bf16 v[124:127], v[156:159], a[220:223], v[124:127]
    ds_read_b128 a[212:215], v24 offset:59392
    v_subrev_u32 v22, s52, v6
    s_waitcnt lgkmcnt(5)
    v_mfma_f32_16x16x32_bf16 v[64:67], v[160:163], a[192:195], v[64:67]
    ds_read_b64_tr_b16 v[168:169], v29 offset:36864
    v_mfma_f32_16x16x32_bf16 v[72:75], v[164:167], a[192:195], v[72:75]
    ds_read_b128 a[216:219], v24 offset:61440
    s_waitcnt lgkmcnt(6)
    v_mfma_f32_16x16x32_bf16 v[68:71], v[160:163], a[196:199], v[68:71]
    buffer_load_dwordx4 v43, s[16:19], s4 offen offset:1024 lds
    v_mfma_f32_16x16x32_bf16 v[76:79], v[164:167], a[196:199], v[76:79]
    ds_read_b64_tr_b16 v[170:171], v29 offset:37376
    s_waitcnt lgkmcnt(5)
    v_mfma_f32_16x16x32_bf16 v[80:83], v[160:163], a[200:203], v[80:83]
    ds_read_b128 a[220:223], v24 offset:63488
    v_mfma_f32_16x16x32_bf16 v[88:91], v[164:167], a[200:203], v[88:91]
    ds_read_b64_tr_b16 v[172:173], v29 offset:45056
    v_mfma_f32_16x16x32_bf16 v[84:87], v[160:163], a[204:207], v[84:87]
    ds_read_b128 a[192:195], v25 offset:49152
    s_add_u32 m0, s70, 16384
    v_mfma_f32_16x16x32_bf16 v[92:95], v[164:167], a[204:207], v[92:95]
    buffer_load_dwordx4 v8, s[8:11], s64 offen lds
    s_waitcnt lgkmcnt(6)
    v_mfma_f32_16x16x32_bf16 v[96:99], v[160:163], a[208:211], v[96:99]
    ds_read_b64_tr_b16 v[174:175], v29 offset:45568
    ds_read_b128 a[196:199], v25 offset:51200
    v_mfma_f32_16x16x32_bf16 v[104:107], v[164:167], a[208:211], v[104:107]
    ds_read_b128 a[200:203], v25 offset:53248
    s_sub_u32 s52, s61, s60
    s_add_u32 m0, s70, 20480
    v_mfma_f32_16x16x32_bf16 v[100:103], v[160:163], a[212:215], v[100:103]
    buffer_load_dwordx4 v1, s[8:11], s64 offen lds
    v_mfma_f32_16x16x32_bf16 v[108:111], v[164:167], a[212:215], v[108:111]
    ds_read_b128 a[204:207], v25 offset:55296
    s_mul_i32 s52, s52, s53
    s_waitcnt lgkmcnt(6)
    v_mfma_f32_16x16x32_bf16 v[112:115], v[160:163], a[216:219], v[112:115]
    ds_read_b128 a[208:211], v25 offset:57344
    s_add_u32 s42, s52, s60
    s_add_u32 m0, s70, 24576
    v_mfma_f32_16x16x32_bf16 v[120:123], v[164:167], a[216:219], v[120:123]
    buffer_load_dwordx4 v2, s[8:11], s64 offen lds
    v_mfma_f32_16x16x32_bf16 v[116:119], v[160:163], a[220:223], v[116:119]
    ds_read_b128 a[212:215], v25 offset:59392
    s_sub_u32 s52, s63, s62
    v_mfma_f32_16x16x32_bf16 v[124:127], v[164:167], a[220:223], v[124:127]
    ds_read_b128 a[216:219], v25 offset:61440
    s_mul_i32 s52, s52, s53
    s_waitcnt lgkmcnt(5)
    v_mfma_f32_16x16x32_bf16 v[64:67], v[168:171], a[192:195], v[64:67]
    s_add_u32 m0, s70, 28672
    s_nop 0
    buffer_load_dwordx4 v3, s[8:11], s64 offen lds
    v_mfma_f32_16x16x32_bf16 v[72:75], v[172:175], a[192:195], v[72:75]
    ds_read_b128 a[220:223], v25 offset:63488
    s_add_u32 s43, s52, s62
    v_mfma_f32_16x16x32_bf16 v[68:71], v[168:171], a[196:199], v[68:71]
    s_sub_u32 s52, s65, s64
    s_mul_i32 s52, s52, s53
    v_mfma_f32_16x16x32_bf16 v[76:79], v[172:175], a[196:199], v[76:79]
    s_add_u32 s44, s52, s64
    s_waitcnt lgkmcnt(4)
    v_mfma_f32_16x16x32_bf16 v[80:83], v[168:171], a[200:203], v[80:83]
    s_waitcnt vmcnt(8)
    s_barrier
    ds_read_b64_tr_b16 v[176:177], v29 offset:0
    v_mfma_f32_16x16x32_bf16 v[88:91], v[172:175], a[200:203], v[88:91]
    ds_read_b64_tr_b16 v[178:179], v29 offset:512
    v_mfma_f32_16x16x32_bf16 v[84:87], v[168:171], a[204:207], v[84:87]
    ds_read_b64_tr_b16 v[180:181], v29 offset:8192
    v_mfma_f32_16x16x32_bf16 v[92:95], v[172:175], a[204:207], v[92:95]
    ds_read_b64_tr_b16 v[182:183], v29 offset:8704
    s_waitcnt lgkmcnt(6)
    v_mfma_f32_16x16x32_bf16 v[96:99], v[168:171], a[208:211], v[96:99]
    ds_read_b128 a[192:195], v24 offset:16384
    v_mfma_f32_16x16x32_bf16 v[104:107], v[172:175], a[208:211], v[104:107]
    ds_read_b128 a[196:199], v24 offset:18432
    s_add_u32 m0, s7, 32768
    s_mul_i32 s4, s65, 1536
    v_mfma_f32_16x16x32_bf16 v[100:103], v[168:171], a[212:215], v[100:103]
    buffer_load_dwordx4 v9, s[12:15], s4 offen lds
    v_mfma_f32_16x16x32_bf16 v[108:111], v[172:175], a[212:215], v[108:111]
    ds_read_b128 a[200:203], v24 offset:20480
    s_waitcnt lgkmcnt(7)
    v_mfma_f32_16x16x32_bf16 v[112:115], v[168:171], a[216:219], v[112:115]
    buffer_load_dwordx4 v42, s[12:15], s4 offen offset:1024 lds
    ds_read_b128 a[204:207], v24 offset:22528
    v_mfma_f32_16x16x32_bf16 v[120:123], v[172:175], a[216:219], v[120:123]
    s_sub_u32 s52, s67, s66
    ds_read_b128 a[208:211], v24 offset:24576
    s_mul_i32 s52, s52, s53
    v_mfma_f32_16x16x32_bf16 v[116:119], v[168:171], a[220:223], v[116:119]
    s_add_u32 m0, s7, 40960
    s_nop 0
    buffer_load_dwordx4 v10, s[16:19], s4 offen lds
    v_mfma_f32_16x16x32_bf16 v[124:127], v[172:175], a[220:223], v[124:127]
    ds_read_b128 a[212:215], v24 offset:26624
    s_add_u32 s45, s52, s66
    s_waitcnt lgkmcnt(5)
    v_mfma_f32_16x16x32_bf16 v[64:67], v[176:179], a[192:195], v[64:67]
    ds_read_b64_tr_b16 v[184:185], v29 offset:4096
    v_mfma_f32_16x16x32_bf16 v[72:75], v[180:183], a[192:195], v[72:75]
    ds_read_b128 a[216:219], v24 offset:28672
    s_waitcnt lgkmcnt(6)
    v_mfma_f32_16x16x32_bf16 v[68:71], v[176:179], a[196:199], v[68:71]
    buffer_load_dwordx4 v43, s[16:19], s4 offen offset:1024 lds
    v_mfma_f32_16x16x32_bf16 v[76:79], v[180:183], a[196:199], v[76:79]
    ds_read_b64_tr_b16 v[186:187], v29 offset:4608
    s_waitcnt lgkmcnt(5)
    v_mfma_f32_16x16x32_bf16 v[80:83], v[176:179], a[200:203], v[80:83]
    ds_read_b128 a[220:223], v24 offset:30720
    v_mfma_f32_16x16x32_bf16 v[88:91], v[180:183], a[200:203], v[88:91]
    ds_read_b64_tr_b16 v[188:189], v29 offset:12288
    v_mfma_f32_16x16x32_bf16 v[84:87], v[176:179], a[204:207], v[84:87]
    ds_read_b128 a[192:195], v25 offset:16384
    s_add_u32 m0, s70, 49152
    v_mfma_f32_16x16x32_bf16 v[92:95], v[180:183], a[204:207], v[92:95]
    buffer_load_dwordx4 v8, s[8:11], s65 offen lds
    s_waitcnt lgkmcnt(6)
    v_mfma_f32_16x16x32_bf16 v[96:99], v[176:179], a[208:211], v[96:99]
    ds_read_b64_tr_b16 v[190:191], v29 offset:12800
    ds_read_b128 a[196:199], v25 offset:18432
    v_mfma_f32_16x16x32_bf16 v[104:107], v[180:183], a[208:211], v[104:107]
    ds_read_b128 a[200:203], v25 offset:20480
    s_sub_u32 s52, s69, s68
    s_add_u32 m0, s70, 53248
    v_mfma_f32_16x16x32_bf16 v[100:103], v[176:179], a[212:215], v[100:103]
    buffer_load_dwordx4 v1, s[8:11], s65 offen lds
    v_mfma_f32_16x16x32_bf16 v[108:111], v[180:183], a[212:215], v[108:111]
    ds_read_b128 a[204:207], v25 offset:22528
    s_mul_i32 s52, s52, s53
    s_waitcnt lgkmcnt(6)
    v_mfma_f32_16x16x32_bf16 v[112:115], v[176:179], a[216:219], v[112:115]
    ds_read_b128 a[208:211], v25 offset:24576
    s_add_u32 s46, s52, s68
    s_add_u32 m0, s70, 57344
    v_mfma_f32_16x16x32_bf16 v[120:123], v[180:183], a[216:219], v[120:123]
    buffer_load_dwordx4 v2, s[8:11], s65 offen lds
    v_mfma_f32_16x16x32_bf16 v[116:119], v[176:179], a[220:223], v[116:119]
    ds_read_b128 a[212:215], v25 offset:26624
    v_mfma_f32_16x16x32_bf16 v[124:127], v[180:183], a[220:223], v[124:127]
    ds_read_b128 a[216:219], v25 offset:28672
    s_add_u32 m0, s70, 61440
    s_waitcnt lgkmcnt(5)
    v_mfma_f32_16x16x32_bf16 v[64:67], v[184:187], a[192:195], v[64:67]
    buffer_load_dwordx4 v3, s[8:11], s65 offen lds
    v_mfma_f32_16x16x32_bf16 v[72:75], v[188:191], a[192:195], v[72:75]
    ds_read_b128 a[220:223], v25 offset:30720
    v_mfma_f32_16x16x32_bf16 v[68:71], v[184:187], a[196:199], v[68:71]
    v_mfma_f32_16x16x32_bf16 v[76:79], v[188:191], a[196:199], v[76:79]
    s_waitcnt lgkmcnt(4)
    v_mfma_f32_16x16x32_bf16 v[80:83], v[184:187], a[200:203], v[80:83]
    s_waitcnt vmcnt(8)
    s_barrier
    ds_read_b64_tr_b16 v[192:193], v28 offset:0
    v_mfma_f32_16x16x32_bf16 v[88:91], v[188:191], a[200:203], v[88:91]
    ds_read_b64_tr_b16 v[194:195], v28 offset:512
    v_mfma_f32_16x16x32_bf16 v[84:87], v[184:187], a[204:207], v[84:87]
    ds_read_b64_tr_b16 v[196:197], v28 offset:8192
    v_mfma_f32_16x16x32_bf16 v[92:95], v[188:191], a[204:207], v[92:95]
    ds_read_b64_tr_b16 v[198:199], v28 offset:8704
    s_waitcnt lgkmcnt(6)
    v_mfma_f32_16x16x32_bf16 v[96:99], v[184:187], a[208:211], v[96:99]
    ds_read_b128 a[192:195], v20 offset:16384
    v_mfma_f32_16x16x32_bf16 v[104:107], v[188:191], a[208:211], v[104:107]
    ds_read_b128 a[196:199], v20 offset:18432
    s_add_u32 m0, s7, 98304
    s_mul_i32 s4, s66, 1536
    v_mfma_f32_16x16x32_bf16 v[100:103], v[184:187], a[212:215], v[100:103]
    buffer_load_dwordx4 v9, s[12:15], s4 offen lds
    v_mfma_f32_16x16x32_bf16 v[108:111], v[188:191], a[212:215], v[108:111]
    ds_read_b128 a[200:203], v20 offset:20480
    s_waitcnt lgkmcnt(7)
    v_mfma_f32_16x16x32_bf16 v[112:115], v[184:187], a[216:219], v[112:115]
    buffer_load_dwordx4 v42, s[12:15], s4 offen offset:1024 lds
    ds_read_b128 a[204:207], v20 offset:22528
    v_mfma_f32_16x16x32_bf16 v[120:123], v[188:191], a[216:219], v[120:123]
    s_add_u32 m0, s7, 106496
    s_nop 0
    buffer_load_dwordx4 v10, s[16:19], s4 offen lds
    v_mfma_f32_16x16x32_bf16 v[116:119], v[184:187], a[220:223], v[116:119]
    ds_read_b128 a[208:211], v20 offset:24576
    v_mfma_f32_16x16x32_bf16 v[124:127], v[188:191], a[220:223], v[124:127]
    buffer_load_dwordx4 v43, s[16:19], s4 offen offset:1024 lds
    s_waitcnt lgkmcnt(4)
    v_mfma_f32_16x16x32_bf16 v[64:67], v[192:195], a[192:195], v[64:67]
    ds_read_b128 a[212:215], v20 offset:26624
    s_add_u32 m0, s70, 114688
    v_mfma_f32_16x16x32_bf16 v[72:75], v[196:199], a[192:195], v[72:75]
    buffer_load_dwordx4 v8, s[8:11], s66 offen lds
    s_waitcnt lgkmcnt(4)
    v_mfma_f32_16x16x32_bf16 v[68:71], v[192:195], a[196:199], v[68:71]
    ds_read_b64_tr_b16 v[200:201], v28 offset:4096
    v_mfma_f32_16x16x32_bf16 v[76:79], v[196:199], a[196:199], v[76:79]
    ds_read_b128 a[216:219], v20 offset:28672
    s_add_u32 m0, s70, 118784
    s_waitcnt lgkmcnt(4)
    v_mfma_f32_16x16x32_bf16 v[80:83], v[192:195], a[200:203], v[80:83]
    buffer_load_dwordx4 v1, s[8:11], s66 offen lds
    ds_read_b64_tr_b16 v[202:203], v28 offset:4608
    ds_read_b128 a[220:223], v20 offset:30720
    v_mfma_f32_16x16x32_bf16 v[88:91], v[196:199], a[200:203], v[88:91]
    s_add_u32 m0, s70, 122880
    s_nop 0
    buffer_load_dwordx4 v2, s[8:11], s66 offen lds
    v_mfma_f32_16x16x32_bf16 v[84:87], v[192:195], a[204:207], v[84:87]
    ds_read_b64_tr_b16 v[204:205], v28 offset:12288
    v_mfma_f32_16x16x32_bf16 v[92:95], v[196:199], a[204:207], v[92:95]
    ds_read_b128 a[192:195], v21 offset:16384
    s_add_u32 m0, s70, 126976
    s_waitcnt lgkmcnt(6)
    v_mfma_f32_16x16x32_bf16 v[96:99], v[192:195], a[208:211], v[96:99]
    ds_read_b64_tr_b16 v[206:207], v28 offset:12800
    ds_read_b128 a[196:199], v21 offset:18432
    v_mfma_f32_16x16x32_bf16 v[104:107], v[196:199], a[208:211], v[104:107]
    buffer_load_dwordx4 v3, s[8:11], s66 offen lds
    s_add_u32 m0, s71, 131072
    s_mul_i32 s6, s72, 40
    v_mfma_f32_16x16x32_bf16 v[100:103], v[192:195], a[212:215], v[100:103]
    buffer_load_dwordx4 v11, s[20:23], s6 offen lds
    v_mfma_f32_16x16x32_bf16 v[108:111], v[196:199], a[212:215], v[108:111]
    ds_read_b128 a[200:203], v21 offset:20480
    s_waitcnt lgkmcnt(5)
    v_mfma_f32_16x16x32_bf16 v[112:115], v[192:195], a[216:219], v[112:115]
    buffer_load_dwordx4 v44, s[20:23], s6 offen offset:1024 lds
    ds_read_b128 a[204:207], v21 offset:22528
    v_mfma_f32_16x16x32_bf16 v[120:123], v[196:199], a[216:219], v[120:123]
    buffer_load_dwordx4 v45, s[20:23], s6 offen offset:2048 lds
    v_mfma_f32_16x16x32_bf16 v[116:119], v[192:195], a[220:223], v[116:119]
    ds_read_b128 a[208:211], v21 offset:24576
    v_mfma_f32_16x16x32_bf16 v[124:127], v[196:199], a[220:223], v[124:127]
    ds_read_b128 a[212:215], v21 offset:26624
    s_waitcnt lgkmcnt(4)
    v_mfma_f32_16x16x32_bf16 v[64:67], v[200:203], a[192:195], v[64:67]
    buffer_load_dwordx4 v46, s[20:23], s6 offen offset:3072 lds
    s_add_u32 m0, s71, 147456
    s_mul_i32 s6, s73, 40
    v_mfma_f32_16x16x32_bf16 v[72:75], v[204:207], a[192:195], v[72:75]
    buffer_load_dwordx4 v11, s[20:23], s6 offen lds
    v_mfma_f32_16x16x32_bf16 v[68:71], v[200:203], a[196:199], v[68:71]
    ds_read_b128 a[216:219], v21 offset:28672
    v_mfma_f32_16x16x32_bf16 v[76:79], v[204:207], a[196:199], v[76:79]
    buffer_load_dwordx4 v44, s[20:23], s6 offen offset:1024 lds
    s_waitcnt lgkmcnt(3)
    v_mfma_f32_16x16x32_bf16 v[80:83], v[200:203], a[200:203], v[80:83]
    ds_read_b128 a[220:223], v21 offset:30720
    v_mfma_f32_16x16x32_bf16 v[88:91], v[204:207], a[200:203], v[88:91]
    buffer_load_dwordx4 v45, s[20:23], s6 offen offset:2048 lds
    s_waitcnt vmcnt(15)
    s_barrier
    v_mfma_f32_16x16x32_bf16 v[84:87], v[200:203], a[204:207], v[84:87]
    ds_read_b64_tr_b16 v[208:209], v28 offset:32768
    v_mfma_f32_16x16x32_bf16 v[92:95], v[204:207], a[204:207], v[92:95]
    ds_read_b64_tr_b16 v[210:211], v28 offset:33280
    s_waitcnt lgkmcnt(4)
    v_mfma_f32_16x16x32_bf16 v[96:99], v[200:203], a[208:211], v[96:99]
    ds_read_b64_tr_b16 v[212:213], v28 offset:40960
    ds_read_b64_tr_b16 v[214:215], v28 offset:41472
    ds_read_b128 a[192:195], v20 offset:49152
    v_mfma_f32_16x16x32_bf16 v[104:107], v[204:207], a[208:211], v[104:107]
    ds_read_b128 a[196:199], v20 offset:51200
    v_mfma_f32_16x16x32_bf16 v[100:103], v[200:203], a[212:215], v[100:103]
    buffer_load_dwordx4 v46, s[20:23], s6 offen offset:3072 lds
    s_add_u32 m0, s7, 65536
    s_mul_i32 s4, s67, 1536
    v_mfma_f32_16x16x32_bf16 v[108:111], v[204:207], a[212:215], v[108:111]
    buffer_load_dwordx4 v9, s[12:15], s4 offen lds
    s_waitcnt lgkmcnt(6)
    v_mfma_f32_16x16x32_bf16 v[112:115], v[200:203], a[216:219], v[112:115]
    ds_read_b128 a[200:203], v20 offset:53248
    buffer_load_dwordx4 v42, s[12:15], s4 offen offset:1024 lds
    ds_read_b128 a[204:207], v20 offset:55296
    v_mfma_f32_16x16x32_bf16 v[120:123], v[204:207], a[216:219], v[120:123]
    s_load_dword s48, s[32:33], 0
    ds_read_b128 a[208:211], v20 offset:57344
    s_add_u32 m0, s7, 73728
    v_mfma_f32_16x16x32_bf16 v[116:119], v[200:203], a[220:223], v[116:119]
    buffer_load_dwordx4 v10, s[16:19], s4 offen lds
    v_mfma_f32_16x16x32_bf16 v[124:127], v[204:207], a[220:223], v[124:127]
    ds_read_b128 a[212:215], v20 offset:59392
    s_waitcnt lgkmcnt(5)
    v_mfma_f32_16x16x32_bf16 v[64:67], v[208:211], a[192:195], v[64:67]
    ds_read_b64_tr_b16 v[216:217], v28 offset:36864
    v_mfma_f32_16x16x32_bf16 v[72:75], v[212:215], a[192:195], v[72:75]
    ds_read_b128 a[216:219], v20 offset:61440
    s_waitcnt lgkmcnt(6)
    v_mfma_f32_16x16x32_bf16 v[68:71], v[208:211], a[196:199], v[68:71]
    buffer_load_dwordx4 v43, s[16:19], s4 offen offset:1024 lds
    v_mfma_f32_16x16x32_bf16 v[76:79], v[212:215], a[196:199], v[76:79]
    ds_read_b64_tr_b16 v[218:219], v28 offset:37376
    s_waitcnt lgkmcnt(5)
    v_mfma_f32_16x16x32_bf16 v[80:83], v[208:211], a[200:203], v[80:83]
    ds_read_b128 a[220:223], v20 offset:63488
    v_mfma_f32_16x16x32_bf16 v[88:91], v[212:215], a[200:203], v[88:91]
    ds_read_b64_tr_b16 v[220:221], v28 offset:45056
    v_mfma_f32_16x16x32_bf16 v[84:87], v[208:211], a[204:207], v[84:87]
    ds_read_b128 a[192:195], v21 offset:49152
    s_add_u32 m0, s70, 81920
    v_mfma_f32_16x16x32_bf16 v[92:95], v[212:215], a[204:207], v[92:95]
    buffer_load_dwordx4 v8, s[8:11], s67 offen lds
    s_waitcnt lgkmcnt(6)
    v_mfma_f32_16x16x32_bf16 v[96:99], v[208:211], a[208:211], v[96:99]
    ds_read_b64_tr_b16 v[222:223], v28 offset:45568
    ds_read_b128 a[196:199], v21 offset:51200
    v_mfma_f32_16x16x32_bf16 v[104:107], v[212:215], a[208:211], v[104:107]
    ds_read_b128 a[200:203], v21 offset:53248
    s_add_u32 m0, s70, 86016
    v_mfma_f32_16x16x32_bf16 v[100:103], v[208:211], a[212:215], v[100:103]
    buffer_load_dwordx4 v1, s[8:11], s67 offen lds
    v_mfma_f32_16x16x32_bf16 v[108:111], v[212:215], a[212:215], v[108:111]
    ds_read_b128 a[204:207], v21 offset:55296
    s_waitcnt lgkmcnt(6)
    v_mfma_f32_16x16x32_bf16 v[112:115], v[208:211], a[216:219], v[112:115]
    ds_read_b128 a[208:211], v21 offset:57344
    s_add_u32 m0, s70, 90112
    v_mfma_f32_16x16x32_bf16 v[120:123], v[212:215], a[216:219], v[120:123]
    buffer_load_dwordx4 v2, s[8:11], s67 offen lds
    v_mfma_f32_16x16x32_bf16 v[116:119], v[208:211], a[220:223], v[116:119]
    ds_read_b128 a[212:215], v21 offset:59392
    v_mfma_f32_16x16x32_bf16 v[124:127], v[212:215], a[220:223], v[124:127]
    ds_read_b128 a[216:219], v21 offset:61440
    s_add_u32 m0, s70, 94208
    s_waitcnt lgkmcnt(5)
    v_mfma_f32_16x16x32_bf16 v[64:67], v[216:219], a[192:195], v[64:67]
    buffer_load_dwordx4 v3, s[8:11], s67 offen lds
    v_mfma_f32_16x16x32_bf16 v[72:75], v[220:223], a[192:195], v[72:75]
    ds_read_b128 a[220:223], v21 offset:63488
    v_mfma_f32_16x16x32_bf16 v[68:71], v[216:219], a[196:199], v[68:71]
    v_mfma_f32_16x16x32_bf16 v[76:79], v[220:223], a[196:199], v[76:79]
    s_waitcnt lgkmcnt(4)
    v_mfma_f32_16x16x32_bf16 v[80:83], v[216:219], a[200:203], v[80:83]
    s_waitcnt lgkmcnt(0)
    s_waitcnt vmcnt(16)
    s_barrier
    v_mfma_f32_16x16x32_bf16 v[88:91], v[220:223], a[200:203], v[88:91]
    ds_read_b64_tr_b16 v[224:225], v29 offset:32768
    v_mfma_f32_16x16x32_bf16 v[84:87], v[216:219], a[204:207], v[84:87]
    ds_read_b64_tr_b16 v[226:227], v29 offset:33280
    v_mfma_f32_16x16x32_bf16 v[92:95], v[220:223], a[204:207], v[92:95]
    ds_read_b64_tr_b16 v[228:229], v29 offset:40960
    v_mfma_f32_16x16x32_bf16 v[96:99], v[216:219], a[208:211], v[96:99]
    ds_read_b64_tr_b16 v[230:231], v29 offset:41472
    ds_read_b128 a[192:195], v24 offset:49152
    v_mfma_f32_16x16x32_bf16 v[104:107], v[220:223], a[208:211], v[104:107]
    ds_read_b128 a[196:199], v24 offset:51200
    s_add_u32 m0, s7, 0
    s_mul_i32 s4, s68, 1536
    v_mfma_f32_16x16x32_bf16 v[100:103], v[216:219], a[212:215], v[100:103]
    ds_read_b128 a[200:203], v24 offset:53248
    v_mfma_f32_16x16x32_bf16 v[108:111], v[220:223], a[212:215], v[108:111]
    buffer_load_dwordx4 v9, s[12:15], s4 offen lds
    s_cmp_eq_u32 s48, 0
    s_cbranch_scc1 L_A_tag
L_A_tag_back:
    v_mfma_f32_16x16x32_bf16 v[112:115], v[216:219], a[216:219], v[112:115]
    ds_read_b128 a[204:207], v24 offset:55296
    v_mov_b32 v40, s48
    v_mfma_f32_16x16x32_bf16 v[120:123], v[220:223], a[216:219], v[120:123]
    buffer_load_dwordx4 v42, s[12:15], s4 offen offset:1024 lds
    s_mov_b32 s49, s48
    v_mfma_f32_16x16x32_bf16 v[116:119], v[216:219], a[220:223], v[116:119]
    ds_read_b128 a[208:211], v24 offset:57344
    s_sub_u32 s100, s48, s100
    s_sub_u32 s101, s48, s101
    v_mfma_f32_16x16x32_bf16 v[124:127], v[220:223], a[220:223], v[124:127]
    s_add_u32 m0, s7, 8192
    s_waitcnt lgkmcnt(4)
    v_mfma_f32_16x16x32_bf16 v[64:67], v[224:227], a[192:195], v[64:67]
    buffer_load_dwordx4 v10, s[16:19], s4 offen lds
    ds_read_b128 a[212:215], v24 offset:59392
    v_mfma_f32_16x16x32_bf16 v[72:75], v[228:231], a[192:195], v[72:75]
    s_sub_u32 s47, s48, s47
    ds_read_b64_tr_b16 v[232:233], v29 offset:36864
    s_waitcnt lgkmcnt(5)
    v_mfma_f32_16x16x32_bf16 v[68:71], v[224:227], a[196:199], v[68:71]
    ds_read_b128 a[216:219], v24 offset:61440
    v_mfma_f32_16x16x32_bf16 v[76:79], v[228:231], a[196:199], v[76:79]
    buffer_load_dwordx4 v43, s[16:19], s4 offen offset:1024 lds
    s_waitcnt lgkmcnt(4)
    v_mfma_f32_16x16x32_bf16 v[80:83], v[224:227], a[200:203], v[80:83]
L_A_w1_0:
    s_cbranch_execz L_A_w1_1
    ds_read_b64_tr_b16 v[234:235], v29 offset:37376
    ds_read_b128 a[220:223], v24 offset:63488
    v_mfma_f32_16x16x32_bf16 v[88:91], v[228:231], a[200:203], v[88:91]
    ds_read_b64_tr_b16 v[236:237], v29 offset:45056
    v_mfma_f32_16x16x32_bf16 v[84:87], v[224:227], a[204:207], v[84:87]
    ds_read_b128 a[192:195], v25 offset:49152
    s_add_u32 m0, s70, 16384
L_A_w1_1:
    s_cbranch_execz L_hopped
    v_mfma_f32_16x16x32_bf16 v[92:95], v[228:231], a[204:207], v[92:95]
    buffer_load_dwordx4 v8, s[8:11], s68 offen lds
    s_waitcnt lgkmcnt(6)
    v_mfma_f32_16x16x32_bf16 v[96:99], v[224:227], a[208:211], v[96:99]
    ds_read_b64_tr_b16 v[238:239], v29 offset:45568
    ds_read_b128 a[196:199], v25 offset:51200
    v_mfma_f32_16x16x32_bf16 v[104:107], v[228:231], a[208:211], v[104:107]
    ds_read_b128 a[200:203], v25 offset:53248
    s_add_u32 m0, s70, 20480
    v_mfma_f32_16x16x32_bf16 v[100:103], v[224:227], a[212:215], v[100:103]
    buffer_load_dwordx4 v1, s[8:11], s68 offen lds
    v_mfma_f32_16x16x32_bf16 v[108:111], v[228:231], a[212:215], v[108:111]
    ds_read_b128 a[204:207], v25 offset:55296
    s_waitcnt lgkmcnt(6)
    v_mfma_f32_16x16x32_bf16 v[112:115], v[224:227], a[216:219], v[112:115]
    ds_read_b128 a[208:211], v25 offset:57344
    s_add_u32 m0, s70, 24576
    v_mfma_f32_16x16x32_bf16 v[120:123], v[228:231], a[216:219], v[120:123]
    buffer_load_dwordx4 v2, s[8:11], s68 offen lds
    v_mfma_f32_16x16x32_bf16 v[116:119], v[224:227], a[220:223], v[116:119]
    ds_read_b128 a[212:215], v25 offset:59392
    v_mfma_f32_16x16x32_bf16 v[124:127], v[228:231], a[220:223], v[124:127]
    ds_read_b128 a[216:219], v25 offset:61440
    s_add_u32 m0, s70, 28672
    s_waitcnt lgkmcnt(5)
    v_mfma_f32_16x16x32_bf16 v[64:67], v[232:235], a[192:195], v[64:67]
    buffer_load_dwordx4 v3, s[8:11], s68 offen lds
    v_mfma_f32_16x16x32_bf16 v[72:75], v[236:239], a[192:195], v[72:75]
    ds_read_b128 a[220:223], v25 offset:63488
    v_mfma_f32_16x16x32_bf16 v[68:71], v[232:235], a[196:199], v[68:71]
    v_mfma_f32_16x16x32_bf16 v[76:79], v[236:239], a[196:199], v[76:79]
    s_waitcnt lgkmcnt(4)
    v_mfma_f32_16x16x32_bf16 v[80:83], v[232:235], a[200:203], v[80:83]
    s_waitcnt vmcnt(8)
    s_barrier
    ds_read_b64_tr_b16 v[240:241], v29 offset:0
    v_mfma_f32_16x16x32_bf16 v[88:91], v[236:239], a[200:203], v[88:91]
    ds_read_b64_tr_b16 v[242:243], v29 offset:512
    v_mfma_f32_16x16x32_bf16 v[84:87], v[232:235], a[204:207], v[84:87]
    ds_read_b64_tr_b16 v[244:245], v29 offset:8192
    v_mfma_f32_16x16x32_bf16 v[92:95], v[236:239], a[204:207], v[92:95]
    ds_read_b64_tr_b16 v[246:247], v29 offset:8704
    s_waitcnt lgkmcnt(6)
    v_mfma_f32_16x16x32_bf16 v[96:99], v[232:235], a[208:211], v[96:99]
    ds_read_b128 a[192:195], v24 offset:16384
    v_mfma_f32_16x16x32_bf16 v[104:107], v[236:239], a[208:211], v[104:107]
    ds_read_b128 a[196:199], v24 offset:18432
    s_add_u32 m0, s7, 32768
    s_mul_i32 s4, s69, 1536
    v_mfma_f32_16x16x32_bf16 v[100:103], v[232:235], a[212:215], v[100:103]
    buffer_load_dwordx4 v9, s[12:15], s4 offen lds
    v_mfma_f32_16x16x32_bf16 v[108:111], v[236:239], a[212:215], v[108:111]
    ds_read_b128 a[200:203], v24 offset:20480
    s_waitcnt lgkmcnt(7)
    v_mfma_f32_16x16x32_bf16 v[112:115], v[232:235], a[216:219], v[112:115]
    buffer_load_dwordx4 v42, s[12:15], s4 offen offset:1024 lds
    ds_read_b128 a[204:207], v24 offset:22528
    v_mfma_f32_16x16x32_bf16 v[120:123], v[236:239], a[216:219], v[120:123]
    ds_read_b64_tr_b16 a[0:1], v30 offset:32768
    v_mfma_f32_16x16x32_bf16 v[116:119], v[232:235], a[220:223], v[116:119]
    ds_read_b64_tr_b16 a[2:3], v30 offset:33792
    v_mfma_f32_16x16x32_bf16 v[124:127], v[236:239], a[220:223], v[124:127]
    ds_read_b128 a[208:211], v24 offset:24576
    s_waitcnt lgkmcnt(6)
    v_mfma_f32_16x16x32_bf16 v[64:67], v[240:243], a[192:195], v[64:67]
    ds_read_b64_tr_b16 a[4:5], v31 offset:32768
    ds_read_b64_tr_b16 a[6:7], v31 offset:33792
    s_add_u32 m0, s7, 40960
    s_nop 0
    buffer_load_dwordx4 v10, s[16:19], s4 offen lds
    ds_read_b128 a[212:215], v24 offset:26624
    v_mfma_f32_16x16x32_bf16 v[72:75], v[244:247], a[192:195], v[72:75]
    ds_read_b64_tr_b16 a[8:9], v32 offset:32768
    s_waitcnt lgkmcnt(9)
    v_mfma_f32_16x16x32_bf16 v[68:71], v[240:243], a[196:199], v[68:71]
    ds_read_b64_tr_b16 a[10:11], v32 offset:33792
    v_mfma_f32_16x16x32_bf16 v[76:79], v[244:247], a[196:199], v[76:79]
    ds_read_b64_tr_b16 v[248:249], v29 offset:4096
    s_waitcnt lgkmcnt(9)
    v_mfma_f32_16x16x32_bf16 v[80:83], v[240:243], a[200:203], v[80:83]
    ds_read_b128 a[216:219], v24 offset:28672
    ds_read_b64_tr_b16 a[12:13], v33 offset:32768
    ds_read_b64_tr_b16 a[14:15], v33 offset:33792
    buffer_load_dwordx4 v43, s[16:19], s4 offen offset:1024 lds
    ds_read_b64_tr_b16 v[250:251], v29 offset:4608
    ds_read_b128 a[220:223], v24 offset:30720
    v_mfma_f32_16x16x32_bf16 v[88:91], v[244:247], a[200:203], v[88:91]
    ds_read_b64_tr_b16 v[252:253], v29 offset:12288
    v_mfma_f32_16x16x32_bf16 v[84:87], v[240:243], a[204:207], v[84:87]
    ds_read_b128 a[192:195], v25 offset:16384
    v_mfma_f32_16x16x32_bf16 v[92:95], v[244:247], a[204:207], v[92:95]
    ds_read_b64_tr_b16 a[16:17], v30 offset:49152
    s_waitcnt lgkmcnt(11)
    v_mfma_f32_16x16x32_bf16 v[96:99], v[240:243], a[208:211], v[96:99]
    ds_read_b64_tr_b16 a[18:19], v30 offset:50176
    s_add_u32 m0, s70, 49152
    ds_read_b64_tr_b16 v[254:255], v29 offset:12800
    ds_read_b128 a[196:199], v25 offset:18432
    v_mfma_f32_16x16x32_bf16 v[104:107], v[244:247], a[208:211], v[104:107]
    ds_read_b64_tr_b16 a[20:21], v31 offset:49152
    v_mfma_f32_16x16x32_bf16 v[100:103], v[240:243], a[212:215], v[100:103]
    ds_read_b64_tr_b16 a[22:23], v31 offset:50176
    v_mfma_f32_16x16x32_bf16 v[108:111], v[244:247], a[212:215], v[108:111]
    buffer_load_dwordx4 v8, s[8:11], s69 offen lds
    s_waitcnt lgkmcnt(8)
    v_mfma_f32_16x16x32_bf16 v[112:115], v[240:243], a[216:219], v[112:115]
    ds_read_b128 a[200:203], v25 offset:20480
    ds_read_b64_tr_b16 a[24:25], v32 offset:49152
    ds_read_b64_tr_b16 a[26:27], v32 offset:50176
    s_add_u32 m0, s70, 53248
    s_nop 0
    buffer_load_dwordx4 v1, s[8:11], s69 offen lds
    ds_read_b128 a[204:207], v25 offset:22528
    v_mfma_f32_16x16x32_bf16 v[120:123], v[244:247], a[216:219], v[120:123]
    ds_read_b64_tr_b16 a[28:29], v33 offset:49152
    v_mfma_f32_16x16x32_bf16 v[116:119], v[240:243], a[220:223], v[116:119]
    ds_read_b64_tr_b16 a[30:31], v33 offset:50176
    v_mfma_f32_16x16x32_bf16 v[124:127], v[244:247], a[220:223], v[124:127]
    ds_read_b128 a[208:211], v25 offset:24576
    s_add_u32 m0, s70, 57344
    s_waitcnt lgkmcnt(9)
    v_mfma_f32_16x16x32_bf16 v[64:67], v[248:251], a[192:195], v[64:67]
    buffer_load_dwordx4 v2, s[8:11], s69 offen lds
    ds_read_b128 a[212:215], v25 offset:26624
    v_mfma_f32_16x16x32_bf16 v[72:75], v[252:255], a[192:195], v[72:75]
    ds_read_b128 a[216:219], v25 offset:28672
    s_add_u32 m0, s70, 61440
    v_mfma_f32_16x16x32_bf16 v[68:71], v[248:251], a[196:199], v[68:71]
    buffer_load_dwordx4 v3, s[8:11], s69 offen lds
    v_mfma_f32_16x16x32_bf16 v[76:79], v[252:255], a[196:199], v[76:79]
    ds_read_b128 a[220:223], v25 offset:30720
    s_waitcnt lgkmcnt(6)
    v_mfma_f32_16x16x32_bf16 v[80:83], v[248:251], a[200:203], v[80:83]
    s_waitcnt vmcnt(8)
    s_barrier
    ds_read_b64_tr_b16 a[224:225], v28 offset:0
    v_mfma_f32_16x16x32_bf16 v[88:91], v[252:255], a[200:203], v[88:91]
    ds_read_b64_tr_b16 a[226:227], v28 offset:512
    v_mfma_f32_16x16x32_bf16 v[84:87], v[248:251], a[204:207], v[84:87]
    ds_read_b64_tr_b16 a[228:229], v28 offset:8192
    v_mfma_f32_16x16x32_bf16 v[92:95], v[252:255], a[204:207], v[92:95]
    ds_read_b64_tr_b16 a[230:231], v28 offset:8704
    s_waitcnt lgkmcnt(6)
    v_mfma_f32_16x16x32_bf16 v[96:99], v[248:251], a[208:211], v[96:99]
    ds_read_b128 a[192:195], v20 offset:16384
    v_mfma_f32_16x16x32_bf16 v[104:107], v[252:255], a[208:211], v[104:107]
    ds_read_b128 a[196:199], v20 offset:18432
    s_add_u32 m0, s70, 98304
    v_mfma_f32_16x16x32_bf16 v[100:103], v[248:251], a[212:215], v[100:103]
    buffer_load_dwordx4 v4, s[8:11], s60 offen lds
    v_mfma_f32_16x16x32_bf16 v[108:111], v[252:255], a[212:215], v[108:111]
    ds_read_b128 a[200:203], v20 offset:20480
    s_waitcnt lgkmcnt(7)
    v_mfma_f32_16x16x32_bf16 v[112:115], v[248:251], a[216:219], v[112:115]
    ds_read_b128 a[204:207], v20 offset:22528
    s_add_u32 m0, s70, 102400
    v_mfma_f32_16x16x32_bf16 v[120:123], v[252:255], a[216:219], v[120:123]
    buffer_load_dwordx4 v4, s[8:11], s61 offen lds
    v_mfma_f32_16x16x32_bf16 v[116:119], v[248:251], a[220:223], v[116:119]
    ds_read_b128 a[208:211], v20 offset:24576
    v_mfma_f32_16x16x32_bf16 v[124:127], v[252:255], a[220:223], v[124:127]
    ds_read_b128 a[212:215], v20 offset:26624
    s_add_u32 m0, s70, 106496
    s_waitcnt lgkmcnt(5)
    v_mfma_f32_16x16x32_bf16 v[64:67], a[224:227], a[192:195], v[64:67]
    buffer_load_dwordx4 v4, s[8:11], s62 offen lds
    v_mfma_f32_16x16x32_bf16 v[72:75], a[228:231], a[192:195], v[72:75]
    ds_read_b64_tr_b16 a[232:233], v28 offset:4096
    s_waitcnt lgkmcnt(5)
    v_mfma_f32_16x16x32_bf16 v[68:71], a[224:227], a[196:199], v[68:71]
    ds_read_b128 a[216:219], v20 offset:28672
    v_mfma_f32_16x16x32_bf16 v[76:79], a[228:231], a[196:199], v[76:79]
    ds_read_b64_tr_b16 a[234:235], v28 offset:4608
    s_waitcnt lgkmcnt(5)
    v_mfma_f32_16x16x32_bf16 v[80:83], a[224:227], a[200:203], v[80:83]
    ds_read_b128 a[220:223], v20 offset:30720
    s_add_u32 m0, s70, 110592
    v_mfma_f32_16x16x32_bf16 v[88:91], a[228:231], a[200:203], v[88:91]
    buffer_load_dwordx4 v4, s[8:11], s63 offen lds
    v_mfma_f32_16x16x32_bf16 v[84:87], a[224:227], a[204:207], v[84:87]
    ds_read_b64_tr_b16 a[236:237], v28 offset:12288
    v_mfma_f32_16x16x32_bf16 v[92:95], a[228:231], a[204:207], v[92:95]
    ds_read_b128 a[192:195], v21 offset:16384
    s_waitcnt lgkmcnt(6)
    v_mfma_f32_16x16x32_bf16 v[96:99], a[224:227], a[208:211], v[96:99]
    ds_read_b64_tr_b16 a[238:239], v28 offset:12800
    ds_read_b128 a[196:199], v21 offset:18432
    v_mfma_f32_16x16x32_bf16 v[104:107], a[228:231], a[208:211], v[104:107]
    s_add_u32 m0, s70, 114688
    s_nop 0
    buffer_load_dwordx4 v4, s[8:11], s64 offen lds
    v_mfma_f32_16x16x32_bf16 v[100:103], a[224:227], a[212:215], v[100:103]
    ds_read_b128 a[200:203], v21 offset:20480
    v_mfma_f32_16x16x32_bf16 v[108:111], a[228:231], a[212:215], v[108:111]
    ds_read_b128 a[204:207], v21 offset:22528
    s_add_u32 m0, s70, 118784
    s_waitcnt lgkmcnt(6)
    v_mfma_f32_16x16x32_bf16 v[112:115], a[224:227], a[216:219], v[112:115]
    buffer_load_dwordx4 v4, s[8:11], s65 offen lds
    v_mfma_f32_16x16x32_bf16 v[120:123], a[228:231], a[216:219], v[120:123]
    ds_read_b128 a[208:211], v21 offset:24576
    v_mfma_f32_16x16x32_bf16 v[116:119], a[224:227], a[220:223], v[116:119]
    ds_read_b128 a[212:215], v21 offset:26624
    s_add_u32 m0, s70, 122880
    v_mfma_f32_16x16x32_bf16 v[124:127], a[228:231], a[220:223], v[124:127]
    buffer_load_dwordx4 v4, s[8:11], s66 offen lds
    s_waitcnt lgkmcnt(4)
    v_mfma_f32_16x16x32_bf16 v[64:67], a[232:235], a[192:195], v[64:67]
    ds_read_b128 a[216:219], v21 offset:28672
    v_mfma_f32_16x16x32_bf16 v[72:75], a[236:239], a[192:195], v[72:75]
    ds_read_b128 a[220:223], v21 offset:30720
    s_add_u32 m0, s70, 126976
    v_mfma_f32_16x16x32_bf16 v[68:71], a[232:235], a[196:199], v[68:71]
    buffer_load_dwordx4 v4, s[8:11], s67 offen lds
    v_mfma_f32_16x16x32_bf16 v[76:79], a[236:239], a[196:199], v[76:79]
    s_waitcnt lgkmcnt(4)
    v_mfma_f32_16x16x32_bf16 v[80:83], a[232:235], a[200:203], v[80:83]
    s_waitcnt vmcnt(8)
    s_barrier
    ds_read_b64_tr_b16 a[240:241], v28 offset:32768
    v_mfma_f32_16x16x32_bf16 v[88:91], a[236:239], a[200:203], v[88:91]
    ds_read_b64_tr_b16 a[242:243], v28 offset:33280
    v_mfma_f32_16x16x32_bf16 v[84:87], a[232:235], a[204:207], v[84:87]
    ds_read_b64_tr_b16 a[244:245], v28 offset:40960
    v_mfma_f32_16x16x32_bf16 v[92:95], a[236:239], a[204:207], v[92:95]
    ds_read_b64_tr_b16 a[246:247], v28 offset:41472
    s_waitcnt lgkmcnt(6)
    v_mfma_f32_16x16x32_bf16 v[96:99], a[232:235], a[208:211], v[96:99]
    ds_read_b128 a[192:195], v20 offset:49152
    v_mfma_f32_16x16x32_bf16 v[104:107], a[236:239], a[208:211], v[104:107]
    ds_read_b128 a[196:199], v20 offset:51200
    s_add_u32 m0, s70, 65536
    v_mfma_f32_16x16x32_bf16 v[100:103], a[232:235], a[212:215], v[100:103]
    ds_read_b64_tr_b16 a[248:249], v28 offset:36864
    v_mfma_f32_16x16x32_bf16 v[108:111], a[236:239], a[212:215], v[108:111]
    ds_read_b64_tr_b16 a[250:251], v28 offset:37376
    s_waitcnt lgkmcnt(8)
    v_mfma_f32_16x16x32_bf16 v[112:115], a[232:235], a[216:219], v[112:115]
    ds_read_b64_tr_b16 a[252:253], v28 offset:45056
    ds_read_b64_tr_b16 a[254:255], v28 offset:45568
    ds_read_b128 a[200:203], v21 offset:49152
    buffer_load_dwordx4 v4, s[8:11], s68 offen lds
    ds_read_b128 a[204:207], v21 offset:51200
    v_mfma_f32_16x16x32_bf16 v[120:123], a[236:239], a[216:219], v[120:123]
    s_add_u32 m0, s70, 69632
    s_nop 0
    buffer_load_dwordx4 v4, s[8:11], s69 offen lds
    v_mfma_f32_16x16x32_bf16 v[116:119], a[232:235], a[220:223], v[116:119]
    ds_read_b128 a[208:211], v20 offset:53248
    v_mfma_f32_16x16x32_bf16 v[124:127], a[236:239], a[220:223], v[124:127]
    ds_read_b128 a[212:215], v20 offset:55296
    s_add_u32 m0, s70, 73728
    s_waitcnt lgkmcnt(9)
    v_mfma_f32_16x16x32_bf16 v[64:67], a[240:243], a[192:195], v[64:67]
    buffer_load_dwordx4 v5, s[8:11], s60 offen lds
    v_mfma_f32_16x16x32_bf16 v[72:75], a[244:247], a[192:195], v[72:75]
    ds_read_b128 a[216:219], v21 offset:53248
    s_waitcnt lgkmcnt(9)
    v_mfma_f32_16x16x32_bf16 v[68:71], a[240:243], a[196:199], v[68:71]
    ds_read_b128 a[220:223], v21 offset:55296
    s_add_u32 m0, s70, 77824
    v_mfma_f32_16x16x32_bf16 v[76:79], a[244:247], a[196:199], v[76:79]
    buffer_load_dwordx4 v5, s[8:11], s61 offen lds
    s_waitcnt lgkmcnt(4)
    v_mfma_f32_16x16x32_bf16 v[64:67], a[248:251], a[200:203], v[64:67]
    ds_read_b128 a[192:195], v20 offset:57344
    v_mfma_f32_16x16x32_bf16 v[72:75], a[252:255], a[200:203], v[72:75]
    ds_read_b128 a[196:199], v20 offset:59392
    s_add_u32 m0, s70, 81920
    v_mfma_f32_16x16x32_bf16 v[68:71], a[248:251], a[204:207], v[68:71]
    buffer_load_dwordx4 v5, s[8:11], s62 offen lds
    v_mfma_f32_16x16x32_bf16 v[76:79], a[252:255], a[204:207], v[76:79]
    ds_read_b128 a[200:203], v21 offset:57344
    s_waitcnt lgkmcnt(5)
    v_mfma_f32_16x16x32_bf16 v[80:83], a[240:243], a[208:211], v[80:83]
    ds_read_b128 a[204:207], v21 offset:59392
    s_add_u32 m0, s70, 86016
    v_mfma_f32_16x16x32_bf16 v[88:91], a[244:247], a[208:211], v[88:91]
    v_mfma_f32_16x16x32_bf16 v[84:87], a[240:243], a[212:215], v[84:87]
    buffer_load_dwordx4 v5, s[8:11], s63 offen lds
    v_mfma_f32_16x16x32_bf16 v[92:95], a[244:247], a[212:215], v[92:95]
    ds_read_b128 a[208:211], v20 offset:61440
    s_waitcnt lgkmcnt(5)
    v_mfma_f32_16x16x32_bf16 v[80:83], a[248:251], a[216:219], v[80:83]
    ds_read_b128 a[212:215], v20 offset:63488
    v_max_f32 v64, 0, v64
    v_mfma_f32_16x16x32_bf16 v[88:91], a[252:255], a[216:219], v[88:91]
    v_max_f32 v65, 0, v65
    v_max_f32 v66, 0, v66
    s_add_u32 m0, s70, 90112
    v_mfma_f32_16x16x32_bf16 v[84:87], a[248:251], a[220:223], v[84:87]
    ds_read_b128 a[216:219], v21 offset:61440
    v_max_f32 v67, 0, v67
    v_max_f32 v68, 0, v68
    v_mfma_f32_16x16x32_bf16 v[92:95], a[252:255], a[220:223], v[92:95]
    buffer_load_dwordx4 v5, s[8:11], s64 offen lds
    v_max_f32 v69, 0, v69
    s_waitcnt lgkmcnt(5)
    v_mfma_f32_16x16x32_bf16 v[96:99], a[240:243], a[192:195], v[96:99]
    ds_read_b128 a[220:223], v21 offset:63488
    v_max_f32 v70, 0, v70
    v_mfma_f32_16x16x32_bf16 v[104:107], a[244:247], a[192:195], v[104:107]
    v_max_f32 v71, 0, v71
    v_mul_f32 v64, v64, v72
    s_add_u32 m0, s70, 94208
    v_mfma_f32_16x16x32_bf16 v[100:103], a[240:243], a[196:199], v[100:103]
    buffer_load_dwordx4 v5, s[8:11], s65 offen lds
    v_mul_f32 v65, v65, v73
    v_mfma_f32_16x16x32_bf16 v[108:111], a[244:247], a[196:199], v[108:111]
    v_mul_f32 v66, v66, v74
    v_mul_f32 v67, v67, v75
    v_mul_f32 v68, v68, v76
    s_waitcnt lgkmcnt(4)
    v_mfma_f32_16x16x32_bf16 v[96:99], a[248:251], a[200:203], v[96:99]
    s_waitcnt vmcnt(11)
    s_barrier
    ds_read_b128 a[192:195], v24 offset:32768
    v_mfma_f32_16x16x32_bf16 v[104:107], a[252:255], a[200:203], v[104:107]
    ds_read_b128 a[196:199], v24 offset:34816
    v_mul_f32 v69, v69, v77
    s_add_u32 m0, s70, 0
    v_mfma_f32_16x16x32_bf16 v[100:103], a[248:251], a[204:207], v[100:103]
    ds_read_b128 a[200:203], v25 offset:32768
    v_mul_f32 v70, v70, v78
    v_mul_f32 v71, v71, v79
    v_mfma_f32_16x16x32_bf16 v[108:111], a[252:255], a[204:207], v[108:111]
    buffer_load_dwordx4 v5, s[8:11], s66 offen lds
    v_cvt_pk_bf16_f32 v52, v64, v65
    s_waitcnt lgkmcnt(5)
    v_mfma_f32_16x16x32_bf16 v[112:115], a[240:243], a[208:211], v[112:115]
    ds_read_b128 a[204:207], v25 offset:34816
    v_cvt_pk_bf16_f32 v53, v66, v67
    v_mfma_f32_16x16x32_bf16 v[120:123], a[244:247], a[208:211], v[120:123]
    v_cvt_pk_bf16_f32 v54, v68, v69
    v_cvt_pk_bf16_f32 v55, v70, v71
    s_add_u32 m0, s70, 4096
    v_mfma_f32_16x16x32_bf16 v[116:119], a[240:243], a[212:215], v[116:119]
    ds_read_b128 a[208:211], v24 offset:36864
    v_permlane32_swap_b32 v52, v54
    v_mfma_f32_16x16x32_bf16 v[124:127], a[244:247], a[212:215], v[124:127]
    buffer_load_dwordx4 v5, s[8:11], s67 offen lds
    v_permlane32_swap_b32 v53, v55
    s_waitcnt lgkmcnt(5)
    v_mfma_f32_16x16x32_bf16 v[112:115], a[248:251], a[216:219], v[112:115]
    ds_read_b128 a[212:215], v24 offset:38912
    s_mov_b32 s50, 0
    v_mfma_f32_16x16x32_bf16 v[120:123], a[252:255], a[216:219], v[120:123]
    buffer_store_dwordx4 v[52:55], v12, s[28:31], s50 offen sc1
    s_add_u32 m0, s70, 8192
    v_mfma_f32_16x16x32_bf16 v[116:119], a[248:251], a[220:223], v[116:119]
    ds_read_b128 a[216:219], v25 offset:36864
    v_max_f32 v80, 0, v80
    v_mfma_f32_16x16x32_bf16 v[124:127], a[252:255], a[220:223], v[124:127]
    buffer_load_dwordx4 v5, s[8:11], s68 offen lds
    v_max_f32 v81, 0, v81
    s_waitcnt lgkmcnt(6)
    v_mfma_f32_16x16x32_bf16 v[64:67], v[128:131], a[192:195], 0
    ds_read_b128 a[220:223], v25 offset:38912
    v_max_f32 v82, 0, v82
    v_mfma_f32_16x16x32_bf16 v[72:75], v[132:135], a[192:195], 0
    v_max_f32 v83, 0, v83
    s_add_u32 m0, s70, 12288
    s_waitcnt lgkmcnt(6)
    v_mfma_f32_16x16x32_bf16 v[68:71], v[128:131], a[196:199], 0
    ds_read_b128 a[192:195], v24 offset:40960
    v_max_f32 v84, 0, v84
    v_mfma_f32_16x16x32_bf16 v[76:79], v[132:135], a[196:199], 0
    buffer_load_dwordx4 v5, s[8:11], s69 offen lds
    v_max_f32 v85, 0, v85
    s_waitcnt lgkmcnt(5)
    v_mfma_f32_16x16x32_bf16 v[64:67], v[136:139], a[200:203], v[64:67]
    ds_read_b128 a[196:199], v24 offset:43008
    v_max_f32 v86, 0, v86
    v_mfma_f32_16x16x32_bf16 v[72:75], v[140:143], a[200:203], v[72:75]
    v_max_f32 v87, 0, v87
    s_add_u32 m0, s70, 16384
    v_mfma_f32_16x16x32_bf16 v[68:71], v[136:139], a[204:207], v[68:71]
    ds_read_b128 a[200:203], v25 offset:40960
    v_mul_f32 v80, v80, v88
    v_mfma_f32_16x16x32_bf16 v[76:79], v[140:143], a[204:207], v[76:79]
    buffer_load_dwordx4 v22, s[8:11], s42 offen lds
    v_mul_f32 v81, v81, v89
    s_waitcnt lgkmcnt(5)
    v_mfma_f32_16x16x32_bf16 v[64:67], v[144:147], a[208:211], v[64:67]
    ds_read_b128 a[204:207], v25 offset:43008
    v_mul_f32 v82, v82, v90
    v_mfma_f32_16x16x32_bf16 v[72:75], v[148:151], a[208:211], v[72:75]
    v_mul_f32 v83, v83, v91
    v_mul_f32 v84, v84, v92
    v_mfma_f32_16x16x32_bf16 v[68:71], v[144:147], a[212:215], v[68:71]
    ds_read_b128 a[208:211], v24 offset:45056
    v_mul_f32 v85, v85, v93
    v_mfma_f32_16x16x32_bf16 v[76:79], v[148:151], a[212:215], v[76:79]
    v_mul_f32 v86, v86, v94
    s_add_u32 m0, s70, 20480
    s_waitcnt lgkmcnt(5)
    v_mfma_f32_16x16x32_bf16 v[64:67], v[152:155], a[216:219], v[64:67]
    ds_read_b128 a[212:215], v24 offset:47104
    v_mul_f32 v87, v87, v95
    v_mfma_f32_16x16x32_bf16 v[72:75], v[156:159], a[216:219], v[72:75]
    buffer_load_dwordx4 v22, s[8:11], s43 offen lds
    v_cvt_pk_bf16_f32 v56, v80, v81
    v_mfma_f32_16x16x32_bf16 v[68:71], v[152:155], a[220:223], v[68:71]
    ds_read_b128 a[216:219], v25 offset:45056
    v_cvt_pk_bf16_f32 v57, v82, v83
    v_mfma_f32_16x16x32_bf16 v[76:79], v[156:159], a[220:223], v[76:79]
    v_cvt_pk_bf16_f32 v58, v84, v85
    s_add_u32 m0, s70, 24576
    s_waitcnt lgkmcnt(5)
    v_mfma_f32_16x16x32_bf16 v[64:67], v[160:163], a[192:195], v[64:67]
    ds_read_b128 a[220:223], v25 offset:47104
    v_cvt_pk_bf16_f32 v59, v86, v87
    v_mfma_f32_16x16x32_bf16 v[72:75], v[164:167], a[192:195], v[72:75]
    buffer_load_dwordx4 v22, s[8:11], s44 offen lds
    v_permlane32_swap_b32 v56, v58
    v_mfma_f32_16x16x32_bf16 v[68:71], v[160:163], a[196:199], v[68:71]
    ds_read_b128 a[192:195], v24 offset:49152
    v_permlane32_swap_b32 v57, v59
    v_mfma_f32_16x16x32_bf16 v[76:79], v[164:167], a[196:199], v[76:79]
    s_waitcnt lgkmcnt(5)
    v_mfma_f32_16x16x32_bf16 v[64:67], v[168:171], a[200:203], v[64:67]
    ds_read_b128 a[196:199], v24 offset:51200
    s_mov_b32 s50, 98304
    v_mfma_f32_16x16x32_bf16 v[72:75], v[172:175], a[200:203], v[72:75]
    buffer_store_dwordx4 v[56:59], v12, s[28:31], s50 offen sc1
    s_add_u32 m0, s70, 28672
    v_mfma_f32_16x16x32_bf16 v[68:71], v[168:171], a[204:207], v[68:71]
    ds_read_b128 a[200:203], v25 offset:49152
    v_max_f32 v96, 0, v96
    v_mfma_f32_16x16x32_bf16 v[76:79], v[172:175], a[204:207], v[76:79]
    buffer_load_dwordx4 v22, s[8:11], s45 offen lds
    v_max_f32 v97, 0, v97
    s_waitcnt lgkmcnt(5)
    v_mfma_f32_16x16x32_bf16 v[64:67], v[176:179], a[208:211], v[64:67]
    ds_read_b128 a[204:207], v25 offset:51200
    v_max_f32 v98, 0, v98
    v_mfma_f32_16x16x32_bf16 v[72:75], v[180:183], a[208:211], v[72:75]
    v_max_f32 v99, 0, v99
    v_max_f32 v100, 0, v100
    v_mfma_f32_16x16x32_bf16 v[68:71], v[176:179], a[212:215], v[68:71]
    v_max_f32 v101, 0, v101
    v_max_f32 v102, 0, v102
    v_mfma_f32_16x16x32_bf16 v[76:79], v[180:183], a[212:215], v[76:79]
    v_max_f32 v103, 0, v103
    v_mul_f32 v96, v96, v104
    s_waitcnt lgkmcnt(4)
    v_mfma_f32_16x16x32_bf16 v[64:67], v[184:187], a[216:219], v[64:67]
    s_waitcnt vmcnt(16)
    s_barrier
    ds_read_b128 a[208:211], v24 offset:53248
    v_mfma_f32_16x16x32_bf16 v[72:75], v[188:191], a[216:219], v[72:75]
    ds_read_b128 a[212:215], v24 offset:55296
    s_add_u32 m0, s70, 32768
    v_mfma_f32_16x16x32_bf16 v[68:71], v[184:187], a[220:223], v[68:71]
    ds_read_b128 a[216:219], v25 offset:53248
    v_mul_f32 v97, v97, v105
    v_mfma_f32_16x16x32_bf16 v[76:79], v[188:191], a[220:223], v[76:79]
    buffer_load_dwordx4 v22, s[8:11], s46 offen lds
    v_mul_f32 v98, v98, v106
    s_waitcnt lgkmcnt(5)
    v_mfma_f32_16x16x32_bf16 v[64:67], v[192:195], a[192:195], v[64:67]
    ds_read_b128 a[220:223], v25 offset:55296
    v_mul_f32 v99, v99, v107
    v_mfma_f32_16x16x32_bf16 v[72:75], v[196:199], a[192:195], v[72:75]
    s_add_u32 m0, s71, 131072
    s_mul_i32 s6, s74, 40
    v_mfma_f32_16x16x32_bf16 v[68:71], v[192:195], a[196:199], v[68:71]
    ds_read_b128 a[192:195], v24 offset:57344
    v_mul_f32 v100, v100, v108
    v_mfma_f32_16x16x32_bf16 v[76:79], v[196:199], a[196:199], v[76:79]
    buffer_load_dwordx4 v11, s[20:23], s6 offen lds
    v_mul_f32 v101, v101, v109
    s_waitcnt lgkmcnt(5)
    v_mfma_f32_16x16x32_bf16 v[64:67], v[200:203], a[200:203], v[64:67]
    ds_read_b128 a[196:199], v24 offset:59392
    v_mul_f32 v102, v102, v110
    v_mfma_f32_16x16x32_bf16 v[72:75], v[204:207], a[200:203], v[72:75]
    v_mul_f32 v103, v103, v111
    v_cvt_pk_bf16_f32 v52, v96, v97
    v_mfma_f32_16x16x32_bf16 v[68:71], v[200:203], a[204:207], v[68:71]
    ds_read_b128 a[200:203], v25 offset:57344
    v_cvt_pk_bf16_f32 v53, v98, v99
    v_mfma_f32_16x16x32_bf16 v[76:79], v[204:207], a[204:207], v[76:79]
    v_cvt_pk_bf16_f32 v54, v100, v101
    s_waitcnt lgkmcnt(6)
    v_mfma_f32_16x16x32_bf16 v[64:67], v[208:211], a[208:211], v[64:67]
    ds_read_b128 a[204:207], v25 offset:59392
    v_cvt_pk_bf16_f32 v55, v102, v103
    v_mfma_f32_16x16x32_bf16 v[72:75], v[212:215], a[208:211], v[72:75]
    buffer_load_dwordx4 v44, s[20:23], s6 offen offset:1024 lds
    v_permlane32_swap_b32 v52, v54
    s_waitcnt lgkmcnt(6)
    v_mfma_f32_16x16x32_bf16 v[68:71], v[208:211], a[212:215], v[68:71]
    ds_read_b128 a[208:211], v24 offset:61440
    v_permlane32_swap_b32 v53, v55
    v_mfma_f32_16x16x32_bf16 v[76:79], v[212:215], a[212:215], v[76:79]
    s_waitcnt lgkmcnt(5)
    v_mfma_f32_16x16x32_bf16 v[64:67], v[216:219], a[216:219], v[64:67]
    ds_read_b128 a[212:215], v24 offset:63488
    v_mfma_f32_16x16x32_bf16 v[72:75], v[220:223], a[216:219], v[72:75]
    v_mfma_f32_16x16x32_bf16 v[68:71], v[216:219], a[220:223], v[68:71]
    ds_read_b128 a[216:219], v25 offset:61440
    v_mfma_f32_16x16x32_bf16 v[76:79], v[220:223], a[220:223], v[76:79]
    s_waitcnt lgkmcnt(5)
    v_mfma_f32_16x16x32_bf16 v[64:67], v[224:227], a[192:195], v[64:67]
    ds_read_b128 a[220:223], v25 offset:63488
    buffer_load_dwordx4 v45, s[20:23], s6 offen offset:2048 lds
    v_mfma_f32_16x16x32_bf16 v[72:75], v[228:231], a[192:195], v[72:75]
    s_mov_b32 s50, 196608
    buffer_store_dwordx4 v[52:55], v12, s[28:31], s50 offen sc1
    v_mfma_f32_16x16x32_bf16 v[68:71], v[224:227], a[196:199], v[68:71]
    ds_read_b128 a[192:195], v24 offset:0
    v_max_f32 v112, 0, v112
    v_mfma_f32_16x16x32_bf16 v[76:79], v[228:231], a[196:199], v[76:79]
    v_max_f32 v113, 0, v113
    v_max_f32 v114, 0, v114
    s_waitcnt lgkmcnt(5)
    v_mfma_f32_16x16x32_bf16 v[64:67], v[232:235], a[200:203], v[64:67]
    ds_read_b128 a[196:199], v24 offset:2048
    v_max_f32 v115, 0, v115
    v_mfma_f32_16x16x32_bf16 v[72:75], v[236:239], a[200:203], v[72:75]
    v_max_f32 v116, 0, v116
    v_mfma_f32_16x16x32_bf16 v[68:71], v[232:235], a[204:207], v[68:71]
    ds_read_b128 a[200:203], v25 offset:0
    v_max_f32 v117, 0, v117
    v_mfma_f32_16x16x32_bf16 v[76:79], v[236:239], a[204:207], v[76:79]
    buffer_load_dwordx4 v46, s[20:23], s6 offen offset:3072 lds
    v_max_f32 v118, 0, v118
    s_waitcnt lgkmcnt(5)
    v_mfma_f32_16x16x32_bf16 v[64:67], v[240:243], a[208:211], v[64:67]
    ds_read_b128 a[204:207], v25 offset:2048
    v_max_f32 v119, 0, v119
    v_mfma_f32_16x16x32_bf16 v[72:75], v[244:247], a[208:211], v[72:75]
    v_mul_f32 v112, v112, v120
    v_mul_f32 v113, v113, v121
    v_mfma_f32_16x16x32_bf16 v[68:71], v[240:243], a[212:215], v[68:71]
    ds_read_b128 a[208:211], v24 offset:4096
    v_mul_f32 v114, v114, v122
    v_mfma_f32_16x16x32_bf16 v[76:79], v[244:247], a[212:215], v[76:79]
    s_add_u32 m0, s71, 147456
    s_mul_i32 s6, s75, 40
    s_waitcnt lgkmcnt(5)
    v_mfma_f32_16x16x32_bf16 v[64:67], v[248:251], a[216:219], v[64:67]
    ds_read_b128 a[212:215], v24 offset:6144
    v_mul_f32 v115, v115, v123
    v_mfma_f32_16x16x32_bf16 v[72:75], v[252:255], a[216:219], v[72:75]
    buffer_load_dwordx4 v11, s[20:23], s6 offen lds
    v_mul_f32 v116, v116, v124
    v_mfma_f32_16x16x32_bf16 v[68:71], v[248:251], a[220:223], v[68:71]
    ds_read_b128 a[216:219], v25 offset:4096
    v_mul_f32 v117, v117, v125
    v_mfma_f32_16x16x32_bf16 v[76:79], v[252:255], a[220:223], v[76:79]
    v_mul_f32 v118, v118, v126
    v_mul_f32 v119, v119, v127
    s_waitcnt lgkmcnt(5)
    v_mfma_f32_16x16x32_bf16 v[64:67], a[224:227], a[192:195], v[64:67]
    ds_read_b128 a[220:223], v25 offset:6144
    v_cvt_pk_bf16_f32 v56, v112, v113
    v_mfma_f32_16x16x32_bf16 v[72:75], a[228:231], a[192:195], v[72:75]
    v_cvt_pk_bf16_f32 v57, v114, v115
    v_cvt_pk_bf16_f32 v58, v116, v117
    v_mfma_f32_16x16x32_bf16 v[68:71], a[224:227], a[196:199], v[68:71]
    v_cvt_pk_bf16_f32 v59, v118, v119
    v_permlane32_swap_b32 v56, v58
    v_mfma_f32_16x16x32_bf16 v[76:79], a[228:231], a[196:199], v[76:79]
    v_permlane32_swap_b32 v57, v59
    s_waitcnt lgkmcnt(4)
    v_mfma_f32_16x16x32_bf16 v[64:67], a[232:235], a[200:203], v[64:67]
    s_waitcnt vmcnt(8)
    s_barrier
    ds_read_b128 a[192:195], v24 offset:8192
    v_mfma_f32_16x16x32_bf16 v[72:75], a[236:239], a[200:203], v[72:75]
    ds_read_b128 a[196:199], v24 offset:10240
    buffer_load_dwordx4 v44, s[20:23], s6 offen offset:1024 lds
    v_mfma_f32_16x16x32_bf16 v[68:71], a[232:235], a[204:207], v[68:71]
    ds_read_b128 a[200:203], v25 offset:8192
L_A_w2_0:
    s_cbranch_execz L_A_w2_1
    s_cmp_lg_u32 s3, 0
    v_mfma_f32_16x16x32_bf16 v[76:79], a[236:239], a[204:207], v[76:79]
    s_cbranch_scc1 L_A_pub0
    s_atomic_add s100, s[28:29], s51
L_A_pub0:
    s_waitcnt lgkmcnt(5)
    v_mfma_f32_16x16x32_bf16 v[64:67], a[240:243], a[208:211], v[64:67]
    ds_read_b128 a[204:207], v25 offset:10240
    v_mfma_f32_16x16x32_bf16 v[72:75], a[244:247], a[208:211], v[72:75]
    v_mfma_f32_16x16x32_bf16 v[68:71], a[240:243], a[212:215], v[68:71]
L_A_w2_1:
    s_cbranch_execz L_hopped
    buffer_load_dwordx4 v45, s[20:23], s6 offen offset:2048 lds
    v_mfma_f32_16x16x32_bf16 v[76:79], a[244:247], a[212:215], v[76:79]
    ds_read_b128 a[208:211], v24 offset:12288
    s_waitcnt lgkmcnt(5)
    v_mfma_f32_16x16x32_bf16 v[64:67], a[248:251], a[216:219], v[64:67]
    ds_read_b128 a[212:215], v24 offset:14336
    s_mov_b32 s50, 294912
    v_mfma_f32_16x16x32_bf16 v[72:75], a[252:255], a[216:219], v[72:75]
    buffer_store_dwordx4 v[56:59], v12, s[28:31], s50 offen sc1
    v_mfma_f32_16x16x32_bf16 v[68:71], a[248:251], a[220:223], v[68:71]
    ds_read_b128 a[216:219], v25 offset:12288
    v_mfma_f32_16x16x32_bf16 v[76:79], a[252:255], a[220:223], v[76:79]
    s_waitcnt lgkmcnt(6)
    v_mfma_f32_16x16x32_bf16 v[80:83], v[128:131], a[192:195], 0
    buffer_load_dwordx4 v46, s[20:23], s6 offen offset:3072 lds
    v_mfma_f32_16x16x32_bf16 v[88:91], v[132:135], a[192:195], 0
    ds_read_b128 a[220:223], v25 offset:14336
    s_waitcnt lgkmcnt(6)
    v_mfma_f32_16x16x32_bf16 v[84:87], v[128:131], a[196:199], 0
    ds_read_b128 a[192:195], v24 offset:16384
    v_mfma_f32_16x16x32_bf16 v[92:95], v[132:135], a[196:199], 0
    s_waitcnt lgkmcnt(5)
    v_mfma_f32_16x16x32_bf16 v[80:83], v[136:139], a[200:203], v[80:83]
    ds_read_b128 a[196:199], v24 offset:18432
    v_mfma_f32_16x16x32_bf16 v[88:91], v[140:143], a[200:203], v[88:91]
    v_mfma_f32_16x16x32_bf16 v[84:87], v[136:139], a[204:207], v[84:87]
    ds_read_b128 a[200:203], v25 offset:16384
    s_add_u32 m0, s71, 49152
    v_mfma_f32_16x16x32_bf16 v[92:95], v[140:143], a[204:207], v[92:95]
    s_mul_i32 s6, s76, 40
    s_waitcnt lgkmcnt(5)
    v_mfma_f32_16x16x32_bf16 v[80:83], v[144:147], a[208:211], v[80:83]
    ds_read_b128 a[204:207], v25 offset:18432
    v_max_f32 v64, 0, v64
    v_mfma_f32_16x16x32_bf16 v[88:91], v[148:151], a[208:211], v[88:91]
    buffer_load_dwordx4 v11, s[20:23], s6 offen lds
    v_max_f32 v65, 0, v65
    v_mfma_f32_16x16x32_bf16 v[84:87], v[144:147], a[212:215], v[84:87]
    ds_read_b128 a[208:211], v24 offset:20480
    v_max_f32 v66, 0, v66
    v_mfma_f32_16x16x32_bf16 v[92:95], v[148:151], a[212:215], v[92:95]
    v_max_f32 v67, 0, v67
    v_max_f32 v68, 0, v68
    s_waitcnt lgkmcnt(5)
    v_mfma_f32_16x16x32_bf16 v[80:83], v[152:155], a[216:219], v[80:83]
    ds_read_b128 a[212:215], v24 offset:22528
    v_max_f32 v69, 0, v69
    v_mfma_f32_16x16x32_bf16 v[88:91], v[156:159], a[216:219], v[88:91]
    v_max_f32 v70, 0, v70
    v_mfma_f32_16x16x32_bf16 v[84:87], v[152:155], a[220:223], v[84:87]
    ds_read_b128 a[216:219], v25 offset:20480
    v_max_f32 v71, 0, v71
    v_mfma_f32_16x16x32_bf16 v[92:95], v[156:159], a[220:223], v[92:95]
    buffer_load_dwordx4 v44, s[20:23], s6 offen offset:1024 lds
    v_mul_f32 v64, v64, v72
    s_waitcnt lgkmcnt(5)
    v_mfma_f32_16x16x32_bf16 v[80:83], v[160:163], a[192:195], v[80:83]
    ds_read_b128 a[220:223], v25 offset:22528
    v_mul_f32 v65, v65, v73
    v_mfma_f32_16x16x32_bf16 v[88:91], v[164:167], a[192:195], v[88:91]
    v_mul_f32 v66, v66, v74
    v_mul_f32 v67, v67, v75
    v_mfma_f32_16x16x32_bf16 v[84:87], v[160:163], a[196:199], v[84:87]
    ds_read_b128 a[192:195], v24 offset:24576
    v_mul_f32 v68, v68, v76
    v_mfma_f32_16x16x32_bf16 v[92:95], v[164:167], a[196:199], v[92:95]
    v_mul_f32 v69, v69, v77
    s_waitcnt lgkmcnt(5)
    v_mfma_f32_16x16x32_bf16 v[80:83], v[168:171], a[200:203], v[80:83]
    ds_read_b128 a[196:199], v24 offset:26624
    v_mul_f32 v70, v70, v78
    v_mfma_f32_16x16x32_bf16 v[88:91], v[172:175], a[200:203], v[88:91]
    buffer_load_dwordx4 v45, s[20:23], s6 offen offset:2048 lds
    v_mul_f32 v71, v71, v79
    v_mfma_f32_16x16x32_bf16 v[84:87], v[168:171], a[204:207], v[84:87]
    ds_read_b128 a[200:203], v25 offset:24576
    v_cvt_pk_bf16_f32 v52, v64, v65
    v_mfma_f32_16x16x32_bf16 v[92:95], v[172:175], a[204:207], v[92:95]
    v_cvt_pk_bf16_f32 v53, v66, v67
    v_cvt_pk_bf16_f32 v54, v68, v69
    s_waitcnt lgkmcnt(5)
    v_mfma_f32_16x16x32_bf16 v[80:83], v[176:179], a[208:211], v[80:83]
    ds_read_b128 a[204:207], v25 offset:26624
    v_cvt_pk_bf16_f32 v55, v70, v71
    v_mfma_f32_16x16x32_bf16 v[88:91], v[180:183], a[208:211], v[88:91]
    v_permlane32_swap_b32 v52, v54
    v_permlane32_swap_b32 v53, v55
    v_mfma_f32_16x16x32_bf16 v[84:87], v[176:179], a[212:215], v[84:87]
    ds_read_b128 a[208:211], v24 offset:28672
    v_mfma_f32_16x16x32_bf16 v[92:95], v[180:183], a[212:215], v[92:95]
    s_waitcnt lgkmcnt(5)
    v_mfma_f32_16x16x32_bf16 v[80:83], v[184:187], a[216:219], v[80:83]
    buffer_load_dwordx4 v46, s[20:23], s6 offen offset:3072 lds
    v_mfma_f32_16x16x32_bf16 v[88:91], v[188:191], a[216:219], v[88:91]
    ds_read_b128 a[212:215], v24 offset:30720
    v_mfma_f32_16x16x32_bf16 v[84:87], v[184:187], a[220:223], v[84:87]
    ds_read_b128 a[216:219], v25 offset:28672
    v_mfma_f32_16x16x32_bf16 v[92:95], v[188:191], a[220:223], v[92:95]
    s_waitcnt lgkmcnt(5)
    v_mfma_f32_16x16x32_bf16 v[80:83], v[192:195], a[192:195], v[80:83]
    ds_read_b128 a[220:223], v25 offset:30720
    v_mfma_f32_16x16x32_bf16 v[88:91], v[196:199], a[192:195], v[88:91]
    s_waitcnt vmcnt(9)
    ds_read_b64_tr_b16 a[32:33], v30 offset:32768
    v_mfma_f32_16x16x32_bf16 v[84:87], v[192:195], a[196:199], v[84:87]
    ds_read_b64_tr_b16 a[34:35], v30 offset:33792
    s_add_u32 m0, s71, 98304
    s_mul_i32 s6, s77, 40
    v_mfma_f32_16x16x32_bf16 v[92:95], v[196:199], a[196:199], v[92:95]
    buffer_load_dwordx4 v11, s[20:23], s6 offen lds
    s_waitcnt lgkmcnt(6)
    v_mfma_f32_16x16x32_bf16 v[80:83], v[200:203], a[200:203], v[80:83]
    ds_read_b128 a[192:195], v20 offset:0
    v_mfma_f32_16x16x32_bf16 v[88:91], v[204:207], a[200:203], v[88:91]
    ds_read_b64_tr_b16 a[36:37], v31 offset:32768
    v_mfma_f32_16x16x32_bf16 v[84:87], v[200:203], a[204:207], v[84:87]
    ds_read_b64_tr_b16 a[38:39], v31 offset:33792
    v_mfma_f32_16x16x32_bf16 v[92:95], v[204:207], a[204:207], v[92:95]
    ds_read_b128 a[196:199], v20 offset:2048
    s_waitcnt lgkmcnt(9)
    v_mfma_f32_16x16x32_bf16 v[80:83], v[208:211], a[208:211], v[80:83]
    ds_read_b64_tr_b16 a[40:41], v32 offset:32768
    v_mfma_f32_16x16x32_bf16 v[88:91], v[212:215], a[208:211], v[88:91]
    ds_read_b64_tr_b16 a[42:43], v32 offset:33792
    s_mov_b32 s50, 393216
    s_waitcnt lgkmcnt(10)
    v_mfma_f32_16x16x32_bf16 v[84:87], v[208:211], a[212:215], v[84:87]
    buffer_store_dwordx4 v[52:55], v12, s[28:31], s50 offen sc1
    v_mfma_f32_16x16x32_bf16 v[92:95], v[212:215], a[212:215], v[92:95]
    ds_read_b128 a[200:203], v21 offset:0
    s_waitcnt lgkmcnt(9)
    v_mfma_f32_16x16x32_bf16 v[80:83], v[216:219], a[216:219], v[80:83]
    ds_read_b64_tr_b16 a[44:45], v33 offset:32768
    ds_read_b64_tr_b16 a[46:47], v33 offset:33792
    buffer_load_dwordx4 v44, s[20:23], s6 offen offset:1024 lds
    ds_read_b128 a[204:207], v21 offset:2048
    v_mfma_f32_16x16x32_bf16 v[88:91], v[220:223], a[216:219], v[88:91]
    ds_read_b128 a[208:211], v20 offset:4096
    v_mfma_f32_16x16x32_bf16 v[84:87], v[216:219], a[220:223], v[84:87]
    ds_read_b128 a[212:215], v20 offset:6144
    v_mfma_f32_16x16x32_bf16 v[92:95], v[220:223], a[220:223], v[92:95]
    ds_read_b128 a[216:219], v21 offset:4096
    s_waitcnt lgkmcnt(9)
    v_mfma_f32_16x16x32_bf16 v[80:83], v[224:227], a[192:195], v[80:83]
    buffer_load_dwordx4 v45, s[20:23], s6 offen offset:2048 lds
    v_mfma_f32_16x16x32_bf16 v[88:91], v[228:231], a[192:195], v[88:91]
    ds_read_b128 a[220:223], v21 offset:6144
    v_mfma_f32_16x16x32_bf16 v[84:87], v[224:227], a[196:199], v[84:87]
    ds_read_b128 a[192:195], v20 offset:8192
    v_mfma_f32_16x16x32_bf16 v[92:95], v[228:231], a[196:199], v[92:95]
    s_waitcnt lgkmcnt(5)
    v_mfma_f32_16x16x32_bf16 v[80:83], v[232:235], a[200:203], v[80:83]
    ds_read_b128 a[196:199], v20 offset:10240
    v_mfma_f32_16x16x32_bf16 v[88:91], v[236:239], a[200:203], v[88:91]
    v_mfma_f32_16x16x32_bf16 v[84:87], v[232:235], a[204:207], v[84:87]
    buffer_load_dwordx4 v46, s[20:23], s6 offen offset:3072 lds
    v_mfma_f32_16x16x32_bf16 v[92:95], v[236:239], a[204:207], v[92:95]
    ds_read_b128 a[200:203], v21 offset:8192
    s_waitcnt lgkmcnt(5)
    v_mfma_f32_16x16x32_bf16 v[80:83], v[240:243], a[208:211], v[80:83]
    ds_read_b128 a[204:207], v21 offset:10240
    v_mfma_f32_16x16x32_bf16 v[88:91], v[244:247], a[208:211], v[88:91]
    v_mfma_f32_16x16x32_bf16 v[84:87], v[240:243], a[212:215], v[84:87]
    ds_read_b128 a[208:211], v20 offset:12288
    s_add_u32 m0, s71, 131072
    v_mfma_f32_16x16x32_bf16 v[92:95], v[244:247], a[212:215], v[92:95]
    s_mul_i32 s6, s78, 40
    s_waitcnt lgkmcnt(5)
    v_mfma_f32_16x16x32_bf16 v[80:83], v[248:251], a[216:219], v[80:83]
    buffer_load_dwordx4 v11, s[20:23], s6 offen lds
    v_mfma_f32_16x16x32_bf16 v[88:91], v[252:255], a[216:219], v[88:91]
    ds_read_b128 a[212:215], v20 offset:14336
    v_mfma_f32_16x16x32_bf16 v[84:87], v[248:251], a[220:223], v[84:87]
    s_waitcnt vmcnt(10)
    ds_read_b64_tr_b16 a[48:49], v30 offset:49152
    v_mfma_f32_16x16x32_bf16 v[92:95], v[252:255], a[220:223], v[92:95]
    ds_read_b64_tr_b16 a[50:51], v30 offset:50176
    s_waitcnt lgkmcnt(6)
    v_mfma_f32_16x16x32_bf16 v[80:83], a[224:227], a[192:195], v[80:83]
    ds_read_b128 a[216:219], v21 offset:12288
    v_mfma_f32_16x16x32_bf16 v[88:91], a[228:231], a[192:195], v[88:91]
    ds_read_b64_tr_b16 a[52:53], v31 offset:49152
    v_mfma_f32_16x16x32_bf16 v[84:87], a[224:227], a[196:199], v[84:87]
    ds_read_b64_tr_b16 a[54:55], v31 offset:50176
    v_mfma_f32_16x16x32_bf16 v[92:95], a[228:231], a[196:199], v[92:95]
    ds_read_b128 a[220:223], v21 offset:14336
    s_waitcnt lgkmcnt(8)
    v_mfma_f32_16x16x32_bf16 v[80:83], a[232:235], a[200:203], v[80:83]
    ds_read_b64_tr_b16 a[56:57], v32 offset:49152
    v_mfma_f32_16x16x32_bf16 v[88:91], a[236:239], a[200:203], v[88:91]
    ds_read_b64_tr_b16 a[58:59], v32 offset:50176
    v_mfma_f32_16x16x32_bf16 v[84:87], a[232:235], a[204:207], v[84:87]
    ds_read_b64_tr_b16 a[60:61], v33 offset:49152
    v_mfma_f32_16x16x32_bf16 v[92:95], a[236:239], a[204:207], v[92:95]
    ds_read_b64_tr_b16 a[62:63], v33 offset:50176
    s_barrier
    s_waitcnt lgkmcnt(10)
    v_mfma_f32_16x16x32_bf16 v[80:83], a[240:243], a[208:211], v[80:83]
    ds_read_b128 a[192:195], v20 offset:16384
    v_mfma_f32_16x16x32_bf16 v[88:91], a[244:247], a[208:211], v[88:91]
    ds_read_b128 a[196:199], v21 offset:16384
    v_mfma_f32_16x16x32_bf16 v[84:87], a[240:243], a[212:215], v[84:87]
    buffer_load_dwordx4 v44, s[20:23], s6 offen offset:1024 lds
    v_mfma_f32_16x16x32_bf16 v[92:95], a[244:247], a[212:215], v[92:95]
    ds_read_b128 a[200:203], v20 offset:18432
    s_cmp_lg_u32 s3, 0
    s_waitcnt lgkmcnt(7)
    v_mfma_f32_16x16x32_bf16 v[80:83], a[248:251], a[216:219], v[80:83]
    s_cbranch_scc1 L_A_pub1
    s_atomic_add s101, s[28:29], s51 offset:128
L_A_pub1:
    ds_read_b128 a[204:207], v21 offset:18432
    v_mfma_f32_16x16x32_bf16 v[88:91], a[252:255], a[216:219], v[88:91]
    buffer_load_dwordx4 v45, s[20:23], s6 offen offset:2048 lds
    v_mfma_f32_16x16x32_bf16 v[84:87], a[248:251], a[220:223], v[84:87]
    ds_read_b128 a[208:211], v20 offset:20480
    v_mfma_f32_16x16x32_bf16 v[92:95], a[252:255], a[220:223], v[92:95]
    ds_read_b128 a[212:215], v21 offset:20480
    s_waitcnt lgkmcnt(5)
    v_mfma_f32_16x16x32_bf16 v[64:67], v[128:131], a[192:195], 0
    ds_read_b128 a[216:219], v20 offset:22528
    v_mfma_f32_16x16x32_bf16 v[72:75], v[132:135], a[192:195], 0
    buffer_load_dwordx4 v46, s[20:23], s6 offen offset:3072 lds
    s_waitcnt lgkmcnt(5)
    v_mfma_f32_16x16x32_bf16 v[64:67], v[136:139], a[196:199], v[64:67]
    ds_read_b128 a[220:223], v21 offset:22528
    v_mfma_f32_16x16x32_bf16 v[72:75], v[140:143], a[196:199], v[72:75]
    ds_read_b128 a[192:195], v20 offset:24576
    s_waitcnt lgkmcnt(5)
    v_mfma_f32_16x16x32_bf16 v[64:67], v[144:147], a[200:203], v[64:67]
    ds_read_b128 a[196:199], v21 offset:24576
    v_mfma_f32_16x16x32_bf16 v[72:75], v[148:151], a[200:203], v[72:75]
    v_mfma_f32_16x16x32_bf16 v[64:67], v[152:155], a[204:207], v[64:67]
    ds_read_b128 a[200:203], v20 offset:26624
    v_mfma_f32_16x16x32_bf16 v[72:75], v[156:159], a[204:207], v[72:75]
    s_waitcnt vmcnt(9)
    ds_read_b64_tr_b16 a[64:65], v60 offset:16384
    s_waitcnt lgkmcnt(6)
    v_mfma_f32_16x16x32_bf16 v[64:67], v[160:163], a[208:211], v[64:67]
    ds_read_b64_tr_b16 a[66:67], v60 offset:17408
    s_add_u32 m0, s71, 114688
    s_mul_i32 s6, s79, 40
    v_mfma_f32_16x16x32_bf16 v[72:75], v[164:167], a[208:211], v[72:75]
    buffer_load_dwordx4 v11, s[20:23], s6 offen lds
    v_mfma_f32_16x16x32_bf16 v[64:67], v[168:171], a[212:215], v[64:67]
    ds_read_b128 a[204:207], v21 offset:26624
    v_mfma_f32_16x16x32_bf16 v[72:75], v[172:175], a[212:215], v[72:75]
    ds_read_b64_tr_b16 a[68:69], v61 offset:16384
    s_waitcnt lgkmcnt(7)
    v_mfma_f32_16x16x32_bf16 v[64:67], v[176:179], a[216:219], v[64:67]
    ds_read_b64_tr_b16 a[70:71], v61 offset:17408
    v_mfma_f32_16x16x32_bf16 v[72:75], v[180:183], a[216:219], v[72:75]
    ds_read_b128 a[208:211], v20 offset:28672
    v_mfma_f32_16x16x32_bf16 v[64:67], v[184:187], a[220:223], v[64:67]
    ds_read_b64_tr_b16 a[72:73], v62 offset:16384
    v_mfma_f32_16x16x32_bf16 v[72:75], v[188:191], a[220:223], v[72:75]
    ds_read_b64_tr_b16 a[74:75], v62 offset:17408
    v_max_f32 v80, 0, v80
    s_waitcnt lgkmcnt(9)
    v_mfma_f32_16x16x32_bf16 v[64:67], v[192:195], a[192:195], v[64:67]
    ds_read_b128 a[212:215], v21 offset:28672
    v_mfma_f32_16x16x32_bf16 v[72:75], v[196:199], a[192:195], v[72:75]
    ds_read_b64_tr_b16 a[76:77], v63 offset:16384
    v_mfma_f32_16x16x32_bf16 v[64:67], v[200:203], a[196:199], v[64:67]
    ds_read_b64_tr_b16 a[78:79], v63 offset:17408
    v_mfma_f32_16x16x32_bf16 v[72:75], v[204:207], a[196:199], v[72:75]
    ds_read_b128 a[216:219], v20 offset:30720
    v_max_f32 v81, 0, v81
    s_waitcnt lgkmcnt(9)
    v_mfma_f32_16x16x32_bf16 v[64:67], v[208:211], a[200:203], v[64:67]
    buffer_load_dwordx4 v44, s[20:23], s6 offen offset:1024 lds
    v_max_f32 v82, 0, v82
    ds_read_b128 a[220:223], v21 offset:30720
    v_mfma_f32_16x16x32_bf16 v[72:75], v[212:215], a[200:203], v[72:75]
    v_max_f32 v83, 0, v83
    v_max_f32 v84, 0, v84
    v_max_f32 v85, 0, v85
    v_mfma_f32_16x16x32_bf16 v[64:67], v[216:219], a[204:207], v[64:67]
    ds_read_b128 a[192:195], v20 offset:32768
    v_max_f32 v86, 0, v86
    v_max_f32 v87, 0, v87
    v_mfma_f32_16x16x32_bf16 v[72:75], v[220:223], a[204:207], v[72:75]
    ds_read_b128 a[196:199], v21 offset:32768
    v_mul_f32 v80, v80, v88
    s_waitcnt lgkmcnt(6)
    v_mfma_f32_16x16x32_bf16 v[64:67], v[224:227], a[208:211], v[64:67]
    buffer_load_dwordx4 v45, s[20:23], s6 offen offset:2048 lds
    v_mul_f32 v81, v81, v89
    v_mfma_f32_16x16x32_bf16 v[72:75], v[228:231], a[208:211], v[72:75]
    ds_read_b128 a[200:203], v20 offset:34816
    v_mul_f32 v82, v82, v90
    v_mul_f32 v83, v83, v91
    v_mfma_f32_16x16x32_bf16 v[64:67], v[232:235], a[212:215], v[64:67]
    v_mul_f32 v84, v84, v92
    ds_read_b128 a[204:207], v21 offset:34816
    v_mul_f32 v85, v85, v93
    v_mfma_f32_16x16x32_bf16 v[72:75], v[236:239], a[212:215], v[72:75]
    v_mul_f32 v86, v86, v94
    v_mul_f32 v87, v87, v95
    s_waitcnt lgkmcnt(4)
    v_mfma_f32_16x16x32_bf16 v[64:67], v[240:243], a[216:219], v[64:67]
    v_cvt_pk_bf16_f32 v56, v80, v81
    v_cvt_pk_bf16_f32 v57, v82, v83
    v_cvt_pk_bf16_f32 v58, v84, v85
    v_mfma_f32_16x16x32_bf16 v[72:75], v[244:247], a[216:219], v[72:75]
    buffer_load_dwordx4 v46, s[20:23], s6 offen offset:3072 lds
    v_cvt_pk_bf16_f32 v59, v86, v87
    v_permlane32_swap_b32 v56, v58
    v_mfma_f32_16x16x32_bf16 v[64:67], v[248:251], a[220:223], v[64:67]
    v_permlane32_swap_b32 v57, v59
    s_mov_b32 s50, 491520
    buffer_store_dwordx4 v[56:59], v12, s[28:31], s50 offen sc1
    v_mfma_f32_16x16x32_bf16 v[72:75], v[252:255], a[220:223], v[72:75]
    s_waitcnt lgkmcnt(2)
    v_mfma_f32_16x16x32_bf16 v[64:67], a[224:227], a[192:195], v[64:67]
    s_add_u32 m0, s71, 65536
    s_mul_i32 s6, s80, 40
    v_mfma_f32_16x16x32_bf16 v[72:75], a[228:231], a[192:195], v[72:75]
    v_mfma_f32_16x16x32_bf16 v[64:67], a[232:235], a[196:199], v[64:67]
    buffer_load_dwordx4 v11, s[20:23], s6 offen lds
    v_mfma_f32_16x16x32_bf16 v[72:75], a[236:239], a[196:199], v[72:75]
    s_waitcnt lgkmcnt(0)
    v_mfma_f32_16x16x32_bf16 v[64:67], a[240:243], a[200:203], v[64:67]
    v_mfma_f32_16x16x32_bf16 v[72:75], a[244:247], a[200:203], v[72:75]
    v_mfma_f32_16x16x32_bf16 v[64:67], a[248:251], a[204:207], v[64:67]
    v_mfma_f32_16x16x32_bf16 v[72:75], a[252:255], a[204:207], v[72:75]
    buffer_load_dwordx4 v44, s[20:23], s6 offen offset:1024 lds
    buffer_load_dwordx4 v45, s[20:23], s6 offen offset:2048 lds
    buffer_load_dwordx4 v46, s[20:23], s6 offen offset:3072 lds
    s_add_u32 m0, s71, 147456
    s_mul_i32 s6, s81, 40
    buffer_load_dwordx4 v11, s[20:23], s6 offen lds
    s_nop 0
    v_max_f32 v64, 0, v64
    v_max_f32 v65, 0, v65
    v_max_f32 v66, 0, v66
    v_max_f32 v67, 0, v67
    v_mul_f32 v64, v64, v72
    v_mul_f32 v65, v65, v73
    v_mul_f32 v66, v66, v74
    v_mul_f32 v67, v67, v75
    v_cvt_pk_bf16_f32 v52, v64, v65
    v_cvt_pk_bf16_f32 v53, v66, v67
    s_nop 0
    v_permlane32_swap_b32 v52, v54
    v_permlane32_swap_b32 v53, v55
    s_mov_b32 s50, 589824
    s_mov_b32 exec_hi, 0
    buffer_store_dwordx4 v[52:55], v12, s[28:31], s50 offen sc1
    s_mov_b32 exec_hi, -1
    s_barrier
    buffer_load_dwordx4 v44, s[20:23], s6 offen offset:1024 lds
    buffer_load_dwordx4 v45, s[20:23], s6 offen offset:2048 lds
    buffer_load_dwordx4 v46, s[20:23], s6 offen offset:3072 lds
    s_waitcnt vmcnt(18)
    ds_read_b64_tr_b16 a[80:81], v30 offset:0
    ds_read_b64_tr_b16 a[82:83], v30 offset:1024
    ds_read_b64_tr_b16 a[84:85], v31 offset:0
    ds_read_b64_tr_b16 a[86:87], v31 offset:1024
    ds_read_b64_tr_b16 a[88:89], v32 offset:0
    ds_read_b64_tr_b16 a[90:91], v32 offset:1024
    ds_read_b64_tr_b16 a[92:93], v33 offset:0
    ds_read_b64_tr_b16 a[94:95], v33 offset:1024
    s_waitcnt vmcnt(14)
    ds_read_b64_tr_b16 a[96:97], v30 offset:32768
    ds_read_b64_tr_b16 a[98:99], v30 offset:33792
    ds_read_b64_tr_b16 a[100:101], v31 offset:32768
    ds_read_b64_tr_b16 a[102:103], v31 offset:33792
    ds_read_b64_tr_b16 a[104:105], v32 offset:32768
    ds_read_b64_tr_b16 a[106:107], v32 offset:33792
    ds_read_b64_tr_b16 a[108:109], v33 offset:32768
    ds_read_b64_tr_b16 a[110:111], v33 offset:33792
    s_waitcnt vmcnt(10)
    ds_read_b64_tr_b16 a[112:113], v30 offset:16384
    ds_read_b64_tr_b16 a[114:115], v30 offset:17408
    ds_read_b64_tr_b16 a[116:117], v31 offset:16384
    ds_read_b64_tr_b16 a[118:119], v31 offset:17408
    ds_read_b64_tr_b16 a[120:121], v32 offset:16384
    ds_read_b64_tr_b16 a[122:123], v32 offset:17408
    ds_read_b64_tr_b16 a[124:125], v33 offset:16384
    ds_read_b64_tr_b16 a[126:127], v33 offset:17408
    s_add_u32 m0, s71, 49152
    s_mul_i32 s6, s82, 40
    buffer_load_dwordx4 v11, s[20:23], s6 offen lds
    buffer_load_dwordx4 v44, s[20:23], s6 offen offset:1024 lds
    s_load_dword s52, s[0:1], s36
    s_load_dword s53, s[0:1], s36 offset:512
    s_load_dword s54, s[0:1], s36 offset:1024
    s_load_dword s55, s[0:1], s36 offset:1536
    s_load_dword s56, s[0:1], s36 offset:2048
    s_load_dword s57, s[0:1], s36 offset:2560
    buffer_load_dwordx4 v45, s[20:23], s6 offen offset:2048 lds
    buffer_load_dwordx4 v46, s[20:23], s6 offen offset:3072 lds
    s_waitcnt vmcnt(9)
    ds_read_b64_tr_b16 a[128:129], v60 offset:32768
    ds_read_b64_tr_b16 a[130:131], v60 offset:33792
    ds_read_b64_tr_b16 a[132:133], v61 offset:32768
    ds_read_b64_tr_b16 a[134:135], v61 offset:33792
    ds_read_b64_tr_b16 a[136:137], v62 offset:32768
    ds_read_b64_tr_b16 a[138:139], v62 offset:33792
    ds_read_b64_tr_b16 a[140:141], v63 offset:32768
    ds_read_b64_tr_b16 a[142:143], v63 offset:33792
    s_add_u32 m0, s71, 81920
    s_mul_i32 s6, s83, 40
    buffer_load_dwordx4 v11, s[20:23], s6 offen lds
    buffer_load_dwordx4 v44, s[20:23], s6 offen offset:1024 lds
    buffer_load_dwordx4 v45, s[20:23], s6 offen offset:2048 lds
    s_waitcnt lgkmcnt(0)
    s_waitcnt vmcnt(10)
    s_barrier
    s_cmp_lg_u32 s3, 0
    s_cbranch_scc1 L_A_pub2
    s_atomic_add s47, s[28:29], s51 offset:256
L_A_pub2:
    buffer_load_dwordx4 v46, s[20:23], s6 offen offset:3072 lds
    v_add_u32 v1, s84, v13
    s_xor_b64 s[52:53], s[52:53], s[48:49]
    s_xor_b64 s[54:55], s[54:55], s[48:49]
    s_or_b64 s[52:53], s[52:53], s[54:55]
    s_xor_b64 s[56:57], s[56:57], s[48:49]
    s_or_b64 s[52:53], s[52:53], s[56:57]
    s_cbranch_scc1 L_A_chk0
L_A_chk0_back:
    s_load_dword s58, s[0:1], s37
    s_load_dword s59, s[0:1], s37 offset:512
    s_load_dword s60, s[0:1], s37 offset:1024
    s_load_dword s61, s[0:1], s37 offset:1536
    s_load_dword s62, s[0:1], s37 offset:2048
    s_load_dword s63, s[0:1], s37 offset:2560
    s_waitcnt vmcnt(8)
    ds_read_b64_tr_b16 a[144:145], v30 offset:49152
    ds_read_b64_tr_b16 a[146:147], v30 offset:50176
    ds_read_b64_tr_b16 a[148:149], v31 offset:49152
    ds_read_b64_tr_b16 a[150:151], v31 offset:50176
    ds_read_b64_tr_b16 a[152:153], v32 offset:49152
    ds_read_b64_tr_b16 a[154:155], v32 offset:50176
    ds_read_b64_tr_b16 a[156:157], v33 offset:49152
    ds_read_b64_tr_b16 a[158:159], v33 offset:50176
    buffer_load_dwordx4 v[128:131], v1, s[28:31], s72 offen sc1
    buffer_load_dwordx4 v[132:135], v1, s[28:31], s73 offen sc1
    buffer_load_dwordx4 v[136:139], v1, s[28:31], s74 offen sc1
    buffer_load_dwordx4 v[140:143], v1, s[28:31], s75 offen sc1
    s_waitcnt vmcnt(8)
    ds_read_b64_tr_b16 a[160:161], v60 offset:16384
    ds_read_b64_tr_b16 a[162:163], v60 offset:17408
    ds_read_b64_tr_b16 a[164:165], v61 offset:16384
    ds_read_b64_tr_b16 a[166:167], v61 offset:17408
    ds_read_b64_tr_b16 a[168:169], v62 offset:16384
    ds_read_b64_tr_b16 a[170:171], v62 offset:17408
    ds_read_b64_tr_b16 a[172:173], v63 offset:16384
    ds_read_b64_tr_b16 a[174:175], v63 offset:17408
    buffer_load_dwordx4 v[144:147], v1, s[28:31], s76 offen sc1
    buffer_load_dwordx4 v[148:151], v1, s[28:31], s77 offen sc1
    buffer_load_dwordx4 v[152:155], v1, s[28:31], s78 offen sc1
    buffer_load_dwordx4 v[156:159], v1, s[28:31], s79 offen sc1
    s_waitcnt vmcnt(8)
    ds_read_b64_tr_b16 a[176:177], v60 offset:49152
    ds_read_b64_tr_b16 a[178:179], v60 offset:50176
    ds_read_b64_tr_b16 a[180:181], v61 offset:49152
    ds_read_b64_tr_b16 a[182:183], v61 offset:50176
    ds_read_b64_tr_b16 a[184:185], v62 offset:49152
    ds_read_b64_tr_b16 a[186:187], v62 offset:50176
    ds_read_b64_tr_b16 a[188:189], v63 offset:49152
    ds_read_b64_tr_b16 a[190:191], v63 offset:50176
    buffer_load_dwordx4 v[160:163], v1, s[28:31], s80 offen sc1
    buffer_load_dwordx4 v[164:167], v1, s[28:31], s81 offen sc1
    s_waitcnt vmcnt(9)
    v_mfma_f32_16x16x32_bf16 v[96:99], a[0:3], v[128:131], 0
    v_mfma_f32_16x16x32_bf16 v[100:103], a[4:7], v[128:131], 0
    buffer_load_dwordx4 v[168:171], v1, s[28:31], s82 offen sc1
    v_mfma_f32_16x16x32_bf16 v[104:107], a[8:11], v[128:131], 0
    v_mfma_f32_16x16x32_bf16 v[108:111], a[12:15], v[128:131], 0
    s_waitcnt lgkmcnt(0)
    s_waitcnt vmcnt(9)
    v_mfma_f32_16x16x32_bf16 v[96:99], a[16:19], v[132:135], v[96:99]
    v_add_u32 v2, s85, v13
    s_xor_b64 s[58:59], s[58:59], s[48:49]
    v_mfma_f32_16x16x32_bf16 v[100:103], a[20:23], v[132:135], v[100:103]
    buffer_load_dwordx4 v[172:175], v1, s[28:31], s83 offen sc1
    s_xor_b64 s[60:61], s[60:61], s[48:49]
    v_mfma_f32_16x16x32_bf16 v[104:107], a[24:27], v[132:135], v[104:107]
    s_or_b64 s[58:59], s[58:59], s[60:61]
    s_xor_b64 s[62:63], s[62:63], s[48:49]
    v_mfma_f32_16x16x32_bf16 v[108:111], a[28:31], v[132:135], v[108:111]
    s_waitcnt vmcnt(9)
    v_mfma_f32_16x16x32_bf16 v[96:99], a[32:35], v[136:139], v[96:99]
    s_or_b64 s[58:59], s[58:59], s[62:63]
    s_cbranch_scc1 L_A_chk1
L_A_chk1_back:
    v_mfma_f32_16x16x32_bf16 v[100:103], a[36:39], v[136:139], v[100:103]
    buffer_load_dwordx4 v[176:179], v2, s[28:31], s72 offen sc1
    s_load_dword s64, s[0:1], s38
    v_mfma_f32_16x16x32_bf16 v[104:107], a[40:43], v[136:139], v[104:107]
    s_load_dword s65, s[0:1], s38 offset:512
    s_load_dword s66, s[0:1], s38 offset:1024
    v_mfma_f32_16x16x32_bf16 v[108:111], a[44:47], v[136:139], v[108:111]
    s_load_dword s67, s[0:1], s38 offset:1536
    s_waitcnt vmcnt(9)
    v_mfma_f32_16x16x32_bf16 v[96:99], a[48:51], v[140:143], v[96:99]
    s_load_dword s68, s[0:1], s38 offset:2048
    s_load_dword s69, s[0:1], s38 offset:2560
    v_mfma_f32_16x16x32_bf16 v[100:103], a[52:55], v[140:143], v[100:103]
    buffer_load_dwordx4 v[180:183], v2, s[28:31], s73 offen sc1
    v_mfma_f32_16x16x32_bf16 v[104:107], a[56:59], v[140:143], v[104:107]
    v_mfma_f32_16x16x32_bf16 v[108:111], a[60:63], v[140:143], v[108:111]
    s_waitcnt vmcnt(9)
    v_mfma_f32_16x16x32_bf16 v[96:99], a[64:67], v[144:147], v[96:99]
    v_mfma_f32_16x16x32_bf16 v[100:103], a[68:71], v[144:147], v[100:103]
    buffer_load_dwordx4 v[184:187], v2, s[28:31], s74 offen sc1
    v_mfma_f32_16x16x32_bf16 v[104:107], a[72:75], v[144:147], v[104:107]
    v_mfma_f32_16x16x32_bf16 v[108:111], a[76:79], v[144:147], v[108:111]
    s_waitcnt vmcnt(9)
    v_mfma_f32_16x16x32_bf16 v[96:99], a[80:83], v[148:151], v[96:99]
    v_mfma_f32_16x16x32_bf16 v[100:103], a[84:87], v[148:151], v[100:103]
    buffer_load_dwordx4 v[188:191], v2, s[28:31], s75 offen sc1
    v_mfma_f32_16x16x32_bf16 v[104:107], a[88:91], v[148:151], v[104:107]
    v_mfma_f32_16x16x32_bf16 v[108:111], a[92:95], v[148:151], v[108:111]
    s_waitcnt vmcnt(9)
    v_mfma_f32_16x16x32_bf16 v[96:99], a[96:99], v[152:155], v[96:99]
    v_mfma_f32_16x16x32_bf16 v[100:103], a[100:103], v[152:155], v[100:103]
    buffer_load_dwordx4 v[192:195], v2, s[28:31], s76 offen sc1
    v_mfma_f32_16x16x32_bf16 v[104:107], a[104:107], v[152:155], v[104:107]
    v_mfma_f32_16x16x32_bf16 v[108:111], a[108:111], v[152:155], v[108:111]
    s_waitcnt vmcnt(9)
    v_mfma_f32_16x16x32_bf16 v[96:99], a[112:115], v[156:159], v[96:99]
    v_mfma_f32_16x16x32_bf16 v[100:103], a[116:119], v[156:159], v[100:103]
    buffer_load_dwordx4 v[196:199], v2, s[28:31], s77 offen sc1
    v_mfma_f32_16x16x32_bf16 v[104:107], a[120:123], v[156:159], v[104:107]
    v_mfma_f32_16x16x32_bf16 v[108:111], a[124:127], v[156:159], v[108:111]
    s_waitcnt vmcnt(9)
    v_mfma_f32_16x16x32_bf16 v[96:99], a[128:131], v[160:163], v[96:99]
    v_mfma_f32_16x16x32_bf16 v[100:103], a[132:135], v[160:163], v[100:103]
    buffer_load_dwordx4 v[200:203], v2, s[28:31], s78 offen sc1
    v_mfma_f32_16x16x32_bf16 v[104:107], a[136:139], v[160:163], v[104:107]
    v_mfma_f32_16x16x32_bf16 v[108:111], a[140:143], v[160:163], v[108:111]
    s_waitcnt vmcnt(9)
    v_mfma_f32_16x16x32_bf16 v[96:99], a[144:147], v[164:167], v[96:99]
    v_mfma_f32_16x16x32_bf16 v[100:103], a[148:151], v[164:167], v[100:103]
    buffer_load_dwordx4 v[204:207], v2, s[28:31], s79 offen sc1
    v_mfma_f32_16x16x32_bf16 v[104:107], a[152:155], v[164:167], v[104:107]
    v_mfma_f32_16x16x32_bf16 v[108:111], a[156:159], v[164:167], v[108:111]
    s_waitcnt vmcnt(9)
    v_mfma_f32_16x16x32_bf16 v[96:99], a[160:163], v[168:171], v[96:99]
    v_mfma_f32_16x16x32_bf16 v[100:103], a[164:167], v[168:171], v[100:103]
    buffer_load_dwordx4 v[208:211], v2, s[28:31], s80 offen sc1
    v_mfma_f32_16x16x32_bf16 v[104:107], a[168:171], v[168:171], v[104:107]
    v_mfma_f32_16x16x32_bf16 v[108:111], a[172:175], v[168:171], v[108:111]
    s_waitcnt vmcnt(9)
    v_mfma_f32_16x16x32_bf16 v[96:99], a[176:179], v[172:175], v[96:99]
    v_mfma_f32_16x16x32_bf16 v[100:103], a[180:183], v[172:175], v[100:103]
    buffer_load_dwordx4 v[212:215], v2, s[28:31], s81 offen sc1
    v_mfma_f32_16x16x32_bf16 v[104:107], a[184:187], v[172:175], v[104:107]
    v_mfma_f32_16x16x32_bf16 v[108:111], a[188:191], v[172:175], v[108:111]
    s_waitcnt vmcnt(9)
    v_mfma_f32_16x16x32_bf16 v[112:115], a[0:3], v[176:179], 0
    v_mfma_f32_16x16x32_bf16 v[116:119], a[4:7], v[176:179], 0
    buffer_load_dwordx4 v[216:219], v2, s[28:31], s82 offen sc1
    v_mfma_f32_16x16x32_bf16 v[120:123], a[8:11], v[176:179], 0
    v_mfma_f32_16x16x32_bf16 v[124:127], a[12:15], v[176:179], 0
    s_waitcnt lgkmcnt(0)
    s_waitcnt vmcnt(9)
    v_mfma_f32_16x16x32_bf16 v[112:115], a[16:19], v[180:183], v[112:115]
    v_add_u32 v3, s86, v13
    s_xor_b64 s[64:65], s[64:65], s[48:49]
    v_mfma_f32_16x16x32_bf16 v[116:119], a[20:23], v[180:183], v[116:119]
    buffer_load_dwordx4 v[220:223], v2, s[28:31], s83 offen sc1
    s_xor_b64 s[66:67], s[66:67], s[48:49]
    v_mfma_f32_16x16x32_bf16 v[120:123], a[24:27], v[180:183], v[120:123]
    s_or_b64 s[64:65], s[64:65], s[66:67]
    s_xor_b64 s[68:69], s[68:69], s[48:49]
    v_mfma_f32_16x16x32_bf16 v[124:127], a[28:31], v[180:183], v[124:127]
    s_waitcnt vmcnt(9)
    v_mfma_f32_16x16x32_bf16 v[112:115], a[32:35], v[184:187], v[112:115]
    s_or_b64 s[64:65], s[64:65], s[68:69]
    s_cbranch_scc1 L_A_chk2
L_A_chk2_back:
    v_mfma_f32_16x16x32_bf16 v[116:119], a[36:39], v[184:187], v[116:119]
    buffer_load_dwordx4 v[224:227], v3, s[28:31], s72 offen sc1
    s_load_dword s52, s[0:1], s39
    v_mfma_f32_16x16x32_bf16 v[120:123], a[40:43], v[184:187], v[120:123]
    s_load_dword s53, s[0:1], s39 offset:512
    s_load_dword s54, s[0:1], s39 offset:1024
    v_mfma_f32_16x16x32_bf16 v[124:127], a[44:47], v[184:187], v[124:127]
L_A_w3_0:
    s_cbranch_execz L_A_w3_1
    s_load_dword s55, s[0:1], s39 offset:1536
    s_waitcnt vmcnt(9)
    v_mfma_f32_16x16x32_bf16 v[112:115], a[48:51], v[188:191], v[112:115]
    s_load_dword s56, s[0:1], s39 offset:2048
    s_load_dword s57, s[0:1], s39 offset:2560
    v_mfma_f32_16x16x32_bf16 v[116:119], a[52:55], v[188:191], v[116:119]
    buffer_load_dwordx4 v[228:231], v3, s[28:31], s73 offen sc1
    v_mfma_f32_16x16x32_bf16 v[120:123], a[56:59], v[188:191], v[120:123]
L_A_w3_1:
    s_cbranch_execz L_hopped
    v_mfma_f32_16x16x32_bf16 v[124:127], a[60:63], v[188:191], v[124:127]
    s_waitcnt vmcnt(9)
    v_mfma_f32_16x16x32_bf16 v[112:115], a[64:67], v[192:195], v[112:115]
    v_mfma_f32_16x16x32_bf16 v[116:119], a[68:71], v[192:195], v[116:119]
    buffer_load_dwordx4 v[232:235], v3, s[28:31], s74 offen sc1
    v_mfma_f32_16x16x32_bf16 v[120:123], a[72:75], v[192:195], v[120:123]
    v_mfma_f32_16x16x32_bf16 v[124:127], a[76:79], v[192:195], v[124:127]
    s_waitcnt vmcnt(9)
    v_mfma_f32_16x16x32_bf16 v[112:115], a[80:83], v[196:199], v[112:115]
    ds_write_b64 v34, v[96:97] offset:0
    v_mfma_f32_16x16x32_bf16 v[116:119], a[84:87], v[196:199], v[116:119]
    buffer_load_dwordx4 v[236:239], v3, s[28:31], s75 offen sc1
    v_mfma_f32_16x16x32_bf16 v[120:123], a[88:91], v[196:199], v[120:123]
    ds_write_b64 v34, v[98:99] offset:8
    v_mfma_f32_16x16x32_bf16 v[124:127], a[92:95], v[196:199], v[124:127]
    s_waitcnt vmcnt(9)
    v_mfma_f32_16x16x32_bf16 v[112:115], a[96:99], v[200:203], v[112:115]
    ds_write_b64 v35, v[100:101] offset:0
    v_mfma_f32_16x16x32_bf16 v[116:119], a[100:103], v[200:203], v[116:119]
    buffer_load_dwordx4 v[240:243], v3, s[28:31], s76 offen sc1
    v_mfma_f32_16x16x32_bf16 v[120:123], a[104:107], v[200:203], v[120:123]
    ds_write_b64 v35, v[102:103] offset:8
    v_mfma_f32_16x16x32_bf16 v[124:127], a[108:111], v[200:203], v[124:127]
    s_waitcnt vmcnt(9)
    v_mfma_f32_16x16x32_bf16 v[112:115], a[112:115], v[204:207], v[112:115]
    ds_write_b64 v36, v[104:105] offset:0
    v_mfma_f32_16x16x32_bf16 v[116:119], a[116:119], v[204:207], v[116:119]
    buffer_load_dwordx4 v[244:247], v3, s[28:31], s77 offen sc1
    v_mfma_f32_16x16x32_bf16 v[120:123], a[120:123], v[204:207], v[120:123]
    ds_write_b64 v36, v[106:107] offset:8
    v_mfma_f32_16x16x32_bf16 v[124:127], a[124:127], v[204:207], v[124:127]
    s_waitcnt vmcnt(9)
    v_mfma_f32_16x16x32_bf16 v[112:115], a[128:131], v[208:211], v[112:115]
    ds_write_b64 v37, v[108:109] offset:0
    v_mfma_f32_16x16x32_bf16 v[116:119], a[132:135], v[208:211], v[116:119]
    buffer_load_dwordx4 v[248:251], v3, s[28:31], s78 offen sc1
    v_mfma_f32_16x16x32_bf16 v[120:123], a[136:139], v[208:211], v[120:123]
    ds_write_b64 v37, v[110:111] offset:8
    v_mfma_f32_16x16x32_bf16 v[124:127], a[140:143], v[208:211], v[124:127]
    s_waitcnt vmcnt(9)
    v_mfma_f32_16x16x32_bf16 v[112:115], a[144:147], v[212:215], v[112:115]
    v_mfma_f32_16x16x32_bf16 v[116:119], a[148:151], v[212:215], v[116:119]
    buffer_load_dwordx4 v[252:255], v3, s[28:31], s79 offen sc1
    v_mfma_f32_16x16x32_bf16 v[120:123], a[152:155], v[212:215], v[120:123]
    v_mfma_f32_16x16x32_bf16 v[124:127], a[156:159], v[212:215], v[124:127]
    s_waitcnt vmcnt(9)
    v_mfma_f32_16x16x32_bf16 v[112:115], a[160:163], v[216:219], v[112:115]
    v_mfma_f32_16x16x32_bf16 v[116:119], a[164:167], v[216:219], v[116:119]
    buffer_load_dwordx4 a[192:195], v3, s[28:31], s80 offen sc1
    v_mfma_f32_16x16x32_bf16 v[120:123], a[168:171], v[216:219], v[120:123]
    v_mfma_f32_16x16x32_bf16 v[124:127], a[172:175], v[216:219], v[124:127]
    s_waitcnt vmcnt(9)
    v_mfma_f32_16x16x32_bf16 v[112:115], a[176:179], v[220:223], v[112:115]
    v_mfma_f32_16x16x32_bf16 v[116:119], a[180:183], v[220:223], v[116:119]
    buffer_load_dwordx4 a[196:199], v3, s[28:31], s81 offen sc1
    v_mfma_f32_16x16x32_bf16 v[120:123], a[184:187], v[220:223], v[120:123]
    v_mfma_f32_16x16x32_bf16 v[124:127], a[188:191], v[220:223], v[124:127]
    s_waitcnt vmcnt(9)
    v_mfma_f32_16x16x32_bf16 v[96:99], a[0:3], v[224:227], 0
    v_mfma_f32_16x16x32_bf16 v[100:103], a[4:7], v[224:227], 0
    buffer_load_dwordx4 a[200:203], v3, s[28:31], s82 offen sc1
    v_mfma_f32_16x16x32_bf16 v[104:107], a[8:11], v[224:227], 0
    v_mfma_f32_16x16x32_bf16 v[108:111], a[12:15], v[224:227], 0
    s_waitcnt lgkmcnt(0)
    s_waitcnt vmcnt(9)
    v_mfma_f32_16x16x32_bf16 v[96:99], a[16:19], v[228:231], v[96:99]
    v_add_u32 v4, s87, v13
    s_xor_b64 s[52:53], s[52:53], s[48:49]
    v_mfma_f32_16x16x32_bf16 v[100:103], a[20:23], v[228:231], v[100:103]
    buffer_load_dwordx4 a[204:207], v3, s[28:31], s83 offen sc1
    s_xor_b64 s[54:55], s[54:55], s[48:49]
    v_mfma_f32_16x16x32_bf16 v[104:107], a[24:27], v[228:231], v[104:107]
    s_or_b64 s[52:53], s[52:53], s[54:55]
    s_xor_b64 s[56:57], s[56:57], s[48:49]
    v_mfma_f32_16x16x32_bf16 v[108:111], a[28:31], v[228:231], v[108:111]
    s_waitcnt vmcnt(9)
    v_mfma_f32_16x16x32_bf16 v[96:99], a[32:35], v[232:235], v[96:99]
    s_or_b64 s[52:53], s[52:53], s[56:57]
    s_cbranch_scc1 L_A_chk3
L_A_chk3_back:
    v_mfma_f32_16x16x32_bf16 v[100:103], a[36:39], v[232:235], v[100:103]
    buffer_load_dwordx4 a[208:211], v4, s[28:31], s72 offen sc1
    s_load_dword s58, s[0:1], s40
    v_mfma_f32_16x16x32_bf16 v[104:107], a[40:43], v[232:235], v[104:107]
    s_load_dword s59, s[0:1], s40 offset:512
    s_load_dword s60, s[0:1], s40 offset:1024
    v_mfma_f32_16x16x32_bf16 v[108:111], a[44:47], v[232:235], v[108:111]
    s_load_dword s61, s[0:1], s40 offset:1536
    s_waitcnt vmcnt(9)
    v_mfma_f32_16x16x32_bf16 v[96:99], a[48:51], v[236:239], v[96:99]
    s_load_dword s62, s[0:1], s40 offset:2048
    s_load_dword s63, s[0:1], s40 offset:2560
    v_mfma_f32_16x16x32_bf16 v[100:103], a[52:55], v[236:239], v[100:103]
    buffer_load_dwordx4 a[212:215], v4, s[28:31], s73 offen sc1
    v_mfma_f32_16x16x32_bf16 v[104:107], a[56:59], v[236:239], v[104:107]
    v_mfma_f32_16x16x32_bf16 v[108:111], a[60:63], v[236:239], v[108:111]
    s_waitcnt vmcnt(9)
    v_mfma_f32_16x16x32_bf16 v[96:99], a[64:67], v[240:243], v[96:99]
    v_mfma_f32_16x16x32_bf16 v[100:103], a[68:71], v[240:243], v[100:103]
    buffer_load_dwordx4 a[216:219], v4, s[28:31], s74 offen sc1
    v_mfma_f32_16x16x32_bf16 v[104:107], a[72:75], v[240:243], v[104:107]
    v_mfma_f32_16x16x32_bf16 v[108:111], a[76:79], v[240:243], v[108:111]
    s_waitcnt vmcnt(9)
    v_mfma_f32_16x16x32_bf16 v[96:99], a[80:83], v[244:247], v[96:99]
    ds_write_b64 v34, v[112:113] offset:16384
    v_mfma_f32_16x16x32_bf16 v[100:103], a[84:87], v[244:247], v[100:103]
    buffer_load_dwordx4 a[220:223], v4, s[28:31], s75 offen sc1
    v_mfma_f32_16x16x32_bf16 v[104:107], a[88:91], v[244:247], v[104:107]
    ds_write_b64 v34, v[114:115] offset:16392
    v_mfma_f32_16x16x32_bf16 v[108:111], a[92:95], v[244:247], v[108:111]
    s_waitcnt vmcnt(9)
    v_mfma_f32_16x16x32_bf16 v[96:99], a[96:99], v[248:251], v[96:99]
    ds_write_b64 v35, v[116:117] offset:16384
    v_mfma_f32_16x16x32_bf16 v[100:103], a[100:103], v[248:251], v[100:103]
    buffer_load_dwordx4 a[224:227], v4, s[28:31], s76 offen sc1
    v_mfma_f32_16x16x32_bf16 v[104:107], a[104:107], v[248:251], v[104:107]
    ds_write_b64 v35, v[118:119] offset:16392
    v_mfma_f32_16x16x32_bf16 v[108:111], a[108:111], v[248:251], v[108:111]
    s_waitcnt vmcnt(9)
    v_mfma_f32_16x16x32_bf16 v[96:99], a[112:115], v[252:255], v[96:99]
    ds_write_b64 v36, v[120:121] offset:16384
    v_mfma_f32_16x16x32_bf16 v[100:103], a[116:119], v[252:255], v[100:103]
    buffer_load_dwordx4 a[228:231], v4, s[28:31], s77 offen sc1
    v_mfma_f32_16x16x32_bf16 v[104:107], a[120:123], v[252:255], v[104:107]
    ds_write_b64 v36, v[122:123] offset:16392
    v_mfma_f32_16x16x32_bf16 v[108:111], a[124:127], v[252:255], v[108:111]
    s_waitcnt vmcnt(9)
    v_mfma_f32_16x16x32_bf16 v[96:99], a[128:131], a[192:195], v[96:99]
    ds_write_b64 v37, v[124:125] offset:16384
    v_mfma_f32_16x16x32_bf16 v[100:103], a[132:135], a[192:195], v[100:103]
    buffer_load_dwordx4 a[232:235], v4, s[28:31], s78 offen sc1
    v_mfma_f32_16x16x32_bf16 v[104:107], a[136:139], a[192:195], v[104:107]
    ds_write_b64 v37, v[126:127] offset:16392
    v_mfma_f32_16x16x32_bf16 v[108:111], a[140:143], a[192:195], v[108:111]
    s_waitcnt vmcnt(9)
    v_mfma_f32_16x16x32_bf16 v[96:99], a[144:147], a[196:199], v[96:99]
    v_mfma_f32_16x16x32_bf16 v[100:103], a[148:151], a[196:199], v[100:103]
    buffer_load_dwordx4 a[236:239], v4, s[28:31], s79 offen sc1
    v_mfma_f32_16x16x32_bf16 v[104:107], a[152:155], a[196:199], v[104:107]
    s_waitcnt lgkmcnt(0)
    s_barrier
    v_mfma_f32_16x16x32_bf16 v[108:111], a[156:159], a[196:199], v[108:111]
    ds_read_b128 v[64:67], v38 offset:0
    s_waitcnt vmcnt(9)
    v_mfma_f32_16x16x32_bf16 v[96:99], a[160:163], a[200:203], v[96:99]
    ds_read_b128 v[68:71], v38 offset:4096
    ds_read_b128 v[72:75], v38 offset:8192
    v_mfma_f32_16x16x32_bf16 v[100:103], a[164:167], a[200:203], v[100:103]
    buffer_load_dwordx4 a[240:243], v4, s[28:31], s80 offen sc1
    ds_read_b128 v[76:79], v38 offset:12288
    v_mfma_f32_16x16x32_bf16 v[104:107], a[168:171], a[200:203], v[104:107]
    v_mfma_f32_16x16x32_bf16 v[108:111], a[172:175], a[200:203], v[108:111]
    s_waitcnt vmcnt(9)
    v_mfma_f32_16x16x32_bf16 v[96:99], a[176:179], a[204:207], v[96:99]
    v_mfma_f32_16x16x32_bf16 v[100:103], a[180:183], a[204:207], v[100:103]
    buffer_load_dwordx4 a[244:247], v4, s[28:31], s81 offen sc1
    s_waitcnt lgkmcnt(2)
    v_add_f32 v64, v64, v68
    v_mfma_f32_16x16x32_bf16 v[104:107], a[184:187], a[204:207], v[104:107]
    v_add_f32 v65, v65, v69
    v_add_f32 v66, v66, v70
    v_mfma_f32_16x16x32_bf16 v[108:111], a[188:191], a[204:207], v[108:111]
    v_add_f32 v67, v67, v71
    s_waitcnt vmcnt(9)
    v_mfma_f32_16x16x32_bf16 v[112:115], a[0:3], a[208:211], 0
    s_waitcnt lgkmcnt(0)
    v_add_f32 v72, v72, v76
    v_add_f32 v73, v73, v77
    v_mfma_f32_16x16x32_bf16 v[116:119], a[4:7], a[208:211], 0
    buffer_load_dwordx4 a[248:251], v4, s[28:31], s82 offen sc1
    v_add_f32 v74, v74, v78
    v_mfma_f32_16x16x32_bf16 v[120:123], a[8:11], a[208:211], 0
    v_add_f32 v75, v75, v79
    v_add_f32 v64, v64, v72
    v_mfma_f32_16x16x32_bf16 v[124:127], a[12:15], a[208:211], 0
    s_waitcnt lgkmcnt(0)
    s_waitcnt vmcnt(9)
    v_mfma_f32_16x16x32_bf16 v[112:115], a[16:19], a[212:215], v[112:115]
    v_add_u32 v5, s88, v13
    s_xor_b64 s[58:59], s[58:59], s[48:49]
    v_mfma_f32_16x16x32_bf16 v[116:119], a[20:23], a[212:215], v[116:119]
    buffer_load_dwordx4 a[252:255], v4, s[28:31], s83 offen sc1
    s_xor_b64 s[60:61], s[60:61], s[48:49]
    v_mfma_f32_16x16x32_bf16 v[120:123], a[24:27], a[212:215], v[120:123]
    s_or_b64 s[58:59], s[58:59], s[60:61]
    s_xor_b64 s[62:63], s[62:63], s[48:49]
    v_mfma_f32_16x16x32_bf16 v[124:127], a[28:31], a[212:215], v[124:127]
    v_add_f32 v65, v65, v73
    s_waitcnt vmcnt(9)
    v_mfma_f32_16x16x32_bf16 v[112:115], a[32:35], a[216:219], v[112:115]
    s_or_b64 s[58:59], s[58:59], s[62:63]
    s_cbranch_scc1 L_A_chk4
L_A_chk4_back:
    v_mfma_f32_16x16x32_bf16 v[116:119], a[36:39], a[216:219], v[116:119]
    buffer_load_dwordx4 v[128:131], v5, s[28:31], s72 offen sc1
    v_add_f32 v66, v66, v74
    v_mfma_f32_16x16x32_bf16 v[120:123], a[40:43], a[216:219], v[120:123]
    v_add_f32 v67, v67, v75
    v_cvt_pk_bf16_f32 v80, v64, v65
    v_mfma_f32_16x16x32_bf16 v[124:127], a[44:47], a[216:219], v[124:127]
    v_cvt_pk_bf16_f32 v81, v66, v67
    s_waitcnt vmcnt(9)
    v_mfma_f32_16x16x32_bf16 v[112:115], a[48:51], a[220:223], v[112:115]
    ds_read_b128 v[64:67], v38 offset:16384
    ds_read_b128 v[68:71], v38 offset:20480
    v_mfma_f32_16x16x32_bf16 v[116:119], a[52:55], a[220:223], v[116:119]
    buffer_load_dwordx4 v[132:135], v5, s[28:31], s73 offen sc1
    ds_read_b128 v[72:75], v38 offset:24576
    v_mfma_f32_16x16x32_bf16 v[120:123], a[56:59], a[220:223], v[120:123]
    ds_read_b128 v[76:79], v38 offset:28672
    v_mfma_f32_16x16x32_bf16 v[124:127], a[60:63], a[220:223], v[124:127]
    s_waitcnt vmcnt(9)
    v_mfma_f32_16x16x32_bf16 v[112:115], a[64:67], a[224:227], v[112:115]
    v_mfma_f32_16x16x32_bf16 v[116:119], a[68:71], a[224:227], v[116:119]
    buffer_load_dwordx4 v[136:139], v5, s[28:31], s74 offen sc1
    v_mfma_f32_16x16x32_bf16 v[120:123], a[72:75], a[224:227], v[120:123]
    s_waitcnt lgkmcnt(2)
    v_add_f32 v64, v64, v68
    v_add_f32 v65, v65, v69
    v_mfma_f32_16x16x32_bf16 v[124:127], a[76:79], a[224:227], v[124:127]
    v_add_f32 v66, v66, v70
    s_waitcnt vmcnt(9)
    v_mfma_f32_16x16x32_bf16 v[112:115], a[80:83], a[228:231], v[112:115]
    v_add_f32 v67, v67, v71
    s_waitcnt lgkmcnt(0)
    v_add_f32 v72, v72, v76
    v_mfma_f32_16x16x32_bf16 v[116:119], a[84:87], a[228:231], v[116:119]
    buffer_load_dwordx4 v[140:143], v5, s[28:31], s75 offen sc1
    v_add_f32 v73, v73, v77
    v_mfma_f32_16x16x32_bf16 v[120:123], a[88:91], a[228:231], v[120:123]
    v_add_f32 v74, v74, v78
    v_add_f32 v75, v75, v79
    v_mfma_f32_16x16x32_bf16 v[124:127], a[92:95], a[228:231], v[124:127]
    v_add_f32 v64, v64, v72
    s_waitcnt vmcnt(9)
    v_mfma_f32_16x16x32_bf16 v[112:115], a[96:99], a[232:235], v[112:115]
    v_add_f32 v65, v65, v73
    v_add_f32 v66, v66, v74
    v_mfma_f32_16x16x32_bf16 v[116:119], a[100:103], a[232:235], v[116:119]
    buffer_load_dwordx4 v[144:147], v5, s[28:31], s76 offen sc1
    v_add_f32 v67, v67, v75
    v_mfma_f32_16x16x32_bf16 v[120:123], a[104:107], a[232:235], v[120:123]
    v_cvt_pk_bf16_f32 v82, v64, v65
    v_cvt_pk_bf16_f32 v83, v66, v67
    v_mfma_f32_16x16x32_bf16 v[124:127], a[108:111], a[232:235], v[124:127]
    s_waitcnt vmcnt(9)
    v_mfma_f32_16x16x32_bf16 v[112:115], a[112:115], a[236:239], v[112:115]
    ds_write_b64 v34, v[96:97] offset:32768
    v_mfma_f32_16x16x32_bf16 v[116:119], a[116:119], a[236:239], v[116:119]
    buffer_load_dwordx4 v[148:151], v5, s[28:31], s77 offen sc1
    v_mfma_f32_16x16x32_bf16 v[120:123], a[120:123], a[236:239], v[120:123]
    ds_write_b64 v34, v[98:99] offset:32776
    v_mfma_f32_16x16x32_bf16 v[124:127], a[124:127], a[236:239], v[124:127]
    s_waitcnt vmcnt(9)
    v_mfma_f32_16x16x32_bf16 v[112:115], a[128:131], a[240:243], v[112:115]
    ds_write_b64 v35, v[100:101] offset:32768
    v_mfma_f32_16x16x32_bf16 v[116:119], a[132:135], a[240:243], v[116:119]
    buffer_load_dwordx4 v[152:155], v5, s[28:31], s78 offen sc1
    v_mfma_f32_16x16x32_bf16 v[120:123], a[136:139], a[240:243], v[120:123]
    ds_write_b64 v35, v[102:103] offset:32776
    v_mfma_f32_16x16x32_bf16 v[124:127], a[140:143], a[240:243], v[124:127]
    s_waitcnt vmcnt(9)
    v_mfma_f32_16x16x32_bf16 v[112:115], a[144:147], a[244:247], v[112:115]
    ds_write_b64 v36, v[104:105] offset:32768
    v_mfma_f32_16x16x32_bf16 v[116:119], a[148:151], a[244:247], v[116:119]
    buffer_load_dwordx4 v[156:159], v5, s[28:31], s79 offen sc1
    v_mfma_f32_16x16x32_bf16 v[120:123], a[152:155], a[244:247], v[120:123]
    ds_write_b64 v36, v[106:107] offset:32776
    v_mfma_f32_16x16x32_bf16 v[124:127], a[156:159], a[244:247], v[124:127]
    s_waitcnt vmcnt(9)
    v_mfma_f32_16x16x32_bf16 v[112:115], a[160:163], a[248:251], v[112:115]
    ds_write_b64 v37, v[108:109] offset:32768
    v_mfma_f32_16x16x32_bf16 v[116:119], a[164:167], a[248:251], v[116:119]
    buffer_load_dwordx4 v[160:163], v5, s[28:31], s80 offen sc1
    v_mfma_f32_16x16x32_bf16 v[120:123], a[168:171], a[248:251], v[120:123]
    ds_write_b64 v37, v[110:111] offset:32776
    v_mfma_f32_16x16x32_bf16 v[124:127], a[172:175], a[248:251], v[124:127]
    s_waitcnt vmcnt(9)
    v_mfma_f32_16x16x32_bf16 v[112:115], a[176:179], a[252:255], v[112:115]
    v_mfma_f32_16x16x32_bf16 v[116:119], a[180:183], a[252:255], v[116:119]
    buffer_load_dwordx4 v[164:167], v5, s[28:31], s81 offen sc1
    v_mfma_f32_16x16x32_bf16 v[120:123], a[184:187], a[252:255], v[120:123]
    s_waitcnt lgkmcnt(0)
    s_barrier
    v_mfma_f32_16x16x32_bf16 v[124:127], a[188:191], a[252:255], v[124:127]
    ds_read_b128 v[64:67], v38 offset:32768
    s_waitcnt vmcnt(9)
    v_mfma_f32_16x16x32_bf16 v[96:99], a[0:3], v[128:131], 0
    ds_read_b128 v[68:71], v38 offset:36864
    ds_read_b128 v[72:75], v38 offset:40960
    v_mfma_f32_16x16x32_bf16 v[100:103], a[4:7], v[128:131], 0
    buffer_load_dwordx4 v[168:171], v5, s[28:31], s82 offen sc1
    ds_read_b128 v[76:79], v38 offset:45056
    v_mfma_f32_16x16x32_bf16 v[104:107], a[8:11], v[128:131], 0
    v_mfma_f32_16x16x32_bf16 v[108:111], a[12:15], v[128:131], 0
    s_waitcnt vmcnt(9)
    v_mfma_f32_16x16x32_bf16 v[96:99], a[16:19], v[132:135], v[96:99]
    v_mfma_f32_16x16x32_bf16 v[100:103], a[20:23], v[132:135], v[100:103]
    buffer_load_dwordx4 v[172:175], v5, s[28:31], s83 offen sc1
    s_waitcnt lgkmcnt(2)
    v_add_f32 v64, v64, v68
    v_mfma_f32_16x16x32_bf16 v[104:107], a[24:27], v[132:135], v[104:107]
    v_add_f32 v65, v65, v69
    v_add_f32 v66, v66, v70
    v_mfma_f32_16x16x32_bf16 v[108:111], a[28:31], v[132:135], v[108:111]
    v_add_f32 v67, v67, v71
    s_waitcnt vmcnt(9)
    v_mfma_f32_16x16x32_bf16 v[96:99], a[32:35], v[136:139], v[96:99]
    s_waitcnt lgkmcnt(0)
    v_add_f32 v72, v72, v76
    v_add_f32 v73, v73, v77
    v_mfma_f32_16x16x32_bf16 v[100:103], a[36:39], v[136:139], v[100:103]
    v_add_f32 v74, v74, v78
    v_add_f32 v75, v75, v79
    v_mfma_f32_16x16x32_bf16 v[104:107], a[40:43], v[136:139], v[104:107]
    v_add_f32 v64, v64, v72
    v_add_f32 v65, v65, v73
    v_mfma_f32_16x16x32_bf16 v[108:111], a[44:47], v[136:139], v[108:111]
    v_add_f32 v66, v66, v74
    s_waitcnt vmcnt(8)
    v_mfma_f32_16x16x32_bf16 v[96:99], a[48:51], v[140:143], v[96:99]
    v_add_f32 v67, v67, v75
    v_cvt_pk_bf16_f32 v84, v64, v65
    v_mfma_f32_16x16x32_bf16 v[100:103], a[52:55], v[140:143], v[100:103]
    v_cvt_pk_bf16_f32 v85, v66, v67
    v_mfma_f32_16x16x32_bf16 v[104:107], a[56:59], v[140:143], v[104:107]
    ds_write_b64 v34, v[112:113] offset:49152
    v_mfma_f32_16x16x32_bf16 v[108:111], a[60:63], v[140:143], v[108:111]
    buffer_store_dwordx2 v[80:81], v17, s[24:27], s90 offen sc1
    s_waitcnt vmcnt(8)
    v_mfma_f32_16x16x32_bf16 v[96:99], a[64:67], v[144:147], v[96:99]
    ds_write_b64 v34, v[114:115] offset:49160
    v_mfma_f32_16x16x32_bf16 v[100:103], a[68:71], v[144:147], v[100:103]
    ds_write_b64 v35, v[116:117] offset:49152
    v_mfma_f32_16x16x32_bf16 v[104:107], a[72:75], v[144:147], v[104:107]
    ds_write_b64 v35, v[118:119] offset:49160
    v_mfma_f32_16x16x32_bf16 v[108:111], a[76:79], v[144:147], v[108:111]
    buffer_store_dwordx2 v[82:83], v17, s[24:27], s91 offen sc1
    s_waitcnt vmcnt(8)
    v_mfma_f32_16x16x32_bf16 v[96:99], a[80:83], v[148:151], v[96:99]
    ds_write_b64 v36, v[120:121] offset:49152
    v_mfma_f32_16x16x32_bf16 v[100:103], a[84:87], v[148:151], v[100:103]
    ds_write_b64 v36, v[122:123] offset:49160
    v_mfma_f32_16x16x32_bf16 v[104:107], a[88:91], v[148:151], v[104:107]
    ds_write_b64 v37, v[124:125] offset:49152
    v_mfma_f32_16x16x32_bf16 v[108:111], a[92:95], v[148:151], v[108:111]
    buffer_store_dwordx2 v[84:85], v17, s[24:27], s92 offen sc1
    s_waitcnt vmcnt(8)
    v_mfma_f32_16x16x32_bf16 v[96:99], a[96:99], v[152:155], v[96:99]
    ds_write_b64 v37, v[126:127] offset:49160
    v_mfma_f32_16x16x32_bf16 v[100:103], a[100:103], v[152:155], v[100:103]
    v_mfma_f32_16x16x32_bf16 v[104:107], a[104:107], v[152:155], v[104:107]
    v_mfma_f32_16x16x32_bf16 v[108:111], a[108:111], v[152:155], v[108:111]
    s_waitcnt vmcnt(7)
    v_mfma_f32_16x16x32_bf16 v[96:99], a[112:115], v[156:159], v[96:99]
    s_waitcnt lgkmcnt(0)
    s_barrier
    v_mfma_f32_16x16x32_bf16 v[100:103], a[116:119], v[156:159], v[100:103]
    ds_read_b128 v[64:67], v38 offset:49152
    ds_read_b128 v[68:71], v38 offset:53248
    v_mfma_f32_16x16x32_bf16 v[104:107], a[120:123], v[156:159], v[104:107]
    ds_read_b128 v[72:75], v38 offset:57344
    ds_read_b128 v[76:79], v38 offset:61440
    v_mfma_f32_16x16x32_bf16 v[108:111], a[124:127], v[156:159], v[108:111]
    s_waitcnt vmcnt(6)
    v_mfma_f32_16x16x32_bf16 v[96:99], a[128:131], v[160:163], v[96:99]
    v_mfma_f32_16x16x32_bf16 v[100:103], a[132:135], v[160:163], v[100:103]
    v_mfma_f32_16x16x32_bf16 v[104:107], a[136:139], v[160:163], v[104:107]
    s_waitcnt lgkmcnt(2)
    v_add_f32 v64, v64, v68
    v_add_f32 v65, v65, v69
    v_mfma_f32_16x16x32_bf16 v[108:111], a[140:143], v[160:163], v[108:111]
    v_add_f32 v66, v66, v70
    s_waitcnt vmcnt(5)
    v_mfma_f32_16x16x32_bf16 v[96:99], a[144:147], v[164:167], v[96:99]
    v_add_f32 v67, v67, v71
    s_waitcnt lgkmcnt(0)
    v_add_f32 v72, v72, v76
    v_mfma_f32_16x16x32_bf16 v[100:103], a[148:151], v[164:167], v[100:103]
    v_add_f32 v73, v73, v77
    v_add_f32 v74, v74, v78
    v_mfma_f32_16x16x32_bf16 v[104:107], a[152:155], v[164:167], v[104:107]
    v_add_f32 v75, v75, v79
    v_add_f32 v64, v64, v72
    v_mfma_f32_16x16x32_bf16 v[108:111], a[156:159], v[164:167], v[108:111]
    v_add_f32 v65, v65, v73
    s_waitcnt vmcnt(4)
    v_mfma_f32_16x16x32_bf16 v[96:99], a[160:163], v[168:171], v[96:99]
    v_add_f32 v66, v66, v74
    v_add_f32 v67, v67, v75
    s_waitcnt vmcnt(3)
    v_mfma_f32_16x16x32_bf16 v[96:99], a[176:179], v[172:175], v[96:99]
    v_cvt_pk_bf16_f32 v86, v64, v65
    v_cvt_pk_bf16_f32 v87, v66, v67
    v_mfma_f32_16x16x32_bf16 v[100:103], a[164:167], v[168:171], v[100:103]
    buffer_store_dwordx2 v[86:87], v17, s[24:27], s93 offen sc1
    v_mfma_f32_16x16x32_bf16 v[100:103], a[180:183], v[172:175], v[100:103]
    v_mfma_f32_16x16x32_bf16 v[104:107], a[168:171], v[168:171], v[104:107]
    v_mfma_f32_16x16x32_bf16 v[104:107], a[184:187], v[172:175], v[104:107]
    v_mfma_f32_16x16x32_bf16 v[108:111], a[172:175], v[168:171], v[108:111]
    ds_write_b128 v34, v[96:99] offset:0
    v_mfma_f32_16x16x32_bf16 v[108:111], a[188:191], v[172:175], v[108:111]
    s_nop 0
    s_nop 1
    ds_write_b128 v35, v[100:103] offset:0
    s_nop 0
    ds_write_b128 v36, v[104:107] offset:0
    s_nop 1
    ds_write_b128 v37, v[108:111] offset:0
    s_waitcnt lgkmcnt(0)
    s_barrier
    ds_read_b128 v[64:67], v38 offset:0
    ds_read_b128 v[68:71], v38 offset:4096
    ds_read_b128 v[72:75], v38 offset:8192
    ds_read_b128 v[76:79], v38 offset:12288
    s_waitcnt lgkmcnt(2)
    v_add_f32 v64, v64, v68
    v_add_f32 v65, v65, v69
    v_add_f32 v66, v66, v70
    v_add_f32 v67, v67, v71
    s_waitcnt lgkmcnt(0)
    v_add_f32 v72, v72, v76
    v_add_f32 v73, v73, v77
    v_add_f32 v74, v74, v78
    v_add_f32 v75, v75, v79
    v_add_f32 v64, v64, v72
    v_add_f32 v65, v65, v73
    v_add_f32 v66, v66, v74
    v_add_f32 v67, v67, v75
    v_cvt_pk_bf16_f32 v88, v64, v65
    v_cvt_pk_bf16_f32 v89, v66, v67
    buffer_store_dwordx2 v[88:89], v17, s[24:27], s94 offen nt
L_A_end:
    s_endpgm
L_A_tag:
    s_mov_b32 s96, 0
L_A_tag_loop:
    buffer_load_dword v48, v19, s[32:35], 0 offen sc1
    s_add_u32 s96, s96, 1
    s_waitcnt vmcnt(0)
    v_readfirstlane_b32 s48, v48
    s_nop 3
    s_cmp_lg_u32 s48, 0
    s_cbranch_scc1 L_A_tag_back
    s_cmp_lt_u32 s96, 40000
    s_cbranch_scc1 L_A_tag_loop
    s_branch L_A_tag_back
L_A_chk0:
    s_mov_b32 s96, 0
L_A_chk0_loop:
    buffer_load_dword v48, v50, s[28:31], s36 offen sc1
    s_add_u32 s96, s96, 1
    s_waitcnt vmcnt(0)
    v_cmp_ne_u32 vcc, s48, v48
    s_nop 1
    s_cmp_eq_u64 vcc, 0
    s_cbranch_scc1 L_A_chk0_back
    s_cmp_lt_u32 s96, 40000
    s_cbranch_scc1 L_A_chk0_loop
    s_branch L_A_chk0_back
L_A_chk1:
    s_mov_b32 s96, 0
L_A_chk1_loop:
    buffer_load_dword v48, v50, s[28:31], s37 offen sc1
    s_add_u32 s96, s96, 1
    s_waitcnt vmcnt(0)
    v_cmp_ne_u32 vcc, s48, v48
    s_nop 1
    s_cmp_eq_u64 vcc, 0
    s_cbranch_scc1 L_A_chk1_back
    s_cmp_lt_u32 s96, 40000
    s_cbranch_scc1 L_A_chk1_loop
    s_branch L_A_chk1_back
L_A_chk2:
    s_mov_b32 s96, 0
L_A_chk2_loop:
    buffer_load_dword v48, v50, s[28:31], s38 offen sc1
    s_add_u32 s96, s96, 1
    s_waitcnt vmcnt(0)
    v_cmp_ne_u32 vcc, s48, v48
    s_nop 1
    s_cmp_eq_u64 vcc, 0
    s_cbranch_scc1 L_A_chk2_back
    s_cmp_lt_u32 s96, 40000
    s_cbranch_scc1 L_A_chk2_loop
    s_branch L_A_chk2_back
L_A_chk3:
    s_mov_b32 s96, 0
L_A_chk3_loop:
    buffer_load_dword v48, v50, s[28:31], s39 offen sc1
    s_add_u32 s96, s96, 1
    s_waitcnt vmcnt(0)
    v_cmp_ne_u32 vcc, s48, v48
    s_nop 1
    s_cmp_eq_u64 vcc, 0
    s_cbranch_scc1 L_A_chk3_back
    s_cmp_lt_u32 s96, 40000
    s_cbranch_scc1 L_A_chk3_loop
    s_branch L_A_chk3_back
L_A_chk4:
    s_mov_b32 s96, 0
L_A_chk4_loop:
    buffer_load_dword v48, v50, s[28:31], s40 offen sc1
    s_add_u32 s96, s96, 1
    s_waitcnt vmcnt(0)
    v_cmp_ne_u32 vcc, s48, v48
    s_nop 1
    s_cmp_eq_u64 vcc, 0
    s_cbranch_scc1 L_A_chk4_back
    s_cmp_lt_u32 s96, 40000
    s_cbranch_scc1 L_A_chk4_loop
    s_branch L_A_chk4_back
.p2align 12
L_B_enter:
L_B_w0_0:
    s_cbranch_execz L_B_w0_1
    s_waitcnt vmcnt(8)
    s_barrier
    ds_read_b64_tr_b16 v[128:129], v28 offset:0
    ds_read_b64_tr_b16 v[130:131], v28 offset:512
    ds_read_b64_tr_b16 v[132:133], v28 offset:8192
    ds_read_b64_tr_b16 v[134:135], v28 offset:8704
    ds_read_b128 a[192:195], v20 offset:16384
    ds_read_b128 a[196:199], v20 offset:18432
    ds_read_b128 a[200:203], v20 offset:20480
L_B_w0_1:
    s_cbranch_execz L_hopped
    ds_read_b128 a[204:207], v20 offset:22528
    ds_read_b128 a[208:211], v20 offset:24576
    ds_read_b128 a[212:215], v20 offset:26624
    ds_read_b128 a[216:219], v20 offset:28672
    s_waitcnt lgkmcnt(6)
    v_mfma_f32_16x16x32_bf16 v[64:67], v[128:131], a[192:195], 0
    ds_read_b128 a[220:223], v20 offset:30720
    s_add_u32 m0, s7, 98304
    v_mfma_f32_16x16x32_bf16 v[72:75], v[132:135], a[192:195], 0
    s_mul_i32 s4, s62, 1536
    buffer_load_dwordx4 v9, s[12:15], s4 offen lds
    s_waitcnt lgkmcnt(6)
    v_mfma_f32_16x16x32_bf16 v[68:71], v[128:131], a[196:199], 0
    ds_read_b64_tr_b16 v[136:137], v28 offset:4096
    v_mfma_f32_16x16x32_bf16 v[76:79], v[132:135], a[196:199], 0
    ds_read_b64_tr_b16 v[138:139], v28 offset:4608
    s_waitcnt lgkmcnt(6)
    v_mfma_f32_16x16x32_bf16 v[80:83], v[128:131], a[200:203], 0
    ds_read_b64_tr_b16 v[140:141], v28 offset:12288
    v_mfma_f32_16x16x32_bf16 v[88:91], v[132:135], a[200:203], 0
    ds_read_b64_tr_b16 v[142:143], v28 offset:12800
    v_mfma_f32_16x16x32_bf16 v[84:87], v[128:131], a[204:207], 0
    ds_read_b128 a[192:195], v21 offset:16384
    v_mfma_f32_16x16x32_bf16 v[92:95], v[132:135], a[204:207], 0
    buffer_load_dwordx4 v42, s[12:15], s4 offen offset:1024 lds
    s_add_u32 m0, s7, 106496
    s_waitcnt lgkmcnt(7)
    v_mfma_f32_16x16x32_bf16 v[96:99], v[128:131], a[208:211], 0
    buffer_load_dwordx4 v10, s[16:19], s4 offen lds
    ds_read_b128 a[196:199], v21 offset:18432
    v_mfma_f32_16x16x32_bf16 v[104:107], v[132:135], a[208:211], 0
    buffer_load_dwordx4 v43, s[16:19], s4 offen offset:1024 lds
    v_mfma_f32_16x16x32_bf16 v[100:103], v[128:131], a[212:215], 0
    ds_read_b128 a[200:203], v21 offset:20480
    v_mfma_f32_16x16x32_bf16 v[108:111], v[132:135], a[212:215], 0
    ds_read_b128 a[204:207], v21 offset:22528
    s_add_u32 m0, s70, 114688
    s_waitcnt lgkmcnt(8)
    v_mfma_f32_16x16x32_bf16 v[112:115], v[128:131], a[216:219], 0
    buffer_load_dwordx4 v8, s[8:11], s62 offen lds
    v_mfma_f32_16x16x32_bf16 v[120:123], v[132:135], a[216:219], 0
    ds_read_b128 a[208:211], v21 offset:24576
    s_add_u32 m0, s70, 118784
    v_mfma_f32_16x16x32_bf16 v[116:119], v[128:131], a[220:223], 0
    buffer_load_dwordx4 v1, s[8:11], s62 offen lds
    v_mfma_f32_16x16x32_bf16 v[124:127], v[132:135], a[220:223], 0
    ds_read_b128 a[212:215], v21 offset:26624
    s_add_u32 m0, s70, 122880
    s_waitcnt lgkmcnt(4)
    v_mfma_f32_16x16x32_bf16 v[64:67], v[136:139], a[192:195], v[64:67]
    buffer_load_dwordx4 v2, s[8:11], s62 offen lds
    v_mfma_f32_16x16x32_bf16 v[72:75], v[140:143], a[192:195], v[72:75]
    ds_read_b128 a[216:219], v21 offset:28672
    s_add_u32 m0, s70, 126976
    v_mfma_f32_16x16x32_bf16 v[68:71], v[136:139], a[196:199], v[68:71]
    buffer_load_dwordx4 v3, s[8:11], s62 offen lds
    v_mfma_f32_16x16x32_bf16 v[76:79], v[140:143], a[196:199], v[76:79]
    ds_read_b128 a[220:223], v21 offset:30720
    s_waitcnt lgkmcnt(4)
    v_mfma_f32_16x16x32_bf16 v[80:83], v[136:139], a[200:203], v[80:83]
    s_waitcnt vmcnt(8)
    s_barrier
    ds_read_b64_tr_b16 v[144:145], v28 offset:32768
    v_mfma_f32_16x16x32_bf16 v[88:91], v[140:143], a[200:203], v[88:91]
    ds_read_b64_tr_b16 v[146:147], v28 offset:33280
    v_mfma_f32_16x16x32_bf16 v[84:87], v[136:139], a[204:207], v[84:87]
    ds_read_b64_tr_b16 v[148:149], v28 offset:40960
    v_mfma_f32_16x16x32_bf16 v[92:95], v[140:143], a[204:207], v[92:95]
    ds_read_b64_tr_b16 v[150:151], v28 offset:41472
    s_waitcnt lgkmcnt(6)
    v_mfma_f32_16x16x32_bf16 v[96:99], v[136:139], a[208:211], v[96:99]
    ds_read_b128 a[192:195], v20 offset:49152
    v_mfma_f32_16x16x32_bf16 v[104:107], v[140:143], a[208:211], v[104:107]
    ds_read_b128 a[196:199], v20 offset:51200
    s_add_u32 m0, s7, 65536
    s_mul_i32 s4, s63, 1536
    v_mfma_f32_16x16x32_bf16 v[100:103], v[136:139], a[212:215], v[100:103]
    buffer_load_dwordx4 v9, s[12:15], s4 offen lds
    v_mfma_f32_16x16x32_bf16 v[108:111], v[140:143], a[212:215], v[108:111]
    ds_read_b128 a[200:203], v20 offset:53248
    s_waitcnt lgkmcnt(7)
    v_mfma_f32_16x16x32_bf16 v[112:115], v[136:139], a[216:219], v[112:115]
    buffer_load_dwordx4 v42, s[12:15], s4 offen offset:1024 lds
    ds_read_b128 a[204:207], v20 offset:55296
    v_mfma_f32_16x16x32_bf16 v[120:123], v[140:143], a[216:219], v[120:123]
    ds_read_b128 a[208:211], v20 offset:57344
    s_add_u32 m0, s7, 73728
    v_mfma_f32_16x16x32_bf16 v[116:119], v[136:139], a[220:223], v[116:119]
    buffer_load_dwordx4 v10, s[16:19], s4 offen lds
    v_mfma_f32_16x16x32_bf16 v[124:127], v[140:143], a[220:223], v[124:127]
    ds_read_b128 a[212:215], v20 offset:59392
    s_waitcnt lgkmcnt(5)
    v_mfma_f32_16x16x32_bf16 v[64:67], v[144:147], a[192:195], v[64:67]
    ds_read_b64_tr_b16 v[152:153], v28 offset:36864
    v_mfma_f32_16x16x32_bf16 v[72:75], v[148:151], a[192:195], v[72:75]
    ds_read_b128 a[216:219], v20 offset:61440
    s_waitcnt lgkmcnt(6)
    v_mfma_f32_16x16x32_bf16 v[68:71], v[144:147], a[196:199], v[68:71]
    buffer_load_dwordx4 v43, s[16:19], s4 offen offset:1024 lds
    v_mfma_f32_16x16x32_bf16 v[76:79], v[148:151], a[196:199], v[76:79]
    ds_read_b64_tr_b16 v[154:155], v28 offset:37376
    s_waitcnt lgkmcnt(5)
    v_mfma_f32_16x16x32_bf16 v[80:83], v[144:147], a[200:203], v[80:83]
    ds_read_b128 a[220:223], v20 offset:63488
    v_mfma_f32_16x16x32_bf16 v[88:91], v[148:151], a[200:203], v[88:91]
    ds_read_b64_tr_b16 v[156:157], v28 offset:45056
    v_mfma_f32_16x16x32_bf16 v[84:87], v[144:147], a[204:207], v[84:87]
    ds_read_b128 a[192:195], v21 offset:49152
    s_add_u32 m0, s70, 81920
    v_mfma_f32_16x16x32_bf16 v[92:95], v[148:151], a[204:207], v[92:95]
    buffer_load_dwordx4 v8, s[8:11], s63 offen lds
    s_waitcnt lgkmcnt(6)
    v_mfma_f32_16x16x32_bf16 v[96:99], v[144:147], a[208:211], v[96:99]
    ds_read_b64_tr_b16 v[158:159], v28 offset:45568
    ds_read_b128 a[196:199], v21 offset:51200
    v_mfma_f32_16x16x32_bf16 v[104:107], v[148:151], a[208:211], v[104:107]
    ds_read_b128 a[200:203], v21 offset:53248
    s_add_u32 m0, s70, 86016
    v_mfma_f32_16x16x32_bf16 v[100:103], v[144:147], a[212:215], v[100:103]
    buffer_load_dwordx4 v1, s[8:11], s63 offen lds
    v_mfma_f32_16x16x32_bf16 v[108:111], v[148:151], a[212:215], v[108:111]
    ds_read_b128 a[204:207], v21 offset:55296
    s_waitcnt lgkmcnt(6)
    v_mfma_f32_16x16x32_bf16 v[112:115], v[144:147], a[216:219], v[112:115]
    ds_read_b128 a[208:211], v21 offset:57344
    s_add_u32 m0, s70, 90112
    v_mfma_f32_16x16x32_bf16 v[120:123], v[148:151], a[216:219], v[120:123]
    buffer_load_dwordx4 v2, s[8:11], s63 offen lds
    v_mfma_f32_16x16x32_bf16 v[116:119], v[144:147], a[220:223], v[116:119]
    ds_read_b128 a[212:215], v21 offset:59392
    v_mfma_f32_16x16x32_bf16 v[124:127], v[148:151], a[220:223], v[124:127]
    ds_read_b128 a[216:219], v21 offset:61440
    s_add_u32 m0, s70, 94208
    s_waitcnt lgkmcnt(5)
    v_mfma_f32_16x16x32_bf16 v[64:67], v[152:155], a[192:195], v[64:67]
    buffer_load_dwordx4 v3, s[8:11], s63 offen lds
    v_mfma_f32_16x16x32_bf16 v[72:75], v[156:159], a[192:195], v[72:75]
    ds_read_b128 a[220:223], v21 offset:63488
    v_mfma_f32_16x16x32_bf16 v[68:71], v[152:155], a[196:199], v[68:71]
    v_mfma_f32_16x16x32_bf16 v[76:79], v[156:159], a[196:199], v[76:79]
    s_waitcnt lgkmcnt(4)
    v_mfma_f32_16x16x32_bf16 v[80:83], v[152:155], a[200:203], v[80:83]
    s_waitcnt vmcnt(8)
    s_barrier
    ds_read_b64_tr_b16 v[160:161], v29 offset:32768
    v_mfma_f32_16x16x32_bf16 v[88:91], v[156:159], a[200:203], v[88:91]
    ds_read_b64_tr_b16 v[162:163], v29 offset:33280
    v_mfma_f32_16x16x32_bf16 v[84:87], v[152:155], a[204:207], v[84:87]
    ds_read_b64_tr_b16 v[164:165], v29 offset:40960
    v_mfma_f32_16x16x32_bf16 v[92:95], v[156:159], a[204:207], v[92:95]
    ds_read_b64_tr_b16 v[166:167], v29 offset:41472
    s_waitcnt lgkmcnt(6)
    v_mfma_f32_16x16x32_bf16 v[96:99], v[152:155], a[208:211], v[96:99]
    ds_read_b128 a[192:195], v24 offset:49152
    v_mfma_f32_16x16x32_bf16 v[104:107], v[156:159], a[208:211], v[104:107]
    ds_read_b128 a[196:199], v24 offset:51200
    s_add_u32 m0, s7, 0
    s_mul_i32 s4, s64, 1536
    v_mfma_f32_16x16x32_bf16 v[100:103], v[152:155], a[212:215], v[100:103]
    buffer_load_dwordx4 v9, s[12:15], s4 offen lds
    v_mfma_f32_16x16x32_bf16 v[108:111], v[156:159], a[212:215], v[108:111]
    ds_read_b128 a[200:203], v24 offset:53248
    s_waitcnt lgkmcnt(7)
    v_mfma_f32_16x16x32_bf16 v[112:115], v[152:155], a[216:219], v[112:115]
    buffer_load_dwordx4 v42, s[12:15], s4 offen offset:1024 lds
    ds_read_b128 a[204:207], v24 offset:55296
    v_mfma_f32_16x16x32_bf16 v[120:123], v[156:159], a[216:219], v[120:123]
    s_add_u32 m0, s7, 8192
    s_nop 0
    buffer_load_dwordx4 v10, s[16:19], s4 offen lds
    v_mfma_f32_16x16x32_bf16 v[116:119], v[152:155], a[220:223], v[116:119]
    ds_read_b128 a[208:211], v24 offset:57344
    v_mfma_f32_16x16x32_bf16 v[124:127], v[156:159], a[220:223], v[124:127]
    buffer_load_dwordx4 v43, s[16:19], s4 offen offset:1024 lds
    s_waitcnt lgkmcnt(4)
    v_mfma_f32_16x16x32_bf16 v[64:67], v[160:163], a[192:195], v[64:67]
    ds_read_b128 a[212:215], v24 offset:59392
    s_add_u32 m0, s70, 16384
    v_mfma_f32_16x16x32_bf16 v[72:75], v[164:167], a[192:195], v[72:75]
    buffer_load_dwordx4 v8, s[8:11], s64 offen lds
    s_waitcnt lgkmcnt(4)
    v_mfma_f32_16x16x32_bf16 v[68:71], v[160:163], a[196:199], v[68:71]
    ds_read_b64_tr_b16 v[168:169], v29 offset:36864
    v_mfma_f32_16x16x32_bf16 v[76:79], v[164:167], a[196:199], v[76:79]
    ds_read_b128 a[216:219], v24 offset:61440
    s_add_u32 m0, s70, 20480
    s_waitcnt lgkmcnt(4)
    v_mfma_f32_16x16x32_bf16 v[80:83], v[160:163], a[200:203], v[80:83]
    buffer_load_dwordx4 v1, s[8:11], s64 offen lds
    ds_read_b64_tr_b16 v[170:171], v29 offset:37376
    ds_read_b128 a[220:223], v24 offset:63488
    v_mfma_f32_16x16x32_bf16 v[88:91], v[164:167], a[200:203], v[88:91]
    s_add_u32 m0, s70, 24576
    s_nop 0
    buffer_load_dwordx4 v2, s[8:11], s64 offen lds
    v_mfma_f32_16x16x32_bf16 v[84:87], v[160:163], a[204:207], v[84:87]
    ds_read_b64_tr_b16 v[172:173], v29 offset:45056
    v_mfma_f32_16x16x32_bf16 v[92:95], v[164:167], a[204:207], v[92:95]
    ds_read_b128 a[192:195], v25 offset:49152
    s_add_u32 m0, s70, 28672
    s_waitcnt lgkmcnt(6)
    v_mfma_f32_16x16x32_bf16 v[96:99], v[160:163], a[208:211], v[96:99]
    ds_read_b64_tr_b16 v[174:175], v29 offset:45568
    ds_read_b128 a[196:199], v25 offset:51200
    v_mfma_f32_16x16x32_bf16 v[104:107], v[164:167], a[208:211], v[104:107]
    buffer_load_dwordx4 v3, s[8:11], s64 offen lds
    s_add_u32 m0, s71, 131072
    s_mul_i32 s6, s72, 40
    v_mfma_f32_16x16x32_bf16 v[100:103], v[160:163], a[212:215], v[100:103]
    buffer_load_dwordx4 v11, s[20:23], s6 offen lds
    v_mfma_f32_16x16x32_bf16 v[108:111], v[164:167], a[212:215], v[108:111]
    ds_read_b128 a[200:203], v25 offset:53248
    s_waitcnt lgkmcnt(5)
    v_mfma_f32_16x16x32_bf16 v[112:115], v[160:163], a[216:219], v[112:115]
    buffer_load_dwordx4 v44, s[20:23], s6 offen offset:1024 lds
    ds_read_b128 a[204:207], v25 offset:55296
    v_mfma_f32_16x16x32_bf16 v[120:123], v[164:167], a[216:219], v[120:123]
    buffer_load_dwordx4 v45, s[20:23], s6 offen offset:2048 lds
    v_mfma_f32_16x16x32_bf16 v[116:119], v[160:163], a[220:223], v[116:119]
    ds_read_b128 a[208:211], v25 offset:57344
    v_mfma_f32_16x16x32_bf16 v[124:127], v[164:167], a[220:223], v[124:127]
    ds_read_b128 a[212:215], v25 offset:59392
    s_waitcnt lgkmcnt(4)
    v_mfma_f32_16x16x32_bf16 v[64:67], v[168:171], a[192:195], v[64:67]
    buffer_load_dwordx4 v46, s[20:23], s6 offen offset:3072 lds
    s_add_u32 m0, s71, 147456
    s_mul_i32 s6, s73, 40
    v_mfma_f32_16x16x32_bf16 v[72:75], v[172:175], a[192:195], v[72:75]
    buffer_load_dwordx4 v11, s[20:23], s6 offen lds
    v_mfma_f32_16x16x32_bf16 v[68:71], v[168:171], a[196:199], v[68:71]
    ds_read_b128 a[216:219], v25 offset:61440
    v_mfma_f32_16x16x32_bf16 v[76:79], v[172:175], a[196:199], v[76:79]
    buffer_load_dwordx4 v44, s[20:23], s6 offen offset:1024 lds
    s_waitcnt lgkmcnt(3)
    v_mfma_f32_16x16x32_bf16 v[80:83], v[168:171], a[200:203], v[80:83]
    ds_read_b128 a[220:223], v25 offset:63488
    v_mfma_f32_16x16x32_bf16 v[88:91], v[172:175], a[200:203], v[88:91]
    buffer_load_dwordx4 v45, s[20:23], s6 offen offset:2048 lds
    s_waitcnt vmcnt(15)
    s_barrier
    v_mfma_f32_16x16x32_bf16 v[84:87], v[168:171], a[204:207], v[84:87]
    ds_read_b64_tr_b16 v[176:177], v29 offset:0
    v_mfma_f32_16x16x32_bf16 v[92:95], v[172:175], a[204:207], v[92:95]
    ds_read_b64_tr_b16 v[178:179], v29 offset:512
    s_waitcnt lgkmcnt(4)
    v_mfma_f32_16x16x32_bf16 v[96:99], v[168:171], a[208:211], v[96:99]
    ds_read_b64_tr_b16 v[180:181], v29 offset:8192
    ds_read_b64_tr_b16 v[182:183], v29 offset:8704
    ds_read_b128 a[192:195], v24 offset:16384
    v_mfma_f32_16x16x32_bf16 v[104:107], v[172:175], a[208:211], v[104:107]
    ds_read_b128 a[196:199], v24 offset:18432
    v_mfma_f32_16x16x32_bf16 v[100:103], v[168:171], a[212:215], v[100:103]
    buffer_load_dwordx4 v46, s[20:23], s6 offen offset:3072 lds
    s_add_u32 m0, s7, 32768
    s_mul_i32 s4, s65, 1536
    v_mfma_f32_16x16x32_bf16 v[108:111], v[172:175], a[212:215], v[108:111]
    buffer_load_dwordx4 v9, s[12:15], s4 offen lds
    s_waitcnt lgkmcnt(6)
    v_mfma_f32_16x16x32_bf16 v[112:115], v[168:171], a[216:219], v[112:115]
    ds_read_b128 a[200:203], v24 offset:20480
    buffer_load_dwordx4 v42, s[12:15], s4 offen offset:1024 lds
    ds_read_b128 a[204:207], v24 offset:22528
    v_mfma_f32_16x16x32_bf16 v[120:123], v[172:175], a[216:219], v[120:123]
    ds_read_b128 a[208:211], v24 offset:24576
    s_add_u32 m0, s7, 40960
    v_mfma_f32_16x16x32_bf16 v[116:119], v[168:171], a[220:223], v[116:119]
    buffer_load_dwordx4 v10, s[16:19], s4 offen lds
    v_mfma_f32_16x16x32_bf16 v[124:127], v[172:175], a[220:223], v[124:127]
    ds_read_b128 a[212:215], v24 offset:26624
    s_waitcnt lgkmcnt(5)
    v_mfma_f32_16x16x32_bf16 v[64:67], v[176:179], a[192:195], v[64:67]
    ds_read_b64_tr_b16 v[184:185], v29 offset:4096
    v_mfma_f32_16x16x32_bf16 v[72:75], v[180:183], a[192:195], v[72:75]
    ds_read_b128 a[216:219], v24 offset:28672
    s_waitcnt lgkmcnt(6)
    v_mfma_f32_16x16x32_bf16 v[68:71], v[176:179], a[196:199], v[68:71]
    buffer_load_dwordx4 v43, s[16:19], s4 offen offset:1024 lds
    v_mfma_f32_16x16x32_bf16 v[76:79], v[180:183], a[196:199], v[76:79]
    ds_read_b64_tr_b16 v[186:187], v29 offset:4608
    s_waitcnt lgkmcnt(5)
    v_mfma_f32_16x16x32_bf16 v[80:83], v[176:179], a[200:203], v[80:83]
    ds_read_b128 a[220:223], v24 offset:30720
    v_mfma_f32_16x16x32_bf16 v[88:91], v[180:183], a[200:203], v[88:91]
    ds_read_b64_tr_b16 v[188:189], v29 offset:12288
    v_mfma_f32_16x16x32_bf16 v[84:87], v[176:179], a[204:207], v[84:87]
    ds_read_b128 a[192:195], v25 offset:16384
    s_add_u32 m0, s70, 49152
    v_mfma_f32_16x16x32_bf16 v[92:95], v[180:183], a[204:207], v[92:95]
    buffer_load_dwordx4 v8, s[8:11], s65 offen lds
    s_waitcnt lgkmcnt(6)
    v_mfma_f32_16x16x32_bf16 v[96:99], v[176:179], a[208:211], v[96:99]
    ds_read_b64_tr_b16 v[190:191], v29 offset:12800
    ds_read_b128 a[196:199], v25 offset:18432
    v_mfma_f32_16x16x32_bf16 v[104:107], v[180:183], a[208:211], v[104:107]
    ds_read_b128 a[200:203], v25 offset:20480
    s_add_u32 m0, s70, 53248
    v_mfma_f32_16x16x32_bf16 v[100:103], v[176:179], a[212:215], v[100:103]
    buffer_load_dwordx4 v1, s[8:11], s65 offen lds
    v_mfma_f32_16x16x32_bf16 v[108:111], v[180:183], a[212:215], v[108:111]
    ds_read_b128 a[204:207], v25 offset:22528
    s_waitcnt lgkmcnt(6)
    v_mfma_f32_16x16x32_bf16 v[112:115], v[176:179], a[216:219], v[112:115]
    ds_read_b128 a[208:211], v25 offset:24576
    s_add_u32 m0, s70, 57344
    v_mfma_f32_16x16x32_bf16 v[120:123], v[180:183], a[216:219], v[120:123]
    buffer_load_dwordx4 v2, s[8:11], s65 offen lds
    v_mfma_f32_16x16x32_bf16 v[116:119], v[176:179], a[220:223], v[116:119]
    ds_read_b128 a[212:215], v25 offset:26624
    v_mfma_f32_16x16x32_bf16 v[124:127], v[180:183], a[220:223], v[124:127]
    ds_read_b128 a[216:219], v25 offset:28672
    s_add_u32 m0, s70, 61440
    s_waitcnt lgkmcnt(5)
    v_mfma_f32_16x16x32_bf16 v[64:67], v[184:187], a[192:195], v[64:67]
    buffer_load_dwordx4 v3, s[8:11], s65 offen lds
    v_mfma_f32_16x16x32_bf16 v[72:75], v[188:191], a[192:195], v[72:75]
    ds_read_b128 a[220:223], v25 offset:30720
    v_mfma_f32_16x16x32_bf16 v[68:71], v[184:187], a[196:199], v[68:71]
    v_mfma_f32_16x16x32_bf16 v[76:79], v[188:191], a[196:199], v[76:79]
    s_waitcnt lgkmcnt(4)
    v_mfma_f32_16x16x32_bf16 v[80:83], v[184:187], a[200:203], v[80:83]
    s_waitcnt vmcnt(16)
    s_barrier
    ds_read_b64_tr_b16 v[192:193], v28 offset:0
    v_mfma_f32_16x16x32_bf16 v[88:91], v[188:191], a[200:203], v[88:91]
    ds_read_b64_tr_b16 v[194:195], v28 offset:512
    v_mfma_f32_16x16x32_bf16 v[84:87], v[184:187], a[204:207], v[84:87]
    ds_read_b64_tr_b16 v[196:197], v28 offset:8192
    v_mfma_f32_16x16x32_bf16 v[92:95], v[188:191], a[204:207], v[92:95]
    ds_read_b64_tr_b16 v[198:199], v28 offset:8704
    s_waitcnt lgkmcnt(6)
    v_mfma_f32_16x16x32_bf16 v[96:99], v[184:187], a[208:211], v[96:99]
    ds_read_b128 a[192:195], v20 offset:16384
    v_mfma_f32_16x16x32_bf16 v[104:107], v[188:191], a[208:211], v[104:107]
    ds_read_b128 a[196:199], v20 offset:18432
    s_add_u32 m0, s7, 98304
    s_mul_i32 s4, s66, 1536
    v_mfma_f32_16x16x32_bf16 v[100:103], v[184:187], a[212:215], v[100:103]
    buffer_load_dwordx4 v9, s[12:15], s4 offen lds
    v_mfma_f32_16x16x32_bf16 v[108:111], v[188:191], a[212:215], v[108:111]
    ds_read_b128 a[200:203], v20 offset:20480
    s_waitcnt lgkmcnt(7)
    v_mfma_f32_16x16x32_bf16 v[112:115], v[184:187], a[216:219], v[112:115]
    buffer_load_dwordx4 v42, s[12:15], s4 offen offset:1024 lds
    ds_read_b128 a[204:207], v20 offset:22528
    v_mfma_f32_16x16x32_bf16 v[120:123], v[188:191], a[216:219], v[120:123]
    ds_read_b128 a[208:211], v20 offset:24576
    s_add_u32 m0, s7, 106496
    v_mfma_f32_16x16x32_bf16 v[116:119], v[184:187], a[220:223], v[116:119]
    buffer_load_dwordx4 v10, s[16:19], s4 offen lds
    v_mfma_f32_16x16x32_bf16 v[124:127], v[188:191], a[220:223], v[124:127]
    ds_read_b128 a[212:215], v20 offset:26624
    s_waitcnt lgkmcnt(5)
    v_mfma_f32_16x16x32_bf16 v[64:67], v[192:195], a[192:195], v[64:67]
    ds_read_b64_tr_b16 v[200:201], v28 offset:4096
    v_mfma_f32_16x16x32_bf16 v[72:75], v[196:199], a[192:195], v[72:75]
    ds_read_b128 a[216:219], v20 offset:28672
    s_waitcnt lgkmcnt(6)
    v_mfma_f32_16x16x32_bf16 v[68:71], v[192:195], a[196:199], v[68:71]
    buffer_load_dwordx4 v43, s[16:19], s4 offen offset:1024 lds
    v_mfma_f32_16x16x32_bf16 v[76:79], v[196:199], a[196:199], v[76:79]
    ds_read_b64_tr_b16 v[202:203], v28 offset:4608
    s_waitcnt lgkmcnt(5)
    v_mfma_f32_16x16x32_bf16 v[80:83], v[192:195], a[200:203], v[80:83]
    ds_read_b128 a[220:223], v20 offset:30720
    v_mfma_f32_16x16x32_bf16 v[88:91], v[196:199], a[200:203], v[88:91]
    ds_read_b64_tr_b16 v[204:205], v28 offset:12288
    v_mfma_f32_16x16x32_bf16 v[84:87], v[192:195], a[204:207], v[84:87]
    ds_read_b128 a[192:195], v21 offset:16384
    s_add_u32 m0, s70, 114688
    v_mfma_f32_16x16x32_bf16 v[92:95], v[196:199], a[204:207], v[92:95]
    buffer_load_dwordx4 v8, s[8:11], s66 offen lds
    s_waitcnt lgkmcnt(6)
    v_mfma_f32_16x16x32_bf16 v[96:99], v[192:195], a[208:211], v[96:99]
    ds_read_b64_tr_b16 v[206:207], v28 offset:12800
    ds_read_b128 a[196:199], v21 offset:18432
    v_mfma_f32_16x16x32_bf16 v[104:107], v[196:199], a[208:211], v[104:107]
    ds_read_b128 a[200:203], v21 offset:20480
    s_add_u32 m0, s70, 118784
    v_mfma_f32_16x16x32_bf16 v[100:103], v[192:195], a[212:215], v[100:103]
    buffer_load_dwordx4 v1, s[8:11], s66 offen lds
    v_mfma_f32_16x16x32_bf16 v[108:111], v[196:199], a[212:215], v[108:111]
    ds_read_b128 a[204:207], v21 offset:22528
    s_waitcnt lgkmcnt(6)
    v_mfma_f32_16x16x32_bf16 v[112:115], v[192:195], a[216:219], v[112:115]
    ds_read_b128 a[208:211], v21 offset:24576
    s_add_u32 m0, s70, 122880
    v_mfma_f32_16x16x32_bf16 v[120:123], v[196:199], a[216:219], v[120:123]
    buffer_load_dwordx4 v2, s[8:11], s66 offen lds
    v_mfma_f32_16x16x32_bf16 v[116:119], v[192:195], a[220:223], v[116:119]
    ds_read_b128 a[212:215], v21 offset:26624
    v_mfma_f32_16x16x32_bf16 v[124:127], v[196:199], a[220:223], v[124:127]
    ds_read_b128 a[216:219], v21 offset:28672
    s_add_u32 m0, s70, 126976
    s_waitcnt lgkmcnt(5)
    v_mfma_f32_16x16x32_bf16 v[64:67], v[200:203], a[192:195], v[64:67]
    buffer_load_dwordx4 v3, s[8:11], s66 offen lds
    v_mfma_f32_16x16x32_bf16 v[72:75], v[204:207], a[192:195], v[72:75]
    ds_read_b128 a[220:223], v21 offset:30720
    v_mfma_f32_16x16x32_bf16 v[68:71], v[200:203], a[196:199], v[68:71]
    v_mfma_f32_16x16x32_bf16 v[76:79], v[204:207], a[196:199], v[76:79]
    s_waitcnt lgkmcnt(4)
    v_mfma_f32_16x16x32_bf16 v[80:83], v[200:203], a[200:203], v[80:83]
    s_waitcnt vmcnt(8)
    s_barrier
    ds_read_b64_tr_b16 v[208:209], v28 offset:32768
    v_mfma_f32_16x16x32_bf16 v[88:91], v[204:207], a[200:203], v[88:91]
    ds_read_b64_tr_b16 v[210:211], v28 offset:33280
    v_mfma_f32_16x16x32_bf16 v[84:87], v[200:203], a[204:207], v[84:87]
    ds_read_b64_tr_b16 v[212:213], v28 offset:40960
    v_mfma_f32_16x16x32_bf16 v[92:95], v[204:207], a[204:207], v[92:95]
    ds_read_b64_tr_b16 v[214:215], v28 offset:41472
    s_waitcnt lgkmcnt(6)
    v_mfma_f32_16x16x32_bf16 v[96:99], v[200:203], a[208:211], v[96:99]
    ds_read_b128 a[192:195], v20 offset:49152
    v_mfma_f32_16x16x32_bf16 v[104:107], v[204:207], a[208:211], v[104:107]
    ds_read_b128 a[196:199], v20 offset:51200
    s_add_u32 m0, s7, 65536
    s_mul_i32 s4, s67, 1536
    v_mfma_f32_16x16x32_bf16 v[100:103], v[200:203], a[212:215], v[100:103]
    buffer_load_dwordx4 v9, s[12:15], s4 offen lds
    v_mfma_f32_16x16x32_bf16 v[108:111], v[204:207], a[212:215], v[108:111]
    ds_read_b128 a[200:203], v20 offset:53248
    s_waitcnt lgkmcnt(7)
    v_mfma_f32_16x16x32_bf16 v[112:115], v[200:203], a[216:219], v[112:115]
    ds_read_b128 a[204:207], v20 offset:55296
    v_mfma_f32_16x16x32_bf16 v[120:123], v[204:207], a[216:219], v[120:123]
    ds_read_b64_tr_b16 a[0:1], v30 offset:32768
    v_mfma_f32_16x16x32_bf16 v[116:119], v[200:203], a[220:223], v[116:119]
    ds_read_b64_tr_b16 a[2:3], v30 offset:33792
    v_mfma_f32_16x16x32_bf16 v[124:127], v[204:207], a[220:223], v[124:127]
    buffer_load_dwordx4 v42, s[12:15], s4 offen offset:1024 lds
    s_load_dword s48, s[32:33], 0
    s_waitcnt lgkmcnt(5)
    v_mfma_f32_16x16x32_bf16 v[64:67], v[208:211], a[192:195], v[64:67]
    ds_read_b128 a[208:211], v20 offset:57344
    ds_read_b64_tr_b16 a[4:5], v31 offset:32768
    ds_read_b64_tr_b16 a[6:7], v31 offset:33792
    s_add_u32 m0, s7, 73728
    s_nop 0
    buffer_load_dwordx4 v10, s[16:19], s4 offen lds
    ds_read_b128 a[212:215], v20 offset:59392
    v_mfma_f32_16x16x32_bf16 v[72:75], v[212:215], a[192:195], v[72:75]
    ds_read_b64_tr_b16 a[8:9], v32 offset:32768
    s_waitcnt lgkmcnt(9)
    v_mfma_f32_16x16x32_bf16 v[68:71], v[208:211], a[196:199], v[68:71]
    ds_read_b64_tr_b16 a[10:11], v32 offset:33792
    v_mfma_f32_16x16x32_bf16 v[76:79], v[212:215], a[196:199], v[76:79]
    ds_read_b64_tr_b16 v[216:217], v28 offset:36864
    s_waitcnt lgkmcnt(9)
    v_mfma_f32_16x16x32_bf16 v[80:83], v[208:211], a[200:203], v[80:83]
    ds_read_b128 a[216:219], v20 offset:61440
    ds_read_b64_tr_b16 a[12:13], v33 offset:32768
    ds_read_b64_tr_b16 a[14:15], v33 offset:33792
    buffer_load_dwordx4 v43, s[16:19], s4 offen offset:1024 lds
    ds_read_b64_tr_b16 v[218:219], v28 offset:37376
    ds_read_b128 a[220:223], v20 offset:63488
    v_mfma_f32_16x16x32_bf16 v[88:91], v[212:215], a[200:203], v[88:91]
    ds_read_b64_tr_b16 v[220:221], v28 offset:45056
    v_mfma_f32_16x16x32_bf16 v[84:87], v[208:211], a[204:207], v[84:87]
    ds_read_b128 a[192:195], v21 offset:49152
    v_mfma_f32_16x16x32_bf16 v[92:95], v[212:215], a[204:207], v[92:95]
    ds_read_b64_tr_b16 a[16:17], v30 offset:49152
    s_waitcnt lgkmcnt(11)
    v_mfma_f32_16x16x32_bf16 v[96:99], v[208:211], a[208:211], v[96:99]
    ds_read_b64_tr_b16 a[18:19], v30 offset:50176
    s_add_u32 m0, s70, 81920
    ds_read_b64_tr_b16 v[222:223], v28 offset:45568
    ds_read_b128 a[196:199], v21 offset:51200
    v_mfma_f32_16x16x32_bf16 v[104:107], v[212:215], a[208:211], v[104:107]
    ds_read_b64_tr_b16 a[20:21], v31 offset:49152
    v_mfma_f32_16x16x32_bf16 v[100:103], v[208:211], a[212:215], v[100:103]
    ds_read_b64_tr_b16 a[22:23], v31 offset:50176
    v_mfma_f32_16x16x32_bf16 v[108:111], v[212:215], a[212:215], v[108:111]
    buffer_load_dwordx4 v8, s[8:11], s67 offen lds
    s_waitcnt lgkmcnt(8)
    v_mfma_f32_16x16x32_bf16 v[112:115], v[208:211], a[216:219], v[112:115]
    ds_read_b128 a[200:203], v21 offset:53248
    ds_read_b64_tr_b16 a[24:25], v32 offset:49152
    ds_read_b64_tr_b16 a[26:27], v32 offset:50176
    s_add_u32 m0, s70, 86016
    s_nop 0
    buffer_load_dwordx4 v1, s[8:11], s67 offen lds
    ds_read_b128 a[204:207], v21 offset:55296
    v_mfma_f32_16x16x32_bf16 v[120:123], v[212:215], a[216:219], v[120:123]
    ds_read_b64_tr_b16 a[28:29], v33 offset:49152
    v_mfma_f32_16x16x32_bf16 v[116:119], v[208:211], a[220:223], v[116:119]
    ds_read_b64_tr_b16 a[30:31], v33 offset:50176
    v_mfma_f32_16x16x32_bf16 v[124:127], v[212:215], a[220:223], v[124:127]
    ds_read_b128 a[208:211], v21 offset:57344
    s_add_u32 m0, s70, 90112
    s_waitcnt lgkmcnt(9)
    v_mfma_f32_16x16x32_bf16 v[64:67], v[216:219], a[192:195], v[64:67]
    buffer_load_dwordx4 v2, s[8:11], s67 offen lds
    ds_read_b128 a[212:215], v21 offset:59392
    v_mfma_f32_16x16x32_bf16 v[72:75], v[220:223], a[192:195], v[72:75]
    ds_read_b128 a[216:219], v21 offset:61440
    s_add_u32 m0, s70, 94208
    v_mfma_f32_16x16x32_bf16 v[68:71], v[216:219], a[196:199], v[68:71]
    buffer_load_dwordx4 v3, s[8:11], s67 offen lds
    v_mfma_f32_16x16x32_bf16 v[76:79], v[220:223], a[196:199], v[76:79]
    ds_read_b128 a[220:223], v21 offset:63488
    s_waitcnt lgkmcnt(6)
    v_mfma_f32_16x16x32_bf16 v[80:83], v[216:219], a[200:203], v[80:83]
    s_waitcnt lgkmcnt(0)
    s_waitcnt vmcnt(8)
    s_barrier
    v_mfma_f32_16x16x32_bf16 v[88:91], v[220:223], a[200:203], v[88:91]
    ds_read_b64_tr_b16 v[224:225], v29 offset:32768
    v_mfma_f32_16x16x32_bf16 v[84:87], v[216:219], a[204:207], v[84:87]
    ds_read_b64_tr_b16 v[226:227], v29 offset:33280
    v_mfma_f32_16x16x32_bf16 v[92:95], v[220:223], a[204:207], v[92:95]
    ds_read_b64_tr_b16 v[228:229], v29 offset:40960
    v_mfma_f32_16x16x32_bf16 v[96:99], v[216:219], a[208:211], v[96:99]
    ds_read_b64_tr_b16 v[230:231], v29 offset:41472
    ds_read_b128 a[192:195], v24 offset:49152
    v_mfma_f32_16x16x32_bf16 v[104:107], v[220:223], a[208:211], v[104:107]
    ds_read_b128 a[196:199], v24 offset:51200
    s_add_u32 m0, s7, 0
    s_mul_i32 s4, s68, 1536
    v_mfma_f32_16x16x32_bf16 v[100:103], v[216:219], a[212:215], v[100:103]
    ds_read_b128 a[200:203], v24 offset:53248
    v_mfma_f32_16x16x32_bf16 v[108:111], v[220:223], a[212:215], v[108:111]
    buffer_load_dwordx4 v9, s[12:15], s4 offen lds
    s_cmp_eq_u32 s48, 0
    s_cbranch_scc1 L_B_tag
L_B_tag_back:
    v_mfma_f32_16x16x32_bf16 v[112:115], v[216:219], a[216:219], v[112:115]
    ds_read_b128 a[204:207], v24 offset:55296
    v_mov_b32 v40, s48
    v_mfma_f32_16x16x32_bf16 v[120:123], v[220:223], a[216:219], v[120:123]
    buffer_load_dwordx4 v42, s[12:15], s4 offen offset:1024 lds
    s_mov_b32 s49, s48
    v_mfma_f32_16x16x32_bf16 v[116:119], v[216:219], a[220:223], v[116:119]
    ds_read_b128 a[208:211], v24 offset:57344
    s_sub_u32 s100, s48, s100
    s_sub_u32 s101, s48, s101
    v_mfma_f32_16x16x32_bf16 v[124:127], v[220:223], a[220:223], v[124:127]
    s_add_u32 m0, s7, 8192
    s_waitcnt lgkmcnt(4)
    v_mfma_f32_16x16x32_bf16 v[64:67], v[224:227], a[192:195], v[64:67]
    buffer_load_dwordx4 v10, s[16:19], s4 offen lds
    ds_read_b128 a[212:215], v24 offset:59392
    v_mfma_f32_16x16x32_bf16 v[72:75], v[228:231], a[192:195], v[72:75]
    s_sub_u32 s5, s48, s5
    ds_read_b64_tr_b16 v[232:233], v29 offset:36864
L_B_w1_0:
    s_cbranch_execz L_B_w1_1
    s_waitcnt lgkmcnt(5)
    v_mfma_f32_16x16x32_bf16 v[68:71], v[224:227], a[196:199], v[68:71]
    ds_read_b128 a[216:219], v24 offset:61440
    v_mfma_f32_16x16x32_bf16 v[76:79], v[228:231], a[196:199], v[76:79]
    buffer_load_dwordx4 v43, s[16:19], s4 offen offset:1024 lds
    s_waitcnt lgkmcnt(4)
    v_mfma_f32_16x16x32_bf16 v[80:83], v[224:227], a[200:203], v[80:83]
    ds_read_b64_tr_b16 v[234:235], v29 offset:37376
L_B_w1_1:
    s_cbranch_execz L_hopped
    ds_read_b128 a[220:223], v24 offset:63488
    v_mfma_f32_16x16x32_bf16 v[88:91], v[228:231], a[200:203], v[88:91]
    ds_read_b64_tr_b16 v[236:237], v29 offset:45056
    v_mfma_f32_16x16x32_bf16 v[84:87], v[224:227], a[204:207], v[84:87]
    ds_read_b128 a[192:195], v25 offset:49152
    s_add_u32 m0, s70, 16384
    v_mfma_f32_16x16x32_bf16 v[92:95], v[228:231], a[204:207], v[92:95]
    buffer_load_dwordx4 v8, s[8:11], s68 offen lds
    s_waitcnt lgkmcnt(6)
    v_mfma_f32_16x16x32_bf16 v[96:99], v[224:227], a[208:211], v[96:99]
    ds_read_b64_tr_b16 v[238:239], v29 offset:45568
    ds_read_b128 a[196:199], v25 offset:51200
    v_mfma_f32_16x16x32_bf16 v[104:107], v[228:231], a[208:211], v[104:107]
    ds_read_b128 a[200:203], v25 offset:53248
    s_add_u32 m0, s70, 20480
    v_mfma_f32_16x16x32_bf16 v[100:103], v[224:227], a[212:215], v[100:103]
    buffer_load_dwordx4 v1, s[8:11], s68 offen lds
    v_mfma_f32_16x16x32_bf16 v[108:111], v[228:231], a[212:215], v[108:111]
    ds_read_b128 a[204:207], v25 offset:55296
    s_waitcnt lgkmcnt(6)
    v_mfma_f32_16x16x32_bf16 v[112:115], v[224:227], a[216:219], v[112:115]
    ds_read_b128 a[208:211], v25 offset:57344
    s_add_u32 m0, s70, 24576
    v_mfma_f32_16x16x32_bf16 v[120:123], v[228:231], a[216:219], v[120:123]
    buffer_load_dwordx4 v2, s[8:11], s68 offen lds
    v_mfma_f32_16x16x32_bf16 v[116:119], v[224:227], a[220:223], v[116:119]
    ds_read_b128 a[212:215], v25 offset:59392
    v_mfma_f32_16x16x32_bf16 v[124:127], v[228:231], a[220:223], v[124:127]
    ds_read_b128 a[216:219], v25 offset:61440
    s_add_u32 m0, s70, 28672
    s_waitcnt lgkmcnt(5)
    v_mfma_f32_16x16x32_bf16 v[64:67], v[232:235], a[192:195], v[64:67]
    buffer_load_dwordx4 v3, s[8:11], s68 offen lds
    v_mfma_f32_16x16x32_bf16 v[72:75], v[236:239], a[192:195], v[72:75]
    ds_read_b128 a[220:223], v25 offset:63488
    v_mfma_f32_16x16x32_bf16 v[68:71], v[232:235], a[196:199], v[68:71]
    v_mfma_f32_16x16x32_bf16 v[76:79], v[236:239], a[196:199], v[76:79]
    s_waitcnt lgkmcnt(4)
    v_mfma_f32_16x16x32_bf16 v[80:83], v[232:235], a[200:203], v[80:83]
    s_waitcnt vmcnt(8)
    s_barrier
    ds_read_b64_tr_b16 v[240:241], v29 offset:0
    v_mfma_f32_16x16x32_bf16 v[88:91], v[236:239], a[200:203], v[88:91]
    ds_read_b64_tr_b16 v[242:243], v29 offset:512
    v_mfma_f32_16x16x32_bf16 v[84:87], v[232:235], a[204:207], v[84:87]
    ds_read_b64_tr_b16 v[244:245], v29 offset:8192
    v_mfma_f32_16x16x32_bf16 v[92:95], v[236:239], a[204:207], v[92:95]
    ds_read_b64_tr_b16 v[246:247], v29 offset:8704
    s_waitcnt lgkmcnt(6)
    v_mfma_f32_16x16x32_bf16 v[96:99], v[232:235], a[208:211], v[96:99]
    ds_read_b128 a[192:195], v24 offset:16384
    v_mfma_f32_16x16x32_bf16 v[104:107], v[236:239], a[208:211], v[104:107]
    ds_read_b128 a[196:199], v24 offset:18432
    s_add_u32 m0, s7, 32768
    s_mul_i32 s4, s69, 1536
    v_mfma_f32_16x16x32_bf16 v[100:103], v[232:235], a[212:215], v[100:103]
    buffer_load_dwordx4 v9, s[12:15], s4 offen lds
    v_mfma_f32_16x16x32_bf16 v[108:111], v[236:239], a[212:215], v[108:111]
    ds_read_b128 a[200:203], v24 offset:20480
    s_waitcnt lgkmcnt(7)
    v_mfma_f32_16x16x32_bf16 v[112:115], v[232:235], a[216:219], v[112:115]
    buffer_load_dwordx4 v42, s[12:15], s4 offen offset:1024 lds
    ds_read_b128 a[204:207], v24 offset:22528
    v_mfma_f32_16x16x32_bf16 v[120:123], v[236:239], a[216:219], v[120:123]
    ds_read_b128 a[208:211], v24 offset:24576
    s_add_u32 m0, s7, 40960
    v_mfma_f32_16x16x32_bf16 v[116:119], v[232:235], a[220:223], v[116:119]
    buffer_load_dwordx4 v10, s[16:19], s4 offen lds
    v_mfma_f32_16x16x32_bf16 v[124:127], v[236:239], a[220:223], v[124:127]
    ds_read_b128 a[212:215], v24 offset:26624
    s_waitcnt lgkmcnt(5)
    v_mfma_f32_16x16x32_bf16 v[64:67], v[240:243], a[192:195], v[64:67]
    ds_read_b64_tr_b16 v[248:249], v29 offset:4096
    v_mfma_f32_16x16x32_bf16 v[72:75], v[244:247], a[192:195], v[72:75]
    ds_read_b128 a[216:219], v24 offset:28672
    s_waitcnt lgkmcnt(6)
    v_mfma_f32_16x16x32_bf16 v[68:71], v[240:243], a[196:199], v[68:71]
    buffer_load_dwordx4 v43, s[16:19], s4 offen offset:1024 lds
    v_mfma_f32_16x16x32_bf16 v[76:79], v[244:247], a[196:199], v[76:79]
    ds_read_b64_tr_b16 v[250:251], v29 offset:4608
    s_waitcnt lgkmcnt(5)
    v_mfma_f32_16x16x32_bf16 v[80:83], v[240:243], a[200:203], v[80:83]
    ds_read_b128 a[220:223], v24 offset:30720
    v_mfma_f32_16x16x32_bf16 v[88:91], v[244:247], a[200:203], v[88:91]
    ds_read_b64_tr_b16 v[252:253], v29 offset:12288
    v_mfma_f32_16x16x32_bf16 v[84:87], v[240:243], a[204:207], v[84:87]
    ds_read_b128 a[192:195], v25 offset:16384
    s_add_u32 m0, s70, 49152
    v_mfma_f32_16x16x32_bf16 v[92:95], v[244:247], a[204:207], v[92:95]
    buffer_load_dwordx4 v8, s[8:11], s69 offen lds
    s_waitcnt lgkmcnt(6)
    v_mfma_f32_16x16x32_bf16 v[96:99], v[240:243], a[208:211], v[96:99]
    ds_read_b64_tr_b16 v[254:255], v29 offset:12800
    ds_read_b128 a[196:199], v25 offset:18432
    v_mfma_f32_16x16x32_bf16 v[104:107], v[244:247], a[208:211], v[104:107]
    ds_read_b128 a[200:203], v25 offset:20480
    s_add_u32 m0, s70, 53248
    v_mfma_f32_16x16x32_bf16 v[100:103], v[240:243], a[212:215], v[100:103]
    buffer_load_dwordx4 v1, s[8:11], s69 offen lds
    v_mfma_f32_16x16x32_bf16 v[108:111], v[244:247], a[212:215], v[108:111]
    ds_read_b128 a[204:207], v25 offset:22528
    s_waitcnt lgkmcnt(6)
    v_mfma_f32_16x16x32_bf16 v[112:115], v[240:243], a[216:219], v[112:115]
    ds_read_b128 a[208:211], v25 offset:24576
    s_add_u32 m0, s70, 57344
    v_mfma_f32_16x16x32_bf16 v[120:123], v[244:247], a[216:219], v[120:123]
    buffer_load_dwordx4 v2, s[8:11], s69 offen lds
    v_mfma_f32_16x16x32_bf16 v[116:119], v[240:243], a[220:223], v[116:119]
    ds_read_b128 a[212:215], v25 offset:26624
    v_mfma_f32_16x16x32_bf16 v[124:127], v[244:247], a[220:223], v[124:127]
    ds_read_b128 a[216:219], v25 offset:28672
    s_add_u32 m0, s70, 61440
    s_waitcnt lgkmcnt(5)
    v_mfma_f32_16x16x32_bf16 v[64:67], v[248:251], a[192:195], v[64:67]
    buffer_load_dwordx4 v3, s[8:11], s69 offen lds
    v_mfma_f32_16x16x32_bf16 v[72:75], v[252:255], a[192:195], v[72:75]
    ds_read_b128 a[220:223], v25 offset:30720
    v_mfma_f32_16x16x32_bf16 v[68:71], v[248:251], a[196:199], v[68:71]
    v_mfma_f32_16x16x32_bf16 v[76:79], v[252:255], a[196:199], v[76:79]
    s_waitcnt lgkmcnt(4)
    v_mfma_f32_16x16x32_bf16 v[80:83], v[248:251], a[200:203], v[80:83]
    s_waitcnt vmcnt(8)
    s_barrier
    ds_read_b64_tr_b16 a[224:225], v28 offset:0
    v_mfma_f32_16x16x32_bf16 v[88:91], v[252:255], a[200:203], v[88:91]
    ds_read_b64_tr_b16 a[226:227], v28 offset:512
    v_mfma_f32_16x16x32_bf16 v[84:87], v[248:251], a[204:207], v[84:87]
    ds_read_b64_tr_b16 a[228:229], v28 offset:8192
    v_mfma_f32_16x16x32_bf16 v[92:95], v[252:255], a[204:207], v[92:95]
    ds_read_b64_tr_b16 a[230:231], v28 offset:8704
    s_waitcnt lgkmcnt(6)
    v_mfma_f32_16x16x32_bf16 v[96:99], v[248:251], a[208:211], v[96:99]
    ds_read_b128 a[192:195], v20 offset:16384
    v_mfma_f32_16x16x32_bf16 v[104:107], v[252:255], a[208:211], v[104:107]
    ds_read_b128 a[196:199], v20 offset:18432
    s_add_u32 m0, s70, 98304
    v_mfma_f32_16x16x32_bf16 v[100:103], v[248:251], a[212:215], v[100:103]
    buffer_load_dwordx4 v4, s[8:11], s60 offen lds
    v_mfma_f32_16x16x32_bf16 v[108:111], v[252:255], a[212:215], v[108:111]
    ds_read_b128 a[200:203], v20 offset:20480
    s_waitcnt lgkmcnt(7)
    v_mfma_f32_16x16x32_bf16 v[112:115], v[248:251], a[216:219], v[112:115]
    ds_read_b128 a[204:207], v20 offset:22528
    s_add_u32 m0, s70, 102400
    v_mfma_f32_16x16x32_bf16 v[120:123], v[252:255], a[216:219], v[120:123]
    buffer_load_dwordx4 v4, s[8:11], s61 offen lds
    v_mfma_f32_16x16x32_bf16 v[116:119], v[248:251], a[220:223], v[116:119]
    ds_read_b128 a[208:211], v20 offset:24576
    v_mfma_f32_16x16x32_bf16 v[124:127], v[252:255], a[220:223], v[124:127]
    ds_read_b128 a[212:215], v20 offset:26624
    s_add_u32 m0, s70, 106496
    s_waitcnt lgkmcnt(5)
    v_mfma_f32_16x16x32_bf16 v[64:67], a[224:227], a[192:195], v[64:67]
    buffer_load_dwordx4 v4, s[8:11], s62 offen lds
    v_mfma_f32_16x16x32_bf16 v[72:75], a[228:231], a[192:195], v[72:75]
    ds_read_b64_tr_b16 a[232:233], v28 offset:4096
    s_waitcnt lgkmcnt(5)
    v_mfma_f32_16x16x32_bf16 v[68:71], a[224:227], a[196:199], v[68:71]
    ds_read_b128 a[216:219], v20 offset:28672
    v_mfma_f32_16x16x32_bf16 v[76:79], a[228:231], a[196:199], v[76:79]
    ds_read_b64_tr_b16 a[234:235], v28 offset:4608
    s_waitcnt lgkmcnt(5)
    v_mfma_f32_16x16x32_bf16 v[80:83], a[224:227], a[200:203], v[80:83]
    ds_read_b128 a[220:223], v20 offset:30720
    s_add_u32 m0, s70, 110592
    v_mfma_f32_16x16x32_bf16 v[88:91], a[228:231], a[200:203], v[88:91]
    buffer_load_dwordx4 v4, s[8:11], s63 offen lds
    v_mfma_f32_16x16x32_bf16 v[84:87], a[224:227], a[204:207], v[84:87]
    ds_read_b64_tr_b16 a[236:237], v28 offset:12288
    v_mfma_f32_16x16x32_bf16 v[92:95], a[228:231], a[204:207], v[92:95]
    ds_read_b128 a[192:195], v21 offset:16384
    s_waitcnt lgkmcnt(6)
    v_mfma_f32_16x16x32_bf16 v[96:99], a[224:227], a[208:211], v[96:99]
    ds_read_b64_tr_b16 a[238:239], v28 offset:12800
    ds_read_b128 a[196:199], v21 offset:18432
    v_mfma_f32_16x16x32_bf16 v[104:107], a[228:231], a[208:211], v[104:107]
    s_add_u32 m0, s70, 114688
    s_nop 0
    buffer_load_dwordx4 v4, s[8:11], s64 offen lds
    v_mfma_f32_16x16x32_bf16 v[100:103], a[224:227], a[212:215], v[100:103]
    ds_read_b128 a[200:203], v21 offset:20480
    v_mfma_f32_16x16x32_bf16 v[108:111], a[228:231], a[212:215], v[108:111]
    ds_read_b128 a[204:207], v21 offset:22528
    s_add_u32 m0, s70, 118784
    s_waitcnt lgkmcnt(6)
    v_mfma_f32_16x16x32_bf16 v[112:115], a[224:227], a[216:219], v[112:115]
    buffer_load_dwordx4 v4, s[8:11], s65 offen lds
    v_mfma_f32_16x16x32_bf16 v[120:123], a[228:231], a[216:219], v[120:123]
    ds_read_b128 a[208:211], v21 offset:24576
    v_mfma_f32_16x16x32_bf16 v[116:119], a[224:227], a[220:223], v[116:119]
    ds_read_b128 a[212:215], v21 offset:26624
    s_add_u32 m0, s70, 122880
    v_mfma_f32_16x16x32_bf16 v[124:127], a[228:231], a[220:223], v[124:127]
    buffer_load_dwordx4 v4, s[8:11], s66 offen lds
    s_waitcnt lgkmcnt(4)
    v_mfma_f32_16x16x32_bf16 v[64:67], a[232:235], a[192:195], v[64:67]
    ds_read_b128 a[216:219], v21 offset:28672
    v_mfma_f32_16x16x32_bf16 v[72:75], a[236:239], a[192:195], v[72:75]
    ds_read_b128 a[220:223], v21 offset:30720
    s_add_u32 m0, s70, 126976
    v_mfma_f32_16x16x32_bf16 v[68:71], a[232:235], a[196:199], v[68:71]
    buffer_load_dwordx4 v4, s[8:11], s67 offen lds
    v_mfma_f32_16x16x32_bf16 v[76:79], a[236:239], a[196:199], v[76:79]
    s_waitcnt lgkmcnt(4)
    v_mfma_f32_16x16x32_bf16 v[80:83], a[232:235], a[200:203], v[80:83]
    s_waitcnt vmcnt(8)
    s_barrier
    ds_read_b64_tr_b16 a[240:241], v28 offset:32768
    v_mfma_f32_16x16x32_bf16 v[88:91], a[236:239], a[200:203], v[88:91]
    ds_read_b64_tr_b16 a[242:243], v28 offset:33280
    v_mfma_f32_16x16x32_bf16 v[84:87], a[232:235], a[204:207], v[84:87]
    ds_read_b64_tr_b16 a[244:245], v28 offset:40960
    v_mfma_f32_16x16x32_bf16 v[92:95], a[236:239], a[204:207], v[92:95]
    ds_read_b64_tr_b16 a[246:247], v28 offset:41472
    s_waitcnt lgkmcnt(6)
    v_mfma_f32_16x16x32_bf16 v[96:99], a[232:235], a[208:211], v[96:99]
    ds_read_b128 a[192:195], v20 offset:49152
    v_mfma_f32_16x16x32_bf16 v[104:107], a[236:239], a[208:211], v[104:107]
    ds_read_b128 a[196:199], v20 offset:51200
    s_add_u32 m0, s70, 65536
    v_mfma_f32_16x16x32_bf16 v[100:103], a[232:235], a[212:215], v[100:103]
    ds_read_b64_tr_b16 a[248:249], v28 offset:36864
    v_mfma_f32_16x16x32_bf16 v[108:111], a[236:239], a[212:215], v[108:111]
    ds_read_b64_tr_b16 a[250:251], v28 offset:37376
    s_waitcnt lgkmcnt(8)
    v_mfma_f32_16x16x32_bf16 v[112:115], a[232:235], a[216:219], v[112:115]
    ds_read_b64_tr_b16 a[252:253], v28 offset:45056
    ds_read_b64_tr_b16 a[254:255], v28 offset:45568
    ds_read_b128 a[200:203], v21 offset:49152
    buffer_load_dwordx4 v4, s[8:11], s68 offen lds
    ds_read_b128 a[204:207], v21 offset:51200
    v_mfma_f32_16x16x32_bf16 v[120:123], a[236:239], a[216:219], v[120:123]
    s_add_u32 m0, s70, 69632
    s_nop 0
    buffer_load_dwordx4 v4, s[8:11], s69 offen lds
    v_mfma_f32_16x16x32_bf16 v[116:119], a[232:235], a[220:223], v[116:119]
    ds_read_b128 a[208:211], v20 offset:53248
    v_mfma_f32_16x16x32_bf16 v[124:127], a[236:239], a[220:223], v[124:127]
    ds_read_b128 a[212:215], v20 offset:55296
    s_add_u32 m0, s70, 73728
    s_waitcnt lgkmcnt(9)
    v_mfma_f32_16x16x32_bf16 v[64:67], a[240:243], a[192:195], v[64:67]
    buffer_load_dwordx4 v5, s[8:11], s60 offen lds
    v_mfma_f32_16x16x32_bf16 v[72:75], a[244:247], a[192:195], v[72:75]
    ds_read_b128 a[216:219], v21 offset:53248
    s_waitcnt lgkmcnt(9)
    v_mfma_f32_16x16x32_bf16 v[68:71], a[240:243], a[196:199], v[68:71]
    ds_read_b128 a[220:223], v21 offset:55296
    s_add_u32 m0, s70, 77824
    v_mfma_f32_16x16x32_bf16 v[76:79], a[244:247], a[196:199], v[76:79]
    buffer_load_dwordx4 v5, s[8:11], s61 offen lds
    s_waitcnt lgkmcnt(4)
    v_mfma_f32_16x16x32_bf16 v[64:67], a[248:251], a[200:203], v[64:67]
    ds_read_b128 a[192:195], v20 offset:57344
    v_mfma_f32_16x16x32_bf16 v[72:75], a[252:255], a[200:203], v[72:75]
    ds_read_b128 a[196:199], v20 offset:59392
    s_add_u32 m0, s70, 81920
    v_mfma_f32_16x16x32_bf16 v[68:71], a[248:251], a[204:207], v[68:71]
    buffer_load_dwordx4 v5, s[8:11], s62 offen lds
    v_mfma_f32_16x16x32_bf16 v[76:79], a[252:255], a[204:207], v[76:79]
    ds_read_b128 a[200:203], v21 offset:57344
    s_waitcnt lgkmcnt(5)
    v_mfma_f32_16x16x32_bf16 v[80:83], a[240:243], a[208:211], v[80:83]
    ds_read_b128 a[204:207], v21 offset:59392
    s_add_u32 m0, s70, 86016
    v_mfma_f32_16x16x32_bf16 v[88:91], a[244:247], a[208:211], v[88:91]
    v_mfma_f32_16x16x32_bf16 v[84:87], a[240:243], a[212:215], v[84:87]
    buffer_load_dwordx4 v5, s[8:11], s63 offen lds
    v_mfma_f32_16x16x32_bf16 v[92:95], a[244:247], a[212:215], v[92:95]
    ds_read_b128 a[208:211], v20 offset:61440
    s_waitcnt lgkmcnt(5)
    v_mfma_f32_16x16x32_bf16 v[80:83], a[248:251], a[216:219], v[80:83]
    ds_read_b128 a[212:215], v20 offset:63488
    v_max_f32 v64, 0, v64
    v_mfma_f32_16x16x32_bf16 v[88:91], a[252:255], a[216:219], v[88:91]
    v_max_f32 v65, 0, v65
    v_max_f32 v66, 0, v66
    s_add_u32 m0, s70, 90112
    v_mfma_f32_16x16x32_bf16 v[84:87], a[248:251], a[220:223], v[84:87]
    ds_read_b128 a[216:219], v21 offset:61440
    v_max_f32 v67, 0, v67
    v_max_f32 v68, 0, v68
    v_mfma_f32_16x16x32_bf16 v[92:95], a[252:255], a[220:223], v[92:95]
    buffer_load_dwordx4 v5, s[8:11], s64 offen lds
    v_max_f32 v69, 0, v69
    s_waitcnt lgkmcnt(5)
    v_mfma_f32_16x16x32_bf16 v[96:99], a[240:243], a[192:195], v[96:99]
    ds_read_b128 a[220:223], v21 offset:63488
    v_max_f32 v70, 0, v70
    v_mfma_f32_16x16x32_bf16 v[104:107], a[244:247], a[192:195], v[104:107]
    v_max_f32 v71, 0, v71
    v_mul_f32 v64, v64, v72
    s_add_u32 m0, s70, 94208
    v_mfma_f32_16x16x32_bf16 v[100:103], a[240:243], a[196:199], v[100:103]
    buffer_load_dwordx4 v5, s[8:11], s65 offen lds
    v_mul_f32 v65, v65, v73
    v_mfma_f32_16x16x32_bf16 v[108:111], a[244:247], a[196:199], v[108:111]
    v_mul_f32 v66, v66, v74
    v_mul_f32 v67, v67, v75
    v_mul_f32 v68, v68, v76
    s_waitcnt lgkmcnt(4)
    v_mfma_f32_16x16x32_bf16 v[96:99], a[248:251], a[200:203], v[96:99]
    s_waitcnt vmcnt(11)
    s_barrier
    ds_read_b128 a[192:195], v24 offset:32768
    v_mfma_f32_16x16x32_bf16 v[104:107], a[252:255], a[200:203], v[104:107]
    ds_read_b128 a[196:199], v24 offset:34816
    v_mul_f32 v69, v69, v77
    s_add_u32 m0, s70, 0
    v_mfma_f32_16x16x32_bf16 v[100:103], a[248:251], a[204:207], v[100:103]
    ds_read_b128 a[200:203], v25 offset:32768
    v_mul_f32 v70, v70, v78
    v_mul_f32 v71, v71, v79
    v_mfma_f32_16x16x32_bf16 v[108:111], a[252:255], a[204:207], v[108:111]
    buffer_load_dwordx4 v5, s[8:11], s66 offen lds
    v_cvt_pk_bf16_f32 v52, v64, v65
    s_waitcnt lgkmcnt(5)
    v_mfma_f32_16x16x32_bf16 v[112:115], a[240:243], a[208:211], v[112:115]
    ds_read_b128 a[204:207], v25 offset:34816
    v_cvt_pk_bf16_f32 v53, v66, v67
    v_mfma_f32_16x16x32_bf16 v[120:123], a[244:247], a[208:211], v[120:123]
    v_cvt_pk_bf16_f32 v54, v68, v69
    v_cvt_pk_bf16_f32 v55, v70, v71
    s_add_u32 m0, s70, 4096
    v_mfma_f32_16x16x32_bf16 v[116:119], a[240:243], a[212:215], v[116:119]
    ds_read_b128 a[208:211], v24 offset:36864
    v_permlane32_swap_b32 v52, v54
    v_mfma_f32_16x16x32_bf16 v[124:127], a[244:247], a[212:215], v[124:127]
    buffer_load_dwordx4 v5, s[8:11], s67 offen lds
    v_permlane32_swap_b32 v53, v55
    s_waitcnt lgkmcnt(5)
    v_mfma_f32_16x16x32_bf16 v[112:115], a[248:251], a[216:219], v[112:115]
    ds_read_b128 a[212:215], v24 offset:38912
    s_mov_b32 s50, 0
    v_mfma_f32_16x16x32_bf16 v[120:123], a[252:255], a[216:219], v[120:123]
    buffer_store_dwordx4 v[52:55], v12, s[28:31], s50 offen sc1
    s_add_u32 m0, s70, 8192
    v_mfma_f32_16x16x32_bf16 v[116:119], a[248:251], a[220:223], v[116:119]
    ds_read_b128 a[216:219], v25 offset:36864
    v_max_f32 v80, 0, v80
    v_mfma_f32_16x16x32_bf16 v[124:127], a[252:255], a[220:223], v[124:127]
    buffer_load_dwordx4 v5, s[8:11], s68 offen lds
    v_max_f32 v81, 0, v81
    s_waitcnt lgkmcnt(6)
    v_mfma_f32_16x16x32_bf16 v[64:67], v[128:131], a[192:195], 0
    ds_read_b128 a[220:223], v25 offset:38912
    v_max_f32 v82, 0, v82
    v_mfma_f32_16x16x32_bf16 v[72:75], v[132:135], a[192:195], 0
    v_max_f32 v83, 0, v83
    s_add_u32 m0, s70, 12288
    s_waitcnt lgkmcnt(6)
    v_mfma_f32_16x16x32_bf16 v[68:71], v[128:131], a[196:199], 0
    ds_read_b128 a[192:195], v24 offset:40960
    v_max_f32 v84, 0, v84
    v_mfma_f32_16x16x32_bf16 v[76:79], v[132:135], a[196:199], 0
    buffer_load_dwordx4 v5, s[8:11], s69 offen lds
    v_max_f32 v85, 0, v85
    s_waitcnt lgkmcnt(5)
    v_mfma_f32_16x16x32_bf16 v[64:67], v[136:139], a[200:203], v[64:67]
    ds_read_b128 a[196:199], v24 offset:43008
    v_max_f32 v86, 0, v86
    v_mfma_f32_16x16x32_bf16 v[72:75], v[140:143], a[200:203], v[72:75]
    v_max_f32 v87, 0, v87
    s_add_u32 m0, s70, 16384
    v_mfma_f32_16x16x32_bf16 v[68:71], v[136:139], a[204:207], v[68:71]
    ds_read_b128 a[200:203], v25 offset:40960
    v_mul_f32 v80, v80, v88
    v_mfma_f32_16x16x32_bf16 v[76:79], v[140:143], a[204:207], v[76:79]
    buffer_load_dwordx4 v6, s[8:11], s60 offen lds
    v_mul_f32 v81, v81, v89
    s_waitcnt lgkmcnt(5)
    v_mfma_f32_16x16x32_bf16 v[64:67], v[144:147], a[208:211], v[64:67]
    ds_read_b128 a[204:207], v25 offset:43008
    v_mul_f32 v82, v82, v90
    v_mfma_f32_16x16x32_bf16 v[72:75], v[148:151], a[208:211], v[72:75]
    v_mul_f32 v83, v83, v91
    v_mul_f32 v84, v84, v92
    v_mfma_f32_16x16x32_bf16 v[68:71], v[144:147], a[212:215], v[68:71]
    ds_read_b128 a[208:211], v24 offset:45056
    v_mul_f32 v85, v85, v93
    v_mfma_f32_16x16x32_bf16 v[76:79], v[148:151], a[212:215], v[76:79]
    v_mul_f32 v86, v86, v94
    s_add_u32 m0, s70, 20480
    s_waitcnt lgkmcnt(5)
    v_mfma_f32_16x16x32_bf16 v[64:67], v[152:155], a[216:219], v[64:67]
    ds_read_b128 a[212:215], v24 offset:47104
    v_mul_f32 v87, v87, v95
    v_mfma_f32_16x16x32_bf16 v[72:75], v[156:159], a[216:219], v[72:75]
    buffer_load_dwordx4 v6, s[8:11], s61 offen lds
    v_cvt_pk_bf16_f32 v56, v80, v81
    v_mfma_f32_16x16x32_bf16 v[68:71], v[152:155], a[220:223], v[68:71]
    ds_read_b128 a[216:219], v25 offset:45056
    v_cvt_pk_bf16_f32 v57, v82, v83
    v_mfma_f32_16x16x32_bf16 v[76:79], v[156:159], a[220:223], v[76:79]
    v_cvt_pk_bf16_f32 v58, v84, v85
    s_add_u32 m0, s70, 24576
    s_waitcnt lgkmcnt(5)
    v_mfma_f32_16x16x32_bf16 v[64:67], v[160:163], a[192:195], v[64:67]
    ds_read_b128 a[220:223], v25 offset:47104
    v_cvt_pk_bf16_f32 v59, v86, v87
    v_mfma_f32_16x16x32_bf16 v[72:75], v[164:167], a[192:195], v[72:75]
    buffer_load_dwordx4 v6, s[8:11], s62 offen lds
    v_permlane32_swap_b32 v56, v58
    v_mfma_f32_16x16x32_bf16 v[68:71], v[160:163], a[196:199], v[68:71]
    ds_read_b128 a[192:195], v24 offset:49152
    v_permlane32_swap_b32 v57, v59
    v_mfma_f32_16x16x32_bf16 v[76:79], v[164:167], a[196:199], v[76:79]
    s_waitcnt lgkmcnt(5)
    v_mfma_f32_16x16x32_bf16 v[64:67], v[168:171], a[200:203], v[64:67]
    ds_read_b128 a[196:199], v24 offset:51200
    s_mov_b32 s50, 98304
    v_mfma_f32_16x16x32_bf16 v[72:75], v[172:175], a[200:203], v[72:75]
    buffer_store_dwordx4 v[56:59], v12, s[28:31], s50 offen sc1
    s_add_u32 m0, s70, 28672
    v_mfma_f32_16x16x32_bf16 v[68:71], v[168:171], a[204:207], v[68:71]
    ds_read_b128 a[200:203], v25 offset:49152
    v_max_f32 v96, 0, v96
    v_mfma_f32_16x16x32_bf16 v[76:79], v[172:175], a[204:207], v[76:79]
    buffer_load_dwordx4 v6, s[8:11], s63 offen lds
    v_max_f32 v97, 0, v97
    s_waitcnt lgkmcnt(5)
    v_mfma_f32_16x16x32_bf16 v[64:67], v[176:179], a[208:211], v[64:67]
    ds_read_b128 a[204:207], v25 offset:51200
    v_max_f32 v98, 0, v98
    v_mfma_f32_16x16x32_bf16 v[72:75], v[180:183], a[208:211], v[72:75]
    v_max_f32 v99, 0, v99
    v_max_f32 v100, 0, v100
    v_mfma_f32_16x16x32_bf16 v[68:71], v[176:179], a[212:215], v[68:71]
    v_max_f32 v101, 0, v101
    v_max_f32 v102, 0, v102
    v_mfma_f32_16x16x32_bf16 v[76:79], v[180:183], a[212:215], v[76:79]
    v_max_f32 v103, 0, v103
    v_mul_f32 v96, v96, v104
    s_waitcnt lgkmcnt(4)
    v_mfma_f32_16x16x32_bf16 v[64:67], v[184:187], a[216:219], v[64:67]
    s_waitcnt vmcnt(16)
    s_barrier
    ds_read_b128 a[208:211], v24 offset:53248
    v_mfma_f32_16x16x32_bf16 v[72:75], v[188:191], a[216:219], v[72:75]
    ds_read_b128 a[212:215], v24 offset:55296
    s_add_u32 m0, s70, 32768
    v_mfma_f32_16x16x32_bf16 v[68:71], v[184:187], a[220:223], v[68:71]
    ds_read_b128 a[216:219], v25 offset:53248
    v_mul_f32 v97, v97, v105
    v_mfma_f32_16x16x32_bf16 v[76:79], v[188:191], a[220:223], v[76:79]
    buffer_load_dwordx4 v6, s[8:11], s64 offen lds
    v_mul_f32 v98, v98, v106
    s_waitcnt lgkmcnt(5)
    v_mfma_f32_16x16x32_bf16 v[64:67], v[192:195], a[192:195], v[64:67]
    ds_read_b128 a[220:223], v25 offset:55296
    v_mul_f32 v99, v99, v107
    v_mfma_f32_16x16x32_bf16 v[72:75], v[196:199], a[192:195], v[72:75]
    v_mul_f32 v100, v100, v108
    s_add_u32 m0, s70, 36864
    v_mfma_f32_16x16x32_bf16 v[68:71], v[192:195], a[196:199], v[68:71]
    ds_read_b128 a[192:195], v24 offset:57344
    v_mul_f32 v101, v101, v109
    v_mfma_f32_16x16x32_bf16 v[76:79], v[196:199], a[196:199], v[76:79]
    buffer_load_dwordx4 v6, s[8:11], s65 offen lds
    v_mul_f32 v102, v102, v110
    s_waitcnt lgkmcnt(5)
    v_mfma_f32_16x16x32_bf16 v[64:67], v[200:203], a[200:203], v[64:67]
    ds_read_b128 a[196:199], v24 offset:59392
    v_mul_f32 v103, v103, v111
    v_mfma_f32_16x16x32_bf16 v[72:75], v[204:207], a[200:203], v[72:75]
    v_cvt_pk_bf16_f32 v52, v96, v97
    v_cvt_pk_bf16_f32 v53, v98, v99
    v_mfma_f32_16x16x32_bf16 v[68:71], v[200:203], a[204:207], v[68:71]
    ds_read_b128 a[200:203], v25 offset:57344
    v_cvt_pk_bf16_f32 v54, v100, v101
    v_mfma_f32_16x16x32_bf16 v[76:79], v[204:207], a[204:207], v[76:79]
    v_cvt_pk_bf16_f32 v55, v102, v103
    s_add_u32 m0, s70, 40960
    s_waitcnt lgkmcnt(6)
    v_mfma_f32_16x16x32_bf16 v[64:67], v[208:211], a[208:211], v[64:67]
    ds_read_b128 a[204:207], v25 offset:59392
    v_permlane32_swap_b32 v52, v54
    v_mfma_f32_16x16x32_bf16 v[72:75], v[212:215], a[208:211], v[72:75]
    buffer_load_dwordx4 v6, s[8:11], s66 offen lds
    v_permlane32_swap_b32 v53, v55
    s_waitcnt lgkmcnt(6)
    v_mfma_f32_16x16x32_bf16 v[68:71], v[208:211], a[212:215], v[68:71]
    ds_read_b128 a[208:211], v24 offset:61440
    s_add_u32 m0, s70, 45056
    v_mfma_f32_16x16x32_bf16 v[76:79], v[212:215], a[212:215], v[76:79]
    s_waitcnt lgkmcnt(5)
    v_mfma_f32_16x16x32_bf16 v[64:67], v[216:219], a[216:219], v[64:67]
    buffer_load_dwordx4 v6, s[8:11], s67 offen lds
    v_mfma_f32_16x16x32_bf16 v[72:75], v[220:223], a[216:219], v[72:75]
    ds_read_b128 a[212:215], v24 offset:63488
    v_mfma_f32_16x16x32_bf16 v[68:71], v[216:219], a[220:223], v[68:71]
    ds_read_b128 a[216:219], v25 offset:61440
    v_mfma_f32_16x16x32_bf16 v[76:79], v[220:223], a[220:223], v[76:79]
    s_waitcnt lgkmcnt(5)
    v_mfma_f32_16x16x32_bf16 v[64:67], v[224:227], a[192:195], v[64:67]
    ds_read_b128 a[220:223], v25 offset:63488
    s_mov_b32 s50, 196608
    v_mfma_f32_16x16x32_bf16 v[72:75], v[228:231], a[192:195], v[72:75]
    buffer_store_dwordx4 v[52:55], v12, s[28:31], s50 offen sc1
    s_add_u32 m0, s70, 49152
    v_mfma_f32_16x16x32_bf16 v[68:71], v[224:227], a[196:199], v[68:71]
    ds_read_b128 a[192:195], v24 offset:0
    v_max_f32 v112, 0, v112
    v_mfma_f32_16x16x32_bf16 v[76:79], v[228:231], a[196:199], v[76:79]
    buffer_load_dwordx4 v6, s[8:11], s68 offen lds
    v_max_f32 v113, 0, v113
    s_waitcnt lgkmcnt(5)
    v_mfma_f32_16x16x32_bf16 v[64:67], v[232:235], a[200:203], v[64:67]
    ds_read_b128 a[196:199], v24 offset:2048
    v_max_f32 v114, 0, v114
    v_mfma_f32_16x16x32_bf16 v[72:75], v[236:239], a[200:203], v[72:75]
    v_max_f32 v115, 0, v115
    s_add_u32 m0, s70, 53248
    v_mfma_f32_16x16x32_bf16 v[68:71], v[232:235], a[204:207], v[68:71]
    ds_read_b128 a[200:203], v25 offset:0
    v_max_f32 v116, 0, v116
    v_mfma_f32_16x16x32_bf16 v[76:79], v[236:239], a[204:207], v[76:79]
    buffer_load_dwordx4 v6, s[8:11], s69 offen lds
    v_max_f32 v117, 0, v117
    s_waitcnt lgkmcnt(5)
    v_mfma_f32_16x16x32_bf16 v[64:67], v[240:243], a[208:211], v[64:67]
    ds_read_b128 a[204:207], v25 offset:2048
    v_max_f32 v118, 0, v118
    v_mfma_f32_16x16x32_bf16 v[72:75], v[244:247], a[208:211], v[72:75]
    v_max_f32 v119, 0, v119
    v_mul_f32 v112, v112, v120
    v_mfma_f32_16x16x32_bf16 v[68:71], v[240:243], a[212:215], v[68:71]
    ds_read_b128 a[208:211], v24 offset:4096
    v_mul_f32 v113, v113, v121
    v_mfma_f32_16x16x32_bf16 v[76:79], v[244:247], a[212:215], v[76:79]
    s_add_u32 m0, s71, 131072
    s_mul_i32 s6, s74, 40
    s_waitcnt lgkmcnt(5)
    v_mfma_f32_16x16x32_bf16 v[64:67], v[248:251], a[216:219], v[64:67]
    ds_read_b128 a[212:215], v24 offset:6144
    v_mul_f32 v114, v114, v122
    v_mfma_f32_16x16x32_bf16 v[72:75], v[252:255], a[216:219], v[72:75]
    buffer_load_dwordx4 v11, s[20:23], s6 offen lds
    v_mul_f32 v115, v115, v123
    v_mfma_f32_16x16x32_bf16 v[68:71], v[248:251], a[220:223], v[68:71]
    ds_read_b128 a[216:219], v25 offset:4096
    v_mul_f32 v116, v116, v124
    v_mfma_f32_16x16x32_bf16 v[76:79], v[252:255], a[220:223], v[76:79]
    v_mul_f32 v117, v117, v125
    v_mul_f32 v118, v118, v126
    s_waitcnt lgkmcnt(5)
    v_mfma_f32_16x16x32_bf16 v[64:67], a[224:227], a[192:195], v[64:67]
    ds_read_b128 a[220:223], v25 offset:6144
    v_mul_f32 v119, v119, v127
    v_mfma_f32_16x16x32_bf16 v[72:75], a[228:231], a[192:195], v[72:75]
    v_cvt_pk_bf16_f32 v56, v112, v113
    v_mfma_f32_16x16x32_bf16 v[68:71], a[224:227], a[196:199], v[68:71]
    buffer_load_dwordx4 v44, s[20:23], s6 offen offset:1024 lds
    v_cvt_pk_bf16_f32 v57, v114, v115
    v_mfma_f32_16x16x32_bf16 v[76:79], a[228:231], a[196:199], v[76:79]
    v_cvt_pk_bf16_f32 v58, v116, v117
    v_cvt_pk_bf16_f32 v59, v118, v119
    s_waitcnt lgkmcnt(4)
    v_mfma_f32_16x16x32_bf16 v[64:67], a[232:235], a[200:203], v[64:67]
    s_waitcnt vmcnt(10)
    s_barrier
    ds_read_b128 a[192:195], v24 offset:8192
    v_mfma_f32_16x16x32_bf16 v[72:75], a[236:239], a[200:203], v[72:75]
    ds_read_b128 a[196:199], v24 offset:10240
    v_permlane32_swap_b32 v56, v58
    v_mfma_f32_16x16x32_bf16 v[68:71], a[232:235], a[204:207], v[68:71]
    ds_read_b128 a[200:203], v25 offset:8192
    v_permlane32_swap_b32 v57, v59
    s_cmp_lg_u32 s3, 0
    v_mfma_f32_16x16x32_bf16 v[76:79], a[236:239], a[204:207], v[76:79]
    s_cbranch_scc1 L_B_pub0
    s_atomic_add s100, s[28:29], s51
L_B_pub0:
    s_waitcnt lgkmcnt(5)
    v_mfma_f32_16x16x32_bf16 v[64:67], a[240:243], a[208:211], v[64:67]
    buffer_load_dwordx4 v45, s[20:23], s6 offen offset:2048 lds
    v_mfma_f32_16x16x32_bf16 v[72:75], a[244:247], a[208:211], v[72:75]
L_B_w2_0:
    s_cbranch_execz L_B_w2_1
    ds_read_b128 a[204:207], v25 offset:10240
    v_mfma_f32_16x16x32_bf16 v[68:71], a[240:243], a[212:215], v[68:71]
    ds_read_b128 a[208:211], v24 offset:12288
    v_mfma_f32_16x16x32_bf16 v[76:79], a[244:247], a[212:215], v[76:79]
    s_waitcnt lgkmcnt(5)
    v_mfma_f32_16x16x32_bf16 v[64:67], a[248:251], a[216:219], v[64:67]
    ds_read_b128 a[212:215], v24 offset:14336
    s_mov_b32 s50, 294912
L_B_w2_1:
    s_cbranch_execz L_hopped
    v_mfma_f32_16x16x32_bf16 v[72:75], a[252:255], a[216:219], v[72:75]
    buffer_store_dwordx4 v[56:59], v12, s[28:31], s50 offen sc1
    v_mfma_f32_16x16x32_bf16 v[68:71], a[248:251], a[220:223], v[68:71]
    ds_read_b128 a[216:219], v25 offset:12288
    v_mfma_f32_16x16x32_bf16 v[76:79], a[252:255], a[220:223], v[76:79]
    s_waitcnt lgkmcnt(6)
    v_mfma_f32_16x16x32_bf16 v[80:83], v[128:131], a[192:195], 0
    buffer_load_dwordx4 v46, s[20:23], s6 offen offset:3072 lds
    v_mfma_f32_16x16x32_bf16 v[88:91], v[132:135], a[192:195], 0
    ds_read_b128 a[220:223], v25 offset:14336
    s_waitcnt lgkmcnt(6)
    v_mfma_f32_16x16x32_bf16 v[84:87], v[128:131], a[196:199], 0
    ds_read_b128 a[192:195], v24 offset:16384
    v_mfma_f32_16x16x32_bf16 v[92:95], v[132:135], a[196:199], 0
    s_waitcnt lgkmcnt(5)
    v_mfma_f32_16x16x32_bf16 v[80:83], v[136:139], a[200:203], v[80:83]
    ds_read_b128 a[196:199], v24 offset:18432
    s_add_u32 m0, s71, 147456
    v_mfma_f32_16x16x32_bf16 v[88:91], v[140:143], a[200:203], v[88:91]
    s_mul_i32 s6, s75, 40
    v_mfma_f32_16x16x32_bf16 v[84:87], v[136:139], a[204:207], v[84:87]
    buffer_load_dwordx4 v11, s[20:23], s6 offen lds
    v_mfma_f32_16x16x32_bf16 v[92:95], v[140:143], a[204:207], v[92:95]
    ds_read_b128 a[200:203], v25 offset:16384
    s_waitcnt lgkmcnt(5)
    v_mfma_f32_16x16x32_bf16 v[80:83], v[144:147], a[208:211], v[80:83]
    ds_read_b128 a[204:207], v25 offset:18432
    v_max_f32 v64, 0, v64
    v_mfma_f32_16x16x32_bf16 v[88:91], v[148:151], a[208:211], v[88:91]
    v_max_f32 v65, 0, v65
    v_max_f32 v66, 0, v66
    v_mfma_f32_16x16x32_bf16 v[84:87], v[144:147], a[212:215], v[84:87]
    ds_read_b128 a[208:211], v24 offset:20480
    v_max_f32 v67, 0, v67
    v_mfma_f32_16x16x32_bf16 v[92:95], v[148:151], a[212:215], v[92:95]
    v_max_f32 v68, 0, v68
    s_waitcnt lgkmcnt(5)
    v_mfma_f32_16x16x32_bf16 v[80:83], v[152:155], a[216:219], v[80:83]
    ds_read_b128 a[212:215], v24 offset:22528
    v_max_f32 v69, 0, v69
    v_mfma_f32_16x16x32_bf16 v[88:91], v[156:159], a[216:219], v[88:91]
    buffer_load_dwordx4 v44, s[20:23], s6 offen offset:1024 lds
    v_max_f32 v70, 0, v70
    v_mfma_f32_16x16x32_bf16 v[84:87], v[152:155], a[220:223], v[84:87]
    ds_read_b128 a[216:219], v25 offset:20480
    v_max_f32 v71, 0, v71
    v_mfma_f32_16x16x32_bf16 v[92:95], v[156:159], a[220:223], v[92:95]
    v_mul_f32 v64, v64, v72
    v_mul_f32 v65, v65, v73
    s_waitcnt lgkmcnt(5)
    v_mfma_f32_16x16x32_bf16 v[80:83], v[160:163], a[192:195], v[80:83]
    ds_read_b128 a[220:223], v25 offset:22528
    v_mul_f32 v66, v66, v74
    v_mfma_f32_16x16x32_bf16 v[88:91], v[164:167], a[192:195], v[88:91]
    v_mul_f32 v67, v67, v75
    v_mul_f32 v68, v68, v76
    v_mfma_f32_16x16x32_bf16 v[84:87], v[160:163], a[196:199], v[84:87]
    ds_read_b128 a[192:195], v24 offset:24576
    v_mul_f32 v69, v69, v77
    v_mfma_f32_16x16x32_bf16 v[92:95], v[164:167], a[196:199], v[92:95]
    v_mul_f32 v70, v70, v78
    s_waitcnt lgkmcnt(5)
    v_mfma_f32_16x16x32_bf16 v[80:83], v[168:171], a[200:203], v[80:83]
    ds_read_b128 a[196:199], v24 offset:26624
    v_mul_f32 v71, v71, v79
    v_mfma_f32_16x16x32_bf16 v[88:91], v[172:175], a[200:203], v[88:91]
    buffer_load_dwordx4 v45, s[20:23], s6 offen offset:2048 lds
    v_cvt_pk_bf16_f32 v52, v64, v65
    v_mfma_f32_16x16x32_bf16 v[84:87], v[168:171], a[204:207], v[84:87]
    ds_read_b128 a[200:203], v25 offset:24576
    v_cvt_pk_bf16_f32 v53, v66, v67
    v_mfma_f32_16x16x32_bf16 v[92:95], v[172:175], a[204:207], v[92:95]
    v_cvt_pk_bf16_f32 v54, v68, v69
    v_cvt_pk_bf16_f32 v55, v70, v71
    s_waitcnt lgkmcnt(5)
    v_mfma_f32_16x16x32_bf16 v[80:83], v[176:179], a[208:211], v[80:83]
    ds_read_b128 a[204:207], v25 offset:26624
    v_permlane32_swap_b32 v52, v54
    v_mfma_f32_16x16x32_bf16 v[88:91], v[180:183], a[208:211], v[88:91]
    v_permlane32_swap_b32 v53, v55
    v_mfma_f32_16x16x32_bf16 v[84:87], v[176:179], a[212:215], v[84:87]
    buffer_load_dwordx4 v46, s[20:23], s6 offen offset:3072 lds
    v_mfma_f32_16x16x32_bf16 v[92:95], v[180:183], a[212:215], v[92:95]
    ds_read_b128 a[208:211], v24 offset:28672
    s_waitcnt lgkmcnt(5)
    v_mfma_f32_16x16x32_bf16 v[80:83], v[184:187], a[216:219], v[80:83]
    ds_read_b128 a[212:215], v24 offset:30720
    v_mfma_f32_16x16x32_bf16 v[88:91], v[188:191], a[216:219], v[88:91]
    v_mfma_f32_16x16x32_bf16 v[84:87], v[184:187], a[220:223], v[84:87]
    ds_read_b128 a[216:219], v25 offset:28672
    s_add_u32 m0, s71, 98304
    v_mfma_f32_16x16x32_bf16 v[92:95], v[188:191], a[220:223], v[92:95]
    s_mul_i32 s6, s76, 40
    s_waitcnt lgkmcnt(5)
    v_mfma_f32_16x16x32_bf16 v[80:83], v[192:195], a[192:195], v[80:83]
    buffer_load_dwordx4 v11, s[20:23], s6 offen lds
    v_mfma_f32_16x16x32_bf16 v[88:91], v[196:199], a[192:195], v[88:91]
    ds_read_b128 a[220:223], v25 offset:30720
    v_mfma_f32_16x16x32_bf16 v[84:87], v[192:195], a[196:199], v[84:87]
    ds_read_b128 a[192:195], v20 offset:0
    v_mfma_f32_16x16x32_bf16 v[92:95], v[196:199], a[196:199], v[92:95]
    s_waitcnt lgkmcnt(5)
    v_mfma_f32_16x16x32_bf16 v[80:83], v[200:203], a[200:203], v[80:83]
    ds_read_b128 a[196:199], v20 offset:2048
    s_mov_b32 s50, 393216
    v_mfma_f32_16x16x32_bf16 v[88:91], v[204:207], a[200:203], v[88:91]
    buffer_store_dwordx4 v[52:55], v12, s[28:31], s50 offen sc1
    v_mfma_f32_16x16x32_bf16 v[84:87], v[200:203], a[204:207], v[84:87]
    ds_read_b128 a[200:203], v21 offset:0
    v_mfma_f32_16x16x32_bf16 v[92:95], v[204:207], a[204:207], v[92:95]
    s_waitcnt lgkmcnt(6)
    v_mfma_f32_16x16x32_bf16 v[80:83], v[208:211], a[208:211], v[80:83]
    buffer_load_dwordx4 v44, s[20:23], s6 offen offset:1024 lds
    v_mfma_f32_16x16x32_bf16 v[88:91], v[212:215], a[208:211], v[88:91]
    ds_read_b128 a[204:207], v21 offset:2048
    s_waitcnt lgkmcnt(6)
    v_mfma_f32_16x16x32_bf16 v[84:87], v[208:211], a[212:215], v[84:87]
    ds_read_b128 a[208:211], v20 offset:4096
    v_mfma_f32_16x16x32_bf16 v[92:95], v[212:215], a[212:215], v[92:95]
    s_waitcnt lgkmcnt(5)
    v_mfma_f32_16x16x32_bf16 v[80:83], v[216:219], a[216:219], v[80:83]
    ds_read_b128 a[212:215], v20 offset:6144
    v_mfma_f32_16x16x32_bf16 v[88:91], v[220:223], a[216:219], v[88:91]
    v_mfma_f32_16x16x32_bf16 v[84:87], v[216:219], a[220:223], v[84:87]
    buffer_load_dwordx4 v45, s[20:23], s6 offen offset:2048 lds
    v_mfma_f32_16x16x32_bf16 v[92:95], v[220:223], a[220:223], v[92:95]
    ds_read_b128 a[216:219], v21 offset:4096
    s_waitcnt lgkmcnt(5)
    v_mfma_f32_16x16x32_bf16 v[80:83], v[224:227], a[192:195], v[80:83]
    ds_read_b128 a[220:223], v21 offset:6144
    v_mfma_f32_16x16x32_bf16 v[88:91], v[228:231], a[192:195], v[88:91]
    v_mfma_f32_16x16x32_bf16 v[84:87], v[224:227], a[196:199], v[84:87]
    ds_read_b128 a[192:195], v20 offset:8192
    v_mfma_f32_16x16x32_bf16 v[92:95], v[228:231], a[196:199], v[92:95]
    s_waitcnt lgkmcnt(5)
    v_mfma_f32_16x16x32_bf16 v[80:83], v[232:235], a[200:203], v[80:83]
    buffer_load_dwordx4 v46, s[20:23], s6 offen offset:3072 lds
    v_mfma_f32_16x16x32_bf16 v[88:91], v[236:239], a[200:203], v[88:91]
    ds_read_b128 a[196:199], v20 offset:10240
    v_mfma_f32_16x16x32_bf16 v[84:87], v[232:235], a[204:207], v[84:87]
    ds_read_b128 a[200:203], v21 offset:8192
    v_mfma_f32_16x16x32_bf16 v[92:95], v[236:239], a[204:207], v[92:95]
    s_waitcnt lgkmcnt(5)
    v_mfma_f32_16x16x32_bf16 v[80:83], v[240:243], a[208:211], v[80:83]
    ds_read_b128 a[204:207], v21 offset:10240
    v_mfma_f32_16x16x32_bf16 v[88:91], v[244:247], a[208:211], v[88:91]
    v_mfma_f32_16x16x32_bf16 v[84:87], v[240:243], a[212:215], v[84:87]
    ds_read_b128 a[208:211], v20 offset:12288
    v_mfma_f32_16x16x32_bf16 v[92:95], v[244:247], a[212:215], v[92:95]
    s_waitcnt vmcnt(9)
    ds_read_b64_tr_b16 a[32:33], v30 offset:32768
    s_waitcnt lgkmcnt(6)
    v_mfma_f32_16x16x32_bf16 v[80:83], v[248:251], a[216:219], v[80:83]
    ds_read_b64_tr_b16 a[34:35], v30 offset:33792
    v_mfma_f32_16x16x32_bf16 v[88:91], v[252:255], a[216:219], v[88:91]
    ds_read_b128 a[212:215], v20 offset:14336
    v_mfma_f32_16x16x32_bf16 v[84:87], v[248:251], a[220:223], v[84:87]
    ds_read_b64_tr_b16 a[36:37], v31 offset:32768
    v_mfma_f32_16x16x32_bf16 v[92:95], v[252:255], a[220:223], v[92:95]
    ds_read_b64_tr_b16 a[38:39], v31 offset:33792
    s_waitcnt lgkmcnt(8)
    v_mfma_f32_16x16x32_bf16 v[80:83], a[224:227], a[192:195], v[80:83]
    ds_read_b128 a[216:219], v21 offset:12288
    v_mfma_f32_16x16x32_bf16 v[88:91], a[228:231], a[192:195], v[88:91]
    ds_read_b64_tr_b16 a[40:41], v32 offset:32768
    v_mfma_f32_16x16x32_bf16 v[84:87], a[224:227], a[196:199], v[84:87]
    ds_read_b64_tr_b16 a[42:43], v32 offset:33792
    v_mfma_f32_16x16x32_bf16 v[92:95], a[228:231], a[196:199], v[92:95]
    ds_read_b128 a[220:223], v21 offset:14336
    s_waitcnt lgkmcnt(10)
    v_mfma_f32_16x16x32_bf16 v[80:83], a[232:235], a[200:203], v[80:83]
    ds_read_b64_tr_b16 a[44:45], v33 offset:32768
    v_mfma_f32_16x16x32_bf16 v[88:91], a[236:239], a[200:203], v[88:91]
    ds_read_b64_tr_b16 a[46:47], v33 offset:33792
    s_barrier
    v_mfma_f32_16x16x32_bf16 v[84:87], a[232:235], a[204:207], v[84:87]
    ds_read_b128 a[192:195], v20 offset:16384
    v_mfma_f32_16x16x32_bf16 v[92:95], a[236:239], a[204:207], v[92:95]
    ds_read_b128 a[196:199], v20 offset:18432
    s_add_u32 m0, s71, 114688
    s_waitcnt lgkmcnt(10)
    v_mfma_f32_16x16x32_bf16 v[80:83], a[240:243], a[208:211], v[80:83]
    s_mul_i32 s6, s77, 40
    buffer_load_dwordx4 v11, s[20:23], s6 offen lds
    v_mfma_f32_16x16x32_bf16 v[88:91], a[244:247], a[208:211], v[88:91]
    ds_read_b128 a[200:203], v21 offset:16384
    v_mfma_f32_16x16x32_bf16 v[84:87], a[240:243], a[212:215], v[84:87]
    ds_read_b128 a[204:207], v21 offset:18432
    v_mfma_f32_16x16x32_bf16 v[92:95], a[244:247], a[212:215], v[92:95]
    ds_read_b128 a[208:211], v20 offset:20480
    s_waitcnt lgkmcnt(7)
    v_mfma_f32_16x16x32_bf16 v[80:83], a[248:251], a[216:219], v[80:83]
    buffer_load_dwordx4 v44, s[20:23], s6 offen offset:1024 lds
    v_mfma_f32_16x16x32_bf16 v[88:91], a[252:255], a[216:219], v[88:91]
    ds_read_b128 a[212:215], v20 offset:22528
    v_mfma_f32_16x16x32_bf16 v[84:87], a[248:251], a[220:223], v[84:87]
    ds_read_b128 a[216:219], v21 offset:20480
    v_mfma_f32_16x16x32_bf16 v[92:95], a[252:255], a[220:223], v[92:95]
    s_waitcnt lgkmcnt(6)
    v_mfma_f32_16x16x32_bf16 v[64:67], v[128:131], a[192:195], 0
    ds_read_b128 a[220:223], v21 offset:22528
    v_mfma_f32_16x16x32_bf16 v[72:75], v[132:135], a[192:195], 0
    s_waitcnt lgkmcnt(6)
    v_mfma_f32_16x16x32_bf16 v[68:71], v[128:131], a[196:199], 0
    buffer_load_dwordx4 v45, s[20:23], s6 offen offset:2048 lds
    v_mfma_f32_16x16x32_bf16 v[76:79], v[132:135], a[196:199], 0
    ds_read_b128 a[192:195], v20 offset:24576
    s_waitcnt lgkmcnt(5)
    v_mfma_f32_16x16x32_bf16 v[64:67], v[136:139], a[200:203], v[64:67]
    ds_read_b128 a[196:199], v20 offset:26624
    v_mfma_f32_16x16x32_bf16 v[72:75], v[140:143], a[200:203], v[72:75]
    s_waitcnt vmcnt(8)
    ds_read_b64_tr_b16 a[48:49], v30 offset:49152
    v_mfma_f32_16x16x32_bf16 v[68:71], v[136:139], a[204:207], v[68:71]
    ds_read_b64_tr_b16 a[50:51], v30 offset:50176
    v_mfma_f32_16x16x32_bf16 v[76:79], v[140:143], a[204:207], v[76:79]
    ds_read_b128 a[200:203], v21 offset:24576
    s_waitcnt lgkmcnt(7)
    v_mfma_f32_16x16x32_bf16 v[64:67], v[144:147], a[208:211], v[64:67]
    ds_read_b64_tr_b16 a[52:53], v31 offset:49152
    v_mfma_f32_16x16x32_bf16 v[72:75], v[148:151], a[208:211], v[72:75]
    ds_read_b64_tr_b16 a[54:55], v31 offset:50176
    v_max_f32 v80, 0, v80
    v_mfma_f32_16x16x32_bf16 v[68:71], v[144:147], a[212:215], v[68:71]
    ds_read_b128 a[204:207], v21 offset:26624
    v_mfma_f32_16x16x32_bf16 v[76:79], v[148:151], a[212:215], v[76:79]
    ds_read_b64_tr_b16 a[56:57], v32 offset:49152
    s_waitcnt lgkmcnt(9)
    v_mfma_f32_16x16x32_bf16 v[64:67], v[152:155], a[216:219], v[64:67]
    ds_read_b64_tr_b16 a[58:59], v32 offset:50176
    v_mfma_f32_16x16x32_bf16 v[72:75], v[156:159], a[216:219], v[72:75]
    buffer_load_dwordx4 v46, s[20:23], s6 offen offset:3072 lds
    v_mfma_f32_16x16x32_bf16 v[68:71], v[152:155], a[220:223], v[68:71]
    ds_read_b128 a[208:211], v20 offset:28672
    v_mfma_f32_16x16x32_bf16 v[76:79], v[156:159], a[220:223], v[76:79]
    ds_read_b64_tr_b16 a[60:61], v33 offset:49152
    s_waitcnt lgkmcnt(10)
    v_mfma_f32_16x16x32_bf16 v[64:67], v[160:163], a[192:195], v[64:67]
    ds_read_b64_tr_b16 a[62:63], v33 offset:50176
    ds_read_b128 a[212:215], v20 offset:30720
    v_mfma_f32_16x16x32_bf16 v[72:75], v[164:167], a[192:195], v[72:75]
    v_max_f32 v81, 0, v81
    v_max_f32 v82, 0, v82
    v_max_f32 v83, 0, v83
    v_mfma_f32_16x16x32_bf16 v[68:71], v[160:163], a[196:199], v[68:71]
    ds_read_b128 a[216:219], v21 offset:28672
    v_max_f32 v84, 0, v84
    s_add_u32 m0, s71, 65536
    v_mfma_f32_16x16x32_bf16 v[76:79], v[164:167], a[196:199], v[76:79]
    s_mul_i32 s6, s78, 40
    ds_read_b128 a[220:223], v21 offset:30720
    s_waitcnt lgkmcnt(8)
    v_mfma_f32_16x16x32_bf16 v[64:67], v[168:171], a[200:203], v[64:67]
    v_max_f32 v85, 0, v85
    buffer_load_dwordx4 v11, s[20:23], s6 offen lds
    v_max_f32 v86, 0, v86
    v_mfma_f32_16x16x32_bf16 v[72:75], v[172:175], a[200:203], v[72:75]
    ds_read_b128 a[192:195], v20 offset:32768
    v_max_f32 v87, 0, v87
    v_mul_f32 v80, v80, v88
    v_mfma_f32_16x16x32_bf16 v[68:71], v[168:171], a[204:207], v[68:71]
    v_mul_f32 v81, v81, v89
    ds_read_b128 a[196:199], v20 offset:34816
    v_mul_f32 v82, v82, v90
    v_mfma_f32_16x16x32_bf16 v[76:79], v[172:175], a[204:207], v[76:79]
    v_mul_f32 v83, v83, v91
    ds_read_b128 a[200:203], v21 offset:32768
    s_waitcnt lgkmcnt(5)
    v_mfma_f32_16x16x32_bf16 v[64:67], v[176:179], a[208:211], v[64:67]
    v_mul_f32 v84, v84, v92
    buffer_load_dwordx4 v44, s[20:23], s6 offen offset:1024 lds
    v_mul_f32 v85, v85, v93
    v_mfma_f32_16x16x32_bf16 v[72:75], v[180:183], a[208:211], v[72:75]
    ds_read_b128 a[204:207], v21 offset:34816
    v_mul_f32 v86, v86, v94
    v_mul_f32 v87, v87, v95
    v_mfma_f32_16x16x32_bf16 v[68:71], v[176:179], a[212:215], v[68:71]
    v_cvt_pk_bf16_f32 v56, v80, v81
    v_cvt_pk_bf16_f32 v57, v82, v83
    v_cvt_pk_bf16_f32 v58, v84, v85
    v_mfma_f32_16x16x32_bf16 v[76:79], v[180:183], a[212:215], v[76:79]
    v_cvt_pk_bf16_f32 v59, v86, v87
    v_permlane32_swap_b32 v56, v58
    s_waitcnt lgkmcnt(4)
    v_mfma_f32_16x16x32_bf16 v[64:67], v[184:187], a[216:219], v[64:67]
    s_waitcnt vmcnt(9)
    s_barrier
    ds_read_b128 a[208:211], v20 offset:36864
    v_mfma_f32_16x16x32_bf16 v[72:75], v[188:191], a[216:219], v[72:75]
    ds_read_b128 a[212:215], v20 offset:38912
    v_mfma_f32_16x16x32_bf16 v[68:71], v[184:187], a[220:223], v[68:71]
    ds_read_b128 a[216:219], v21 offset:36864
    v_mfma_f32_16x16x32_bf16 v[76:79], v[188:191], a[220:223], v[76:79]
    buffer_load_dwordx4 v45, s[20:23], s6 offen offset:2048 lds
    v_permlane32_swap_b32 v57, v59
    s_waitcnt lgkmcnt(5)
    v_mfma_f32_16x16x32_bf16 v[64:67], v[192:195], a[192:195], v[64:67]
    s_cmp_lg_u32 s3, 0
    s_cbranch_scc1 L_B_pub1
    s_atomic_add s101, s[28:29], s51 offset:128
L_B_pub1:
    v_mfma_f32_16x16x32_bf16 v[72:75], v[196:199], a[192:195], v[72:75]
    ds_read_b128 a[220:223], v21 offset:38912
    v_mfma_f32_16x16x32_bf16 v[68:71], v[192:195], a[196:199], v[68:71]
    s_waitcnt vmcnt(7)
    ds_read_b64_tr_b16 a[64:65], v30 offset:0
    v_mfma_f32_16x16x32_bf16 v[76:79], v[196:199], a[196:199], v[76:79]
    ds_read_b64_tr_b16 a[66:67], v30 offset:1024
    s_mov_b32 s50, 491520
    s_waitcnt lgkmcnt(6)
    v_mfma_f32_16x16x32_bf16 v[64:67], v[200:203], a[200:203], v[64:67]
    buffer_store_dwordx4 v[56:59], v12, s[28:31], s50 offen sc1
    v_mfma_f32_16x16x32_bf16 v[72:75], v[204:207], a[200:203], v[72:75]
    ds_read_b128 a[192:195], v20 offset:40960
    v_mfma_f32_16x16x32_bf16 v[68:71], v[200:203], a[204:207], v[68:71]
    ds_read_b64_tr_b16 a[68:69], v31 offset:0
    v_mfma_f32_16x16x32_bf16 v[76:79], v[204:207], a[204:207], v[76:79]
    ds_read_b64_tr_b16 a[70:71], v31 offset:1024
    s_waitcnt lgkmcnt(8)
    v_mfma_f32_16x16x32_bf16 v[64:67], v[208:211], a[208:211], v[64:67]
    buffer_load_dwordx4 v46, s[20:23], s6 offen offset:3072 lds
    ds_read_b128 a[196:199], v20 offset:43008
    v_mfma_f32_16x16x32_bf16 v[72:75], v[212:215], a[208:211], v[72:75]
    ds_read_b64_tr_b16 a[72:73], v32 offset:0
    s_waitcnt lgkmcnt(9)
    v_mfma_f32_16x16x32_bf16 v[68:71], v[208:211], a[212:215], v[68:71]
    ds_read_b64_tr_b16 a[74:75], v32 offset:1024
    v_mfma_f32_16x16x32_bf16 v[76:79], v[212:215], a[212:215], v[76:79]
    ds_read_b128 a[200:203], v21 offset:40960
    s_waitcnt lgkmcnt(9)
    v_mfma_f32_16x16x32_bf16 v[64:67], v[216:219], a[216:219], v[64:67]
    ds_read_b64_tr_b16 a[76:77], v33 offset:0
    ds_read_b64_tr_b16 a[78:79], v33 offset:1024
    ds_read_b128 a[204:207], v21 offset:43008
    v_mfma_f32_16x16x32_bf16 v[72:75], v[220:223], a[216:219], v[72:75]
    s_add_u32 m0, s71, 131072
    s_mul_i32 s6, s79, 40
    buffer_load_dwordx4 v11, s[20:23], s6 offen lds
    v_mfma_f32_16x16x32_bf16 v[68:71], v[216:219], a[220:223], v[68:71]
    ds_read_b128 a[208:211], v20 offset:45056
    v_mfma_f32_16x16x32_bf16 v[76:79], v[220:223], a[220:223], v[76:79]
    ds_read_b128 a[212:215], v20 offset:47104
    s_waitcnt lgkmcnt(8)
    v_mfma_f32_16x16x32_bf16 v[64:67], v[224:227], a[192:195], v[64:67]
    ds_read_b128 a[216:219], v21 offset:45056
    v_mfma_f32_16x16x32_bf16 v[72:75], v[228:231], a[192:195], v[72:75]
    ds_read_b128 a[220:223], v21 offset:47104
    v_mfma_f32_16x16x32_bf16 v[68:71], v[224:227], a[196:199], v[68:71]
    buffer_load_dwordx4 v44, s[20:23], s6 offen offset:1024 lds
    v_mfma_f32_16x16x32_bf16 v[76:79], v[228:231], a[196:199], v[76:79]
    ds_read_b128 a[192:195], v20 offset:49152
    s_waitcnt lgkmcnt(5)
    v_mfma_f32_16x16x32_bf16 v[64:67], v[232:235], a[200:203], v[64:67]
    ds_read_b128 a[196:199], v20 offset:51200
    v_mfma_f32_16x16x32_bf16 v[72:75], v[236:239], a[200:203], v[72:75]
    v_mfma_f32_16x16x32_bf16 v[68:71], v[232:235], a[204:207], v[68:71]
    ds_read_b128 a[200:203], v21 offset:49152
    v_mfma_f32_16x16x32_bf16 v[76:79], v[236:239], a[204:207], v[76:79]
    s_waitcnt lgkmcnt(5)
    v_mfma_f32_16x16x32_bf16 v[64:67], v[240:243], a[208:211], v[64:67]
    buffer_load_dwordx4 v45, s[20:23], s6 offen offset:2048 lds
    v_mfma_f32_16x16x32_bf16 v[72:75], v[244:247], a[208:211], v[72:75]
    ds_read_b128 a[204:207], v21 offset:51200
    v_mfma_f32_16x16x32_bf16 v[68:71], v[240:243], a[212:215], v[68:71]
    ds_read_b128 a[208:211], v20 offset:53248
    v_mfma_f32_16x16x32_bf16 v[76:79], v[244:247], a[212:215], v[76:79]
    s_waitcnt lgkmcnt(5)
    v_mfma_f32_16x16x32_bf16 v[64:67], v[248:251], a[216:219], v[64:67]
    ds_read_b128 a[212:215], v20 offset:55296
    v_mfma_f32_16x16x32_bf16 v[72:75], v[252:255], a[216:219], v[72:75]
    v_mfma_f32_16x16x32_bf16 v[68:71], v[248:251], a[220:223], v[68:71]
    buffer_load_dwordx4 v46, s[20:23], s6 offen offset:3072 lds
    v_mfma_f32_16x16x32_bf16 v[76:79], v[252:255], a[220:223], v[76:79]
    ds_read_b128 a[216:219], v21 offset:53248
    s_waitcnt lgkmcnt(5)
    v_mfma_f32_16x16x32_bf16 v[64:67], a[224:227], a[192:195], v[64:67]
    ds_read_b128 a[220:223], v21 offset:55296
    v_mfma_f32_16x16x32_bf16 v[72:75], a[228:231], a[192:195], v[72:75]
    v_mfma_f32_16x16x32_bf16 v[68:71], a[224:227], a[196:199], v[68:71]
    s_add_u32 m0, s71, 147456
    s_mul_i32 s6, s80, 40
    v_mfma_f32_16x16x32_bf16 v[76:79], a[228:231], a[196:199], v[76:79]
    s_waitcnt lgkmcnt(4)
    v_mfma_f32_16x16x32_bf16 v[64:67], a[232:235], a[200:203], v[64:67]
    buffer_load_dwordx4 v11, s[20:23], s6 offen lds
    v_mfma_f32_16x16x32_bf16 v[72:75], a[236:239], a[200:203], v[72:75]
    s_waitcnt vmcnt(10)
    ds_read_b64_tr_b16 a[80:81], v30 offset:16384
    v_mfma_f32_16x16x32_bf16 v[68:71], a[232:235], a[204:207], v[68:71]
    ds_read_b64_tr_b16 a[82:83], v30 offset:17408
    v_mfma_f32_16x16x32_bf16 v[76:79], a[236:239], a[204:207], v[76:79]
    ds_read_b64_tr_b16 a[84:85], v31 offset:16384
    s_waitcnt lgkmcnt(5)
    v_mfma_f32_16x16x32_bf16 v[64:67], a[240:243], a[208:211], v[64:67]
    ds_read_b64_tr_b16 a[86:87], v31 offset:17408
    v_mfma_f32_16x16x32_bf16 v[72:75], a[244:247], a[208:211], v[72:75]
    ds_read_b64_tr_b16 a[88:89], v32 offset:16384
    v_mfma_f32_16x16x32_bf16 v[68:71], a[240:243], a[212:215], v[68:71]
    ds_read_b64_tr_b16 a[90:91], v32 offset:17408
    v_mfma_f32_16x16x32_bf16 v[76:79], a[244:247], a[212:215], v[76:79]
    ds_read_b64_tr_b16 a[92:93], v33 offset:16384
    s_waitcnt lgkmcnt(7)
    v_mfma_f32_16x16x32_bf16 v[64:67], a[248:251], a[216:219], v[64:67]
    ds_read_b64_tr_b16 a[94:95], v33 offset:17408
    v_mfma_f32_16x16x32_bf16 v[72:75], a[252:255], a[216:219], v[72:75]
    buffer_load_dwordx4 v44, s[20:23], s6 offen offset:1024 lds
    v_mfma_f32_16x16x32_bf16 v[68:71], a[248:251], a[220:223], v[68:71]
    v_mfma_f32_16x16x32_bf16 v[76:79], a[252:255], a[220:223], v[76:79]
    buffer_load_dwordx4 v45, s[20:23], s6 offen offset:2048 lds
    buffer_load_dwordx4 v46, s[20:23], s6 offen offset:3072 lds
    s_add_u32 m0, s71, 81920
    s_mul_i32 s6, s81, 40
    buffer_load_dwordx4 v11, s[20:23], s6 offen lds
    buffer_load_dwordx4 v44, s[20:23], s6 offen offset:1024 lds
    v_max_f32 v64, 0, v64
    v_max_f32 v65, 0, v65
    v_max_f32 v66, 0, v66
    v_max_f32 v67, 0, v67
    v_max_f32 v68, 0, v68
    v_max_f32 v69, 0, v69
    v_max_f32 v70, 0, v70
    v_max_f32 v71, 0, v71
    v_mul_f32 v64, v64, v72
    v_mul_f32 v65, v65, v73
    v_mul_f32 v66, v66, v74
    v_mul_f32 v67, v67, v75
    v_mul_f32 v68, v68, v76
    v_mul_f32 v69, v69, v77
    v_mul_f32 v70, v70, v78
    v_mul_f32 v71, v71, v79
    v_cvt_pk_bf16_f32 v52, v64, v65
    v_cvt_pk_bf16_f32 v53, v66, v67
    v_cvt_pk_bf16_f32 v54, v68, v69
    v_cvt_pk_bf16_f32 v55, v70, v71
    s_nop 0
    v_permlane32_swap_b32 v52, v54
    v_permlane32_swap_b32 v53, v55
    s_mov_b32 s50, 589824
    buffer_store_dwordx4 v[52:55], v12, s[28:31], s50 offen sc1
    s_waitcnt vmcnt(12) lgkmcnt(0)
    s_barrier
    s_cmp_lg_u32 s3, 0
    s_cbranch_scc1 L_B_pub2
    s_mov_b64 exec, 1
    buffer_store_dword v40, v18, s[28:31], 0 offen offset:256 sc1
    s_mov_b64 exec, -1
L_B_pub2:
    buffer_load_dwordx4 v45, s[20:23], s6 offen offset:2048 lds
    buffer_load_dwordx4 v46, s[20:23], s6 offen offset:3072 lds
    s_waitcnt vmcnt(13)
    ds_read_b64_tr_b16 a[96:97], v60 offset:32768
    ds_read_b64_tr_b16 a[98:99], v60 offset:33792
    ds_read_b64_tr_b16 a[100:101], v61 offset:32768
    ds_read_b64_tr_b16 a[102:103], v61 offset:33792
    ds_read_b64_tr_b16 a[104:105], v62 offset:32768
    ds_read_b64_tr_b16 a[106:107], v62 offset:33792
    ds_read_b64_tr_b16 a[108:109], v63 offset:32768
    ds_read_b64_tr_b16 a[110:111], v63 offset:33792
    s_waitcnt vmcnt(9)
    ds_read_b64_tr_b16 a[112:113], v30 offset:32768
    ds_read_b64_tr_b16 a[114:115], v30 offset:33792
    ds_read_b64_tr_b16 a[116:117], v31 offset:32768
    ds_read_b64_tr_b16 a[118:119], v31 offset:33792
    ds_read_b64_tr_b16 a[120:121], v32 offset:32768
    ds_read_b64_tr_b16 a[122:123], v32 offset:33792
    ds_read_b64_tr_b16 a[124:125], v33 offset:32768
    ds_read_b64_tr_b16 a[126:127], v33 offset:33792
    s_add_u32 m0, s71, 98304
    s_mul_i32 s6, s82, 40
    buffer_load_dwordx4 v11, s[20:23], s6 offen lds
    buffer_load_dwordx4 v44, s[20:23], s6 offen offset:1024 lds
    s_load_dword s52, s[0:1], s36
    s_load_dword s53, s[0:1], s36 offset:512
    s_load_dword s54, s[0:1], s36 offset:1024
    s_load_dword s55, s[0:1], s36 offset:1536
    s_load_dword s56, s[0:1], s36 offset:2048
    s_load_dword s57, s[0:1], s36 offset:2560
    buffer_load_dwordx4 v45, s[20:23], s6 offen offset:2048 lds
    buffer_load_dwordx4 v46, s[20:23], s6 offen offset:3072 lds
    s_waitcnt vmcnt(9)
    ds_read_b64_tr_b16 a[128:129], v30 offset:49152
    ds_read_b64_tr_b16 a[130:131], v30 offset:50176
    ds_read_b64_tr_b16 a[132:133], v31 offset:49152
    ds_read_b64_tr_b16 a[134:135], v31 offset:50176
    ds_read_b64_tr_b16 a[136:137], v32 offset:49152
    ds_read_b64_tr_b16 a[138:139], v32 offset:50176
    ds_read_b64_tr_b16 a[140:141], v33 offset:49152
    ds_read_b64_tr_b16 a[142:143], v33 offset:50176
    s_add_u32 m0, s71, 32768
    s_mul_i32 s6, s83, 40
    buffer_load_dwordx4 v11, s[20:23], s6 offen lds
    buffer_load_dwordx4 v44, s[20:23], s6 offen offset:1024 lds
    buffer_load_dwordx4 v45, s[20:23], s6 offen offset:2048 lds
    buffer_load_dwordx4 v46, s[20:23], s6 offen offset:3072 lds
    s_waitcnt lgkmcnt(0)
    v_add_u32 v1, s84, v13
    s_xor_b64 s[52:53], s[52:53], s[48:49]
    s_xor_b64 s[54:55], s[54:55], s[48:49]
    s_or_b64 s[52:53], s[52:53], s[54:55]
    s_xor_b64 s[56:57], s[56:57], s[48:49]
    s_or_b64 s[52:53], s[52:53], s[56:57]
    s_cbranch_scc1 L_B_chk0
L_B_chk0_back:
    s_load_dword s58, s[0:1], s37
    s_load_dword s59, s[0:1], s37 offset:512
    s_load_dword s60, s[0:1], s37 offset:1024
    s_load_dword s61, s[0:1], s37 offset:1536
    s_load_dword s62, s[0:1], s37 offset:2048
    s_load_dword s63, s[0:1], s37 offset:2560
    s_waitcnt vmcnt(8)
    ds_read_b64_tr_b16 a[144:145], v60 offset:49152
    ds_read_b64_tr_b16 a[146:147], v60 offset:50176
    ds_read_b64_tr_b16 a[148:149], v61 offset:49152
    ds_read_b64_tr_b16 a[150:151], v61 offset:50176
    ds_read_b64_tr_b16 a[152:153], v62 offset:49152
    ds_read_b64_tr_b16 a[154:155], v62 offset:50176
    ds_read_b64_tr_b16 a[156:157], v63 offset:49152
    ds_read_b64_tr_b16 a[158:159], v63 offset:50176
    s_waitcnt lgkmcnt(0)
    s_barrier
    s_cmp_lg_u32 s3, 0
    s_cbranch_scc1 L_B_pub3
    s_atomic_add s5, s[28:29], s51 offset:384
L_B_pub3:
    buffer_load_dwordx4 v[128:131], v1, s[28:31], s72 offen sc1
    buffer_load_dwordx4 v[132:135], v1, s[28:31], s73 offen sc1
    buffer_load_dwordx4 v[136:139], v1, s[28:31], s74 offen sc1
    buffer_load_dwordx4 v[140:143], v1, s[28:31], s75 offen sc1
    s_waitcnt vmcnt(8)
    ds_read_b64_tr_b16 a[160:161], v30 offset:0
    ds_read_b64_tr_b16 a[162:163], v30 offset:1024
    ds_read_b64_tr_b16 a[164:165], v31 offset:0
    ds_read_b64_tr_b16 a[166:167], v31 offset:1024
    ds_read_b64_tr_b16 a[168:169], v32 offset:0
    ds_read_b64_tr_b16 a[170:171], v32 offset:1024
    ds_read_b64_tr_b16 a[172:173], v33 offset:0
    ds_read_b64_tr_b16 a[174:175], v33 offset:1024
    buffer_load_dwordx4 v[144:147], v1, s[28:31], s76 offen sc1
    buffer_load_dwordx4 v[148:151], v1, s[28:31], s77 offen sc1
    buffer_load_dwordx4 v[152:155], v1, s[28:31], s78 offen sc1
    buffer_load_dwordx4 v[156:159], v1, s[28:31], s79 offen sc1
    s_waitcnt vmcnt(8)
    ds_read_b64_tr_b16 a[176:177], v60 offset:0
    ds_read_b64_tr_b16 a[178:179], v60 offset:1024
    ds_read_b64_tr_b16 a[180:181], v61 offset:0
    ds_read_b64_tr_b16 a[182:183], v61 offset:1024
    ds_read_b64_tr_b16 a[184:185], v62 offset:0
    ds_read_b64_tr_b16 a[186:187], v62 offset:1024
    ds_read_b64_tr_b16 a[188:189], v63 offset:0
    ds_read_b64_tr_b16 a[190:191], v63 offset:1024
    buffer_load_dwordx4 v[160:163], v1, s[28:31], s80 offen sc1
    buffer_load_dwordx4 v[164:167], v1, s[28:31], s81 offen sc1
    s_waitcnt vmcnt(9)
    v_mfma_f32_16x16x32_bf16 v[96:99], a[0:3], v[128:131], 0
    v_mfma_f32_16x16x32_bf16 v[100:103], a[4:7], v[128:131], 0
    buffer_load_dwordx4 v[168:171], v1, s[28:31], s82 offen sc1
    v_mfma_f32_16x16x32_bf16 v[104:107], a[8:11], v[128:131], 0
    v_mfma_f32_16x16x32_bf16 v[108:111], a[12:15], v[128:131], 0
    v_add_u32 v2, s85, v13
    s_waitcnt vmcnt(9)
    v_mfma_f32_16x16x32_bf16 v[96:99], a[16:19], v[132:135], v[96:99]
    s_xor_b64 s[58:59], s[58:59], s[48:49]
    s_xor_b64 s[60:61], s[60:61], s[48:49]
    v_mfma_f32_16x16x32_bf16 v[100:103], a[20:23], v[132:135], v[100:103]
    buffer_load_dwordx4 v[172:175], v1, s[28:31], s83 offen sc1
    s_or_b64 s[58:59], s[58:59], s[60:61]
    v_mfma_f32_16x16x32_bf16 v[104:107], a[24:27], v[132:135], v[104:107]
    s_xor_b64 s[62:63], s[62:63], s[48:49]
    v_mfma_f32_16x16x32_bf16 v[108:111], a[28:31], v[132:135], v[108:111]
    s_waitcnt vmcnt(9)
    v_mfma_f32_16x16x32_bf16 v[96:99], a[32:35], v[136:139], v[96:99]
    s_or_b64 s[58:59], s[58:59], s[62:63]
    s_cbranch_scc1 L_B_chk1
L_B_chk1_back:
    v_mfma_f32_16x16x32_bf16 v[100:103], a[36:39], v[136:139], v[100:103]
    buffer_load_dwordx4 v[176:179], v2, s[28:31], s72 offen sc1
    s_load_dword s64, s[0:1], s38
    v_mfma_f32_16x16x32_bf16 v[104:107], a[40:43], v[136:139], v[104:107]
    s_load_dword s65, s[0:1], s38 offset:512
    s_load_dword s66, s[0:1], s38 offset:1024
    v_mfma_f32_16x16x32_bf16 v[108:111], a[44:47], v[136:139], v[108:111]
    s_load_dword s67, s[0:1], s38 offset:1536
    s_waitcnt vmcnt(9)
    v_mfma_f32_16x16x32_bf16 v[96:99], a[48:51], v[140:143], v[96:99]
    s_load_dword s68, s[0:1], s38 offset:2048
L_B_w3_0:
    s_cbranch_execz L_B_w3_1
    s_load_dword s69, s[0:1], s38 offset:2560
    v_mfma_f32_16x16x32_bf16 v[100:103], a[52:55], v[140:143], v[100:103]
    buffer_load_dwordx4 v[180:183], v2, s[28:31], s73 offen sc1
    v_mfma_f32_16x16x32_bf16 v[104:107], a[56:59], v[140:143], v[104:107]
    v_mfma_f32_16x16x32_bf16 v[108:111], a[60:63], v[140:143], v[108:111]
    s_waitcnt vmcnt(9)
    v_mfma_f32_16x16x32_bf16 v[96:99], a[64:67], v[144:147], v[96:99]
    v_mfma_f32_16x16x32_bf16 v[100:103], a[68:71], v[144:147], v[100:103]
L_B_w3_1:
    s_cbranch_execz L_hopped
    buffer_load_dwordx4 v[184:187], v2, s[28:31], s74 offen sc1
    v_mfma_f32_16x16x32_bf16 v[104:107], a[72:75], v[144:147], v[104:107]
    v_mfma_f32_16x16x32_bf16 v[108:111], a[76:79], v[144:147], v[108:111]
    s_waitcnt vmcnt(9)
    v_mfma_f32_16x16x32_bf16 v[96:99], a[80:83], v[148:151], v[96:99]
    v_mfma_f32_16x16x32_bf16 v[100:103], a[84:87], v[148:151], v[100:103]
    buffer_load_dwordx4 v[188:191], v2, s[28:31], s75 offen sc1
    v_mfma_f32_16x16x32_bf16 v[104:107], a[88:91], v[148:151], v[104:107]
    v_mfma_f32_16x16x32_bf16 v[108:111], a[92:95], v[148:151], v[108:111]
    s_waitcnt vmcnt(9)
    v_mfma_f32_16x16x32_bf16 v[96:99], a[96:99], v[152:155], v[96:99]
    v_mfma_f32_16x16x32_bf16 v[100:103], a[100:103], v[152:155], v[100:103]
    buffer_load_dwordx4 v[192:195], v2, s[28:31], s76 offen sc1
    v_mfma_f32_16x16x32_bf16 v[104:107], a[104:107], v[152:155], v[104:107]
    v_mfma_f32_16x16x32_bf16 v[108:111], a[108:111], v[152:155], v[108:111]
    s_waitcnt vmcnt(9)
    v_mfma_f32_16x16x32_bf16 v[96:99], a[112:115], v[156:159], v[96:99]
    v_mfma_f32_16x16x32_bf16 v[100:103], a[116:119], v[156:159], v[100:103]
    buffer_load_dwordx4 v[196:199], v2, s[28:31], s77 offen sc1
    v_mfma_f32_16x16x32_bf16 v[104:107], a[120:123], v[156:159], v[104:107]
    v_mfma_f32_16x16x32_bf16 v[108:111], a[124:127], v[156:159], v[108:111]
    s_waitcnt vmcnt(9)
    v_mfma_f32_16x16x32_bf16 v[96:99], a[128:131], v[160:163], v[96:99]
    v_mfma_f32_16x16x32_bf16 v[100:103], a[132:135], v[160:163], v[100:103]
    buffer_load_dwordx4 v[200:203], v2, s[28:31], s78 offen sc1
    v_mfma_f32_16x16x32_bf16 v[104:107], a[136:139], v[160:163], v[104:107]
    v_mfma_f32_16x16x32_bf16 v[108:111], a[140:143], v[160:163], v[108:111]
    s_waitcnt vmcnt(9)
    v_mfma_f32_16x16x32_bf16 v[96:99], a[144:147], v[164:167], v[96:99]
    v_mfma_f32_16x16x32_bf16 v[100:103], a[148:151], v[164:167], v[100:103]
    buffer_load_dwordx4 v[204:207], v2, s[28:31], s79 offen sc1
    v_mfma_f32_16x16x32_bf16 v[104:107], a[152:155], v[164:167], v[104:107]
    v_mfma_f32_16x16x32_bf16 v[108:111], a[156:159], v[164:167], v[108:111]
    s_waitcnt vmcnt(9) lgkmcnt(8)
    v_mfma_f32_16x16x32_bf16 v[96:99], a[160:163], v[168:171], v[96:99]
    v_mfma_f32_16x16x32_bf16 v[100:103], a[164:167], v[168:171], v[100:103]
    buffer_load_dwordx4 v[208:211], v2, s[28:31], s80 offen sc1
    v_mfma_f32_16x16x32_bf16 v[104:107], a[168:171], v[168:171], v[104:107]
    v_mfma_f32_16x16x32_bf16 v[108:111], a[172:175], v[168:171], v[108:111]
    s_waitcnt vmcnt(9) lgkmcnt(0)
    v_mfma_f32_16x16x32_bf16 v[96:99], a[176:179], v[172:175], v[96:99]
    v_mfma_f32_16x16x32_bf16 v[100:103], a[180:183], v[172:175], v[100:103]
    buffer_load_dwordx4 v[212:215], v2, s[28:31], s81 offen sc1
    v_mfma_f32_16x16x32_bf16 v[104:107], a[184:187], v[172:175], v[104:107]
    v_mfma_f32_16x16x32_bf16 v[108:111], a[188:191], v[172:175], v[108:111]
    s_waitcnt vmcnt(9)
    v_mfma_f32_16x16x32_bf16 v[112:115], a[0:3], v[176:179], 0
    v_mfma_f32_16x16x32_bf16 v[116:119], a[4:7], v[176:179], 0
    buffer_load_dwordx4 v[216:219], v2, s[28:31], s82 offen sc1
    v_mfma_f32_16x16x32_bf16 v[120:123], a[8:11], v[176:179], 0
    v_mfma_f32_16x16x32_bf16 v[124:127], a[12:15], v[176:179], 0
    s_waitcnt lgkmcnt(0)
    s_waitcnt vmcnt(9)
    v_mfma_f32_16x16x32_bf16 v[112:115], a[16:19], v[180:183], v[112:115]
    v_add_u32 v3, s86, v13
    s_xor_b64 s[64:65], s[64:65], s[48:49]
    v_mfma_f32_16x16x32_bf16 v[116:119], a[20:23], v[180:183], v[116:119]
    buffer_load_dwordx4 v[220:223], v2, s[28:31], s83 offen sc1
    s_xor_b64 s[66:67], s[66:67], s[48:49]
    v_mfma_f32_16x16x32_bf16 v[120:123], a[24:27], v[180:183], v[120:123]
    s_or_b64 s[64:65], s[64:65], s[66:67]
    s_xor_b64 s[68:69], s[68:69], s[48:49]
    v_mfma_f32_16x16x32_bf16 v[124:127], a[28:31], v[180:183], v[124:127]
    s_waitcnt vmcnt(9)
    v_mfma_f32_16x16x32_bf16 v[112:115], a[32:35], v[184:187], v[112:115]
    s_or_b64 s[64:65], s[64:65], s[68:69]
    s_cbranch_scc1 L_B_chk2
L_B_chk2_back:
    v_mfma_f32_16x16x32_bf16 v[116:119], a[36:39], v[184:187], v[116:119]
    buffer_load_dwordx4 v[224:227], v3, s[28:31], s72 offen sc1
    s_load_dword s52, s[0:1], s39
    v_mfma_f32_16x16x32_bf16 v[120:123], a[40:43], v[184:187], v[120:123]
    s_load_dword s53, s[0:1], s39 offset:512
    s_load_dword s54, s[0:1], s39 offset:1024
    v_mfma_f32_16x16x32_bf16 v[124:127], a[44:47], v[184:187], v[124:127]
    s_load_dword s55, s[0:1], s39 offset:1536
    s_waitcnt vmcnt(9)
    v_mfma_f32_16x16x32_bf16 v[112:115], a[48:51], v[188:191], v[112:115]
    s_load_dword s56, s[0:1], s39 offset:2048
    s_load_dword s57, s[0:1], s39 offset:2560
    v_mfma_f32_16x16x32_bf16 v[116:119], a[52:55], v[188:191], v[116:119]
    buffer_load_dwordx4 v[228:231], v3, s[28:31], s73 offen sc1
    v_mfma_f32_16x16x32_bf16 v[120:123], a[56:59], v[188:191], v[120:123]
    v_mfma_f32_16x16x32_bf16 v[124:127], a[60:63], v[188:191], v[124:127]
    s_waitcnt vmcnt(9)
    v_mfma_f32_16x16x32_bf16 v[112:115], a[64:67], v[192:195], v[112:115]
    v_mfma_f32_16x16x32_bf16 v[116:119], a[68:71], v[192:195], v[116:119]
    buffer_load_dwordx4 v[232:235], v3, s[28:31], s74 offen sc1
    v_mfma_f32_16x16x32_bf16 v[120:123], a[72:75], v[192:195], v[120:123]
    v_mfma_f32_16x16x32_bf16 v[124:127], a[76:79], v[192:195], v[124:127]
    s_waitcnt vmcnt(9)
    v_mfma_f32_16x16x32_bf16 v[112:115], a[80:83], v[196:199], v[112:115]
    ds_write_b64 v34, v[96:97] offset:0
    v_mfma_f32_16x16x32_bf16 v[116:119], a[84:87], v[196:199], v[116:119]
    buffer_load_dwordx4 v[236:239], v3, s[28:31], s75 offen sc1
    v_mfma_f32_16x16x32_bf16 v[120:123], a[88:91], v[196:199], v[120:123]
    ds_write_b64 v34, v[98:99] offset:8
    v_mfma_f32_16x16x32_bf16 v[124:127], a[92:95], v[196:199], v[124:127]
    s_waitcnt vmcnt(9)
    v_mfma_f32_16x16x32_bf16 v[112:115], a[96:99], v[200:203], v[112:115]
    ds_write_b64 v35, v[100:101] offset:0
    v_mfma_f32_16x16x32_bf16 v[116:119], a[100:103], v[200:203], v[116:119]
    buffer_load_dwordx4 v[240:243], v3, s[28:31], s76 offen sc1
    v_mfma_f32_16x16x32_bf16 v[120:123], a[104:107], v[200:203], v[120:123]
    ds_write_b64 v35, v[102:103] offset:8
    v_mfma_f32_16x16x32_bf16 v[124:127], a[108:111], v[200:203], v[124:127]
    s_waitcnt vmcnt(9)
    v_mfma_f32_16x16x32_bf16 v[112:115], a[112:115], v[204:207], v[112:115]
    ds_write_b64 v36, v[104:105] offset:0
    v_mfma_f32_16x16x32_bf16 v[116:119], a[116:119], v[204:207], v[116:119]
    buffer_load_dwordx4 v[244:247], v3, s[28:31], s77 offen sc1
    v_mfma_f32_16x16x32_bf16 v[120:123], a[120:123], v[204:207], v[120:123]
    ds_write_b64 v36, v[106:107] offset:8
    v_mfma_f32_16x16x32_bf16 v[124:127], a[124:127], v[204:207], v[124:127]
    s_waitcnt vmcnt(9)
    v_mfma_f32_16x16x32_bf16 v[112:115], a[128:131], v[208:211], v[112:115]
    ds_write_b64 v37, v[108:109] offset:0
    v_mfma_f32_16x16x32_bf16 v[116:119], a[132:135], v[208:211], v[116:119]
    buffer_load_dwordx4 v[248:251], v3, s[28:31], s78 offen sc1
    v_mfma_f32_16x16x32_bf16 v[120:123], a[136:139], v[208:211], v[120:123]
    ds_write_b64 v37, v[110:111] offset:8
    v_mfma_f32_16x16x32_bf16 v[124:127], a[140:143], v[208:211], v[124:127]
    s_waitcnt vmcnt(9)
    v_mfma_f32_16x16x32_bf16 v[112:115], a[144:147], v[212:215], v[112:115]
    v_mfma_f32_16x16x32_bf16 v[116:119], a[148:151], v[212:215], v[116:119]
    buffer_load_dwordx4 v[252:255], v3, s[28:31], s79 offen sc1
    v_mfma_f32_16x16x32_bf16 v[120:123], a[152:155], v[212:215], v[120:123]
    s_waitcnt lgkmcnt(0)
    s_barrier
    v_mfma_f32_16x16x32_bf16 v[124:127], a[156:159], v[212:215], v[124:127]
    ds_read_b128 v[64:67], v38 offset:0
    s_waitcnt vmcnt(9)
    v_mfma_f32_16x16x32_bf16 v[112:115], a[160:163], v[216:219], v[112:115]
    ds_read_b128 v[68:71], v38 offset:4096
    ds_read_b128 v[72:75], v38 offset:8192
    v_mfma_f32_16x16x32_bf16 v[116:119], a[164:167], v[216:219], v[116:119]
    buffer_load_dwordx4 a[192:195], v3, s[28:31], s80 offen sc1
    ds_read_b128 v[76:79], v38 offset:12288
    v_mfma_f32_16x16x32_bf16 v[120:123], a[168:171], v[216:219], v[120:123]
    v_mfma_f32_16x16x32_bf16 v[124:127], a[172:175], v[216:219], v[124:127]
    s_waitcnt vmcnt(9)
    v_mfma_f32_16x16x32_bf16 v[112:115], a[176:179], v[220:223], v[112:115]
    v_mfma_f32_16x16x32_bf16 v[116:119], a[180:183], v[220:223], v[116:119]
    buffer_load_dwordx4 a[196:199], v3, s[28:31], s81 offen sc1
    s_waitcnt lgkmcnt(2)
    v_add_f32 v64, v64, v68
    v_mfma_f32_16x16x32_bf16 v[120:123], a[184:187], v[220:223], v[120:123]
    v_add_f32 v65, v65, v69
    v_add_f32 v66, v66, v70
    v_mfma_f32_16x16x32_bf16 v[124:127], a[188:191], v[220:223], v[124:127]
    v_add_f32 v67, v67, v71
    s_waitcnt vmcnt(9)
    v_mfma_f32_16x16x32_bf16 v[96:99], a[0:3], v[224:227], 0
    s_waitcnt lgkmcnt(0)
    v_add_f32 v72, v72, v76
    v_add_f32 v73, v73, v77
    v_mfma_f32_16x16x32_bf16 v[100:103], a[4:7], v[224:227], 0
    buffer_load_dwordx4 a[200:203], v3, s[28:31], s82 offen sc1
    v_add_f32 v74, v74, v78
    v_mfma_f32_16x16x32_bf16 v[104:107], a[8:11], v[224:227], 0
    v_add_f32 v75, v75, v79
    v_add_f32 v64, v64, v72
    v_mfma_f32_16x16x32_bf16 v[108:111], a[12:15], v[224:227], 0
    s_waitcnt lgkmcnt(0)
    s_waitcnt vmcnt(9)
    v_mfma_f32_16x16x32_bf16 v[96:99], a[16:19], v[228:231], v[96:99]
    v_add_u32 v4, s87, v13
    s_xor_b64 s[52:53], s[52:53], s[48:49]
    v_mfma_f32_16x16x32_bf16 v[100:103], a[20:23], v[228:231], v[100:103]
    buffer_load_dwordx4 a[204:207], v3, s[28:31], s83 offen sc1
    s_xor_b64 s[54:55], s[54:55], s[48:49]
    v_mfma_f32_16x16x32_bf16 v[104:107], a[24:27], v[228:231], v[104:107]
    s_or_b64 s[52:53], s[52:53], s[54:55]
    s_xor_b64 s[56:57], s[56:57], s[48:49]
    v_mfma_f32_16x16x32_bf16 v[108:111], a[28:31], v[228:231], v[108:111]
    v_add_f32 v65, v65, v73
    s_waitcnt vmcnt(9)
    v_mfma_f32_16x16x32_bf16 v[96:99], a[32:35], v[232:235], v[96:99]
    s_or_b64 s[52:53], s[52:53], s[56:57]
    s_cbranch_scc1 L_B_chk3
L_B_chk3_back:
    v_mfma_f32_16x16x32_bf16 v[100:103], a[36:39], v[232:235], v[100:103]
    buffer_load_dwordx4 a[208:211], v4, s[28:31], s72 offen sc1
    v_add_f32 v66, v66, v74
    v_mfma_f32_16x16x32_bf16 v[104:107], a[40:43], v[232:235], v[104:107]
    v_add_f32 v67, v67, v75
    v_cvt_pk_bf16_f32 v80, v64, v65
    v_mfma_f32_16x16x32_bf16 v[108:111], a[44:47], v[232:235], v[108:111]
    v_cvt_pk_bf16_f32 v81, v66, v67
    s_waitcnt vmcnt(9)
    v_mfma_f32_16x16x32_bf16 v[96:99], a[48:51], v[236:239], v[96:99]
    ds_write_b64 v34, v[112:113] offset:16384
    v_mfma_f32_16x16x32_bf16 v[100:103], a[52:55], v[236:239], v[100:103]
    buffer_load_dwordx4 a[212:215], v4, s[28:31], s73 offen sc1
    v_mfma_f32_16x16x32_bf16 v[104:107], a[56:59], v[236:239], v[104:107]
    ds_write_b64 v34, v[114:115] offset:16392
    v_mfma_f32_16x16x32_bf16 v[108:111], a[60:63], v[236:239], v[108:111]
    s_waitcnt vmcnt(9)
    v_mfma_f32_16x16x32_bf16 v[96:99], a[64:67], v[240:243], v[96:99]
    ds_write_b64 v35, v[116:117] offset:16384
    v_mfma_f32_16x16x32_bf16 v[100:103], a[68:71], v[240:243], v[100:103]
    buffer_load_dwordx4 a[216:219], v4, s[28:31], s74 offen sc1
    v_mfma_f32_16x16x32_bf16 v[104:107], a[72:75], v[240:243], v[104:107]
    ds_write_b64 v35, v[118:119] offset:16392
    v_mfma_f32_16x16x32_bf16 v[108:111], a[76:79], v[240:243], v[108:111]
    s_waitcnt vmcnt(9)
    v_mfma_f32_16x16x32_bf16 v[96:99], a[80:83], v[244:247], v[96:99]
    ds_write_b64 v36, v[120:121] offset:16384
    v_mfma_f32_16x16x32_bf16 v[100:103], a[84:87], v[244:247], v[100:103]
    buffer_load_dwordx4 a[220:223], v4, s[28:31], s75 offen sc1
    v_mfma_f32_16x16x32_bf16 v[104:107], a[88:91], v[244:247], v[104:107]
    ds_write_b64 v36, v[122:123] offset:16392
    v_mfma_f32_16x16x32_bf16 v[108:111], a[92:95], v[244:247], v[108:111]
    s_waitcnt vmcnt(9)
    v_mfma_f32_16x16x32_bf16 v[96:99], a[96:99], v[248:251], v[96:99]
    ds_write_b64 v37, v[124:125] offset:16384
    v_mfma_f32_16x16x32_bf16 v[100:103], a[100:103], v[248:251], v[100:103]
    buffer_load_dwordx4 a[224:227], v4, s[28:31], s76 offen sc1
    v_mfma_f32_16x16x32_bf16 v[104:107], a[104:107], v[248:251], v[104:107]
    ds_write_b64 v37, v[126:127] offset:16392
    v_mfma_f32_16x16x32_bf16 v[108:111], a[108:111], v[248:251], v[108:111]
    s_waitcnt vmcnt(9)
    v_mfma_f32_16x16x32_bf16 v[96:99], a[112:115], v[252:255], v[96:99]
    v_mfma_f32_16x16x32_bf16 v[100:103], a[116:119], v[252:255], v[100:103]
    buffer_load_dwordx4 a[228:231], v4, s[28:31], s77 offen sc1
    v_mfma_f32_16x16x32_bf16 v[104:107], a[120:123], v[252:255], v[104:107]
    s_waitcnt lgkmcnt(0)
    s_barrier
    v_mfma_f32_16x16x32_bf16 v[108:111], a[124:127], v[252:255], v[108:111]
    ds_read_b128 v[64:67], v38 offset:16384
    s_waitcnt vmcnt(9)
    v_mfma_f32_16x16x32_bf16 v[96:99], a[128:131], a[192:195], v[96:99]
    ds_read_b128 v[68:71], v38 offset:20480
    ds_read_b128 v[72:75], v38 offset:24576
    v_mfma_f32_16x16x32_bf16 v[100:103], a[132:135], a[192:195], v[100:103]
    buffer_load_dwordx4 a[232:235], v4, s[28:31], s78 offen sc1
    ds_read_b128 v[76:79], v38 offset:28672
    v_mfma_f32_16x16x32_bf16 v[104:107], a[136:139], a[192:195], v[104:107]
    v_mfma_f32_16x16x32_bf16 v[108:111], a[140:143], a[192:195], v[108:111]
    s_waitcnt vmcnt(9)
    v_mfma_f32_16x16x32_bf16 v[96:99], a[144:147], a[196:199], v[96:99]
    v_mfma_f32_16x16x32_bf16 v[100:103], a[148:151], a[196:199], v[100:103]
    buffer_load_dwordx4 a[236:239], v4, s[28:31], s79 offen sc1
    s_waitcnt lgkmcnt(2)
    v_add_f32 v64, v64, v68
    v_mfma_f32_16x16x32_bf16 v[104:107], a[152:155], a[196:199], v[104:107]
    v_add_f32 v65, v65, v69
    v_add_f32 v66, v66, v70
    v_mfma_f32_16x16x32_bf16 v[108:111], a[156:159], a[196:199], v[108:111]
    v_add_f32 v67, v67, v71
    s_waitcnt vmcnt(9)
    v_mfma_f32_16x16x32_bf16 v[96:99], a[160:163], a[200:203], v[96:99]
    s_waitcnt lgkmcnt(0)
    v_add_f32 v72, v72, v76
    v_add_f32 v73, v73, v77
    v_mfma_f32_16x16x32_bf16 v[100:103], a[164:167], a[200:203], v[100:103]
    buffer_load_dwordx4 a[240:243], v4, s[28:31], s80 offen sc1
    v_add_f32 v74, v74, v78
    v_mfma_f32_16x16x32_bf16 v[104:107], a[168:171], a[200:203], v[104:107]
    v_add_f32 v75, v75, v79
    v_add_f32 v64, v64, v72
    v_mfma_f32_16x16x32_bf16 v[108:111], a[172:175], a[200:203], v[108:111]
    v_add_f32 v65, v65, v73
    s_waitcnt vmcnt(9)
    v_mfma_f32_16x16x32_bf16 v[96:99], a[176:179], a[204:207], v[96:99]
    v_add_f32 v66, v66, v74
    v_add_f32 v67, v67, v75
    v_mfma_f32_16x16x32_bf16 v[100:103], a[180:183], a[204:207], v[100:103]
    buffer_load_dwordx4 a[244:247], v4, s[28:31], s81 offen sc1
    v_cvt_pk_bf16_f32 v82, v64, v65
    v_mfma_f32_16x16x32_bf16 v[104:107], a[184:187], a[204:207], v[104:107]
    v_cvt_pk_bf16_f32 v83, v66, v67
    v_mfma_f32_16x16x32_bf16 v[108:111], a[188:191], a[204:207], v[108:111]
    s_waitcnt vmcnt(9)
    v_mfma_f32_16x16x32_bf16 v[112:115], a[0:3], a[208:211], 0
    v_mfma_f32_16x16x32_bf16 v[116:119], a[4:7], a[208:211], 0
    buffer_load_dwordx4 a[248:251], v4, s[28:31], s82 offen sc1
    v_mfma_f32_16x16x32_bf16 v[120:123], a[8:11], a[208:211], 0
    v_mfma_f32_16x16x32_bf16 v[124:127], a[12:15], a[208:211], 0
    s_waitcnt vmcnt(9)
    v_mfma_f32_16x16x32_bf16 v[112:115], a[16:19], a[212:215], v[112:115]
    v_mfma_f32_16x16x32_bf16 v[116:119], a[20:23], a[212:215], v[116:119]
    buffer_load_dwordx4 a[252:255], v4, s[28:31], s83 offen sc1
    v_mfma_f32_16x16x32_bf16 v[120:123], a[24:27], a[212:215], v[120:123]
    v_mfma_f32_16x16x32_bf16 v[124:127], a[28:31], a[212:215], v[124:127]
    buffer_store_dwordx2 v[80:81], v17, s[24:27], s90 offen sc1
    s_waitcnt vmcnt(10)
    v_mfma_f32_16x16x32_bf16 v[112:115], a[32:35], a[216:219], v[112:115]
    buffer_store_dwordx2 v[82:83], v17, s[24:27], s91 offen sc1
    v_mfma_f32_16x16x32_bf16 v[116:119], a[36:39], a[216:219], v[116:119]
    v_mfma_f32_16x16x32_bf16 v[120:123], a[40:43], a[216:219], v[120:123]
    ds_write_b64 v34, v[96:97] offset:32768
    v_mfma_f32_16x16x32_bf16 v[124:127], a[44:47], a[216:219], v[124:127]
    s_waitcnt vmcnt(10)
    v_mfma_f32_16x16x32_bf16 v[112:115], a[48:51], a[220:223], v[112:115]
    ds_write_b64 v34, v[98:99] offset:32776
    v_mfma_f32_16x16x32_bf16 v[116:119], a[52:55], a[220:223], v[116:119]
    ds_write_b64 v35, v[100:101] offset:32768
    v_mfma_f32_16x16x32_bf16 v[120:123], a[56:59], a[220:223], v[120:123]
    ds_write_b64 v35, v[102:103] offset:32776
    v_mfma_f32_16x16x32_bf16 v[124:127], a[60:63], a[220:223], v[124:127]
    s_waitcnt vmcnt(9)
    v_mfma_f32_16x16x32_bf16 v[112:115], a[64:67], a[224:227], v[112:115]
    ds_write_b64 v36, v[104:105] offset:32768
    v_mfma_f32_16x16x32_bf16 v[116:119], a[68:71], a[224:227], v[116:119]
    ds_write_b64 v36, v[106:107] offset:32776
    v_mfma_f32_16x16x32_bf16 v[120:123], a[72:75], a[224:227], v[120:123]
    ds_write_b64 v37, v[108:109] offset:32768
    v_mfma_f32_16x16x32_bf16 v[124:127], a[76:79], a[224:227], v[124:127]
    s_waitcnt vmcnt(8)
    v_mfma_f32_16x16x32_bf16 v[112:115], a[80:83], a[228:231], v[112:115]
    ds_write_b64 v37, v[110:111] offset:32776
    v_mfma_f32_16x16x32_bf16 v[116:119], a[84:87], a[228:231], v[116:119]
    v_mfma_f32_16x16x32_bf16 v[120:123], a[88:91], a[228:231], v[120:123]
    v_mfma_f32_16x16x32_bf16 v[124:127], a[92:95], a[228:231], v[124:127]
    s_waitcnt vmcnt(7)
    v_mfma_f32_16x16x32_bf16 v[112:115], a[96:99], a[232:235], v[112:115]
    s_waitcnt lgkmcnt(0)
    s_barrier
    v_mfma_f32_16x16x32_bf16 v[116:119], a[100:103], a[232:235], v[116:119]
    ds_read_b128 v[64:67], v38 offset:32768
    ds_read_b128 v[68:71], v38 offset:36864
    v_mfma_f32_16x16x32_bf16 v[120:123], a[104:107], a[232:235], v[120:123]
    ds_read_b128 v[72:75], v38 offset:40960
    ds_read_b128 v[76:79], v38 offset:45056
    v_mfma_f32_16x16x32_bf16 v[124:127], a[108:111], a[232:235], v[124:127]
    s_waitcnt vmcnt(6)
    v_mfma_f32_16x16x32_bf16 v[112:115], a[112:115], a[236:239], v[112:115]
    v_mfma_f32_16x16x32_bf16 v[116:119], a[116:119], a[236:239], v[116:119]
    v_mfma_f32_16x16x32_bf16 v[120:123], a[120:123], a[236:239], v[120:123]
    s_waitcnt lgkmcnt(2)
    v_add_f32 v64, v64, v68
    v_add_f32 v65, v65, v69
    v_mfma_f32_16x16x32_bf16 v[124:127], a[124:127], a[236:239], v[124:127]
    v_add_f32 v66, v66, v70
    s_waitcnt vmcnt(5)
    v_mfma_f32_16x16x32_bf16 v[112:115], a[128:131], a[240:243], v[112:115]
    v_add_f32 v67, v67, v71
    s_waitcnt lgkmcnt(0)
    v_add_f32 v72, v72, v76
    v_mfma_f32_16x16x32_bf16 v[116:119], a[132:135], a[240:243], v[116:119]
    v_add_f32 v73, v73, v77
    v_add_f32 v74, v74, v78
    v_mfma_f32_16x16x32_bf16 v[120:123], a[136:139], a[240:243], v[120:123]
    v_add_f32 v75, v75, v79
    v_add_f32 v64, v64, v72
    v_mfma_f32_16x16x32_bf16 v[124:127], a[140:143], a[240:243], v[124:127]
    v_add_f32 v65, v65, v73
    s_waitcnt vmcnt(4)
    v_mfma_f32_16x16x32_bf16 v[112:115], a[144:147], a[244:247], v[112:115]
    v_add_f32 v66, v66, v74
    v_add_f32 v67, v67, v75
    v_mfma_f32_16x16x32_bf16 v[116:119], a[148:151], a[244:247], v[116:119]
    v_cvt_pk_bf16_f32 v84, v64, v65
    v_cvt_pk_bf16_f32 v85, v66, v67
    v_mfma_f32_16x16x32_bf16 v[120:123], a[152:155], a[244:247], v[120:123]
    buffer_store_dwordx2 v[84:85], v17, s[24:27], s92 offen sc1
    v_mfma_f32_16x16x32_bf16 v[124:127], a[156:159], a[244:247], v[124:127]
    s_waitcnt vmcnt(4)
    v_mfma_f32_16x16x32_bf16 v[112:115], a[160:163], a[248:251], v[112:115]
    s_waitcnt vmcnt(3)
    v_mfma_f32_16x16x32_bf16 v[112:115], a[176:179], a[252:255], v[112:115]
    v_mfma_f32_16x16x32_bf16 v[116:119], a[164:167], a[248:251], v[116:119]
    v_mfma_f32_16x16x32_bf16 v[116:119], a[180:183], a[252:255], v[116:119]
    v_mfma_f32_16x16x32_bf16 v[120:123], a[168:171], a[248:251], v[120:123]
    v_mfma_f32_16x16x32_bf16 v[120:123], a[184:187], a[252:255], v[120:123]
    v_mfma_f32_16x16x32_bf16 v[124:127], a[172:175], a[248:251], v[124:127]
    s_nop 0
    s_nop 1
    ds_write_b128 v34, v[112:115] offset:49152
    v_mfma_f32_16x16x32_bf16 v[124:127], a[188:191], a[252:255], v[124:127]
    ds_write_b128 v35, v[116:119] offset:49152
    s_nop 0
    ds_write_b128 v36, v[120:123] offset:49152
    s_nop 4
    ds_write_b128 v37, v[124:127] offset:49152
    s_waitcnt lgkmcnt(0)
    s_barrier
    ds_read_b128 v[64:67], v38 offset:49152
    ds_read_b128 v[68:71], v38 offset:53248
    ds_read_b128 v[72:75], v38 offset:57344
    ds_read_b128 v[76:79], v38 offset:61440
    s_waitcnt lgkmcnt(2)
    v_add_f32 v64, v64, v68
    v_add_f32 v65, v65, v69
    v_add_f32 v66, v66, v70
    v_add_f32 v67, v67, v71
    s_waitcnt lgkmcnt(0)
    v_add_f32 v72, v72, v76
    v_add_f32 v73, v73, v77
    v_add_f32 v74, v74, v78
    v_add_f32 v75, v75, v79
    v_add_f32 v64, v64, v72
    v_add_f32 v65, v65, v73
    v_add_f32 v66, v66, v74
    v_add_f32 v67, v67, v75
    v_cvt_pk_bf16_f32 v86, v64, v65
    v_cvt_pk_bf16_f32 v87, v66, v67
    buffer_store_dwordx2 v[86:87], v17, s[24:27], s93 offen nt
L_B_end:
    s_endpgm
L_B_tag:
    s_mov_b32 s96, 0
L_B_tag_loop:
    buffer_load_dword v48, v19, s[32:35], 0 offen sc1
    s_add_u32 s96, s96, 1
    s_waitcnt vmcnt(0)
    v_readfirstlane_b32 s48, v48
    s_nop 3
    s_cmp_lg_u32 s48, 0
    s_cbranch_scc1 L_B_tag_back
    s_cmp_lt_u32 s96, 40000
    s_cbranch_scc1 L_B_tag_loop
    s_branch L_B_tag_back
L_B_chk0:
    s_mov_b32 s96, 0
L_B_chk0_loop:
    buffer_load_dword v48, v50, s[28:31], s36 offen sc1
    s_add_u32 s96, s96, 1
    s_waitcnt vmcnt(0)
    v_cmp_ne_u32 vcc, s48, v48
    s_nop 1
    s_cmp_eq_u64 vcc, 0
    s_cbranch_scc1 L_B_chk0_back
    s_cmp_lt_u32 s96, 40000
    s_cbranch_scc1 L_B_chk0_loop
    s_branch L_B_chk0_back
L_B_chk1:
    s_mov_b32 s96, 0
L_B_chk1_loop:
    buffer_load_dword v48, v50, s[28:31], s37 offen sc1
    s_add_u32 s96, s96, 1
    s_waitcnt vmcnt(0)
    v_cmp_ne_u32 vcc, s48, v48
    s_nop 1
    s_cmp_eq_u64 vcc, 0
    s_cbranch_scc1 L_B_chk1_back
    s_cmp_lt_u32 s96, 40000
    s_cbranch_scc1 L_B_chk1_loop
    s_branch L_B_chk1_back
L_B_chk2:
    s_mov_b32 s96, 0
L_B_chk2_loop:
    buffer_load_dword v48, v50, s[28:31], s38 offen sc1
    s_add_u32 s96, s96, 1
    s_waitcnt vmcnt(0)
    v_cmp_ne_u32 vcc, s48, v48
    s_nop 1
    s_cmp_eq_u64 vcc, 0
    s_cbranch_scc1 L_B_chk2_back
    s_cmp_lt_u32 s96, 40000
    s_cbranch_scc1 L_B_chk2_loop
    s_branch L_B_chk2_back
L_B_chk3:
    s_mov_b32 s96, 0
L_B_chk3_loop:
    buffer_load_dword v48, v50, s[28:31], s39 offen sc1
    s_add_u32 s96, s96, 1
    s_waitcnt vmcnt(0)
    v_cmp_ne_u32 vcc, s48, v48
    s_nop 1
    s_cmp_eq_u64 vcc, 0
    s_cbranch_scc1 L_B_chk3_back
    s_cmp_lt_u32 s96, 40000
    s_cbranch_scc1 L_B_chk3_loop
    s_branch L_B_chk3_back
.p2align 12
L_C_enter:
L_C_w0_0:
    s_cbranch_execz L_C_w0_1
    s_waitcnt vmcnt(8)
    s_barrier
    ds_read_b64_tr_b16 v[128:129], v28 offset:0
    ds_read_b64_tr_b16 v[130:131], v28 offset:512
    ds_read_b64_tr_b16 v[132:133], v28 offset:8192
    ds_read_b64_tr_b16 v[134:135], v28 offset:8704
    ds_read_b128 a[192:195], v20 offset:16384
    ds_read_b128 a[196:199], v20 offset:18432
    ds_read_b128 a[200:203], v20 offset:20480
L_C_w0_1:
    s_cbranch_execz L_hopped
    ds_read_b128 a[204:207], v20 offset:22528
    ds_read_b128 a[208:211], v20 offset:24576
    ds_read_b128 a[212:215], v20 offset:26624
    ds_read_b128 a[216:219], v20 offset:28672
    s_waitcnt lgkmcnt(6)
    v_mfma_f32_16x16x32_bf16 v[64:67], v[128:131], a[192:195], 0
    ds_read_b128 a[220:223], v20 offset:30720
    s_add_u32 m0, s7, 98304
    v_mfma_f32_16x16x32_bf16 v[72:75], v[132:135], a[192:195], 0
    s_mul_i32 s4, s62, 1536
    buffer_load_dwordx4 v9, s[12:15], s4 offen lds
    s_waitcnt lgkmcnt(6)
    v_mfma_f32_16x16x32_bf16 v[68:71], v[128:131], a[196:199], 0
    ds_read_b64_tr_b16 v[136:137], v28 offset:4096
    v_mfma_f32_16x16x32_bf16 v[76:79], v[132:135], a[196:199], 0
    ds_read_b64_tr_b16 v[138:139], v28 offset:4608
    s_waitcnt lgkmcnt(6)
    v_mfma_f32_16x16x32_bf16 v[80:83], v[128:131], a[200:203], 0
    ds_read_b64_tr_b16 v[140:141], v28 offset:12288
    v_mfma_f32_16x16x32_bf16 v[88:91], v[132:135], a[200:203], 0
    ds_read_b64_tr_b16 v[142:143], v28 offset:12800
    v_mfma_f32_16x16x32_bf16 v[84:87], v[128:131], a[204:207], 0
    ds_read_b128 a[192:195], v21 offset:16384
    v_mfma_f32_16x16x32_bf16 v[92:95], v[132:135], a[204:207], 0
    buffer_load_dwordx4 v42, s[12:15], s4 offen offset:1024 lds
    s_add_u32 m0, s7, 106496
    s_waitcnt lgkmcnt(7)
    v_mfma_f32_16x16x32_bf16 v[96:99], v[128:131], a[208:211], 0
    buffer_load_dwordx4 v10, s[16:19], s4 offen lds
    ds_read_b128 a[196:199], v21 offset:18432
    v_mfma_f32_16x16x32_bf16 v[104:107], v[132:135], a[208:211], 0
    buffer_load_dwordx4 v43, s[16:19], s4 offen offset:1024 lds
    v_mfma_f32_16x16x32_bf16 v[100:103], v[128:131], a[212:215], 0
    ds_read_b128 a[200:203], v21 offset:20480
    v_mfma_f32_16x16x32_bf16 v[108:111], v[132:135], a[212:215], 0
    ds_read_b128 a[204:207], v21 offset:22528
    s_add_u32 m0, s70, 114688
    s_waitcnt lgkmcnt(8)
    v_mfma_f32_16x16x32_bf16 v[112:115], v[128:131], a[216:219], 0
    buffer_load_dwordx4 v8, s[8:11], s62 offen lds
    v_mfma_f32_16x16x32_bf16 v[120:123], v[132:135], a[216:219], 0
    ds_read_b128 a[208:211], v21 offset:24576
    s_add_u32 m0, s70, 118784
    v_mfma_f32_16x16x32_bf16 v[116:119], v[128:131], a[220:223], 0
    buffer_load_dwordx4 v1, s[8:11], s62 offen lds
    v_mfma_f32_16x16x32_bf16 v[124:127], v[132:135], a[220:223], 0
    ds_read_b128 a[212:215], v21 offset:26624
    s_add_u32 m0, s70, 122880
    s_waitcnt lgkmcnt(4)
    v_mfma_f32_16x16x32_bf16 v[64:67], v[136:139], a[192:195], v[64:67]
    buffer_load_dwordx4 v2, s[8:11], s62 offen lds
    v_mfma_f32_16x16x32_bf16 v[72:75], v[140:143], a[192:195], v[72:75]
    ds_read_b128 a[216:219], v21 offset:28672
    s_add_u32 m0, s70, 126976
    v_mfma_f32_16x16x32_bf16 v[68:71], v[136:139], a[196:199], v[68:71]
    buffer_load_dwordx4 v3, s[8:11], s62 offen lds
    v_mfma_f32_16x16x32_bf16 v[76:79], v[140:143], a[196:199], v[76:79]
    ds_read_b128 a[220:223], v21 offset:30720
    s_waitcnt lgkmcnt(4)
    v_mfma_f32_16x16x32_bf16 v[80:83], v[136:139], a[200:203], v[80:83]
    s_waitcnt vmcnt(8)
    s_barrier
    ds_read_b64_tr_b16 v[144:145], v28 offset:32768
    v_mfma_f32_16x16x32_bf16 v[88:91], v[140:143], a[200:203], v[88:91]
    ds_read_b64_tr_b16 v[146:147], v28 offset:33280
    v_mfma_f32_16x16x32_bf16 v[84:87], v[136:139], a[204:207], v[84:87]
    ds_read_b64_tr_b16 v[148:149], v28 offset:40960
    v_mfma_f32_16x16x32_bf16 v[92:95], v[140:143], a[204:207], v[92:95]
    ds_read_b64_tr_b16 v[150:151], v28 offset:41472
    s_waitcnt lgkmcnt(6)
    v_mfma_f32_16x16x32_bf16 v[96:99], v[136:139], a[208:211], v[96:99]
    ds_read_b128 a[192:195], v20 offset:49152
    v_mfma_f32_16x16x32_bf16 v[104:107], v[140:143], a[208:211], v[104:107]
    ds_read_b128 a[196:199], v20 offset:51200
    s_add_u32 m0, s7, 65536
    s_mul_i32 s4, s63, 1536
    v_mfma_f32_16x16x32_bf16 v[100:103], v[136:139], a[212:215], v[100:103]
    buffer_load_dwordx4 v9, s[12:15], s4 offen lds
    v_mfma_f32_16x16x32_bf16 v[108:111], v[140:143], a[212:215], v[108:111]
    ds_read_b128 a[200:203], v20 offset:53248
    s_waitcnt lgkmcnt(7)
    v_mfma_f32_16x16x32_bf16 v[112:115], v[136:139], a[216:219], v[112:115]
    buffer_load_dwordx4 v42, s[12:15], s4 offen offset:1024 lds
    ds_read_b128 a[204:207], v20 offset:55296
    v_mfma_f32_16x16x32_bf16 v[120:123], v[140:143], a[216:219], v[120:123]
    ds_read_b128 a[208:211], v20 offset:57344
    s_add_u32 m0, s7, 73728
    v_mfma_f32_16x16x32_bf16 v[116:119], v[136:139], a[220:223], v[116:119]
    buffer_load_dwordx4 v10, s[16:19], s4 offen lds
    v_mfma_f32_16x16x32_bf16 v[124:127], v[140:143], a[220:223], v[124:127]
    ds_read_b128 a[212:215], v20 offset:59392
    s_waitcnt lgkmcnt(5)
    v_mfma_f32_16x16x32_bf16 v[64:67], v[144:147], a[192:195], v[64:67]
    ds_read_b64_tr_b16 v[152:153], v28 offset:36864
    v_mfma_f32_16x16x32_bf16 v[72:75], v[148:151], a[192:195], v[72:75]
    ds_read_b128 a[216:219], v20 offset:61440
    s_waitcnt lgkmcnt(6)
    v_mfma_f32_16x16x32_bf16 v[68:71], v[144:147], a[196:199], v[68:71]
    buffer_load_dwordx4 v43, s[16:19], s4 offen offset:1024 lds
    v_mfma_f32_16x16x32_bf16 v[76:79], v[148:151], a[196:199], v[76:79]
    ds_read_b64_tr_b16 v[154:155], v28 offset:37376
    s_waitcnt lgkmcnt(5)
    v_mfma_f32_16x16x32_bf16 v[80:83], v[144:147], a[200:203], v[80:83]
    ds_read_b128 a[220:223], v20 offset:63488
    v_mfma_f32_16x16x32_bf16 v[88:91], v[148:151], a[200:203], v[88:91]
    ds_read_b64_tr_b16 v[156:157], v28 offset:45056
    v_mfma_f32_16x16x32_bf16 v[84:87], v[144:147], a[204:207], v[84:87]
    ds_read_b128 a[192:195], v21 offset:49152
    s_add_u32 m0, s70, 81920
    v_mfma_f32_16x16x32_bf16 v[92:95], v[148:151], a[204:207], v[92:95]
    buffer_load_dwordx4 v8, s[8:11], s63 offen lds
    s_waitcnt lgkmcnt(6)
    v_mfma_f32_16x16x32_bf16 v[96:99], v[144:147], a[208:211], v[96:99]
    ds_read_b64_tr_b16 v[158:159], v28 offset:45568
    ds_read_b128 a[196:199], v21 offset:51200
    v_mfma_f32_16x16x32_bf16 v[104:107], v[148:151], a[208:211], v[104:107]
    ds_read_b128 a[200:203], v21 offset:53248
    s_add_u32 m0, s70, 86016
    v_mfma_f32_16x16x32_bf16 v[100:103], v[144:147], a[212:215], v[100:103]
    buffer_load_dwordx4 v1, s[8:11], s63 offen lds
    v_mfma_f32_16x16x32_bf16 v[108:111], v[148:151], a[212:215], v[108:111]
    ds_read_b128 a[204:207], v21 offset:55296
    s_waitcnt lgkmcnt(6)
    v_mfma_f32_16x16x32_bf16 v[112:115], v[144:147], a[216:219], v[112:115]
    ds_read_b128 a[208:211], v21 offset:57344
    s_add_u32 m0, s70, 90112
    v_mfma_f32_16x16x32_bf16 v[120:123], v[148:151], a[216:219], v[120:123]
    buffer_load_dwordx4 v2, s[8:11], s63 offen lds
    v_mfma_f32_16x16x32_bf16 v[116:119], v[144:147], a[220:223], v[116:119]
    ds_read_b128 a[212:215], v21 offset:59392
    v_mfma_f32_16x16x32_bf16 v[124:127], v[148:151], a[220:223], v[124:127]
    ds_read_b128 a[216:219], v21 offset:61440
    s_add_u32 m0, s70, 94208
    s_waitcnt lgkmcnt(5)
    v_mfma_f32_16x16x32_bf16 v[64:67], v[152:155], a[192:195], v[64:67]
    buffer_load_dwordx4 v3, s[8:11], s63 offen lds
    v_mfma_f32_16x16x32_bf16 v[72:75], v[156:159], a[192:195], v[72:75]
    ds_read_b128 a[220:223], v21 offset:63488
    v_mfma_f32_16x16x32_bf16 v[68:71], v[152:155], a[196:199], v[68:71]
    v_mfma_f32_16x16x32_bf16 v[76:79], v[156:159], a[196:199], v[76:79]
    s_waitcnt lgkmcnt(4)
    v_mfma_f32_16x16x32_bf16 v[80:83], v[152:155], a[200:203], v[80:83]
    s_waitcnt vmcnt(8)
    s_barrier
    ds_read_b64_tr_b16 v[160:161], v29 offset:32768
    v_mfma_f32_16x16x32_bf16 v[88:91], v[156:159], a[200:203], v[88:91]
    ds_read_b64_tr_b16 v[162:163], v29 offset:33280
    v_mfma_f32_16x16x32_bf16 v[84:87], v[152:155], a[204:207], v[84:87]
    ds_read_b64_tr_b16 v[164:165], v29 offset:40960
    v_mfma_f32_16x16x32_bf16 v[92:95], v[156:159], a[204:207], v[92:95]
    ds_read_b64_tr_b16 v[166:167], v29 offset:41472
    s_waitcnt lgkmcnt(6)
    v_mfma_f32_16x16x32_bf16 v[96:99], v[152:155], a[208:211], v[96:99]
    ds_read_b128 a[192:195], v24 offset:49152
    v_mfma_f32_16x16x32_bf16 v[104:107], v[156:159], a[208:211], v[104:107]
    ds_read_b128 a[196:199], v24 offset:51200
    s_add_u32 m0, s7, 0
    s_mul_i32 s4, s64, 1536
    v_mfma_f32_16x16x32_bf16 v[100:103], v[152:155], a[212:215], v[100:103]
    buffer_load_dwordx4 v9, s[12:15], s4 offen lds
    v_mfma_f32_16x16x32_bf16 v[108:111], v[156:159], a[212:215], v[108:111]
    ds_read_b128 a[200:203], v24 offset:53248
    s_waitcnt lgkmcnt(7)
    v_mfma_f32_16x16x32_bf16 v[112:115], v[152:155], a[216:219], v[112:115]
    buffer_load_dwordx4 v42, s[12:15], s4 offen offset:1024 lds
    ds_read_b128 a[204:207], v24 offset:55296
    v_mfma_f32_16x16x32_bf16 v[120:123], v[156:159], a[216:219], v[120:123]
    s_lshr_b32 s53, s3, 1
    ds_read_b128 a[208:211], v24 offset:57344
    s_mul_i32 s52, s53, 20480
    v_mfma_f32_16x16x32_bf16 v[116:119], v[152:155], a[220:223], v[116:119]
    s_add_u32 m0, s7, 8192
    s_nop 0
    buffer_load_dwordx4 v10, s[16:19], s4 offen lds
    v_mfma_f32_16x16x32_bf16 v[124:127], v[156:159], a[220:223], v[124:127]
    ds_read_b128 a[212:215], v24 offset:59392
    v_subrev_u32 v22, s52, v5
    s_waitcnt lgkmcnt(5)
    v_mfma_f32_16x16x32_bf16 v[64:67], v[160:163], a[192:195], v[64:67]
    ds_read_b64_tr_b16 v[168:169], v29 offset:36864
    v_mfma_f32_16x16x32_bf16 v[72:75], v[164:167], a[192:195], v[72:75]
    ds_read_b128 a[216:219], v24 offset:61440
    s_waitcnt lgkmcnt(6)
    v_mfma_f32_16x16x32_bf16 v[68:71], v[160:163], a[196:199], v[68:71]
    buffer_load_dwordx4 v43, s[16:19], s4 offen offset:1024 lds
    v_mfma_f32_16x16x32_bf16 v[76:79], v[164:167], a[196:199], v[76:79]
    ds_read_b64_tr_b16 v[170:171], v29 offset:37376
    s_waitcnt lgkmcnt(5)
    v_mfma_f32_16x16x32_bf16 v[80:83], v[160:163], a[200:203], v[80:83]
    ds_read_b128 a[220:223], v24 offset:63488
    v_mfma_f32_16x16x32_bf16 v[88:91], v[164:167], a[200:203], v[88:91]
    ds_read_b64_tr_b16 v[172:173], v29 offset:45056
    v_mfma_f32_16x16x32_bf16 v[84:87], v[160:163], a[204:207], v[84:87]
    ds_read_b128 a[192:195], v25 offset:49152
    s_add_u32 m0, s70, 16384
    v_mfma_f32_16x16x32_bf16 v[92:95], v[164:167], a[204:207], v[92:95]
    buffer_load_dwordx4 v8, s[8:11], s64 offen lds
    s_waitcnt lgkmcnt(6)
    v_mfma_f32_16x16x32_bf16 v[96:99], v[160:163], a[208:211], v[96:99]
    ds_read_b64_tr_b16 v[174:175], v29 offset:45568
    ds_read_b128 a[196:199], v25 offset:51200
    v_mfma_f32_16x16x32_bf16 v[104:107], v[164:167], a[208:211], v[104:107]
    ds_read_b128 a[200:203], v25 offset:53248
    s_sub_u32 s52, s61, s60
    s_add_u32 m0, s70, 20480
    v_mfma_f32_16x16x32_bf16 v[100:103], v[160:163], a[212:215], v[100:103]
    buffer_load_dwordx4 v1, s[8:11], s64 offen lds
    v_mfma_f32_16x16x32_bf16 v[108:111], v[164:167], a[212:215], v[108:111]
    ds_read_b128 a[204:207], v25 offset:55296
    s_mul_i32 s52, s52, s53
    s_waitcnt lgkmcnt(6)
    v_mfma_f32_16x16x32_bf16 v[112:115], v[160:163], a[216:219], v[112:115]
    ds_read_b128 a[208:211], v25 offset:57344
    s_add_u32 s42, s52, s60
    s_add_u32 m0, s70, 24576
    v_mfma_f32_16x16x32_bf16 v[120:123], v[164:167], a[216:219], v[120:123]
    buffer_load_dwordx4 v2, s[8:11], s64 offen lds
    v_mfma_f32_16x16x32_bf16 v[116:119], v[160:163], a[220:223], v[116:119]
    ds_read_b128 a[212:215], v25 offset:59392
    s_sub_u32 s52, s63, s62
    v_mfma_f32_16x16x32_bf16 v[124:127], v[164:167], a[220:223], v[124:127]
    ds_read_b128 a[216:219], v25 offset:61440
    s_mul_i32 s52, s52, s53
    s_waitcnt lgkmcnt(5)
    v_mfma_f32_16x16x32_bf16 v[64:67], v[168:171], a[192:195], v[64:67]
    s_add_u32 m0, s70, 28672
    s_nop 0
    buffer_load_dwordx4 v3, s[8:11], s64 offen lds
    v_mfma_f32_16x16x32_bf16 v[72:75], v[172:175], a[192:195], v[72:75]
    ds_read_b128 a[220:223], v25 offset:63488
    s_add_u32 s43, s52, s62
    v_mfma_f32_16x16x32_bf16 v[68:71], v[168:171], a[196:199], v[68:71]
    s_sub_u32 s52, s65, s64
    s_mul_i32 s52, s52, s53
    v_mfma_f32_16x16x32_bf16 v[76:79], v[172:175], a[196:199], v[76:79]
    s_add_u32 s44, s52, s64
    s_waitcnt lgkmcnt(4)
    v_mfma_f32_16x16x32_bf16 v[80:83], v[168:171], a[200:203], v[80:83]
    s_waitcnt vmcnt(8)
    s_barrier
    ds_read_b64_tr_b16 v[176:177], v29 offset:0
    v_mfma_f32_16x16x32_bf16 v[88:91], v[172:175], a[200:203], v[88:91]
    ds_read_b64_tr_b16 v[178:179], v29 offset:512
    v_mfma_f32_16x16x32_bf16 v[84:87], v[168:171], a[204:207], v[84:87]
    ds_read_b64_tr_b16 v[180:181], v29 offset:8192
    v_mfma_f32_16x16x32_bf16 v[92:95], v[172:175], a[204:207], v[92:95]
    ds_read_b64_tr_b16 v[182:183], v29 offset:8704
    s_waitcnt lgkmcnt(6)
    v_mfma_f32_16x16x32_bf16 v[96:99], v[168:171], a[208:211], v[96:99]
    ds_read_b128 a[192:195], v24 offset:16384
    v_mfma_f32_16x16x32_bf16 v[104:107], v[172:175], a[208:211], v[104:107]
    ds_read_b128 a[196:199], v24 offset:18432
    s_add_u32 m0, s7, 32768
    s_mul_i32 s4, s65, 1536
    v_mfma_f32_16x16x32_bf16 v[100:103], v[168:171], a[212:215], v[100:103]
    buffer_load_dwordx4 v9, s[12:15], s4 offen lds
    v_mfma_f32_16x16x32_bf16 v[108:111], v[172:175], a[212:215], v[108:111]
    ds_read_b128 a[200:203], v24 offset:20480
    s_waitcnt lgkmcnt(7)
    v_mfma_f32_16x16x32_bf16 v[112:115], v[168:171], a[216:219], v[112:115]
    buffer_load_dwordx4 v42, s[12:15], s4 offen offset:1024 lds
    ds_read_b128 a[204:207], v24 offset:22528
    v_mfma_f32_16x16x32_bf16 v[120:123], v[172:175], a[216:219], v[120:123]
    s_sub_u32 s52, s67, s66
    ds_read_b128 a[208:211], v24 offset:24576
    s_mul_i32 s52, s52, s53
    v_mfma_f32_16x16x32_bf16 v[116:119], v[168:171], a[220:223], v[116:119]
    s_add_u32 m0, s7, 40960
    s_nop 0
    buffer_load_dwordx4 v10, s[16:19], s4 offen lds
    v_mfma_f32_16x16x32_bf16 v[124:127], v[172:175], a[220:223], v[124:127]
    ds_read_b128 a[212:215], v24 offset:26624
    s_add_u32 s45, s52, s66
    s_waitcnt lgkmcnt(5)
    v_mfma_f32_16x16x32_bf16 v[64:67], v[176:179], a[192:195], v[64:67]
    ds_read_b64_tr_b16 v[184:185], v29 offset:4096
    v_mfma_f32_16x16x32_bf16 v[72:75], v[180:183], a[192:195], v[72:75]
    ds_read_b128 a[216:219], v24 offset:28672
    s_waitcnt lgkmcnt(6)
    v_mfma_f32_16x16x32_bf16 v[68:71], v[176:179], a[196:199], v[68:71]
    buffer_load_dwordx4 v43, s[16:19], s4 offen offset:1024 lds
    v_mfma_f32_16x16x32_bf16 v[76:79], v[180:183], a[196:199], v[76:79]
    ds_read_b64_tr_b16 v[186:187], v29 offset:4608
    s_waitcnt lgkmcnt(5)
    v_mfma_f32_16x16x32_bf16 v[80:83], v[176:179], a[200:203], v[80:83]
    ds_read_b128 a[220:223], v24 offset:30720
    v_mfma_f32_16x16x32_bf16 v[88:91], v[180:183], a[200:203], v[88:91]
    ds_read_b64_tr_b16 v[188:189], v29 offset:12288
    v_mfma_f32_16x16x32_bf16 v[84:87], v[176:179], a[204:207], v[84:87]
    ds_read_b128 a[192:195], v25 offset:16384
    s_add_u32 m0, s70, 49152
    v_mfma_f32_16x16x32_bf16 v[92:95], v[180:183], a[204:207], v[92:95]
    buffer_load_dwordx4 v8, s[8:11], s65 offen lds
    s_waitcnt lgkmcnt(6)
    v_mfma_f32_16x16x32_bf16 v[96:99], v[176:179], a[208:211], v[96:99]
    ds_read_b64_tr_b16 v[190:191], v29 offset:12800
    ds_read_b128 a[196:199], v25 offset:18432
    v_mfma_f32_16x16x32_bf16 v[104:107], v[180:183], a[208:211], v[104:107]
    ds_read_b128 a[200:203], v25 offset:20480
    s_sub_u32 s52, s69, s68
    s_add_u32 m0, s70, 53248
    v_mfma_f32_16x16x32_bf16 v[100:103], v[176:179], a[212:215], v[100:103]
    buffer_load_dwordx4 v1, s[8:11], s65 offen lds
    v_mfma_f32_16x16x32_bf16 v[108:111], v[180:183], a[212:215], v[108:111]
    ds_read_b128 a[204:207], v25 offset:22528
    s_mul_i32 s52, s52, s53
    s_waitcnt lgkmcnt(6)
    v_mfma_f32_16x16x32_bf16 v[112:115], v[176:179], a[216:219], v[112:115]
    ds_read_b128 a[208:211], v25 offset:24576
    s_add_u32 s46, s52, s68
    s_add_u32 m0, s70, 57344
    v_mfma_f32_16x16x32_bf16 v[120:123], v[180:183], a[216:219], v[120:123]
    buffer_load_dwordx4 v2, s[8:11], s65 offen lds
    v_mfma_f32_16x16x32_bf16 v[116:119], v[176:179], a[220:223], v[116:119]
    ds_read_b128 a[212:215], v25 offset:26624
    v_mfma_f32_16x16x32_bf16 v[124:127], v[180:183], a[220:223], v[124:127]
    ds_read_b128 a[216:219], v25 offset:28672
    s_add_u32 m0, s70, 61440
    s_waitcnt lgkmcnt(5)
    v_mfma_f32_16x16x32_bf16 v[64:67], v[184:187], a[192:195], v[64:67]
    buffer_load_dwordx4 v3, s[8:11], s65 offen lds
    v_mfma_f32_16x16x32_bf16 v[72:75], v[188:191], a[192:195], v[72:75]
    ds_read_b128 a[220:223], v25 offset:30720
    v_mfma_f32_16x16x32_bf16 v[68:71], v[184:187], a[196:199], v[68:71]
    v_mfma_f32_16x16x32_bf16 v[76:79], v[188:191], a[196:199], v[76:79]
    s_waitcnt lgkmcnt(4)
    v_mfma_f32_16x16x32_bf16 v[80:83], v[184:187], a[200:203], v[80:83]
    s_waitcnt vmcnt(8)
    s_barrier
    ds_read_b64_tr_b16 v[192:193], v28 offset:0
    v_mfma_f32_16x16x32_bf16 v[88:91], v[188:191], a[200:203], v[88:91]
    ds_read_b64_tr_b16 v[194:195], v28 offset:512
    v_mfma_f32_16x16x32_bf16 v[84:87], v[184:187], a[204:207], v[84:87]
    ds_read_b64_tr_b16 v[196:197], v28 offset:8192
    v_mfma_f32_16x16x32_bf16 v[92:95], v[188:191], a[204:207], v[92:95]
    ds_read_b64_tr_b16 v[198:199], v28 offset:8704
    s_waitcnt lgkmcnt(6)
    v_mfma_f32_16x16x32_bf16 v[96:99], v[184:187], a[208:211], v[96:99]
    ds_read_b128 a[192:195], v20 offset:16384
    v_mfma_f32_16x16x32_bf16 v[104:107], v[188:191], a[208:211], v[104:107]
    ds_read_b128 a[196:199], v20 offset:18432
    s_add_u32 m0, s7, 98304
    s_mul_i32 s4, s66, 1536
    v_mfma_f32_16x16x32_bf16 v[100:103], v[184:187], a[212:215], v[100:103]
    buffer_load_dwordx4 v9, s[12:15], s4 offen lds
    v_mfma_f32_16x16x32_bf16 v[108:111], v[188:191], a[212:215], v[108:111]
    ds_read_b128 a[200:203], v20 offset:20480
    s_waitcnt lgkmcnt(7)
    v_mfma_f32_16x16x32_bf16 v[112:115], v[184:187], a[216:219], v[112:115]
    buffer_load_dwordx4 v42, s[12:15], s4 offen offset:1024 lds
    ds_read_b128 a[204:207], v20 offset:22528
    v_mfma_f32_16x16x32_bf16 v[120:123], v[188:191], a[216:219], v[120:123]
    ds_read_b128 a[208:211], v20 offset:24576
    s_add_u32 m0, s7, 106496
    v_mfma_f32_16x16x32_bf16 v[116:119], v[184:187], a[220:223], v[116:119]
    buffer_load_dwordx4 v10, s[16:19], s4 offen lds
    v_mfma_f32_16x16x32_bf16 v[124:127], v[188:191], a[220:223], v[124:127]
    ds_read_b128 a[212:215], v20 offset:26624
    s_waitcnt lgkmcnt(5)
    v_mfma_f32_16x16x32_bf16 v[64:67], v[192:195], a[192:195], v[64:67]
    ds_read_b64_tr_b16 v[200:201], v28 offset:4096
    v_mfma_f32_16x16x32_bf16 v[72:75], v[196:199], a[192:195], v[72:75]
    ds_read_b128 a[216:219], v20 offset:28672
    s_waitcnt lgkmcnt(6)
    v_mfma_f32_16x16x32_bf16 v[68:71], v[192:195], a[196:199], v[68:71]
    buffer_load_dwordx4 v43, s[16:19], s4 offen offset:1024 lds
    v_mfma_f32_16x16x32_bf16 v[76:79], v[196:199], a[196:199], v[76:79]
    ds_read_b64_tr_b16 v[202:203], v28 offset:4608
    s_waitcnt lgkmcnt(5)
    v_mfma_f32_16x16x32_bf16 v[80:83], v[192:195], a[200:203], v[80:83]
    ds_read_b128 a[220:223], v20 offset:30720
    v_mfma_f32_16x16x32_bf16 v[88:91], v[196:199], a[200:203], v[88:91]
    ds_read_b64_tr_b16 v[204:205], v28 offset:12288
    v_mfma_f32_16x16x32_bf16 v[84:87], v[192:195], a[204:207], v[84:87]
    ds_read_b128 a[192:195], v21 offset:16384
    s_add_u32 m0, s70, 114688
    v_mfma_f32_16x16x32_bf16 v[92:95], v[196:199], a[204:207], v[92:95]
    buffer_load_dwordx4 v8, s[8:11], s66 offen lds
    s_waitcnt lgkmcnt(6)
    v_mfma_f32_16x16x32_bf16 v[96:99], v[192:195], a[208:211], v[96:99]
    ds_read_b64_tr_b16 v[206:207], v28 offset:12800
    ds_read_b128 a[196:199], v21 offset:18432
    v_mfma_f32_16x16x32_bf16 v[104:107], v[196:199], a[208:211], v[104:107]
    ds_read_b128 a[200:203], v21 offset:20480
    s_add_u32 m0, s70, 118784
    v_mfma_f32_16x16x32_bf16 v[100:103], v[192:195], a[212:215], v[100:103]
    buffer_load_dwordx4 v1, s[8:11], s66 offen lds
    v_mfma_f32_16x16x32_bf16 v[108:111], v[196:199], a[212:215], v[108:111]
    ds_read_b128 a[204:207], v21 offset:22528
    s_waitcnt lgkmcnt(6)
    v_mfma_f32_16x16x32_bf16 v[112:115], v[192:195], a[216:219], v[112:115]
    ds_read_b128 a[208:211], v21 offset:24576
    s_add_u32 m0, s70, 122880
    v_mfma_f32_16x16x32_bf16 v[120:123], v[196:199], a[216:219], v[120:123]
    buffer_load_dwordx4 v2, s[8:11], s66 offen lds
    v_mfma_f32_16x16x32_bf16 v[116:119], v[192:195], a[220:223], v[116:119]
    ds_read_b128 a[212:215], v21 offset:26624
    v_mfma_f32_16x16x32_bf16 v[124:127], v[196:199], a[220:223], v[124:127]
    ds_read_b128 a[216:219], v21 offset:28672
    s_add_u32 m0, s70, 126976
    s_waitcnt lgkmcnt(5)
    v_mfma_f32_16x16x32_bf16 v[64:67], v[200:203], a[192:195], v[64:67]
    buffer_load_dwordx4 v3, s[8:11], s66 offen lds
    v_mfma_f32_16x16x32_bf16 v[72:75], v[204:207], a[192:195], v[72:75]
    ds_read_b128 a[220:223], v21 offset:30720
    v_mfma_f32_16x16x32_bf16 v[68:71], v[200:203], a[196:199], v[68:71]
    v_mfma_f32_16x16x32_bf16 v[76:79], v[204:207], a[196:199], v[76:79]
    s_waitcnt lgkmcnt(4)
    v_mfma_f32_16x16x32_bf16 v[80:83], v[200:203], a[200:203], v[80:83]
    s_waitcnt vmcnt(8)
    s_barrier
    ds_read_b64_tr_b16 v[208:209], v28 offset:32768
    v_mfma_f32_16x16x32_bf16 v[88:91], v[204:207], a[200:203], v[88:91]
    ds_read_b64_tr_b16 v[210:211], v28 offset:33280
    v_mfma_f32_16x16x32_bf16 v[84:87], v[200:203], a[204:207], v[84:87]
    ds_read_b64_tr_b16 v[212:213], v28 offset:40960
    v_mfma_f32_16x16x32_bf16 v[92:95], v[204:207], a[204:207], v[92:95]
    ds_read_b64_tr_b16 v[214:215], v28 offset:41472
    s_waitcnt lgkmcnt(6)
    v_mfma_f32_16x16x32_bf16 v[96:99], v[200:203], a[208:211], v[96:99]
    ds_read_b128 a[192:195], v20 offset:49152
    v_mfma_f32_16x16x32_bf16 v[104:107], v[204:207], a[208:211], v[104:107]
    ds_read_b128 a[196:199], v20 offset:51200
    s_add_u32 m0, s7, 65536
    s_mul_i32 s4, s67, 1536
    v_mfma_f32_16x16x32_bf16 v[100:103], v[200:203], a[212:215], v[100:103]
    buffer_load_dwordx4 v9, s[12:15], s4 offen lds
    v_mfma_f32_16x16x32_bf16 v[108:111], v[204:207], a[212:215], v[108:111]
    ds_read_b128 a[200:203], v20 offset:53248
    s_waitcnt lgkmcnt(7)
    v_mfma_f32_16x16x32_bf16 v[112:115], v[200:203], a[216:219], v[112:115]
    buffer_load_dwordx4 v42, s[12:15], s4 offen offset:1024 lds
    ds_read_b128 a[204:207], v20 offset:55296
    v_mfma_f32_16x16x32_bf16 v[120:123], v[204:207], a[216:219], v[120:123]
    s_load_dword s48, s[32:33], 0
    ds_read_b128 a[208:211], v20 offset:57344
    s_add_u32 m0, s7, 73728
    v_mfma_f32_16x16x32_bf16 v[116:119], v[200:203], a[220:223], v[116:119]
    buffer_load_dwordx4 v10, s[16:19], s4 offen lds
    v_mfma_f32_16x16x32_bf16 v[124:127], v[204:207], a[220:223], v[124:127]
    ds_read_b128 a[212:215], v20 offset:59392
    s_waitcnt lgkmcnt(5)
    v_mfma_f32_16x16x32_bf16 v[64:67], v[208:211], a[192:195], v[64:67]
    ds_read_b64_tr_b16 v[216:217], v28 offset:36864
    v_mfma_f32_16x16x32_bf16 v[72:75], v[212:215], a[192:195], v[72:75]
    ds_read_b128 a[216:219], v20 offset:61440
    s_waitcnt lgkmcnt(6)
    v_mfma_f32_16x16x32_bf16 v[68:71], v[208:211], a[196:199], v[68:71]
    buffer_load_dwordx4 v43, s[16:19], s4 offen offset:1024 lds
    v_mfma_f32_16x16x32_bf16 v[76:79], v[212:215], a[196:199], v[76:79]
    ds_read_b64_tr_b16 v[218:219], v28 offset:37376
    s_waitcnt lgkmcnt(5)
    v_mfma_f32_16x16x32_bf16 v[80:83], v[208:211], a[200:203], v[80:83]
    ds_read_b128 a[220:223], v20 offset:63488
    v_mfma_f32_16x16x32_bf16 v[88:91], v[212:215], a[200:203], v[88:91]
    ds_read_b64_tr_b16 v[220:221], v28 offset:45056
    v_mfma_f32_16x16x32_bf16 v[84:87], v[208:211], a[204:207], v[84:87]
    ds_read_b128 a[192:195], v21 offset:49152
    s_add_u32 m0, s70, 81920
    v_mfma_f32_16x16x32_bf16 v[92:95], v[212:215], a[204:207], v[92:95]
    buffer_load_dwordx4 v8, s[8:11], s67 offen lds
    s_waitcnt lgkmcnt(6)
    v_mfma_f32_16x16x32_bf16 v[96:99], v[208:211], a[208:211], v[96:99]
    ds_read_b64_tr_b16 v[222:223], v28 offset:45568
    ds_read_b128 a[196:199], v21 offset:51200
    v_mfma_f32_16x16x32_bf16 v[104:107], v[212:215], a[208:211], v[104:107]
    ds_read_b128 a[200:203], v21 offset:53248
    s_add_u32 m0, s70, 86016
    v_mfma_f32_16x16x32_bf16 v[100:103], v[208:211], a[212:215], v[100:103]
    buffer_load_dwordx4 v1, s[8:11], s67 offen lds
    v_mfma_f32_16x16x32_bf16 v[108:111], v[212:215], a[212:215], v[108:111]
    ds_read_b128 a[204:207], v21 offset:55296
    s_waitcnt lgkmcnt(6)
    v_mfma_f32_16x16x32_bf16 v[112:115], v[208:211], a[216:219], v[112:115]
    ds_read_b128 a[208:211], v21 offset:57344
    s_add_u32 m0, s70, 90112
    v_mfma_f32_16x16x32_bf16 v[120:123], v[212:215], a[216:219], v[120:123]
    buffer_load_dwordx4 v2, s[8:11], s67 offen lds
    v_mfma_f32_16x16x32_bf16 v[116:119], v[208:211], a[220:223], v[116:119]
    ds_read_b128 a[212:215], v21 offset:59392
    v_mfma_f32_16x16x32_bf16 v[124:127], v[212:215], a[220:223], v[124:127]
    ds_read_b128 a[216:219], v21 offset:61440
    s_add_u32 m0, s70, 94208
    s_waitcnt lgkmcnt(5)
    v_mfma_f32_16x16x32_bf16 v[64:67], v[216:219], a[192:195], v[64:67]
    buffer_load_dwordx4 v3, s[8:11], s67 offen lds
    v_mfma_f32_16x16x32_bf16 v[72:75], v[220:223], a[192:195], v[72:75]
    ds_read_b128 a[220:223], v21 offset:63488
    v_mfma_f32_16x16x32_bf16 v[68:71], v[216:219], a[196:199], v[68:71]
    v_mfma_f32_16x16x32_bf16 v[76:79], v[220:223], a[196:199], v[76:79]
    s_waitcnt lgkmcnt(4)
    v_mfma_f32_16x16x32_bf16 v[80:83], v[216:219], a[200:203], v[80:83]
    s_waitcnt lgkmcnt(0)
    s_waitcnt vmcnt(8)
    s_barrier
    v_mfma_f32_16x16x32_bf16 v[88:91], v[220:223], a[200:203], v[88:91]
    ds_read_b64_tr_b16 v[224:225], v29 offset:32768
    v_mfma_f32_16x16x32_bf16 v[84:87], v[216:219], a[204:207], v[84:87]
    ds_read_b64_tr_b16 v[226:227], v29 offset:33280
    v_mfma_f32_16x16x32_bf16 v[92:95], v[220:223], a[204:207], v[92:95]
    ds_read_b64_tr_b16 v[228:229], v29 offset:40960
    v_mfma_f32_16x16x32_bf16 v[96:99], v[216:219], a[208:211], v[96:99]
    ds_read_b64_tr_b16 v[230:231], v29 offset:41472
    ds_read_b128 a[192:195], v24 offset:49152
    v_mfma_f32_16x16x32_bf16 v[104:107], v[220:223], a[208:211], v[104:107]
    ds_read_b128 a[196:199], v24 offset:51200
    s_add_u32 m0, s7, 0
    s_mul_i32 s4, s68, 1536
    v_mfma_f32_16x16x32_bf16 v[100:103], v[216:219], a[212:215], v[100:103]
    ds_read_b128 a[200:203], v24 offset:53248
    v_mfma_f32_16x16x32_bf16 v[108:111], v[220:223], a[212:215], v[108:111]
    buffer_load_dwordx4 v9, s[12:15], s4 offen lds
    s_cmp_eq_u32 s48, 0
    s_cbranch_scc1 L_C_tag
L_C_tag_back:
    v_mfma_f32_16x16x32_bf16 v[112:115], v[216:219], a[216:219], v[112:115]
    ds_read_b128 a[204:207], v24 offset:55296
    v_mov_b32 v40, s48
    s_mov_b32 s49, s48
    v_mfma_f32_16x16x32_bf16 v[120:123], v[220:223], a[216:219], v[120:123]
    buffer_load_dwordx4 v42, s[12:15], s4 offen offset:1024 lds
    s_add_u32 m0, s7, 8192
    v_mfma_f32_16x16x32_bf16 v[116:119], v[216:219], a[220:223], v[116:119]
    ds_read_b128 a[208:211], v24 offset:57344
    s_sub_u32 s100, s48, s100
    v_mfma_f32_16x16x32_bf16 v[124:127], v[220:223], a[220:223], v[124:127]
    buffer_load_dwordx4 v10, s[16:19], s4 offen lds
    s_waitcnt lgkmcnt(4)
    v_mfma_f32_16x16x32_bf16 v[64:67], v[224:227], a[192:195], v[64:67]
    ds_read_b128 a[212:215], v24 offset:59392
    s_sub_u32 s47, s48, s47
    v_mfma_f32_16x16x32_bf16 v[72:75], v[228:231], a[192:195], v[72:75]
    buffer_load_dwordx4 v43, s[16:19], s4 offen offset:1024 lds
    s_add_u32 m0, s70, 16384
    s_waitcnt lgkmcnt(4)
    v_mfma_f32_16x16x32_bf16 v[68:71], v[224:227], a[196:199], v[68:71]
    buffer_load_dwordx4 v8, s[8:11], s68 offen lds
    v_mfma_f32_16x16x32_bf16 v[76:79], v[228:231], a[196:199], v[76:79]
    ds_read_b64_tr_b16 v[232:233], v29 offset:36864
    s_waitcnt lgkmcnt(3)
    v_mfma_f32_16x16x32_bf16 v[80:83], v[224:227], a[200:203], v[80:83]
    ds_read_b128 a[216:219], v24 offset:61440
    s_add_u32 m0, s70, 20480
    s_nop 0
    buffer_load_dwordx4 v1, s[8:11], s68 offen lds
    ds_read_b64_tr_b16 v[234:235], v29 offset:37376
    ds_read_b128 a[220:223], v24 offset:63488
    v_mfma_f32_16x16x32_bf16 v[88:91], v[228:231], a[200:203], v[88:91]
    s_add_u32 m0, s70, 24576
    s_nop 0
    buffer_load_dwordx4 v2, s[8:11], s68 offen lds
    v_mfma_f32_16x16x32_bf16 v[84:87], v[224:227], a[204:207], v[84:87]
    ds_read_b64_tr_b16 v[236:237], v29 offset:45056
L_C_w1_0:
    s_cbranch_execz L_C_w1_1
    v_mfma_f32_16x16x32_bf16 v[92:95], v[228:231], a[204:207], v[92:95]
    ds_read_b128 a[192:195], v25 offset:49152
    s_add_u32 m0, s70, 28672
    s_waitcnt lgkmcnt(6)
    v_mfma_f32_16x16x32_bf16 v[96:99], v[224:227], a[208:211], v[96:99]
    ds_read_b64_tr_b16 v[238:239], v29 offset:45568
    ds_read_b128 a[196:199], v25 offset:51200
    v_mfma_f32_16x16x32_bf16 v[104:107], v[228:231], a[208:211], v[104:107]
L_C_w1_1:
    s_cbranch_execz L_hopped
    buffer_load_dwordx4 v3, s[8:11], s68 offen lds
    s_add_u32 m0, s71, 131072
    s_mul_i32 s6, s72, 40
    v_mfma_f32_16x16x32_bf16 v[100:103], v[224:227], a[212:215], v[100:103]
    buffer_load_dwordx4 v11, s[20:23], s6 offen lds
    v_mfma_f32_16x16x32_bf16 v[108:111], v[228:231], a[212:215], v[108:111]
    ds_read_b128 a[200:203], v25 offset:53248
    s_waitcnt lgkmcnt(5)
    v_mfma_f32_16x16x32_bf16 v[112:115], v[224:227], a[216:219], v[112:115]
    buffer_load_dwordx4 v44, s[20:23], s6 offen offset:1024 lds
    ds_read_b128 a[204:207], v25 offset:55296
    v_mfma_f32_16x16x32_bf16 v[120:123], v[228:231], a[216:219], v[120:123]
    buffer_load_dwordx4 v45, s[20:23], s6 offen offset:2048 lds
    v_mfma_f32_16x16x32_bf16 v[116:119], v[224:227], a[220:223], v[116:119]
    ds_read_b128 a[208:211], v25 offset:57344
    v_mfma_f32_16x16x32_bf16 v[124:127], v[228:231], a[220:223], v[124:127]
    ds_read_b128 a[212:215], v25 offset:59392
    s_waitcnt lgkmcnt(4)
    v_mfma_f32_16x16x32_bf16 v[64:67], v[232:235], a[192:195], v[64:67]
    buffer_load_dwordx4 v46, s[20:23], s6 offen offset:3072 lds
    s_add_u32 m0, s71, 147456
    s_mul_i32 s6, s73, 40
    v_mfma_f32_16x16x32_bf16 v[72:75], v[236:239], a[192:195], v[72:75]
    buffer_load_dwordx4 v11, s[20:23], s6 offen lds
    v_mfma_f32_16x16x32_bf16 v[68:71], v[232:235], a[196:199], v[68:71]
    ds_read_b128 a[216:219], v25 offset:61440
    v_mfma_f32_16x16x32_bf16 v[76:79], v[236:239], a[196:199], v[76:79]
    buffer_load_dwordx4 v44, s[20:23], s6 offen offset:1024 lds
    s_waitcnt lgkmcnt(3)
    v_mfma_f32_16x16x32_bf16 v[80:83], v[232:235], a[200:203], v[80:83]
    ds_read_b128 a[220:223], v25 offset:63488
    v_mfma_f32_16x16x32_bf16 v[88:91], v[236:239], a[200:203], v[88:91]
    buffer_load_dwordx4 v45, s[20:23], s6 offen offset:2048 lds
    s_waitcnt vmcnt(15)
    s_barrier
    v_mfma_f32_16x16x32_bf16 v[84:87], v[232:235], a[204:207], v[84:87]
    ds_read_b64_tr_b16 v[240:241], v29 offset:0
    v_mfma_f32_16x16x32_bf16 v[92:95], v[236:239], a[204:207], v[92:95]
    ds_read_b64_tr_b16 v[242:243], v29 offset:512
    s_waitcnt lgkmcnt(4)
    v_mfma_f32_16x16x32_bf16 v[96:99], v[232:235], a[208:211], v[96:99]
    ds_read_b64_tr_b16 v[244:245], v29 offset:8192
    ds_read_b64_tr_b16 v[246:247], v29 offset:8704
    ds_read_b128 a[192:195], v24 offset:16384
    v_mfma_f32_16x16x32_bf16 v[104:107], v[236:239], a[208:211], v[104:107]
    ds_read_b128 a[196:199], v24 offset:18432
    v_mfma_f32_16x16x32_bf16 v[100:103], v[232:235], a[212:215], v[100:103]
    buffer_load_dwordx4 v46, s[20:23], s6 offen offset:3072 lds
    s_add_u32 m0, s7, 32768
    s_mul_i32 s4, s69, 1536
    v_mfma_f32_16x16x32_bf16 v[108:111], v[236:239], a[212:215], v[108:111]
    buffer_load_dwordx4 v9, s[12:15], s4 offen lds
    s_waitcnt lgkmcnt(6)
    v_mfma_f32_16x16x32_bf16 v[112:115], v[232:235], a[216:219], v[112:115]
    ds_read_b128 a[200:203], v24 offset:20480
    buffer_load_dwordx4 v42, s[12:15], s4 offen offset:1024 lds
    ds_read_b128 a[204:207], v24 offset:22528
    v_mfma_f32_16x16x32_bf16 v[120:123], v[236:239], a[216:219], v[120:123]
    ds_read_b128 a[208:211], v24 offset:24576
    s_add_u32 m0, s7, 40960
    v_mfma_f32_16x16x32_bf16 v[116:119], v[232:235], a[220:223], v[116:119]
    buffer_load_dwordx4 v10, s[16:19], s4 offen lds
    v_mfma_f32_16x16x32_bf16 v[124:127], v[236:239], a[220:223], v[124:127]
    ds_read_b128 a[212:215], v24 offset:26624
    s_waitcnt lgkmcnt(5)
    v_mfma_f32_16x16x32_bf16 v[64:67], v[240:243], a[192:195], v[64:67]
    ds_read_b64_tr_b16 v[248:249], v29 offset:4096
    v_mfma_f32_16x16x32_bf16 v[72:75], v[244:247], a[192:195], v[72:75]
    ds_read_b128 a[216:219], v24 offset:28672
    s_waitcnt lgkmcnt(6)
    v_mfma_f32_16x16x32_bf16 v[68:71], v[240:243], a[196:199], v[68:71]
    buffer_load_dwordx4 v43, s[16:19], s4 offen offset:1024 lds
    v_mfma_f32_16x16x32_bf16 v[76:79], v[244:247], a[196:199], v[76:79]
    ds_read_b64_tr_b16 v[250:251], v29 offset:4608
    s_waitcnt lgkmcnt(5)
    v_mfma_f32_16x16x32_bf16 v[80:83], v[240:243], a[200:203], v[80:83]
    ds_read_b128 a[220:223], v24 offset:30720
    v_mfma_f32_16x16x32_bf16 v[88:91], v[244:247], a[200:203], v[88:91]
    ds_read_b64_tr_b16 v[252:253], v29 offset:12288
    v_mfma_f32_16x16x32_bf16 v[84:87], v[240:243], a[204:207], v[84:87]
    ds_read_b128 a[192:195], v25 offset:16384
    s_add_u32 m0, s70, 49152
    v_mfma_f32_16x16x32_bf16 v[92:95], v[244:247], a[204:207], v[92:95]
    buffer_load_dwordx4 v8, s[8:11], s69 offen lds
    s_waitcnt lgkmcnt(6)
    v_mfma_f32_16x16x32_bf16 v[96:99], v[240:243], a[208:211], v[96:99]
    ds_read_b64_tr_b16 v[254:255], v29 offset:12800
    ds_read_b128 a[196:199], v25 offset:18432
    v_mfma_f32_16x16x32_bf16 v[104:107], v[244:247], a[208:211], v[104:107]
    ds_read_b128 a[200:203], v25 offset:20480
    s_add_u32 m0, s70, 53248
    v_mfma_f32_16x16x32_bf16 v[100:103], v[240:243], a[212:215], v[100:103]
    buffer_load_dwordx4 v1, s[8:11], s69 offen lds
    v_mfma_f32_16x16x32_bf16 v[108:111], v[244:247], a[212:215], v[108:111]
    ds_read_b128 a[204:207], v25 offset:22528
    s_waitcnt lgkmcnt(6)
    v_mfma_f32_16x16x32_bf16 v[112:115], v[240:243], a[216:219], v[112:115]
    ds_read_b128 a[208:211], v25 offset:24576
    s_add_u32 m0, s70, 57344
    v_mfma_f32_16x16x32_bf16 v[120:123], v[244:247], a[216:219], v[120:123]
    buffer_load_dwordx4 v2, s[8:11], s69 offen lds
    v_mfma_f32_16x16x32_bf16 v[116:119], v[240:243], a[220:223], v[116:119]
    ds_read_b128 a[212:215], v25 offset:26624
    v_mfma_f32_16x16x32_bf16 v[124:127], v[244:247], a[220:223], v[124:127]
    ds_read_b128 a[216:219], v25 offset:28672
    s_add_u32 m0, s70, 61440
    s_waitcnt lgkmcnt(5)
    v_mfma_f32_16x16x32_bf16 v[64:67], v[248:251], a[192:195], v[64:67]
    buffer_load_dwordx4 v3, s[8:11], s69 offen lds
    v_mfma_f32_16x16x32_bf16 v[72:75], v[252:255], a[192:195], v[72:75]
    ds_read_b128 a[220:223], v25 offset:30720
    v_mfma_f32_16x16x32_bf16 v[68:71], v[248:251], a[196:199], v[68:71]
    v_mfma_f32_16x16x32_bf16 v[76:79], v[252:255], a[196:199], v[76:79]
    s_waitcnt lgkmcnt(4)
    v_mfma_f32_16x16x32_bf16 v[80:83], v[248:251], a[200:203], v[80:83]
    s_waitcnt vmcnt(16)
    s_barrier
    ds_read_b64_tr_b16 a[224:225], v28 offset:0
    v_mfma_f32_16x16x32_bf16 v[88:91], v[252:255], a[200:203], v[88:91]
    ds_read_b64_tr_b16 a[226:227], v28 offset:512
    v_mfma_f32_16x16x32_bf16 v[84:87], v[248:251], a[204:207], v[84:87]
    ds_read_b64_tr_b16 a[228:229], v28 offset:8192
    v_mfma_f32_16x16x32_bf16 v[92:95], v[252:255], a[204:207], v[92:95]
    ds_read_b64_tr_b16 a[230:231], v28 offset:8704
    s_waitcnt lgkmcnt(6)
    v_mfma_f32_16x16x32_bf16 v[96:99], v[248:251], a[208:211], v[96:99]
    ds_read_b128 a[192:195], v20 offset:16384
    v_mfma_f32_16x16x32_bf16 v[104:107], v[252:255], a[208:211], v[104:107]
    ds_read_b128 a[196:199], v20 offset:18432
    s_add_u32 m0, s70, 98304
    v_mfma_f32_16x16x32_bf16 v[100:103], v[248:251], a[212:215], v[100:103]
    buffer_load_dwordx4 v4, s[8:11], s60 offen lds
    v_mfma_f32_16x16x32_bf16 v[108:111], v[252:255], a[212:215], v[108:111]
    ds_read_b128 a[200:203], v20 offset:20480
    s_waitcnt lgkmcnt(7)
    v_mfma_f32_16x16x32_bf16 v[112:115], v[248:251], a[216:219], v[112:115]
    ds_read_b128 a[204:207], v20 offset:22528
    s_add_u32 m0, s70, 102400
    v_mfma_f32_16x16x32_bf16 v[120:123], v[252:255], a[216:219], v[120:123]
    buffer_load_dwordx4 v4, s[8:11], s61 offen lds
    v_mfma_f32_16x16x32_bf16 v[116:119], v[248:251], a[220:223], v[116:119]
    ds_read_b128 a[208:211], v20 offset:24576
    v_mfma_f32_16x16x32_bf16 v[124:127], v[252:255], a[220:223], v[124:127]
    ds_read_b128 a[212:215], v20 offset:26624
    s_add_u32 m0, s70, 106496
    s_waitcnt lgkmcnt(5)
    v_mfma_f32_16x16x32_bf16 v[64:67], a[224:227], a[192:195], v[64:67]
    buffer_load_dwordx4 v4, s[8:11], s62 offen lds
    v_mfma_f32_16x16x32_bf16 v[72:75], a[228:231], a[192:195], v[72:75]
    ds_read_b64_tr_b16 a[232:233], v28 offset:4096
    s_waitcnt lgkmcnt(5)
    v_mfma_f32_16x16x32_bf16 v[68:71], a[224:227], a[196:199], v[68:71]
    ds_read_b128 a[216:219], v20 offset:28672
    v_mfma_f32_16x16x32_bf16 v[76:79], a[228:231], a[196:199], v[76:79]
    ds_read_b64_tr_b16 a[234:235], v28 offset:4608
    s_waitcnt lgkmcnt(5)
    v_mfma_f32_16x16x32_bf16 v[80:83], a[224:227], a[200:203], v[80:83]
    ds_read_b128 a[220:223], v20 offset:30720
    s_add_u32 m0, s70, 110592
    v_mfma_f32_16x16x32_bf16 v[88:91], a[228:231], a[200:203], v[88:91]
    buffer_load_dwordx4 v4, s[8:11], s63 offen lds
    v_mfma_f32_16x16x32_bf16 v[84:87], a[224:227], a[204:207], v[84:87]
    ds_read_b64_tr_b16 a[236:237], v28 offset:12288
    v_mfma_f32_16x16x32_bf16 v[92:95], a[228:231], a[204:207], v[92:95]
    ds_read_b128 a[192:195], v21 offset:16384
    s_waitcnt lgkmcnt(6)
    v_mfma_f32_16x16x32_bf16 v[96:99], a[224:227], a[208:211], v[96:99]
    ds_read_b64_tr_b16 a[238:239], v28 offset:12800
    ds_read_b128 a[196:199], v21 offset:18432
    v_mfma_f32_16x16x32_bf16 v[104:107], a[228:231], a[208:211], v[104:107]
    s_add_u32 m0, s70, 114688
    s_nop 0
    buffer_load_dwordx4 v4, s[8:11], s64 offen lds
    v_mfma_f32_16x16x32_bf16 v[100:103], a[224:227], a[212:215], v[100:103]
    ds_read_b128 a[200:203], v21 offset:20480
    v_mfma_f32_16x16x32_bf16 v[108:111], a[228:231], a[212:215], v[108:111]
    ds_read_b128 a[204:207], v21 offset:22528
    s_add_u32 m0, s70, 118784
    s_waitcnt lgkmcnt(6)
    v_mfma_f32_16x16x32_bf16 v[112:115], a[224:227], a[216:219], v[112:115]
    buffer_load_dwordx4 v4, s[8:11], s65 offen lds
    v_mfma_f32_16x16x32_bf16 v[120:123], a[228:231], a[216:219], v[120:123]
    ds_read_b128 a[208:211], v21 offset:24576
    v_mfma_f32_16x16x32_bf16 v[116:119], a[224:227], a[220:223], v[116:119]
    ds_read_b128 a[212:215], v21 offset:26624
    s_add_u32 m0, s70, 122880
    v_mfma_f32_16x16x32_bf16 v[124:127], a[228:231], a[220:223], v[124:127]
    buffer_load_dwordx4 v4, s[8:11], s66 offen lds
    s_waitcnt lgkmcnt(4)
    v_mfma_f32_16x16x32_bf16 v[64:67], a[232:235], a[192:195], v[64:67]
    ds_read_b128 a[216:219], v21 offset:28672
    v_mfma_f32_16x16x32_bf16 v[72:75], a[236:239], a[192:195], v[72:75]
    ds_read_b128 a[220:223], v21 offset:30720
    s_add_u32 m0, s70, 126976
    v_mfma_f32_16x16x32_bf16 v[68:71], a[232:235], a[196:199], v[68:71]
    buffer_load_dwordx4 v4, s[8:11], s67 offen lds
    v_mfma_f32_16x16x32_bf16 v[76:79], a[236:239], a[196:199], v[76:79]
    s_waitcnt lgkmcnt(4)
    v_mfma_f32_16x16x32_bf16 v[80:83], a[232:235], a[200:203], v[80:83]
    s_waitcnt vmcnt(8)
    s_barrier
    ds_read_b64_tr_b16 a[240:241], v28 offset:32768
    v_mfma_f32_16x16x32_bf16 v[88:91], a[236:239], a[200:203], v[88:91]
    ds_read_b64_tr_b16 a[242:243], v28 offset:33280
    v_mfma_f32_16x16x32_bf16 v[84:87], a[232:235], a[204:207], v[84:87]
    ds_read_b64_tr_b16 a[244:245], v28 offset:40960
    v_mfma_f32_16x16x32_bf16 v[92:95], a[236:239], a[204:207], v[92:95]
    ds_read_b64_tr_b16 a[246:247], v28 offset:41472
    s_waitcnt lgkmcnt(6)
    v_mfma_f32_16x16x32_bf16 v[96:99], a[232:235], a[208:211], v[96:99]
    ds_read_b128 a[192:195], v20 offset:49152
    v_mfma_f32_16x16x32_bf16 v[104:107], a[236:239], a[208:211], v[104:107]
    ds_read_b128 a[196:199], v20 offset:51200
    s_add_u32 m0, s70, 65536
    v_mfma_f32_16x16x32_bf16 v[100:103], a[232:235], a[212:215], v[100:103]
    ds_read_b64_tr_b16 a[248:249], v28 offset:36864
    v_mfma_f32_16x16x32_bf16 v[108:111], a[236:239], a[212:215], v[108:111]
    ds_read_b64_tr_b16 a[250:251], v28 offset:37376
    s_waitcnt lgkmcnt(8)
    v_mfma_f32_16x16x32_bf16 v[112:115], a[232:235], a[216:219], v[112:115]
    ds_read_b64_tr_b16 a[252:253], v28 offset:45056
    ds_read_b64_tr_b16 a[254:255], v28 offset:45568
    ds_read_b128 a[200:203], v21 offset:49152
    buffer_load_dwordx4 v4, s[8:11], s68 offen lds
    ds_read_b128 a[204:207], v21 offset:51200
    v_mfma_f32_16x16x32_bf16 v[120:123], a[236:239], a[216:219], v[120:123]
    ds_read_b64_tr_b16 a[0:1], v30 offset:32768
    v_mfma_f32_16x16x32_bf16 v[116:119], a[232:235], a[220:223], v[116:119]
    ds_read_b64_tr_b16 a[2:3], v30 offset:33792
    s_add_u32 m0, s70, 69632
    v_mfma_f32_16x16x32_bf16 v[124:127], a[236:239], a[220:223], v[124:127]
    buffer_load_dwordx4 v4, s[8:11], s69 offen lds
    s_waitcnt lgkmcnt(9)
    v_mfma_f32_16x16x32_bf16 v[64:67], a[240:243], a[192:195], v[64:67]
    ds_read_b128 a[208:211], v20 offset:53248
    ds_read_b64_tr_b16 a[4:5], v31 offset:32768
    ds_read_b64_tr_b16 a[6:7], v31 offset:33792
    ds_read_b128 a[212:215], v20 offset:55296
    v_mfma_f32_16x16x32_bf16 v[72:75], a[244:247], a[192:195], v[72:75]
    ds_read_b64_tr_b16 a[8:9], v32 offset:32768
    s_waitcnt lgkmcnt(13)
    v_mfma_f32_16x16x32_bf16 v[68:71], a[240:243], a[196:199], v[68:71]
    ds_read_b64_tr_b16 a[10:11], v32 offset:33792
    s_add_u32 m0, s70, 73728
    v_mfma_f32_16x16x32_bf16 v[76:79], a[244:247], a[196:199], v[76:79]
    buffer_load_dwordx4 v22, s[8:11], s42 offen lds
    s_waitcnt lgkmcnt(8)
    v_mfma_f32_16x16x32_bf16 v[64:67], a[248:251], a[200:203], v[64:67]
    ds_read_b128 a[216:219], v21 offset:53248
    ds_read_b64_tr_b16 a[12:13], v33 offset:32768
    ds_read_b64_tr_b16 a[14:15], v33 offset:33792
    ds_read_b128 a[220:223], v21 offset:55296
    v_mfma_f32_16x16x32_bf16 v[72:75], a[252:255], a[200:203], v[72:75]
    s_add_u32 m0, s70, 77824
    s_nop 0
    buffer_load_dwordx4 v22, s[8:11], s43 offen lds
    v_mfma_f32_16x16x32_bf16 v[68:71], a[248:251], a[204:207], v[68:71]
    ds_read_b128 a[192:195], v20 offset:57344
    v_mfma_f32_16x16x32_bf16 v[76:79], a[252:255], a[204:207], v[76:79]
    ds_read_b64_tr_b16 a[16:17], v30 offset:49152
    ds_read_b64_tr_b16 a[18:19], v30 offset:50176
    ds_read_b128 a[196:199], v20 offset:59392
    ds_read_b64_tr_b16 a[20:21], v31 offset:49152
    ds_read_b64_tr_b16 a[22:23], v31 offset:50176
    s_add_u32 m0, s70, 81920
    s_nop 0
    buffer_load_dwordx4 v22, s[8:11], s44 offen lds
    ds_read_b128 a[200:203], v21 offset:57344
    ds_read_b64_tr_b16 a[24:25], v32 offset:49152
    ds_read_b64_tr_b16 a[26:27], v32 offset:50176
    s_waitcnt lgkmcnt(15)
    v_mfma_f32_16x16x32_bf16 v[80:83], a[240:243], a[208:211], v[80:83]
    ds_read_b128 a[204:207], v21 offset:59392
    ds_read_b64_tr_b16 a[28:29], v33 offset:49152
    v_mfma_f32_16x16x32_bf16 v[88:91], a[244:247], a[208:211], v[88:91]
    ds_read_b64_tr_b16 a[30:31], v33 offset:50176
    s_add_u32 m0, s70, 86016
    v_mfma_f32_16x16x32_bf16 v[84:87], a[240:243], a[212:215], v[84:87]
    buffer_load_dwordx4 v22, s[8:11], s45 offen lds
    v_mfma_f32_16x16x32_bf16 v[92:95], a[244:247], a[212:215], v[92:95]
    ds_read_b128 a[208:211], v20 offset:61440
    s_waitcnt lgkmcnt(13)
    v_mfma_f32_16x16x32_bf16 v[80:83], a[248:251], a[216:219], v[80:83]
    ds_read_b128 a[212:215], v20 offset:63488
    v_max_f32 v64, 0, v64
    v_mfma_f32_16x16x32_bf16 v[88:91], a[252:255], a[216:219], v[88:91]
    v_max_f32 v65, 0, v65
    v_max_f32 v66, 0, v66
    s_add_u32 m0, s70, 90112
    v_mfma_f32_16x16x32_bf16 v[84:87], a[248:251], a[220:223], v[84:87]
    ds_read_b128 a[216:219], v21 offset:61440
    v_max_f32 v67, 0, v67
    v_max_f32 v68, 0, v68
    v_mfma_f32_16x16x32_bf16 v[92:95], a[252:255], a[220:223], v[92:95]
    buffer_load_dwordx4 v22, s[8:11], s46 offen lds
    v_max_f32 v69, 0, v69
    s_waitcnt lgkmcnt(11)
    v_mfma_f32_16x16x32_bf16 v[96:99], a[240:243], a[192:195], v[96:99]
    ds_read_b128 a[220:223], v21 offset:63488
    v_max_f32 v70, 0, v70
    v_mfma_f32_16x16x32_bf16 v[104:107], a[244:247], a[192:195], v[104:107]
    v_max_f32 v71, 0, v71
    s_add_u32 m0, s71, 131072
    s_mul_i32 s6, s74, 40
    v_mfma_f32_16x16x32_bf16 v[100:103], a[240:243], a[196:199], v[100:103]
    buffer_load_dwordx4 v11, s[20:23], s6 offen lds
    v_mul_f32 v64, v64, v72
    v_mfma_f32_16x16x32_bf16 v[108:111], a[244:247], a[196:199], v[108:111]
    v_mul_f32 v65, v65, v73
    v_mul_f32 v66, v66, v74
    v_mul_f32 v67, v67, v75
    s_waitcnt lgkmcnt(6)
    v_mfma_f32_16x16x32_bf16 v[96:99], a[248:251], a[200:203], v[96:99]
    s_waitcnt vmcnt(11)
    s_barrier
    ds_read_b128 a[192:195], v24 offset:32768
    v_mfma_f32_16x16x32_bf16 v[104:107], a[252:255], a[200:203], v[104:107]
    ds_read_b128 a[196:199], v24 offset:34816
    v_mul_f32 v68, v68, v76
    v_mfma_f32_16x16x32_bf16 v[100:103], a[248:251], a[204:207], v[100:103]
    ds_read_b128 a[200:203], v25 offset:32768
    v_mul_f32 v69, v69, v77
    v_mul_f32 v70, v70, v78
    v_mfma_f32_16x16x32_bf16 v[108:111], a[252:255], a[204:207], v[108:111]
    buffer_load_dwordx4 v44, s[20:23], s6 offen offset:1024 lds
    v_mul_f32 v71, v71, v79
    s_waitcnt lgkmcnt(5)
    v_mfma_f32_16x16x32_bf16 v[112:115], a[240:243], a[208:211], v[112:115]
    ds_read_b128 a[204:207], v25 offset:34816
    v_cvt_pk_bf16_f32 v52, v64, v65
    v_mfma_f32_16x16x32_bf16 v[120:123], a[244:247], a[208:211], v[120:123]
    v_cvt_pk_bf16_f32 v53, v66, v67
    v_cvt_pk_bf16_f32 v54, v68, v69
    v_mfma_f32_16x16x32_bf16 v[116:119], a[240:243], a[212:215], v[116:119]
    ds_read_b128 a[208:211], v24 offset:36864
    v_cvt_pk_bf16_f32 v55, v70, v71
    v_permlane32_swap_b32 v52, v54
    v_mfma_f32_16x16x32_bf16 v[124:127], a[244:247], a[212:215], v[124:127]
    buffer_load_dwordx4 v45, s[20:23], s6 offen offset:2048 lds
    v_permlane32_swap_b32 v53, v55
    s_waitcnt lgkmcnt(5)
    v_mfma_f32_16x16x32_bf16 v[112:115], a[248:251], a[216:219], v[112:115]
    ds_read_b128 a[212:215], v24 offset:38912
    s_mov_b32 s50, 0
    v_mfma_f32_16x16x32_bf16 v[120:123], a[252:255], a[216:219], v[120:123]
    buffer_store_dwordx4 v[52:55], v12, s[28:31], s50 offen sc1
    v_mfma_f32_16x16x32_bf16 v[116:119], a[248:251], a[220:223], v[116:119]
    ds_read_b128 a[216:219], v25 offset:36864
    v_max_f32 v80, 0, v80
    v_mfma_f32_16x16x32_bf16 v[124:127], a[252:255], a[220:223], v[124:127]
    buffer_load_dwordx4 v46, s[20:23], s6 offen offset:3072 lds
    v_max_f32 v81, 0, v81
    s_waitcnt lgkmcnt(6)
    v_mfma_f32_16x16x32_bf16 v[64:67], v[128:131], a[192:195], 0
    ds_read_b128 a[220:223], v25 offset:38912
    v_max_f32 v82, 0, v82
    v_mfma_f32_16x16x32_bf16 v[72:75], v[132:135], a[192:195], 0
    s_add_u32 m0, s71, 147456
    s_mul_i32 s6, s75, 40
    s_waitcnt lgkmcnt(6)
    v_mfma_f32_16x16x32_bf16 v[68:71], v[128:131], a[196:199], 0
    ds_read_b128 a[192:195], v24 offset:40960
    v_max_f32 v83, 0, v83
    v_mfma_f32_16x16x32_bf16 v[76:79], v[132:135], a[196:199], 0
    buffer_load_dwordx4 v11, s[20:23], s6 offen lds
    v_max_f32 v84, 0, v84
    s_waitcnt lgkmcnt(5)
    v_mfma_f32_16x16x32_bf16 v[64:67], v[136:139], a[200:203], v[64:67]
    ds_read_b128 a[196:199], v24 offset:43008
    v_max_f32 v85, 0, v85
    v_mfma_f32_16x16x32_bf16 v[72:75], v[140:143], a[200:203], v[72:75]
    v_max_f32 v86, 0, v86
    v_max_f32 v87, 0, v87
    v_mfma_f32_16x16x32_bf16 v[68:71], v[136:139], a[204:207], v[68:71]
    ds_read_b128 a[200:203], v25 offset:40960
    v_mul_f32 v80, v80, v88
    v_mfma_f32_16x16x32_bf16 v[76:79], v[140:143], a[204:207], v[76:79]
    v_mul_f32 v81, v81, v89
    s_waitcnt lgkmcnt(5)
    v_mfma_f32_16x16x32_bf16 v[64:67], v[144:147], a[208:211], v[64:67]
    ds_read_b128 a[204:207], v25 offset:43008
    v_mul_f32 v82, v82, v90
    v_mfma_f32_16x16x32_bf16 v[72:75], v[148:151], a[208:211], v[72:75]
    buffer_load_dwordx4 v44, s[20:23], s6 offen offset:1024 lds
    v_mul_f32 v83, v83, v91
    v_mfma_f32_16x16x32_bf16 v[68:71], v[144:147], a[212:215], v[68:71]
    ds_read_b128 a[208:211], v24 offset:45056
    v_mul_f32 v84, v84, v92
    v_mfma_f32_16x16x32_bf16 v[76:79], v[148:151], a[212:215], v[76:79]
    v_mul_f32 v85, v85, v93
    v_mul_f32 v86, v86, v94
    s_waitcnt lgkmcnt(5)
    v_mfma_f32_16x16x32_bf16 v[64:67], v[152:155], a[216:219], v[64:67]
    ds_read_b128 a[212:215], v24 offset:47104
    v_mul_f32 v87, v87, v95
    v_mfma_f32_16x16x32_bf16 v[72:75], v[156:159], a[216:219], v[72:75]
    v_cvt_pk_bf16_f32 v56, v80, v81
    v_mfma_f32_16x16x32_bf16 v[68:71], v[152:155], a[220:223], v[68:71]
    ds_read_b128 a[216:219], v25 offset:45056
    v_cvt_pk_bf16_f32 v57, v82, v83
    v_mfma_f32_16x16x32_bf16 v[76:79], v[156:159], a[220:223], v[76:79]
    buffer_load_dwordx4 v45, s[20:23], s6 offen offset:2048 lds
    v_cvt_pk_bf16_f32 v58, v84, v85
    s_waitcnt lgkmcnt(5)
    v_mfma_f32_16x16x32_bf16 v[64:67], v[160:163], a[192:195], v[64:67]
    ds_read_b128 a[220:223], v25 offset:47104
    v_cvt_pk_bf16_f32 v59, v86, v87
    v_mfma_f32_16x16x32_bf16 v[72:75], v[164:167], a[192:195], v[72:75]
    v_permlane32_swap_b32 v56, v58
    v_permlane32_swap_b32 v57, v59
    v_mfma_f32_16x16x32_bf16 v[68:71], v[160:163], a[196:199], v[68:71]
    ds_read_b128 a[192:195], v24 offset:49152
    s_mov_b32 s50, 98304
    v_mfma_f32_16x16x32_bf16 v[76:79], v[164:167], a[196:199], v[76:79]
    buffer_store_dwordx4 v[56:59], v12, s[28:31], s50 offen sc1
    v_max_f32 v96, 0, v96
    s_waitcnt lgkmcnt(5)
    v_mfma_f32_16x16x32_bf16 v[64:67], v[168:171], a[200:203], v[64:67]
    ds_read_b128 a[196:199], v24 offset:51200
    v_max_f32 v97, 0, v97
    v_mfma_f32_16x16x32_bf16 v[72:75], v[172:175], a[200:203], v[72:75]
    v_max_f32 v98, 0, v98
    v_mfma_f32_16x16x32_bf16 v[68:71], v[168:171], a[204:207], v[68:71]
    ds_read_b128 a[200:203], v25 offset:49152
    v_max_f32 v99, 0, v99
    v_mfma_f32_16x16x32_bf16 v[76:79], v[172:175], a[204:207], v[76:79]
    buffer_load_dwordx4 v46, s[20:23], s6 offen offset:3072 lds
    v_max_f32 v100, 0, v100
    s_waitcnt lgkmcnt(5)
    v_mfma_f32_16x16x32_bf16 v[64:67], v[176:179], a[208:211], v[64:67]
    ds_read_b128 a[204:207], v25 offset:51200
    v_max_f32 v101, 0, v101
    v_mfma_f32_16x16x32_bf16 v[72:75], v[180:183], a[208:211], v[72:75]
    v_max_f32 v102, 0, v102
    v_max_f32 v103, 0, v103
    v_mfma_f32_16x16x32_bf16 v[68:71], v[176:179], a[212:215], v[68:71]
    v_mul_f32 v96, v96, v104
    v_mul_f32 v97, v97, v105
    v_mfma_f32_16x16x32_bf16 v[76:79], v[180:183], a[212:215], v[76:79]
    v_mul_f32 v98, v98, v106
    v_mul_f32 v99, v99, v107
    s_waitcnt lgkmcnt(4)
    v_mfma_f32_16x16x32_bf16 v[64:67], v[184:187], a[216:219], v[64:67]
    s_waitcnt vmcnt(15)
    s_barrier
    ds_read_b128 a[208:211], v24 offset:53248
    v_mfma_f32_16x16x32_bf16 v[72:75], v[188:191], a[216:219], v[72:75]
    ds_read_b128 a[212:215], v24 offset:55296
    s_add_u32 m0, s71, 32768
    s_mul_i32 s6, s76, 40
    v_mfma_f32_16x16x32_bf16 v[68:71], v[184:187], a[220:223], v[68:71]
    ds_read_b128 a[216:219], v25 offset:53248
    v_mul_f32 v100, v100, v108
    v_mfma_f32_16x16x32_bf16 v[76:79], v[188:191], a[220:223], v[76:79]
    buffer_load_dwordx4 v11, s[20:23], s6 offen lds
    v_mul_f32 v101, v101, v109
    s_waitcnt lgkmcnt(5)
    v_mfma_f32_16x16x32_bf16 v[64:67], v[192:195], a[192:195], v[64:67]
    ds_read_b128 a[220:223], v25 offset:55296
    v_mul_f32 v102, v102, v110
    v_mfma_f32_16x16x32_bf16 v[72:75], v[196:199], a[192:195], v[72:75]
    v_mul_f32 v103, v103, v111
    v_cvt_pk_bf16_f32 v52, v96, v97
    v_mfma_f32_16x16x32_bf16 v[68:71], v[192:195], a[196:199], v[68:71]
    ds_read_b128 a[192:195], v24 offset:57344
    v_cvt_pk_bf16_f32 v53, v98, v99
    v_mfma_f32_16x16x32_bf16 v[76:79], v[196:199], a[196:199], v[76:79]
    v_cvt_pk_bf16_f32 v54, v100, v101
    s_waitcnt lgkmcnt(5)
    v_mfma_f32_16x16x32_bf16 v[64:67], v[200:203], a[200:203], v[64:67]
    ds_read_b128 a[196:199], v24 offset:59392
    v_cvt_pk_bf16_f32 v55, v102, v103
    v_mfma_f32_16x16x32_bf16 v[72:75], v[204:207], a[200:203], v[72:75]
    buffer_load_dwordx4 v44, s[20:23], s6 offen offset:1024 lds
    v_permlane32_swap_b32 v52, v54
    v_mfma_f32_16x16x32_bf16 v[68:71], v[200:203], a[204:207], v[68:71]
    ds_read_b128 a[200:203], v25 offset:57344
    v_permlane32_swap_b32 v53, v55
    v_mfma_f32_16x16x32_bf16 v[76:79], v[204:207], a[204:207], v[76:79]
    s_waitcnt lgkmcnt(6)
    v_mfma_f32_16x16x32_bf16 v[64:67], v[208:211], a[208:211], v[64:67]
    ds_read_b128 a[204:207], v25 offset:59392
    v_mfma_f32_16x16x32_bf16 v[72:75], v[212:215], a[208:211], v[72:75]
    s_waitcnt lgkmcnt(6)
    v_mfma_f32_16x16x32_bf16 v[68:71], v[208:211], a[212:215], v[68:71]
    ds_read_b128 a[208:211], v24 offset:61440
    buffer_load_dwordx4 v45, s[20:23], s6 offen offset:2048 lds
    v_mfma_f32_16x16x32_bf16 v[76:79], v[212:215], a[212:215], v[76:79]
    s_mov_b32 s50, 196608
    buffer_store_dwordx4 v[52:55], v12, s[28:31], s50 offen sc1
    s_waitcnt lgkmcnt(5)
    v_mfma_f32_16x16x32_bf16 v[64:67], v[216:219], a[216:219], v[64:67]
    ds_read_b128 a[212:215], v24 offset:63488
    v_max_f32 v112, 0, v112
    v_mfma_f32_16x16x32_bf16 v[72:75], v[220:223], a[216:219], v[72:75]
    v_max_f32 v113, 0, v113
    v_max_f32 v114, 0, v114
    v_mfma_f32_16x16x32_bf16 v[68:71], v[216:219], a[220:223], v[68:71]
    ds_read_b128 a[216:219], v25 offset:61440
    v_max_f32 v115, 0, v115
    v_mfma_f32_16x16x32_bf16 v[76:79], v[220:223], a[220:223], v[76:79]
    v_max_f32 v116, 0, v116
    v_max_f32 v117, 0, v117
    s_waitcnt lgkmcnt(5)
    v_mfma_f32_16x16x32_bf16 v[64:67], v[224:227], a[192:195], v[64:67]
    ds_read_b128 a[220:223], v25 offset:63488
    v_max_f32 v118, 0, v118
    v_mfma_f32_16x16x32_bf16 v[72:75], v[228:231], a[192:195], v[72:75]
    v_max_f32 v119, 0, v119
    v_mfma_f32_16x16x32_bf16 v[68:71], v[224:227], a[196:199], v[68:71]
    ds_read_b128 a[192:195], v24 offset:0
    v_mul_f32 v112, v112, v120
    v_mfma_f32_16x16x32_bf16 v[76:79], v[228:231], a[196:199], v[76:79]
    buffer_load_dwordx4 v46, s[20:23], s6 offen offset:3072 lds
    v_mul_f32 v113, v113, v121
    s_waitcnt lgkmcnt(5)
    v_mfma_f32_16x16x32_bf16 v[64:67], v[232:235], a[200:203], v[64:67]
    ds_read_b128 a[196:199], v24 offset:2048
    v_mul_f32 v114, v114, v122
    v_mfma_f32_16x16x32_bf16 v[72:75], v[236:239], a[200:203], v[72:75]
    v_mul_f32 v115, v115, v123
    v_mul_f32 v116, v116, v124
    v_mfma_f32_16x16x32_bf16 v[68:71], v[232:235], a[204:207], v[68:71]
    ds_read_b128 a[200:203], v25 offset:0
    s_waitcnt vmcnt(10)
    ds_read_b64_tr_b16 a[32:33], v30 offset:32768
    v_mfma_f32_16x16x32_bf16 v[76:79], v[236:239], a[204:207], v[76:79]
    ds_read_b64_tr_b16 a[34:35], v30 offset:33792
    s_add_u32 m0, s71, 49152
    s_mul_i32 s6, s77, 40
    s_waitcnt lgkmcnt(7)
    v_mfma_f32_16x16x32_bf16 v[64:67], v[240:243], a[208:211], v[64:67]
    buffer_load_dwordx4 v11, s[20:23], s6 offen lds
    ds_read_b128 a[204:207], v25 offset:2048
    v_mfma_f32_16x16x32_bf16 v[72:75], v[244:247], a[208:211], v[72:75]
    ds_read_b64_tr_b16 a[36:37], v31 offset:32768
    ds_read_b64_tr_b16 a[38:39], v31 offset:33792
    v_mfma_f32_16x16x32_bf16 v[68:71], v[240:243], a[212:215], v[68:71]
    ds_read_b128 a[208:211], v24 offset:4096
    ds_read_b64_tr_b16 a[40:41], v32 offset:32768
    v_mfma_f32_16x16x32_bf16 v[76:79], v[244:247], a[212:215], v[76:79]
    ds_read_b64_tr_b16 a[42:43], v32 offset:33792
    v_mul_f32 v117, v117, v125
    s_waitcnt lgkmcnt(11)
    v_mfma_f32_16x16x32_bf16 v[64:67], v[248:251], a[216:219], v[64:67]
    ds_read_b128 a[212:215], v24 offset:6144
    ds_read_b64_tr_b16 a[44:45], v33 offset:32768
    v_mfma_f32_16x16x32_bf16 v[72:75], v[252:255], a[216:219], v[72:75]
    ds_read_b64_tr_b16 a[46:47], v33 offset:33792
    v_mfma_f32_16x16x32_bf16 v[68:71], v[248:251], a[220:223], v[68:71]
    ds_read_b128 a[216:219], v25 offset:4096
    v_mul_f32 v118, v118, v126
    v_mfma_f32_16x16x32_bf16 v[76:79], v[252:255], a[220:223], v[76:79]
    buffer_load_dwordx4 v44, s[20:23], s6 offen offset:1024 lds
    v_mul_f32 v119, v119, v127
    s_waitcnt lgkmcnt(13)
    v_mfma_f32_16x16x32_bf16 v[64:67], a[224:227], a[192:195], v[64:67]
    ds_read_b128 a[220:223], v25 offset:6144
    v_cvt_pk_bf16_f32 v56, v112, v113
    v_mfma_f32_16x16x32_bf16 v[72:75], a[228:231], a[192:195], v[72:75]
    v_cvt_pk_bf16_f32 v57, v114, v115
    v_cvt_pk_bf16_f32 v58, v116, v117
    v_mfma_f32_16x16x32_bf16 v[68:71], a[224:227], a[196:199], v[68:71]
    v_cvt_pk_bf16_f32 v59, v118, v119
    v_permlane32_swap_b32 v56, v58
    v_mfma_f32_16x16x32_bf16 v[76:79], a[228:231], a[196:199], v[76:79]
    v_permlane32_swap_b32 v57, v59
    s_mov_b32 s50, 294912
    buffer_store_dwordx4 v[56:59], v12, s[28:31], s50 offen sc1
    s_waitcnt lgkmcnt(10)
    v_mfma_f32_16x16x32_bf16 v[64:67], a[232:235], a[200:203], v[64:67]
    s_waitcnt vmcnt(9)
    s_barrier
    ds_read_b128 a[192:195], v24 offset:8192
    v_mfma_f32_16x16x32_bf16 v[72:75], a[236:239], a[200:203], v[72:75]
    ds_read_b128 a[196:199], v25 offset:8192
    v_mfma_f32_16x16x32_bf16 v[68:71], a[232:235], a[204:207], v[68:71]
L_C_w2_0:
    s_cbranch_execz L_C_w2_1
    ds_read_b128 a[200:203], v24 offset:10240
    buffer_load_dwordx4 v45, s[20:23], s6 offen offset:2048 lds
    v_mfma_f32_16x16x32_bf16 v[76:79], a[236:239], a[204:207], v[76:79]
    s_cmp_lg_u32 s3, 0
    s_cbranch_scc1 L_C_pub0
    s_atomic_add s100, s[28:29], s51
L_C_pub0:
    s_waitcnt lgkmcnt(7)
    v_mfma_f32_16x16x32_bf16 v[64:67], a[240:243], a[208:211], v[64:67]
    ds_read_b128 a[204:207], v25 offset:10240
L_C_w2_1:
    s_cbranch_execz L_hopped
    v_mfma_f32_16x16x32_bf16 v[72:75], a[244:247], a[208:211], v[72:75]
    v_mfma_f32_16x16x32_bf16 v[68:71], a[240:243], a[212:215], v[68:71]
    ds_read_b128 a[208:211], v24 offset:12288
    v_mfma_f32_16x16x32_bf16 v[76:79], a[244:247], a[212:215], v[76:79]
    s_waitcnt lgkmcnt(5)
    v_mfma_f32_16x16x32_bf16 v[64:67], a[248:251], a[216:219], v[64:67]
    buffer_load_dwordx4 v46, s[20:23], s6 offen offset:3072 lds
    v_mfma_f32_16x16x32_bf16 v[72:75], a[252:255], a[216:219], v[72:75]
    ds_read_b128 a[212:215], v25 offset:12288
    v_mfma_f32_16x16x32_bf16 v[68:71], a[248:251], a[220:223], v[68:71]
    ds_read_b128 a[216:219], v24 offset:14336
    v_mfma_f32_16x16x32_bf16 v[76:79], a[252:255], a[220:223], v[76:79]
    s_waitcnt lgkmcnt(6)
    v_mfma_f32_16x16x32_bf16 v[80:83], v[128:131], a[192:195], 0
    ds_read_b128 a[220:223], v25 offset:14336
    v_mfma_f32_16x16x32_bf16 v[88:91], v[132:135], a[192:195], 0
    s_waitcnt vmcnt(10)
    ds_read_b64_tr_b16 a[48:49], v30 offset:49152
    s_waitcnt lgkmcnt(7)
    v_mfma_f32_16x16x32_bf16 v[80:83], v[136:139], a[196:199], v[80:83]
    ds_read_b64_tr_b16 a[50:51], v30 offset:50176
    s_add_u32 m0, s71, 131072
    s_mul_i32 s6, s78, 40
    v_mfma_f32_16x16x32_bf16 v[88:91], v[140:143], a[196:199], v[88:91]
    buffer_load_dwordx4 v11, s[20:23], s6 offen lds
    s_waitcnt lgkmcnt(6)
    v_mfma_f32_16x16x32_bf16 v[80:83], v[144:147], a[200:203], v[80:83]
    ds_read_b128 a[192:195], v24 offset:16384
    v_mfma_f32_16x16x32_bf16 v[88:91], v[148:151], a[200:203], v[88:91]
    ds_read_b64_tr_b16 a[52:53], v31 offset:49152
    v_mfma_f32_16x16x32_bf16 v[80:83], v[152:155], a[204:207], v[80:83]
    ds_read_b64_tr_b16 a[54:55], v31 offset:50176
    v_mfma_f32_16x16x32_bf16 v[88:91], v[156:159], a[204:207], v[88:91]
    ds_read_b128 a[196:199], v25 offset:16384
    s_waitcnt lgkmcnt(8)
    v_mfma_f32_16x16x32_bf16 v[80:83], v[160:163], a[208:211], v[80:83]
    ds_read_b64_tr_b16 a[56:57], v32 offset:49152
    v_mfma_f32_16x16x32_bf16 v[88:91], v[164:167], a[208:211], v[88:91]
    ds_read_b64_tr_b16 a[58:59], v32 offset:50176
    v_mfma_f32_16x16x32_bf16 v[80:83], v[168:171], a[212:215], v[80:83]
    ds_read_b128 a[200:203], v24 offset:18432
    v_mfma_f32_16x16x32_bf16 v[88:91], v[172:175], a[212:215], v[88:91]
    ds_read_b64_tr_b16 a[60:61], v33 offset:49152
    s_waitcnt lgkmcnt(10)
    v_mfma_f32_16x16x32_bf16 v[80:83], v[176:179], a[216:219], v[80:83]
    ds_read_b64_tr_b16 a[62:63], v33 offset:50176
    v_max_f32 v64, 0, v64
    ds_read_b128 a[204:207], v25 offset:18432
    v_mfma_f32_16x16x32_bf16 v[88:91], v[180:183], a[216:219], v[88:91]
    v_max_f32 v65, 0, v65
    v_max_f32 v66, 0, v66
    ds_read_b128 a[208:211], v24 offset:20480
    v_mfma_f32_16x16x32_bf16 v[80:83], v[184:187], a[220:223], v[80:83]
    v_max_f32 v67, 0, v67
    buffer_load_dwordx4 v44, s[20:23], s6 offen offset:1024 lds
    v_max_f32 v68, 0, v68
    v_mfma_f32_16x16x32_bf16 v[88:91], v[188:191], a[220:223], v[88:91]
    ds_read_b128 a[212:215], v25 offset:20480
    v_max_f32 v69, 0, v69
    s_waitcnt lgkmcnt(8)
    v_mfma_f32_16x16x32_bf16 v[80:83], v[192:195], a[192:195], v[80:83]
    v_max_f32 v70, 0, v70
    v_max_f32 v71, 0, v71
    ds_read_b128 a[216:219], v24 offset:22528
    v_mfma_f32_16x16x32_bf16 v[88:91], v[196:199], a[192:195], v[88:91]
    v_mul_f32 v64, v64, v72
    v_mul_f32 v65, v65, v73
    ds_read_b128 a[220:223], v25 offset:22528
    v_mfma_f32_16x16x32_bf16 v[80:83], v[200:203], a[196:199], v[80:83]
    v_mul_f32 v66, v66, v74
    buffer_load_dwordx4 v45, s[20:23], s6 offen offset:2048 lds
    v_mul_f32 v67, v67, v75
    v_mfma_f32_16x16x32_bf16 v[88:91], v[204:207], a[196:199], v[88:91]
    ds_read_b128 a[192:195], v24 offset:24576
    v_mul_f32 v68, v68, v76
    s_waitcnt lgkmcnt(5)
    v_mfma_f32_16x16x32_bf16 v[80:83], v[208:211], a[200:203], v[80:83]
    v_mul_f32 v69, v69, v77
    v_mul_f32 v70, v70, v78
    ds_read_b128 a[196:199], v25 offset:24576
    v_mfma_f32_16x16x32_bf16 v[88:91], v[212:215], a[200:203], v[88:91]
    v_mul_f32 v71, v71, v79
    v_cvt_pk_bf16_f32 v52, v64, v65
    v_mfma_f32_16x16x32_bf16 v[80:83], v[216:219], a[204:207], v[80:83]
    ds_read_b128 a[200:203], v24 offset:26624
    v_cvt_pk_bf16_f32 v53, v66, v67
    v_mfma_f32_16x16x32_bf16 v[88:91], v[220:223], a[204:207], v[88:91]
    buffer_load_dwordx4 v46, s[20:23], s6 offen offset:3072 lds
    v_cvt_pk_bf16_f32 v54, v68, v69
    s_waitcnt lgkmcnt(5)
    v_mfma_f32_16x16x32_bf16 v[80:83], v[224:227], a[208:211], v[80:83]
    ds_read_b128 a[204:207], v25 offset:26624
    v_cvt_pk_bf16_f32 v55, v70, v71
    v_mfma_f32_16x16x32_bf16 v[88:91], v[228:231], a[208:211], v[88:91]
    v_permlane32_swap_b32 v52, v54
    v_permlane32_swap_b32 v53, v55
    v_mfma_f32_16x16x32_bf16 v[80:83], v[232:235], a[212:215], v[80:83]
    v_mfma_f32_16x16x32_bf16 v[88:91], v[236:239], a[212:215], v[88:91]
    s_waitcnt lgkmcnt(4)
    v_mfma_f32_16x16x32_bf16 v[80:83], v[240:243], a[216:219], v[80:83]
    s_waitcnt vmcnt(9)
    ds_read_b64_tr_b16 a[64:65], v60 offset:0
    s_mov_b32 s50, 393216
    v_mfma_f32_16x16x32_bf16 v[88:91], v[244:247], a[216:219], v[88:91]
    ds_read_b64_tr_b16 a[66:67], v60 offset:1024
    s_add_u32 m0, s71, 98304
    s_mul_i32 s6, s79, 40
    v_mfma_f32_16x16x32_bf16 v[80:83], v[248:251], a[220:223], v[80:83]
    ds_read_b64_tr_b16 a[68:69], v61 offset:0
    v_mfma_f32_16x16x32_bf16 v[88:91], v[252:255], a[220:223], v[88:91]
    ds_read_b64_tr_b16 a[70:71], v61 offset:1024
    s_waitcnt lgkmcnt(6)
    v_mfma_f32_16x16x32_bf16 v[80:83], a[224:227], a[192:195], v[80:83]
    buffer_load_dwordx4 v11, s[20:23], s6 offen lds
    v_mfma_f32_16x16x32_bf16 v[88:91], a[228:231], a[192:195], v[88:91]
    buffer_store_dwordx4 v[52:55], v12, s[28:31], s50 offen sc1
    v_mfma_f32_16x16x32_bf16 v[80:83], a[232:235], a[196:199], v[80:83]
    ds_read_b64_tr_b16 a[72:73], v62 offset:0
    v_mfma_f32_16x16x32_bf16 v[88:91], a[236:239], a[196:199], v[88:91]
    ds_read_b64_tr_b16 a[74:75], v62 offset:1024
    s_waitcnt lgkmcnt(6)
    v_mfma_f32_16x16x32_bf16 v[80:83], a[240:243], a[200:203], v[80:83]
    ds_read_b64_tr_b16 a[76:77], v63 offset:0
    v_mfma_f32_16x16x32_bf16 v[88:91], a[244:247], a[200:203], v[88:91]
    ds_read_b64_tr_b16 a[78:79], v63 offset:1024
    v_mfma_f32_16x16x32_bf16 v[80:83], a[248:251], a[204:207], v[80:83]
    buffer_load_dwordx4 v44, s[20:23], s6 offen offset:1024 lds
    v_mfma_f32_16x16x32_bf16 v[88:91], a[252:255], a[204:207], v[88:91]
    buffer_load_dwordx4 v45, s[20:23], s6 offen offset:2048 lds
    buffer_load_dwordx4 v46, s[20:23], s6 offen offset:3072 lds
    s_add_u32 m0, s71, 147456
    s_mul_i32 s6, s80, 40
    buffer_load_dwordx4 v11, s[20:23], s6 offen lds
    buffer_load_dwordx4 v44, s[20:23], s6 offen offset:1024 lds
    v_max_f32 v80, 0, v80
    v_max_f32 v81, 0, v81
    v_max_f32 v82, 0, v82
    v_max_f32 v83, 0, v83
    v_mul_f32 v80, v80, v88
    v_mul_f32 v81, v81, v89
    v_mul_f32 v82, v82, v90
    v_mul_f32 v83, v83, v91
    v_cvt_pk_bf16_f32 v56, v80, v81
    v_cvt_pk_bf16_f32 v57, v82, v83
    s_nop 0
    v_permlane32_swap_b32 v56, v58
    v_permlane32_swap_b32 v57, v59
    s_mov_b32 s50, 491520
    s_mov_b32 exec_hi, 0
    buffer_store_dwordx4 v[56:59], v12, s[28:31], s50 offen sc1
    s_mov_b32 exec_hi, -1
    s_waitcnt vmcnt(14) lgkmcnt(0)
    s_barrier
    s_cmp_lg_u32 s3, 0
    s_cbranch_scc1 L_C_pub1
    s_mov_b64 exec, 1
    buffer_store_dword v40, v18, s[28:31], 0 offen offset:128 sc1
    s_mov_b64 exec, -1
L_C_pub1:
    buffer_load_dwordx4 v45, s[20:23], s6 offen offset:2048 lds
    buffer_load_dwordx4 v46, s[20:23], s6 offen offset:3072 lds
    s_waitcnt vmcnt(14)
    ds_read_b64_tr_b16 a[80:81], v60 offset:16384
    ds_read_b64_tr_b16 a[82:83], v60 offset:17408
    ds_read_b64_tr_b16 a[84:85], v61 offset:16384
    ds_read_b64_tr_b16 a[86:87], v61 offset:17408
    ds_read_b64_tr_b16 a[88:89], v62 offset:16384
    ds_read_b64_tr_b16 a[90:91], v62 offset:17408
    ds_read_b64_tr_b16 a[92:93], v63 offset:16384
    ds_read_b64_tr_b16 a[94:95], v63 offset:17408
    s_waitcnt vmcnt(10)
    ds_read_b64_tr_b16 a[96:97], v30 offset:32768
    ds_read_b64_tr_b16 a[98:99], v30 offset:33792
    ds_read_b64_tr_b16 a[100:101], v31 offset:32768
    ds_read_b64_tr_b16 a[102:103], v31 offset:33792
    ds_read_b64_tr_b16 a[104:105], v32 offset:32768
    ds_read_b64_tr_b16 a[106:107], v32 offset:33792
    ds_read_b64_tr_b16 a[108:109], v33 offset:32768
    ds_read_b64_tr_b16 a[110:111], v33 offset:33792
    s_add_u32 m0, s71, 114688
    s_mul_i32 s6, s81, 40
    buffer_load_dwordx4 v11, s[20:23], s6 offen lds
    buffer_load_dwordx4 v44, s[20:23], s6 offen offset:1024 lds
    buffer_load_dwordx4 v45, s[20:23], s6 offen offset:2048 lds
    buffer_load_dwordx4 v46, s[20:23], s6 offen offset:3072 lds
    s_waitcnt vmcnt(9)
    ds_read_b64_tr_b16 a[112:113], v30 offset:0
    ds_read_b64_tr_b16 a[114:115], v30 offset:1024
    ds_read_b64_tr_b16 a[116:117], v31 offset:0
    ds_read_b64_tr_b16 a[118:119], v31 offset:1024
    ds_read_b64_tr_b16 a[120:121], v32 offset:0
    ds_read_b64_tr_b16 a[122:123], v32 offset:1024
    ds_read_b64_tr_b16 a[124:125], v33 offset:0
    ds_read_b64_tr_b16 a[126:127], v33 offset:1024
    s_add_u32 m0, s71, 65536
    s_mul_i32 s6, s82, 40
    buffer_load_dwordx4 v11, s[20:23], s6 offen lds
    buffer_load_dwordx4 v44, s[20:23], s6 offen offset:1024 lds
    s_load_dword s52, s[0:1], s36
    s_load_dword s53, s[0:1], s36 offset:512
    s_load_dword s54, s[0:1], s36 offset:1024
    s_load_dword s55, s[0:1], s36 offset:1536
    s_load_dword s56, s[0:1], s36 offset:2048
    s_load_dword s57, s[0:1], s36 offset:2560
    buffer_load_dwordx4 v45, s[20:23], s6 offen offset:2048 lds
    buffer_load_dwordx4 v46, s[20:23], s6 offen offset:3072 lds
    s_waitcnt vmcnt(8)
    ds_read_b64_tr_b16 a[128:129], v30 offset:49152
    ds_read_b64_tr_b16 a[130:131], v30 offset:50176
    ds_read_b64_tr_b16 a[132:133], v31 offset:49152
    ds_read_b64_tr_b16 a[134:135], v31 offset:50176
    ds_read_b64_tr_b16 a[136:137], v32 offset:49152
    ds_read_b64_tr_b16 a[138:139], v32 offset:50176
    ds_read_b64_tr_b16 a[140:141], v33 offset:49152
    ds_read_b64_tr_b16 a[142:143], v33 offset:50176
    s_waitcnt lgkmcnt(0)
    s_barrier
    s_cmp_lg_u32 s3, 0
    s_cbranch_scc1 L_C_pub2
    s_atomic_add s47, s[28:29], s51 offset:256
L_C_pub2:
    s_add_u32 m0, s71, 81920
    s_mul_i32 s6, s83, 40
    buffer_load_dwordx4 v11, s[20:23], s6 offen lds
    buffer_load_dwordx4 v44, s[20:23], s6 offen offset:1024 lds
    buffer_load_dwordx4 v45, s[20:23], s6 offen offset:2048 lds
    buffer_load_dwordx4 v46, s[20:23], s6 offen offset:3072 lds
    v_add_u32 v1, s84, v13
    s_xor_b64 s[52:53], s[52:53], s[48:49]
    s_xor_b64 s[54:55], s[54:55], s[48:49]
    s_or_b64 s[52:53], s[52:53], s[54:55]
    s_xor_b64 s[56:57], s[56:57], s[48:49]
    s_or_b64 s[52:53], s[52:53], s[56:57]
    s_cbranch_scc1 L_C_chk0
L_C_chk0_back:
    s_load_dword s58, s[0:1], s37
    s_load_dword s59, s[0:1], s37 offset:512
    s_load_dword s60, s[0:1], s37 offset:1024
    s_load_dword s61, s[0:1], s37 offset:1536
    s_load_dword s62, s[0:1], s37 offset:2048
    s_load_dword s63, s[0:1], s37 offset:2560
    s_waitcnt vmcnt(8)
    ds_read_b64_tr_b16 a[144:145], v30 offset:16384
    ds_read_b64_tr_b16 a[146:147], v30 offset:17408
    ds_read_b64_tr_b16 a[148:149], v31 offset:16384
    ds_read_b64_tr_b16 a[150:151], v31 offset:17408
    ds_read_b64_tr_b16 a[152:153], v32 offset:16384
    ds_read_b64_tr_b16 a[154:155], v32 offset:17408
    ds_read_b64_tr_b16 a[156:157], v33 offset:16384
    ds_read_b64_tr_b16 a[158:159], v33 offset:17408
    buffer_load_dwordx4 v[128:131], v1, s[28:31], s72 offen sc1
    buffer_load_dwordx4 v[132:135], v1, s[28:31], s73 offen sc1
    buffer_load_dwordx4 v[136:139], v1, s[28:31], s74 offen sc1
    buffer_load_dwordx4 v[140:143], v1, s[28:31], s75 offen sc1
    s_waitcnt vmcnt(8)
    ds_read_b64_tr_b16 a[160:161], v60 offset:32768
    ds_read_b64_tr_b16 a[162:163], v60 offset:33792
    ds_read_b64_tr_b16 a[164:165], v61 offset:32768
    ds_read_b64_tr_b16 a[166:167], v61 offset:33792
    ds_read_b64_tr_b16 a[168:169], v62 offset:32768
    ds_read_b64_tr_b16 a[170:171], v62 offset:33792
    ds_read_b64_tr_b16 a[172:173], v63 offset:32768
    ds_read_b64_tr_b16 a[174:175], v63 offset:33792
    buffer_load_dwordx4 v[144:147], v1, s[28:31], s76 offen sc1
    buffer_load_dwordx4 v[148:151], v1, s[28:31], s77 offen sc1
    buffer_load_dwordx4 v[152:155], v1, s[28:31], s78 offen sc1
    buffer_load_dwordx4 v[156:159], v1, s[28:31], s79 offen sc1
    s_waitcnt vmcnt(8)
    ds_read_b64_tr_b16 a[176:177], v60 offset:49152
    ds_read_b64_tr_b16 a[178:179], v60 offset:50176
    ds_read_b64_tr_b16 a[180:181], v61 offset:49152
    ds_read_b64_tr_b16 a[182:183], v61 offset:50176
    ds_read_b64_tr_b16 a[184:185], v62 offset:49152
    ds_read_b64_tr_b16 a[186:187], v62 offset:50176
    ds_read_b64_tr_b16 a[188:189], v63 offset:49152
    ds_read_b64_tr_b16 a[190:191], v63 offset:50176
    buffer_load_dwordx4 v[160:163], v1, s[28:31], s80 offen sc1
    buffer_load_dwordx4 v[164:167], v1, s[28:31], s81 offen sc1
    s_waitcnt vmcnt(9)
    v_mfma_f32_16x16x32_bf16 v[96:99], a[0:3], v[128:131], 0
    v_mfma_f32_16x16x32_bf16 v[100:103], a[4:7], v[128:131], 0
    buffer_load_dwordx4 v[168:171], v1, s[28:31], s82 offen sc1
    v_mfma_f32_16x16x32_bf16 v[104:107], a[8:11], v[128:131], 0
    v_mfma_f32_16x16x32_bf16 v[108:111], a[12:15], v[128:131], 0
    s_waitcnt lgkmcnt(0)
    s_waitcnt vmcnt(9)
    v_mfma_f32_16x16x32_bf16 v[96:99], a[16:19], v[132:135], v[96:99]
    v_add_u32 v2, s85, v13
    s_xor_b64 s[58:59], s[58:59], s[48:49]
    v_mfma_f32_16x16x32_bf16 v[100:103], a[20:23], v[132:135], v[100:103]
    buffer_load_dwordx4 v[172:175], v1, s[28:31], s83 offen sc1
    s_xor_b64 s[60:61], s[60:61], s[48:49]
    v_mfma_f32_16x16x32_bf16 v[104:107], a[24:27], v[132:135], v[104:107]
    s_or_b64 s[58:59], s[58:59], s[60:61]
    s_xor_b64 s[62:63], s[62:63], s[48:49]
    v_mfma_f32_16x16x32_bf16 v[108:111], a[28:31], v[132:135], v[108:111]
    s_waitcnt vmcnt(9)
    v_mfma_f32_16x16x32_bf16 v[96:99], a[32:35], v[136:139], v[96:99]
    s_or_b64 s[58:59], s[58:59], s[62:63]
    s_cbranch_scc1 L_C_chk1
L_C_chk1_back:
    v_mfma_f32_16x16x32_bf16 v[100:103], a[36:39], v[136:139], v[100:103]
    buffer_load_dwordx4 v[176:179], v2, s[28:31], s72 offen sc1
    s_load_dword s64, s[0:1], s38
    v_mfma_f32_16x16x32_bf16 v[104:107], a[40:43], v[136:139], v[104:107]
    s_load_dword s65, s[0:1], s38 offset:512
    s_load_dword s66, s[0:1], s38 offset:1024
    v_mfma_f32_16x16x32_bf16 v[108:111], a[44:47], v[136:139], v[108:111]
    s_load_dword s67, s[0:1], s38 offset:1536
    s_waitcnt vmcnt(9)
    v_mfma_f32_16x16x32_bf16 v[96:99], a[48:51], v[140:143], v[96:99]
    s_load_dword s68, s[0:1], s38 offset:2048
    s_load_dword s69, s[0:1], s38 offset:2560
    v_mfma_f32_16x16x32_bf16 v[100:103], a[52:55], v[140:143], v[100:103]
    buffer_load_dwordx4 v[180:183], v2, s[28:31], s73 offen sc1
    v_mfma_f32_16x16x32_bf16 v[104:107], a[56:59], v[140:143], v[104:107]
    v_mfma_f32_16x16x32_bf16 v[108:111], a[60:63], v[140:143], v[108:111]
    s_waitcnt vmcnt(9)
    v_mfma_f32_16x16x32_bf16 v[96:99], a[64:67], v[144:147], v[96:99]
    v_mfma_f32_16x16x32_bf16 v[100:103], a[68:71], v[144:147], v[100:103]
    buffer_load_dwordx4 v[184:187], v2, s[28:31], s74 offen sc1
    v_mfma_f32_16x16x32_bf16 v[104:107], a[72:75], v[144:147], v[104:107]
    v_mfma_f32_16x16x32_bf16 v[108:111], a[76:79], v[144:147], v[108:111]
    s_waitcnt vmcnt(9)
    v_mfma_f32_16x16x32_bf16 v[96:99], a[80:83], v[148:151], v[96:99]
    v_mfma_f32_16x16x32_bf16 v[100:103], a[84:87], v[148:151], v[100:103]
    buffer_load_dwordx4 v[188:191], v2, s[28:31], s75 offen sc1
    v_mfma_f32_16x16x32_bf16 v[104:107], a[88:91], v[148:151], v[104:107]
    v_mfma_f32_16x16x32_bf16 v[108:111], a[92:95], v[148:151], v[108:111]
    s_waitcnt vmcnt(9)
    v_mfma_f32_16x16x32_bf16 v[96:99], a[96:99], v[152:155], v[96:99]
    v_mfma_f32_16x16x32_bf16 v[100:103], a[100:103], v[152:155], v[100:103]
    buffer_load_dwordx4 v[192:195], v2, s[28:31], s76 offen sc1
    v_mfma_f32_16x16x32_bf16 v[104:107], a[104:107], v[152:155], v[104:107]
    v_mfma_f32_16x16x32_bf16 v[108:111], a[108:111], v[152:155], v[108:111]
    s_waitcnt vmcnt(9)
    v_mfma_f32_16x16x32_bf16 v[96:99], a[112:115], v[156:159], v[96:99]
    v_mfma_f32_16x16x32_bf16 v[100:103], a[116:119], v[156:159], v[100:103]
    buffer_load_dwordx4 v[196:199], v2, s[28:31], s77 offen sc1
    v_mfma_f32_16x16x32_bf16 v[104:107], a[120:123], v[156:159], v[104:107]
    v_mfma_f32_16x16x32_bf16 v[108:111], a[124:127], v[156:159], v[108:111]
    s_waitcnt vmcnt(9)
    v_mfma_f32_16x16x32_bf16 v[96:99], a[128:131], v[160:163], v[96:99]
    v_mfma_f32_16x16x32_bf16 v[100:103], a[132:135], v[160:163], v[100:103]
    buffer_load_dwordx4 v[200:203], v2, s[28:31], s78 offen sc1
    v_mfma_f32_16x16x32_bf16 v[104:107], a[136:139], v[160:163], v[104:107]
    v_mfma_f32_16x16x32_bf16 v[108:111], a[140:143], v[160:163], v[108:111]
    s_waitcnt vmcnt(9)
    v_mfma_f32_16x16x32_bf16 v[96:99], a[144:147], v[164:167], v[96:99]
    v_mfma_f32_16x16x32_bf16 v[100:103], a[148:151], v[164:167], v[100:103]
    buffer_load_dwordx4 v[204:207], v2, s[28:31], s79 offen sc1
    v_mfma_f32_16x16x32_bf16 v[104:107], a[152:155], v[164:167], v[104:107]
    v_mfma_f32_16x16x32_bf16 v[108:111], a[156:159], v[164:167], v[108:111]
    s_waitcnt vmcnt(9)
    v_mfma_f32_16x16x32_bf16 v[96:99], a[160:163], v[168:171], v[96:99]
    v_mfma_f32_16x16x32_bf16 v[100:103], a[164:167], v[168:171], v[100:103]
    buffer_load_dwordx4 v[208:211], v2, s[28:31], s80 offen sc1
    v_mfma_f32_16x16x32_bf16 v[104:107], a[168:171], v[168:171], v[104:107]
    v_mfma_f32_16x16x32_bf16 v[108:111], a[172:175], v[168:171], v[108:111]
    s_waitcnt vmcnt(9)
    v_mfma_f32_16x16x32_bf16 v[96:99], a[176:179], v[172:175], v[96:99]
    v_mfma_f32_16x16x32_bf16 v[100:103], a[180:183], v[172:175], v[100:103]
    buffer_load_dwordx4 v[212:215], v2, s[28:31], s81 offen sc1
    v_mfma_f32_16x16x32_bf16 v[104:107], a[184:187], v[172:175], v[104:107]
    v_mfma_f32_16x16x32_bf16 v[108:111], a[188:191], v[172:175], v[108:111]
    s_waitcnt vmcnt(9)
    v_mfma_f32_16x16x32_bf16 v[112:115], a[0:3], v[176:179], 0
    v_mfma_f32_16x16x32_bf16 v[116:119], a[4:7], v[176:179], 0
    buffer_load_dwordx4 v[216:219], v2, s[28:31], s82 offen sc1
    v_mfma_f32_16x16x32_bf16 v[120:123], a[8:11], v[176:179], 0
    v_mfma_f32_16x16x32_bf16 v[124:127], a[12:15], v[176:179], 0
    s_waitcnt lgkmcnt(0)
    s_waitcnt vmcnt(9)
    v_mfma_f32_16x16x32_bf16 v[112:115], a[16:19], v[180:183], v[112:115]
    v_add_u32 v3, s86, v13
    s_xor_b64 s[64:65], s[64:65], s[48:49]
    v_mfma_f32_16x16x32_bf16 v[116:119], a[20:23], v[180:183], v[116:119]
    buffer_load_dwordx4 v[220:223], v2, s[28:31], s83 offen sc1
    s_xor_b64 s[66:67], s[66:67], s[48:49]
    v_mfma_f32_16x16x32_bf16 v[120:123], a[24:27], v[180:183], v[120:123]
    s_or_b64 s[64:65], s[64:65], s[66:67]
    s_xor_b64 s[68:69], s[68:69], s[48:49]
    v_mfma_f32_16x16x32_bf16 v[124:127], a[28:31], v[180:183], v[124:127]
    s_waitcnt vmcnt(9)
    v_mfma_f32_16x16x32_bf16 v[112:115], a[32:35], v[184:187], v[112:115]
    s_or_b64 s[64:65], s[64:65], s[68:69]
    s_cbranch_scc1 L_C_chk2
L_C_chk2_back:
    v_mfma_f32_16x16x32_bf16 v[116:119], a[36:39], v[184:187], v[116:119]
    buffer_load_dwordx4 v[224:227], v3, s[28:31], s72 offen sc1
    s_load_dword s52, s[0:1], s39
    v_mfma_f32_16x16x32_bf16 v[120:123], a[40:43], v[184:187], v[120:123]
    s_load_dword s53, s[0:1], s39 offset:512
    s_load_dword s54, s[0:1], s39 offset:1024
    v_mfma_f32_16x16x32_bf16 v[124:127], a[44:47], v[184:187], v[124:127]
    s_load_dword s55, s[0:1], s39 offset:1536
    s_waitcnt vmcnt(9)
    v_mfma_f32_16x16x32_bf16 v[112:115], a[48:51], v[188:191], v[112:115]
    s_load_dword s56, s[0:1], s39 offset:2048
    s_load_dword s57, s[0:1], s39 offset:2560
    v_mfma_f32_16x16x32_bf16 v[116:119], a[52:55], v[188:191], v[116:119]
    buffer_load_dwordx4 v[228:231], v3, s[28:31], s73 offen sc1
    v_mfma_f32_16x16x32_bf16 v[120:123], a[56:59], v[188:191], v[120:123]
    v_mfma_f32_16x16x32_bf16 v[124:127], a[60:63], v[188:191], v[124:127]
    s_waitcnt vmcnt(9)
    v_mfma_f32_16x16x32_bf16 v[112:115], a[64:67], v[192:195], v[112:115]
    v_mfma_f32_16x16x32_bf16 v[116:119], a[68:71], v[192:195], v[116:119]
    buffer_load_dwordx4 v[232:235], v3, s[28:31], s74 offen sc1
    v_mfma_f32_16x16x32_bf16 v[120:123], a[72:75], v[192:195], v[120:123]
    v_mfma_f32_16x16x32_bf16 v[124:127], a[76:79], v[192:195], v[124:127]
    s_waitcnt vmcnt(9)
    v_mfma_f32_16x16x32_bf16 v[112:115], a[80:83], v[196:199], v[112:115]
    ds_write_b64 v34, v[96:97] offset:0
    v_mfma_f32_16x16x32_bf16 v[116:119], a[84:87], v[196:199], v[116:119]
    buffer_load_dwordx4 v[236:239], v3, s[28:31], s75 offen sc1
    v_mfma_f32_16x16x32_bf16 v[120:123], a[88:91], v[196:199], v[120:123]
    ds_write_b64 v34, v[98:99] offset:8
    v_mfma_f32_16x16x32_bf16 v[124:127], a[92:95], v[196:199], v[124:127]
    s_waitcnt vmcnt(9)
    v_mfma_f32_16x16x32_bf16 v[112:115], a[96:99], v[200:203], v[112:115]
    ds_write_b64 v35, v[100:101] offset:0
    v_mfma_f32_16x16x32_bf16 v[116:119], a[100:103], v[200:203], v[116:119]
    buffer_load_dwordx4 v[240:243], v3, s[28:31], s76 offen sc1
    v_mfma_f32_16x16x32_bf16 v[120:123], a[104:107], v[200:203], v[120:123]
    ds_write_b64 v35, v[102:103] offset:8
    v_mfma_f32_16x16x32_bf16 v[124:127], a[108:111], v[200:203], v[124:127]
    s_waitcnt vmcnt(9)
    v_mfma_f32_16x16x32_bf16 v[112:115], a[112:115], v[204:207], v[112:115]
    ds_write_b64 v36, v[104:105] offset:0
    v_mfma_f32_16x16x32_bf16 v[116:119], a[116:119], v[204:207], v[116:119]
    buffer_load_dwordx4 v[244:247], v3, s[28:31], s77 offen sc1
    v_mfma_f32_16x16x32_bf16 v[120:123], a[120:123], v[204:207], v[120:123]
    ds_write_b64 v36, v[106:107] offset:8
    v_mfma_f32_16x16x32_bf16 v[124:127], a[124:127], v[204:207], v[124:127]
    s_waitcnt vmcnt(9)
    v_mfma_f32_16x16x32_bf16 v[112:115], a[128:131], v[208:211], v[112:115]
    ds_write_b64 v37, v[108:109] offset:0
    v_mfma_f32_16x16x32_bf16 v[116:119], a[132:135], v[208:211], v[116:119]
    buffer_load_dwordx4 v[248:251], v3, s[28:31], s78 offen sc1
    v_mfma_f32_16x16x32_bf16 v[120:123], a[136:139], v[208:211], v[120:123]
    ds_write_b64 v37, v[110:111] offset:8
    v_mfma_f32_16x16x32_bf16 v[124:127], a[140:143], v[208:211], v[124:127]
    s_waitcnt vmcnt(9)
    v_mfma_f32_16x16x32_bf16 v[112:115], a[144:147], v[212:215], v[112:115]
    v_mfma_f32_16x16x32_bf16 v[116:119], a[148:151], v[212:215], v[116:119]
    buffer_load_dwordx4 v[252:255], v3, s[28:31], s79 offen sc1
    v_mfma_f32_16x16x32_bf16 v[120:123], a[152:155], v[212:215], v[120:123]
    s_waitcnt lgkmcnt(0)
    s_barrier
    v_mfma_f32_16x16x32_bf16 v[124:127], a[156:159], v[212:215], v[124:127]
    ds_read_b128 v[64:67], v38 offset:0
    s_waitcnt vmcnt(9)
    v_mfma_f32_16x16x32_bf16 v[112:115], a[160:163], v[216:219], v[112:115]
    ds_read_b128 v[68:71], v38 offset:4096
    ds_read_b128 v[72:75], v38 offset:8192
    v_mfma_f32_16x16x32_bf16 v[116:119], a[164:167], v[216:219], v[116:119]
    buffer_load_dwordx4 a[192:195], v3, s[28:31], s80 offen sc1
    ds_read_b128 v[76:79], v38 offset:12288
    v_mfma_f32_16x16x32_bf16 v[120:123], a[168:171], v[216:219], v[120:123]
    v_mfma_f32_16x16x32_bf16 v[124:127], a[172:175], v[216:219], v[124:127]
    s_waitcnt vmcnt(9)
    v_mfma_f32_16x16x32_bf16 v[112:115], a[176:179], v[220:223], v[112:115]
    v_mfma_f32_16x16x32_bf16 v[116:119], a[180:183], v[220:223], v[116:119]
    buffer_load_dwordx4 a[196:199], v3, s[28:31], s81 offen sc1
    s_waitcnt lgkmcnt(2)
    v_add_f32 v64, v64, v68
    v_mfma_f32_16x16x32_bf16 v[120:123], a[184:187], v[220:223], v[120:123]
    v_add_f32 v65, v65, v69
    v_add_f32 v66, v66, v70
    v_mfma_f32_16x16x32_bf16 v[124:127], a[188:191], v[220:223], v[124:127]
    v_add_f32 v67, v67, v71
    s_waitcnt vmcnt(9)
    v_mfma_f32_16x16x32_bf16 v[96:99], a[0:3], v[224:227], 0
    s_waitcnt lgkmcnt(0)
    v_add_f32 v72, v72, v76
    v_add_f32 v73, v73, v77
    v_mfma_f32_16x16x32_bf16 v[100:103], a[4:7], v[224:227], 0
    buffer_load_dwordx4 a[200:203], v3, s[28:31], s82 offen sc1
    v_add_f32 v74, v74, v78
    v_mfma_f32_16x16x32_bf16 v[104:107], a[8:11], v[224:227], 0
    v_add_f32 v75, v75, v79
    v_add_f32 v64, v64, v72
    v_mfma_f32_16x16x32_bf16 v[108:111], a[12:15], v[224:227], 0
    s_waitcnt lgkmcnt(0)
    s_waitcnt vmcnt(9)
    v_mfma_f32_16x16x32_bf16 v[96:99], a[16:19], v[228:231], v[96:99]
    v_add_u32 v4, s87, v13
    s_xor_b64 s[52:53], s[52:53], s[48:49]
    v_mfma_f32_16x16x32_bf16 v[100:103], a[20:23], v[228:231], v[100:103]
    buffer_load_dwordx4 a[204:207], v3, s[28:31], s83 offen sc1
    s_xor_b64 s[54:55], s[54:55], s[48:49]
    v_mfma_f32_16x16x32_bf16 v[104:107], a[24:27], v[228:231], v[104:107]
    s_or_b64 s[52:53], s[52:53], s[54:55]
    s_xor_b64 s[56:57], s[56:57], s[48:49]
    v_mfma_f32_16x16x32_bf16 v[108:111], a[28:31], v[228:231], v[108:111]
    v_add_f32 v65, v65, v73
    s_waitcnt vmcnt(9)
    v_mfma_f32_16x16x32_bf16 v[96:99], a[32:35], v[232:235], v[96:99]
    s_or_b64 s[52:53], s[52:53], s[56:57]
    s_cbranch_scc1 L_C_chk3
L_C_chk3_back:
    v_mfma_f32_16x16x32_bf16 v[100:103], a[36:39], v[232:235], v[100:103]
    buffer_load_dwordx4 a[208:211], v4, s[28:31], s72 offen sc1
    v_add_f32 v66, v66, v74
    v_mfma_f32_16x16x32_bf16 v[104:107], a[40:43], v[232:235], v[104:107]
    v_add_f32 v67, v67, v75
    v_cvt_pk_bf16_f32 v80, v64, v65
    v_mfma_f32_16x16x32_bf16 v[108:111], a[44:47], v[232:235], v[108:111]
    v_cvt_pk_bf16_f32 v81, v66, v67
    s_waitcnt vmcnt(9)
    v_mfma_f32_16x16x32_bf16 v[96:99], a[48:51], v[236:239], v[96:99]
    s_load_dword s58, s[0:1], s40
    s_load_dword s59, s[0:1], s40 offset:512
    v_mfma_f32_16x16x32_bf16 v[100:103], a[52:55], v[236:239], v[100:103]
    buffer_load_dwordx4 a[212:215], v4, s[28:31], s73 offen sc1
    s_load_dword s60, s[0:1], s40 offset:1024
    v_mfma_f32_16x16x32_bf16 v[104:107], a[56:59], v[236:239], v[104:107]
    s_load_dword s61, s[0:1], s40 offset:1536
    s_load_dword s62, s[0:1], s40 offset:2048
    v_mfma_f32_16x16x32_bf16 v[108:111], a[60:63], v[236:239], v[108:111]
    s_load_dword s63, s[0:1], s40 offset:2560
    s_waitcnt vmcnt(9)
    v_mfma_f32_16x16x32_bf16 v[96:99], a[64:67], v[240:243], v[96:99]
    v_mfma_f32_16x16x32_bf16 v[100:103], a[68:71], v[240:243], v[100:103]
    buffer_load_dwordx4 a[216:219], v4, s[28:31], s74 offen sc1
    v_mfma_f32_16x16x32_bf16 v[104:107], a[72:75], v[240:243], v[104:107]
    v_mfma_f32_16x16x32_bf16 v[108:111], a[76:79], v[240:243], v[108:111]
    s_waitcnt vmcnt(9)
    v_mfma_f32_16x16x32_bf16 v[96:99], a[80:83], v[244:247], v[96:99]
    ds_write_b64 v34, v[112:113] offset:16384
    v_mfma_f32_16x16x32_bf16 v[100:103], a[84:87], v[244:247], v[100:103]
    buffer_load_dwordx4 a[220:223], v4, s[28:31], s75 offen sc1
    v_mfma_f32_16x16x32_bf16 v[104:107], a[88:91], v[244:247], v[104:107]
    ds_write_b64 v34, v[114:115] offset:16392
    v_mfma_f32_16x16x32_bf16 v[108:111], a[92:95], v[244:247], v[108:111]
    s_waitcnt vmcnt(9)
    v_mfma_f32_16x16x32_bf16 v[96:99], a[96:99], v[248:251], v[96:99]
    ds_write_b64 v35, v[116:117] offset:16384
    v_mfma_f32_16x16x32_bf16 v[100:103], a[100:103], v[248:251], v[100:103]
    buffer_load_dwordx4 a[224:227], v4, s[28:31], s76 offen sc1
    v_mfma_f32_16x16x32_bf16 v[104:107], a[104:107], v[248:251], v[104:107]
    ds_write_b64 v35, v[118:119] offset:16392
    v_mfma_f32_16x16x32_bf16 v[108:111], a[108:111], v[248:251], v[108:111]
    s_waitcnt vmcnt(9)
    v_mfma_f32_16x16x32_bf16 v[96:99], a[112:115], v[252:255], v[96:99]
    ds_write_b64 v36, v[120:121] offset:16384
    v_mfma_f32_16x16x32_bf16 v[100:103], a[116:119], v[252:255], v[100:103]
    buffer_load_dwordx4 a[228:231], v4, s[28:31], s77 offen sc1
    v_mfma_f32_16x16x32_bf16 v[104:107], a[120:123], v[252:255], v[104:107]
    ds_write_b64 v36, v[122:123] offset:16392
    v_mfma_f32_16x16x32_bf16 v[108:111], a[124:127], v[252:255], v[108:111]
    s_waitcnt vmcnt(9)
    v_mfma_f32_16x16x32_bf16 v[96:99], a[128:131], a[192:195], v[96:99]
    ds_write_b64 v37, v[124:125] offset:16384
    v_mfma_f32_16x16x32_bf16 v[100:103], a[132:135], a[192:195], v[100:103]
    buffer_load_dwordx4 a[232:235], v4, s[28:31], s78 offen sc1
    v_mfma_f32_16x16x32_bf16 v[104:107], a[136:139], a[192:195], v[104:107]
    ds_write_b64 v37, v[126:127] offset:16392
    v_mfma_f32_16x16x32_bf16 v[108:111], a[140:143], a[192:195], v[108:111]
    s_waitcnt vmcnt(9)
    v_mfma_f32_16x16x32_bf16 v[96:99], a[144:147], a[196:199], v[96:99]
    v_mfma_f32_16x16x32_bf16 v[100:103], a[148:151], a[196:199], v[100:103]
    buffer_load_dwordx4 a[236:239], v4, s[28:31], s79 offen sc1
    v_mfma_f32_16x16x32_bf16 v[104:107], a[152:155], a[196:199], v[104:107]
    s_waitcnt lgkmcnt(0)
    s_barrier
    v_mfma_f32_16x16x32_bf16 v[108:111], a[156:159], a[196:199], v[108:111]
    ds_read_b128 v[64:67], v38 offset:16384
    s_waitcnt vmcnt(9)
    v_mfma_f32_16x16x32_bf16 v[96:99], a[160:163], a[200:203], v[96:99]
    ds_read_b128 v[68:71], v38 offset:20480
    ds_read_b128 v[72:75], v38 offset:24576
    v_mfma_f32_16x16x32_bf16 v[100:103], a[164:167], a[200:203], v[100:103]
    buffer_load_dwordx4 a[240:243], v4, s[28:31], s80 offen sc1
    ds_read_b128 v[76:79], v38 offset:28672
    v_mfma_f32_16x16x32_bf16 v[104:107], a[168:171], a[200:203], v[104:107]
    v_mfma_f32_16x16x32_bf16 v[108:111], a[172:175], a[200:203], v[108:111]
    s_waitcnt vmcnt(9)
    v_mfma_f32_16x16x32_bf16 v[96:99], a[176:179], a[204:207], v[96:99]
    v_mfma_f32_16x16x32_bf16 v[100:103], a[180:183], a[204:207], v[100:103]
    buffer_load_dwordx4 a[244:247], v4, s[28:31], s81 offen sc1
    s_waitcnt lgkmcnt(2)
    v_add_f32 v64, v64, v68
    v_mfma_f32_16x16x32_bf16 v[104:107], a[184:187], a[204:207], v[104:107]
    v_add_f32 v65, v65, v69
    v_add_f32 v66, v66, v70
    v_mfma_f32_16x16x32_bf16 v[108:111], a[188:191], a[204:207], v[108:111]
    v_add_f32 v67, v67, v71
    s_waitcnt vmcnt(9)
L_C_w3_0:
    s_cbranch_execz L_C_w3_1
    v_mfma_f32_16x16x32_bf16 v[112:115], a[0:3], a[208:211], 0
    s_waitcnt lgkmcnt(0)
    v_add_f32 v72, v72, v76
    v_add_f32 v73, v73, v77
    v_mfma_f32_16x16x32_bf16 v[116:119], a[4:7], a[208:211], 0
    buffer_load_dwordx4 a[248:251], v4, s[28:31], s82 offen sc1
    v_add_f32 v74, v74, v78
    v_mfma_f32_16x16x32_bf16 v[120:123], a[8:11], a[208:211], 0
    v_add_f32 v75, v75, v79
    v_add_f32 v64, v64, v72
    v_mfma_f32_16x16x32_bf16 v[124:127], a[12:15], a[208:211], 0
L_C_w3_1:
    s_cbranch_execz L_hopped
    s_waitcnt lgkmcnt(0)
    s_waitcnt vmcnt(9)
    v_mfma_f32_16x16x32_bf16 v[112:115], a[16:19], a[212:215], v[112:115]
    v_add_u32 v5, s88, v13
    s_xor_b64 s[58:59], s[58:59], s[48:49]
    v_mfma_f32_16x16x32_bf16 v[116:119], a[20:23], a[212:215], v[116:119]
    buffer_load_dwordx4 a[252:255], v4, s[28:31], s83 offen sc1
    s_xor_b64 s[60:61], s[60:61], s[48:49]
    v_mfma_f32_16x16x32_bf16 v[120:123], a[24:27], a[212:215], v[120:123]
    s_or_b64 s[58:59], s[58:59], s[60:61]
    s_xor_b64 s[62:63], s[62:63], s[48:49]
    v_mfma_f32_16x16x32_bf16 v[124:127], a[28:31], a[212:215], v[124:127]
    v_add_f32 v65, v65, v73
    s_waitcnt vmcnt(9)
    v_mfma_f32_16x16x32_bf16 v[112:115], a[32:35], a[216:219], v[112:115]
    s_or_b64 s[58:59], s[58:59], s[62:63]
    s_cbranch_scc1 L_C_chk4
L_C_chk4_back:
    v_mfma_f32_16x16x32_bf16 v[116:119], a[36:39], a[216:219], v[116:119]
    buffer_load_dwordx4 v[128:131], v5, s[28:31], s72 offen sc1
    v_add_f32 v66, v66, v74
    v_mfma_f32_16x16x32_bf16 v[120:123], a[40:43], a[216:219], v[120:123]
    v_add_f32 v67, v67, v75
    v_cvt_pk_bf16_f32 v82, v64, v65
    v_mfma_f32_16x16x32_bf16 v[124:127], a[44:47], a[216:219], v[124:127]
    v_cvt_pk_bf16_f32 v83, v66, v67
    s_waitcnt vmcnt(9)
    v_mfma_f32_16x16x32_bf16 v[112:115], a[48:51], a[220:223], v[112:115]
    s_load_dword s64, s[0:1], s41
    s_load_dword s65, s[0:1], s41 offset:512
    v_mfma_f32_16x16x32_bf16 v[116:119], a[52:55], a[220:223], v[116:119]
    buffer_load_dwordx4 v[132:135], v5, s[28:31], s73 offen sc1
    s_load_dword s66, s[0:1], s41 offset:1024
    v_mfma_f32_16x16x32_bf16 v[120:123], a[56:59], a[220:223], v[120:123]
    s_load_dword s67, s[0:1], s41 offset:1536
    s_load_dword s68, s[0:1], s41 offset:2048
    v_mfma_f32_16x16x32_bf16 v[124:127], a[60:63], a[220:223], v[124:127]
    s_load_dword s69, s[0:1], s41 offset:2560
    s_waitcnt vmcnt(9)
    v_mfma_f32_16x16x32_bf16 v[112:115], a[64:67], a[224:227], v[112:115]
    v_mfma_f32_16x16x32_bf16 v[116:119], a[68:71], a[224:227], v[116:119]
    buffer_load_dwordx4 v[136:139], v5, s[28:31], s74 offen sc1
    v_mfma_f32_16x16x32_bf16 v[120:123], a[72:75], a[224:227], v[120:123]
    v_mfma_f32_16x16x32_bf16 v[124:127], a[76:79], a[224:227], v[124:127]
    s_waitcnt vmcnt(9)
    v_mfma_f32_16x16x32_bf16 v[112:115], a[80:83], a[228:231], v[112:115]
    ds_write_b64 v34, v[96:97] offset:32768
    v_mfma_f32_16x16x32_bf16 v[116:119], a[84:87], a[228:231], v[116:119]
    buffer_load_dwordx4 v[140:143], v5, s[28:31], s75 offen sc1
    v_mfma_f32_16x16x32_bf16 v[120:123], a[88:91], a[228:231], v[120:123]
    ds_write_b64 v34, v[98:99] offset:32776
    v_mfma_f32_16x16x32_bf16 v[124:127], a[92:95], a[228:231], v[124:127]
    s_waitcnt vmcnt(9)
    v_mfma_f32_16x16x32_bf16 v[112:115], a[96:99], a[232:235], v[112:115]
    ds_write_b64 v35, v[100:101] offset:32768
    v_mfma_f32_16x16x32_bf16 v[116:119], a[100:103], a[232:235], v[116:119]
    buffer_load_dwordx4 v[144:147], v5, s[28:31], s76 offen sc1
    v_mfma_f32_16x16x32_bf16 v[120:123], a[104:107], a[232:235], v[120:123]
    ds_write_b64 v35, v[102:103] offset:32776
    v_mfma_f32_16x16x32_bf16 v[124:127], a[108:111], a[232:235], v[124:127]
    s_waitcnt vmcnt(9)
    v_mfma_f32_16x16x32_bf16 v[112:115], a[112:115], a[236:239], v[112:115]
    ds_write_b64 v36, v[104:105] offset:32768
    v_mfma_f32_16x16x32_bf16 v[116:119], a[116:119], a[236:239], v[116:119]
    buffer_load_dwordx4 v[148:151], v5, s[28:31], s77 offen sc1
    v_mfma_f32_16x16x32_bf16 v[120:123], a[120:123], a[236:239], v[120:123]
    ds_write_b64 v36, v[106:107] offset:32776
    v_mfma_f32_16x16x32_bf16 v[124:127], a[124:127], a[236:239], v[124:127]
    s_waitcnt vmcnt(9)
    v_mfma_f32_16x16x32_bf16 v[112:115], a[128:131], a[240:243], v[112:115]
    ds_write_b64 v37, v[108:109] offset:32768
    v_mfma_f32_16x16x32_bf16 v[116:119], a[132:135], a[240:243], v[116:119]
    buffer_load_dwordx4 v[152:155], v5, s[28:31], s78 offen sc1
    v_mfma_f32_16x16x32_bf16 v[120:123], a[136:139], a[240:243], v[120:123]
    ds_write_b64 v37, v[110:111] offset:32776
    v_mfma_f32_16x16x32_bf16 v[124:127], a[140:143], a[240:243], v[124:127]
    s_waitcnt vmcnt(9)
    v_mfma_f32_16x16x32_bf16 v[112:115], a[144:147], a[244:247], v[112:115]
    v_mfma_f32_16x16x32_bf16 v[116:119], a[148:151], a[244:247], v[116:119]
    buffer_load_dwordx4 v[156:159], v5, s[28:31], s79 offen sc1
    v_mfma_f32_16x16x32_bf16 v[120:123], a[152:155], a[244:247], v[120:123]
    s_waitcnt lgkmcnt(0)
    s_barrier
    v_mfma_f32_16x16x32_bf16 v[124:127], a[156:159], a[244:247], v[124:127]
    ds_read_b128 v[64:67], v38 offset:32768
    s_waitcnt vmcnt(9)
    v_mfma_f32_16x16x32_bf16 v[112:115], a[160:163], a[248:251], v[112:115]
    ds_read_b128 v[68:71], v38 offset:36864
    ds_read_b128 v[72:75], v38 offset:40960
    v_mfma_f32_16x16x32_bf16 v[116:119], a[164:167], a[248:251], v[116:119]
    buffer_load_dwordx4 v[160:163], v5, s[28:31], s80 offen sc1
    ds_read_b128 v[76:79], v38 offset:45056
    v_mfma_f32_16x16x32_bf16 v[120:123], a[168:171], a[248:251], v[120:123]
    v_mfma_f32_16x16x32_bf16 v[124:127], a[172:175], a[248:251], v[124:127]
    s_waitcnt vmcnt(9)
    v_mfma_f32_16x16x32_bf16 v[112:115], a[176:179], a[252:255], v[112:115]
    v_mfma_f32_16x16x32_bf16 v[116:119], a[180:183], a[252:255], v[116:119]
    buffer_load_dwordx4 v[164:167], v5, s[28:31], s81 offen sc1
    s_waitcnt lgkmcnt(2)
    v_add_f32 v64, v64, v68
    v_mfma_f32_16x16x32_bf16 v[120:123], a[184:187], a[252:255], v[120:123]
    v_add_f32 v65, v65, v69
    v_add_f32 v66, v66, v70
    v_mfma_f32_16x16x32_bf16 v[124:127], a[188:191], a[252:255], v[124:127]
    v_add_f32 v67, v67, v71
    s_waitcnt vmcnt(9)
    v_mfma_f32_16x16x32_bf16 v[96:99], a[0:3], v[128:131], 0
    s_waitcnt lgkmcnt(0)
    v_add_f32 v72, v72, v76
    v_add_f32 v73, v73, v77
    v_mfma_f32_16x16x32_bf16 v[100:103], a[4:7], v[128:131], 0
    buffer_load_dwordx4 v[168:171], v5, s[28:31], s82 offen sc1
    v_add_f32 v74, v74, v78
    v_mfma_f32_16x16x32_bf16 v[104:107], a[8:11], v[128:131], 0
    v_add_f32 v75, v75, v79
    v_add_f32 v64, v64, v72
    v_mfma_f32_16x16x32_bf16 v[108:111], a[12:15], v[128:131], 0
    s_waitcnt lgkmcnt(0)
    s_waitcnt vmcnt(9)
    v_mfma_f32_16x16x32_bf16 v[96:99], a[16:19], v[132:135], v[96:99]
    v_add_u32 v6, s89, v13
    s_xor_b64 s[64:65], s[64:65], s[48:49]
    v_mfma_f32_16x16x32_bf16 v[100:103], a[20:23], v[132:135], v[100:103]
    buffer_load_dwordx4 v[172:175], v5, s[28:31], s83 offen sc1
    s_xor_b64 s[66:67], s[66:67], s[48:49]
    v_mfma_f32_16x16x32_bf16 v[104:107], a[24:27], v[132:135], v[104:107]
    s_or_b64 s[64:65], s[64:65], s[66:67]
    s_xor_b64 s[68:69], s[68:69], s[48:49]
    v_mfma_f32_16x16x32_bf16 v[108:111], a[28:31], v[132:135], v[108:111]
    v_add_f32 v65, v65, v73
    s_waitcnt vmcnt(9)
    v_mfma_f32_16x16x32_bf16 v[96:99], a[32:35], v[136:139], v[96:99]
    s_or_b64 s[64:65], s[64:65], s[68:69]
    s_cbranch_scc1 L_C_chk5
L_C_chk5_back:
    v_mfma_f32_16x16x32_bf16 v[100:103], a[36:39], v[136:139], v[100:103]
    buffer_load_dwordx4 v[176:179], v6, s[28:31], s72 offen sc1
    v_add_f32 v66, v66, v74
    v_mfma_f32_16x16x32_bf16 v[104:107], a[40:43], v[136:139], v[104:107]
    v_add_f32 v67, v67, v75
    v_cvt_pk_bf16_f32 v84, v64, v65
    v_mfma_f32_16x16x32_bf16 v[108:111], a[44:47], v[136:139], v[108:111]
    v_cvt_pk_bf16_f32 v85, v66, v67
    s_waitcnt vmcnt(9)
    v_mfma_f32_16x16x32_bf16 v[96:99], a[48:51], v[140:143], v[96:99]
    ds_write_b64 v34, v[112:113] offset:49152
    v_mfma_f32_16x16x32_bf16 v[100:103], a[52:55], v[140:143], v[100:103]
    buffer_load_dwordx4 v[180:183], v6, s[28:31], s73 offen sc1
    v_mfma_f32_16x16x32_bf16 v[104:107], a[56:59], v[140:143], v[104:107]
    ds_write_b64 v34, v[114:115] offset:49160
    v_mfma_f32_16x16x32_bf16 v[108:111], a[60:63], v[140:143], v[108:111]
    s_waitcnt vmcnt(9)
    v_mfma_f32_16x16x32_bf16 v[96:99], a[64:67], v[144:147], v[96:99]
    ds_write_b64 v35, v[116:117] offset:49152
    v_mfma_f32_16x16x32_bf16 v[100:103], a[68:71], v[144:147], v[100:103]
    buffer_load_dwordx4 v[184:187], v6, s[28:31], s74 offen sc1
    v_mfma_f32_16x16x32_bf16 v[104:107], a[72:75], v[144:147], v[104:107]
    ds_write_b64 v35, v[118:119] offset:49160
    v_mfma_f32_16x16x32_bf16 v[108:111], a[76:79], v[144:147], v[108:111]
    s_waitcnt vmcnt(9)
    v_mfma_f32_16x16x32_bf16 v[96:99], a[80:83], v[148:151], v[96:99]
    ds_write_b64 v36, v[120:121] offset:49152
    v_mfma_f32_16x16x32_bf16 v[100:103], a[84:87], v[148:151], v[100:103]
    buffer_load_dwordx4 v[188:191], v6, s[28:31], s75 offen sc1
    v_mfma_f32_16x16x32_bf16 v[104:107], a[88:91], v[148:151], v[104:107]
    ds_write_b64 v36, v[122:123] offset:49160
    v_mfma_f32_16x16x32_bf16 v[108:111], a[92:95], v[148:151], v[108:111]
    s_waitcnt vmcnt(9)
    v_mfma_f32_16x16x32_bf16 v[96:99], a[96:99], v[152:155], v[96:99]
    ds_write_b64 v37, v[124:125] offset:49152
    v_mfma_f32_16x16x32_bf16 v[100:103], a[100:103], v[152:155], v[100:103]
    buffer_load_dwordx4 v[192:195], v6, s[28:31], s76 offen sc1
    v_mfma_f32_16x16x32_bf16 v[104:107], a[104:107], v[152:155], v[104:107]
    ds_write_b64 v37, v[126:127] offset:49160
    v_mfma_f32_16x16x32_bf16 v[108:111], a[108:111], v[152:155], v[108:111]
    s_waitcnt vmcnt(9)
    v_mfma_f32_16x16x32_bf16 v[96:99], a[112:115], v[156:159], v[96:99]
    v_mfma_f32_16x16x32_bf16 v[100:103], a[116:119], v[156:159], v[100:103]
    buffer_load_dwordx4 v[196:199], v6, s[28:31], s77 offen sc1
    v_mfma_f32_16x16x32_bf16 v[104:107], a[120:123], v[156:159], v[104:107]
    s_waitcnt lgkmcnt(0)
    s_barrier
    v_mfma_f32_16x16x32_bf16 v[108:111], a[124:127], v[156:159], v[108:111]
    ds_read_b128 v[64:67], v38 offset:49152
    s_waitcnt vmcnt(9)
    v_mfma_f32_16x16x32_bf16 v[96:99], a[128:131], v[160:163], v[96:99]
    ds_read_b128 v[68:71], v38 offset:53248
    ds_read_b128 v[72:75], v38 offset:57344
    v_mfma_f32_16x16x32_bf16 v[100:103], a[132:135], v[160:163], v[100:103]
    buffer_load_dwordx4 v[200:203], v6, s[28:31], s78 offen sc1
    ds_read_b128 v[76:79], v38 offset:61440
    v_mfma_f32_16x16x32_bf16 v[104:107], a[136:139], v[160:163], v[104:107]
    v_mfma_f32_16x16x32_bf16 v[108:111], a[140:143], v[160:163], v[108:111]
    s_waitcnt vmcnt(9)
    v_mfma_f32_16x16x32_bf16 v[96:99], a[144:147], v[164:167], v[96:99]
    v_mfma_f32_16x16x32_bf16 v[100:103], a[148:151], v[164:167], v[100:103]
    buffer_load_dwordx4 v[204:207], v6, s[28:31], s79 offen sc1
    s_waitcnt lgkmcnt(2)
    v_add_f32 v64, v64, v68
    v_mfma_f32_16x16x32_bf16 v[104:107], a[152:155], v[164:167], v[104:107]
    v_add_f32 v65, v65, v69
    v_add_f32 v66, v66, v70
    v_mfma_f32_16x16x32_bf16 v[108:111], a[156:159], v[164:167], v[108:111]
    v_add_f32 v67, v67, v71
    s_waitcnt vmcnt(9)
    v_mfma_f32_16x16x32_bf16 v[96:99], a[160:163], v[168:171], v[96:99]
    s_waitcnt lgkmcnt(0)
    v_add_f32 v72, v72, v76
    v_add_f32 v73, v73, v77
    v_mfma_f32_16x16x32_bf16 v[100:103], a[164:167], v[168:171], v[100:103]
    buffer_load_dwordx4 v[208:211], v6, s[28:31], s80 offen sc1
    v_add_f32 v74, v74, v78
    v_mfma_f32_16x16x32_bf16 v[104:107], a[168:171], v[168:171], v[104:107]
    v_add_f32 v75, v75, v79
    v_add_f32 v64, v64, v72
    v_mfma_f32_16x16x32_bf16 v[108:111], a[172:175], v[168:171], v[108:111]
    v_add_f32 v65, v65, v73
    s_waitcnt vmcnt(9)
    v_mfma_f32_16x16x32_bf16 v[96:99], a[176:179], v[172:175], v[96:99]
    v_add_f32 v66, v66, v74
    v_add_f32 v67, v67, v75
    v_mfma_f32_16x16x32_bf16 v[100:103], a[180:183], v[172:175], v[100:103]
    buffer_load_dwordx4 v[212:215], v6, s[28:31], s81 offen sc1
    v_cvt_pk_bf16_f32 v86, v64, v65
    v_mfma_f32_16x16x32_bf16 v[104:107], a[184:187], v[172:175], v[104:107]
    v_cvt_pk_bf16_f32 v87, v66, v67
    v_mfma_f32_16x16x32_bf16 v[108:111], a[188:191], v[172:175], v[108:111]
    s_waitcnt vmcnt(9)
    v_mfma_f32_16x16x32_bf16 v[112:115], a[0:3], v[176:179], 0
    v_mfma_f32_16x16x32_bf16 v[116:119], a[4:7], v[176:179], 0
    buffer_load_dwordx4 v[216:219], v6, s[28:31], s82 offen sc1
    v_mfma_f32_16x16x32_bf16 v[120:123], a[8:11], v[176:179], 0
    v_mfma_f32_16x16x32_bf16 v[124:127], a[12:15], v[176:179], 0
    s_waitcnt vmcnt(9)
    v_mfma_f32_16x16x32_bf16 v[112:115], a[16:19], v[180:183], v[112:115]
    v_mfma_f32_16x16x32_bf16 v[116:119], a[20:23], v[180:183], v[116:119]
    buffer_load_dwordx4 v[220:223], v6, s[28:31], s83 offen sc1
    v_mfma_f32_16x16x32_bf16 v[120:123], a[24:27], v[180:183], v[120:123]
    v_mfma_f32_16x16x32_bf16 v[124:127], a[28:31], v[180:183], v[124:127]
    buffer_store_dwordx2 v[80:81], v17, s[24:27], s90 offen sc1
    s_waitcnt vmcnt(10)
    v_mfma_f32_16x16x32_bf16 v[112:115], a[32:35], v[184:187], v[112:115]
    buffer_store_dwordx2 v[82:83], v17, s[24:27], s91 offen sc1
    v_mfma_f32_16x16x32_bf16 v[116:119], a[36:39], v[184:187], v[116:119]
    buffer_store_dwordx2 v[84:85], v17, s[24:27], s92 offen sc1
    v_mfma_f32_16x16x32_bf16 v[120:123], a[40:43], v[184:187], v[120:123]
    ds_write_b64 v34, v[96:97] offset:0
    v_mfma_f32_16x16x32_bf16 v[124:127], a[44:47], v[184:187], v[124:127]
    buffer_store_dwordx2 v[86:87], v17, s[24:27], s93 offen sc1
    s_waitcnt vmcnt(12)
    v_mfma_f32_16x16x32_bf16 v[112:115], a[48:51], v[188:191], v[112:115]
    ds_write_b64 v34, v[98:99] offset:8
    v_mfma_f32_16x16x32_bf16 v[116:119], a[52:55], v[188:191], v[116:119]
    ds_write_b64 v35, v[100:101] offset:0
    v_mfma_f32_16x16x32_bf16 v[120:123], a[56:59], v[188:191], v[120:123]
    ds_write_b64 v35, v[102:103] offset:8
    v_mfma_f32_16x16x32_bf16 v[124:127], a[60:63], v[188:191], v[124:127]
    s_waitcnt vmcnt(11)
    v_mfma_f32_16x16x32_bf16 v[112:115], a[64:67], v[192:195], v[112:115]
    ds_write_b64 v36, v[104:105] offset:0
    v_mfma_f32_16x16x32_bf16 v[116:119], a[68:71], v[192:195], v[116:119]
    ds_write_b64 v36, v[106:107] offset:8
    v_mfma_f32_16x16x32_bf16 v[120:123], a[72:75], v[192:195], v[120:123]
    ds_write_b64 v37, v[108:109] offset:0
    v_mfma_f32_16x16x32_bf16 v[124:127], a[76:79], v[192:195], v[124:127]
    s_waitcnt vmcnt(10)
    v_mfma_f32_16x16x32_bf16 v[112:115], a[80:83], v[196:199], v[112:115]
    ds_write_b64 v37, v[110:111] offset:8
    v_mfma_f32_16x16x32_bf16 v[116:119], a[84:87], v[196:199], v[116:119]
    v_mfma_f32_16x16x32_bf16 v[120:123], a[88:91], v[196:199], v[120:123]
    v_mfma_f32_16x16x32_bf16 v[124:127], a[92:95], v[196:199], v[124:127]
    s_waitcnt vmcnt(9)
    v_mfma_f32_16x16x32_bf16 v[112:115], a[96:99], v[200:203], v[112:115]
    s_waitcnt lgkmcnt(0)
    s_barrier
    v_mfma_f32_16x16x32_bf16 v[116:119], a[100:103], v[200:203], v[116:119]
    ds_read_b128 v[64:67], v38 offset:0
    ds_read_b128 v[68:71], v38 offset:4096
    v_mfma_f32_16x16x32_bf16 v[120:123], a[104:107], v[200:203], v[120:123]
    ds_read_b128 v[72:75], v38 offset:8192
    ds_read_b128 v[76:79], v38 offset:12288
    v_mfma_f32_16x16x32_bf16 v[124:127], a[108:111], v[200:203], v[124:127]
    s_waitcnt vmcnt(8)
    v_mfma_f32_16x16x32_bf16 v[112:115], a[112:115], v[204:207], v[112:115]
    v_mfma_f32_16x16x32_bf16 v[116:119], a[116:119], v[204:207], v[116:119]
    v_mfma_f32_16x16x32_bf16 v[120:123], a[120:123], v[204:207], v[120:123]
    s_waitcnt lgkmcnt(2)
    v_add_f32 v64, v64, v68
    v_add_f32 v65, v65, v69
    v_mfma_f32_16x16x32_bf16 v[124:127], a[124:127], v[204:207], v[124:127]
    v_add_f32 v66, v66, v70
    s_waitcnt vmcnt(7)
    v_mfma_f32_16x16x32_bf16 v[112:115], a[128:131], v[208:211], v[112:115]
    v_add_f32 v67, v67, v71
    s_waitcnt lgkmcnt(0)
    v_add_f32 v72, v72, v76
    v_mfma_f32_16x16x32_bf16 v[116:119], a[132:135], v[208:211], v[116:119]
    v_add_f32 v73, v73, v77
    v_add_f32 v74, v74, v78
    v_mfma_f32_16x16x32_bf16 v[120:123], a[136:139], v[208:211], v[120:123]
    v_add_f32 v75, v75, v79
    v_add_f32 v64, v64, v72
    v_mfma_f32_16x16x32_bf16 v[124:127], a[140:143], v[208:211], v[124:127]
    v_add_f32 v65, v65, v73
    s_waitcnt vmcnt(6)
    v_mfma_f32_16x16x32_bf16 v[112:115], a[144:147], v[212:215], v[112:115]
    v_add_f32 v66, v66, v74
    v_add_f32 v67, v67, v75
    v_mfma_f32_16x16x32_bf16 v[116:119], a[148:151], v[212:215], v[116:119]
    v_cvt_pk_bf16_f32 v88, v64, v65
    v_cvt_pk_bf16_f32 v89, v66, v67
    v_mfma_f32_16x16x32_bf16 v[120:123], a[152:155], v[212:215], v[120:123]
    buffer_store_dwordx2 v[88:89], v17, s[24:27], s94 offen sc1
    v_mfma_f32_16x16x32_bf16 v[124:127], a[156:159], v[212:215], v[124:127]
    s_waitcnt vmcnt(6)
    v_mfma_f32_16x16x32_bf16 v[112:115], a[160:163], v[216:219], v[112:115]
    s_waitcnt vmcnt(5)
    v_mfma_f32_16x16x32_bf16 v[112:115], a[176:179], v[220:223], v[112:115]
    v_mfma_f32_16x16x32_bf16 v[116:119], a[164:167], v[216:219], v[116:119]
    v_mfma_f32_16x16x32_bf16 v[116:119], a[180:183], v[220:223], v[116:119]
    v_mfma_f32_16x16x32_bf16 v[120:123], a[168:171], v[216:219], v[120:123]
    v_mfma_f32_16x16x32_bf16 v[120:123], a[184:187], v[220:223], v[120:123]
    v_mfma_f32_16x16x32_bf16 v[124:127], a[172:175], v[216:219], v[124:127]
    s_nop 0
    s_nop 1
    ds_write_b128 v34, v[112:115] offset:16384
    v_mfma_f32_16x16x32_bf16 v[124:127], a[188:191], v[220:223], v[124:127]
    ds_write_b128 v35, v[116:119] offset:16384
    s_nop 0
    ds_write_b128 v36, v[120:123] offset:16384
    s_nop 4
    ds_write_b128 v37, v[124:127] offset:16384
    s_waitcnt lgkmcnt(0)
    s_barrier
    ds_read_b128 v[64:67], v38 offset:16384
    ds_read_b128 v[68:71], v38 offset:20480
    ds_read_b128 v[72:75], v38 offset:24576
    ds_read_b128 v[76:79], v38 offset:28672
    s_waitcnt lgkmcnt(2)
    v_add_f32 v64, v64, v68
    v_add_f32 v65, v65, v69
    v_add_f32 v66, v66, v70
    v_add_f32 v67, v67, v71
    s_waitcnt lgkmcnt(0)
    v_add_f32 v72, v72, v76
    v_add_f32 v73, v73, v77
    v_add_f32 v74, v74, v78
    v_add_f32 v75, v75, v79
    v_add_f32 v64, v64, v72
    v_add_f32 v65, v65, v73
    v_add_f32 v66, v66, v74
    v_add_f32 v67, v67, v75
    v_cvt_pk_bf16_f32 v90, v64, v65
    v_cvt_pk_bf16_f32 v91, v66, v67
    buffer_store_dwordx2 v[90:91], v17, s[24:27], s95 offen nt
L_C_end:
    s_endpgm
L_C_tag:
    s_mov_b32 s96, 0
L_C_tag_loop:
    buffer_load_dword v48, v19, s[32:35], 0 offen sc1
    s_add_u32 s96, s96, 1
    s_waitcnt vmcnt(0)
    v_readfirstlane_b32 s48, v48
    s_nop 3
    s_cmp_lg_u32 s48, 0
    s_cbranch_scc1 L_C_tag_back
    s_cmp_lt_u32 s96, 40000
    s_cbranch_scc1 L_C_tag_loop
    s_branch L_C_tag_back
L_C_chk0:
    s_mov_b32 s96, 0
L_C_chk0_loop:
    buffer_load_dword v48, v50, s[28:31], s36 offen sc1
    s_add_u32 s96, s96, 1
    s_waitcnt vmcnt(0)
    v_cmp_ne_u32 vcc, s48, v48
    s_nop 1
    s_cmp_eq_u64 vcc, 0
    s_cbranch_scc1 L_C_chk0_back
    s_cmp_lt_u32 s96, 40000
    s_cbranch_scc1 L_C_chk0_loop
    s_branch L_C_chk0_back
L_C_chk1:
    s_mov_b32 s96, 0
L_C_chk1_loop:
    buffer_load_dword v48, v50, s[28:31], s37 offen sc1
    s_add_u32 s96, s96, 1
    s_waitcnt vmcnt(0)
    v_cmp_ne_u32 vcc, s48, v48
    s_nop 1
    s_cmp_eq_u64 vcc, 0
    s_cbranch_scc1 L_C_chk1_back
    s_cmp_lt_u32 s96, 40000
    s_cbranch_scc1 L_C_chk1_loop
    s_branch L_C_chk1_back
L_C_chk2:
    s_mov_b32 s96, 0
L_C_chk2_loop:
    buffer_load_dword v48, v50, s[28:31], s38 offen sc1
    s_add_u32 s96, s96, 1
    s_waitcnt vmcnt(0)
    v_cmp_ne_u32 vcc, s48, v48
    s_nop 1
    s_cmp_eq_u64 vcc, 0
    s_cbranch_scc1 L_C_chk2_back
    s_cmp_lt_u32 s96, 40000
    s_cbranch_scc1 L_C_chk2_loop
    s_branch L_C_chk2_back
L_C_chk3:
    s_mov_b32 s96, 0
L_C_chk3_loop:
    buffer_load_dword v48, v50, s[28:31], s39 offen sc1
    s_add_u32 s96, s96, 1
    s_waitcnt vmcnt(0)
    v_cmp_ne_u32 vcc, s48, v48
    s_nop 1
    s_cmp_eq_u64 vcc, 0
    s_cbranch_scc1 L_C_chk3_back
    s_cmp_lt_u32 s96, 40000
    s_cbranch_scc1 L_C_chk3_loop
    s_branch L_C_chk3_back
L_C_chk4:
    s_mov_b32 s96, 0
L_C_chk4_loop:
    buffer_load_dword v48, v50, s[28:31], s40 offen sc1
    s_add_u32 s96, s96, 1
    s_waitcnt vmcnt(0)
    v_cmp_ne_u32 vcc, s48, v48
    s_nop 1
    s_cmp_eq_u64 vcc, 0
    s_cbranch_scc1 L_C_chk4_back
    s_cmp_lt_u32 s96, 40000
    s_cbranch_scc1 L_C_chk4_loop
    s_branch L_C_chk4_back
L_C_chk5:
    s_mov_b32 s96, 0
L_C_chk5_loop:
    buffer_load_dword v48, v50, s[28:31], s41 offen sc1
    s_add_u32 s96, s96, 1
    s_waitcnt vmcnt(0)
    v_cmp_ne_u32 vcc, s48, v48
    s_nop 1
    s_cmp_eq_u64 vcc, 0
    s_cbranch_scc1 L_C_chk5_back
    s_cmp_lt_u32 s96, 40000
    s_cbranch_scc1 L_C_chk5_loop
    s_branch L_C_chk5_back
.p2align 12
L_D_enter:
L_D_w0_0:
    s_cbranch_execz L_D_w0_1
    s_bfe_u32 s4, s2, 0x10002
    s_mul_i32 s4, s4, 1310720
    s_bfe_u32 s5, s2, 0x10003
    s_lshl_b32 s5, s5, 2
    s_add_u32 s5, s5, s3
    s_mul_i32 s5, s5, 5120
    s_add_u32 s4, s4, s5
    v_lshlrev_b32 v1, 4, v0
    v_add_u32 v1, s4, v1
    v_add_u32 v2, 4096, v1
L_D_w0_1:
    s_cbranch_execz L_hopped
    s_lshr_b32 s5, s5, 1
    v_subrev_u32 v3, s5, v1
    s_add_u32 m0, s71, 131072
    s_mul_i32 s6, s72, 40
    buffer_load_dwordx4 v11, s[20:23], s6 offen lds
    buffer_load_dwordx4 v44, s[20:23], s6 offen offset:1024 lds
    buffer_load_dwordx4 v45, s[20:23], s6 offen offset:2048 lds
    buffer_load_dwordx4 v46, s[20:23], s6 offen offset:3072 lds
    s_add_u32 m0, s71, 147456
    s_mul_i32 s6, s73, 40
    buffer_load_dwordx4 v11, s[20:23], s6 offen lds
    buffer_load_dwordx4 v44, s[20:23], s6 offen offset:1024 lds
    buffer_load_dwordx4 v45, s[20:23], s6 offen offset:2048 lds
    buffer_load_dwordx4 v46, s[20:23], s6 offen offset:3072 lds
    s_mov_b32 s5, 163840
    buffer_load_dwordx4 v[128:131], v1, s[8:11], s5 offen offset:0
    buffer_load_dwordx4 v[132:135], v1, s[8:11], s5 offen offset:1024
    buffer_load_dwordx4 v[136:139], v1, s[8:11], s5 offen offset:2048
    buffer_load_dwordx4 v[140:143], v1, s[8:11], s5 offen offset:3072
    buffer_load_dwordx4 v[144:147], v2, s[8:11], s5 offen offset:0
    s_mov_b32 s5, 430080
    buffer_load_dwordx4 v[148:151], v1, s[8:11], s5 offen offset:0
    buffer_load_dwordx4 v[152:155], v1, s[8:11], s5 offen offset:1024
    buffer_load_dwordx4 v[156:159], v1, s[8:11], s5 offen offset:2048
    buffer_load_dwordx4 v[160:163], v1, s[8:11], s5 offen offset:3072
    buffer_load_dwordx4 v[164:167], v2, s[8:11], s5 offen offset:0
    s_mov_b32 s5, 716800
    buffer_load_dwordx4 v[168:171], v1, s[8:11], s5 offen offset:0
    buffer_load_dwordx4 v[172:175], v1, s[8:11], s5 offen offset:1024
    buffer_load_dwordx4 v[176:179], v1, s[8:11], s5 offen offset:2048
    buffer_load_dwordx4 v[180:183], v1, s[8:11], s5 offen offset:3072
    buffer_load_dwordx4 v[184:187], v2, s[8:11], s5 offen offset:0
    s_mov_b32 s5, 942080
    buffer_load_dwordx4 v[188:191], v1, s[8:11], s5 offen offset:0
    buffer_load_dwordx4 v[192:195], v1, s[8:11], s5 offen offset:1024
    buffer_load_dwordx4 v[196:199], v1, s[8:11], s5 offen offset:2048
    buffer_load_dwordx4 v[200:203], v1, s[8:11], s5 offen offset:3072
    buffer_load_dwordx4 v[204:207], v2, s[8:11], s5 offen offset:0
    s_mov_b32 s5, 1208320
    buffer_load_dwordx4 v[208:211], v1, s[8:11], s5 offen offset:0
    buffer_load_dwordx4 v[212:215], v1, s[8:11], s5 offen offset:1024
    buffer_load_dwordx4 v[216:219], v1, s[8:11], s5 offen offset:2048
    buffer_load_dwordx4 v[220:223], v1, s[8:11], s5 offen offset:3072
    buffer_load_dwordx4 v[224:227], v2, s[8:11], s5 offen offset:0
    s_mov_b32 s5, 204800
    buffer_load_dwordx4 v[228:231], v1, s[8:11], s5 offen offset:0
    buffer_load_dwordx4 v[232:235], v1, s[8:11], s5 offen offset:1024
    buffer_load_dwordx4 v[236:239], v1, s[8:11], s5 offen offset:2048
    buffer_load_dwordx4 v[240:243], v1, s[8:11], s5 offen offset:3072
    buffer_load_dwordx4 v[244:247], v2, s[8:11], s5 offen offset:0
    s_mov_b32 s5, 471040
    buffer_load_dwordx4 v[248:251], v1, s[8:11], s5 offen offset:0
    buffer_load_dwordx4 v[252:255], v1, s[8:11], s5 offen offset:1024
    s_waitcnt vmcnt(31)
    buffer_load_dwordx4 v[128:131], v1, s[8:11], s5 offen offset:2048
    s_waitcnt vmcnt(31)
    buffer_load_dwordx4 v[132:135], v1, s[8:11], s5 offen offset:3072
    s_waitcnt vmcnt(31)
    buffer_load_dwordx4 v[136:139], v2, s[8:11], s5 offen offset:0
    s_mov_b32 s5, 757760
    s_waitcnt vmcnt(31)
    buffer_load_dwordx4 v[140:143], v3, s[8:11], s5 offen offset:0
    s_waitcnt vmcnt(31)
    buffer_load_dwordx4 v[144:147], v3, s[8:11], s5 offen offset:1024
    s_waitcnt vmcnt(31)
    buffer_load_dwordx4 v[148:151], v3, s[8:11], s5 offen offset:2048
    s_mov_b32 s5, 983040
    s_waitcnt vmcnt(31)
    buffer_load_dwordx4 v[152:155], v1, s[8:11], s5 offen offset:0
    s_waitcnt vmcnt(31)
    buffer_load_dwordx4 v[156:159], v1, s[8:11], s5 offen offset:1024
    s_waitcnt vmcnt(31)
    buffer_load_dwordx4 v[160:163], v1, s[8:11], s5 offen offset:2048
    s_waitcnt vmcnt(31)
    buffer_load_dwordx4 v[164:167], v1, s[8:11], s5 offen offset:3072
    s_waitcnt vmcnt(31)
    buffer_load_dwordx4 v[168:171], v2, s[8:11], s5 offen offset:0
    s_mov_b32 s5, 1249280
    s_waitcnt vmcnt(31)
    buffer_load_dwordx4 v[172:175], v1, s[8:11], s5 offen offset:0
    s_waitcnt vmcnt(31)
    buffer_load_dwordx4 v[176:179], v1, s[8:11], s5 offen offset:1024
    s_waitcnt vmcnt(31)
    buffer_load_dwordx4 v[180:183], v1, s[8:11], s5 offen offset:2048
    s_waitcnt vmcnt(31)
    buffer_load_dwordx4 v[184:187], v1, s[8:11], s5 offen offset:3072
    s_waitcnt vmcnt(31)
    buffer_load_dwordx4 v[188:191], v2, s[8:11], s5 offen offset:0
    s_mov_b32 s5, 245760
    s_waitcnt vmcnt(31)
    buffer_load_dwordx4 v[192:195], v3, s[8:11], s5 offen offset:0
    s_waitcnt vmcnt(31)
    buffer_load_dwordx4 v[196:199], v3, s[8:11], s5 offen offset:1024
    s_waitcnt vmcnt(31)
    buffer_load_dwordx4 v[200:203], v3, s[8:11], s5 offen offset:2048
    s_mov_b32 s5, 512000
    s_waitcnt vmcnt(31)
    buffer_load_dwordx4 v[204:207], v1, s[8:11], s5 offen offset:0
    s_waitcnt vmcnt(31)
    buffer_load_dwordx4 v[208:211], v1, s[8:11], s5 offen offset:1024
    s_waitcnt vmcnt(31)
    buffer_load_dwordx4 v[212:215], v1, s[8:11], s5 offen offset:2048
    s_waitcnt vmcnt(31)
    buffer_load_dwordx4 v[216:219], v1, s[8:11], s5 offen offset:3072
    s_waitcnt vmcnt(31)
    buffer_load_dwordx4 v[220:223], v2, s[8:11], s5 offen offset:0
    s_mov_b32 s5, 1024000
    s_waitcnt vmcnt(31)
    buffer_load_dwordx4 v[224:227], v3, s[8:11], s5 offen offset:0
    s_waitcnt vmcnt(31)
    buffer_load_dwordx4 v[228:231], v3, s[8:11], s5 offen offset:1024
    s_waitcnt vmcnt(31)
    buffer_load_dwordx4 v[232:235], v3, s[8:11], s5 offen offset:2048
    s_mov_b32 s5, 1290240
    s_waitcnt vmcnt(31)
    buffer_load_dwordx4 v[236:239], v3, s[8:11], s5 offen offset:0
    s_waitcnt vmcnt(31)
    buffer_load_dwordx4 v[240:243], v3, s[8:11], s5 offen offset:1024
    s_waitcnt vmcnt(31)
    buffer_load_dwordx4 v[244:247], v3, s[8:11], s5 offen offset:2048
    s_add_u32 m0, s71, 98304
    s_mul_i32 s6, s74, 40
    buffer_load_dwordx4 v11, s[20:23], s6 offen lds
    buffer_load_dwordx4 v44, s[20:23], s6 offen offset:1024 lds
    buffer_load_dwordx4 v45, s[20:23], s6 offen offset:2048 lds
    buffer_load_dwordx4 v46, s[20:23], s6 offen offset:3072 lds
    ds_read_b64_tr_b16 a[0:1], v30 offset:32768
    ds_read_b64_tr_b16 a[2:3], v30 offset:33792
    ds_read_b64_tr_b16 a[4:5], v31 offset:32768
    ds_read_b64_tr_b16 a[6:7], v31 offset:33792
    ds_read_b64_tr_b16 a[8:9], v32 offset:32768
    ds_read_b64_tr_b16 a[10:11], v32 offset:33792
    ds_read_b64_tr_b16 a[12:13], v33 offset:32768
    ds_read_b64_tr_b16 a[14:15], v33 offset:33792
    s_add_u32 m0, s71, 114688
    s_mul_i32 s6, s75, 40
    buffer_load_dwordx4 v11, s[20:23], s6 offen lds
    buffer_load_dwordx4 v44, s[20:23], s6 offen offset:1024 lds
    buffer_load_dwordx4 v45, s[20:23], s6 offen offset:2048 lds
    buffer_load_dwordx4 v46, s[20:23], s6 offen offset:3072 lds
    ds_read_b64_tr_b16 a[16:17], v30 offset:49152
    ds_read_b64_tr_b16 a[18:19], v30 offset:50176
    ds_read_b64_tr_b16 a[20:21], v31 offset:49152
    ds_read_b64_tr_b16 a[22:23], v31 offset:50176
    ds_read_b64_tr_b16 a[24:25], v32 offset:49152
    ds_read_b64_tr_b16 a[26:27], v32 offset:50176
    ds_read_b64_tr_b16 a[28:29], v33 offset:49152
    ds_read_b64_tr_b16 a[30:31], v33 offset:50176
    s_add_u32 m0, s71, 131072
    s_mul_i32 s6, s76, 40
    s_waitcnt lgkmcnt(8)
    buffer_load_dwordx4 v11, s[20:23], s6 offen lds
    buffer_load_dwordx4 v44, s[20:23], s6 offen offset:1024 lds
    buffer_load_dwordx4 v45, s[20:23], s6 offen offset:2048 lds
    buffer_load_dwordx4 v46, s[20:23], s6 offen offset:3072 lds
    s_waitcnt vmcnt(8)
    ds_read_b64_tr_b16 a[32:33], v30 offset:0
    ds_read_b64_tr_b16 a[34:35], v30 offset:1024
    ds_read_b64_tr_b16 a[36:37], v31 offset:0
    ds_read_b64_tr_b16 a[38:39], v31 offset:1024
    ds_read_b64_tr_b16 a[40:41], v32 offset:0
    ds_read_b64_tr_b16 a[42:43], v32 offset:1024
    ds_read_b64_tr_b16 a[44:45], v33 offset:0
    ds_read_b64_tr_b16 a[46:47], v33 offset:1024
    s_add_u32 m0, s71, 147456
    s_mul_i32 s6, s77, 40
    s_waitcnt lgkmcnt(8)
    buffer_load_dwordx4 v11, s[20:23], s6 offen lds
    buffer_load_dwordx4 v44, s[20:23], s6 offen offset:1024 lds
    buffer_load_dwordx4 v45, s[20:23], s6 offen offset:2048 lds
    buffer_load_dwordx4 v46, s[20:23], s6 offen offset:3072 lds
    s_waitcnt vmcnt(8)
    ds_read_b64_tr_b16 a[48:49], v30 offset:16384
    ds_read_b64_tr_b16 a[50:51], v30 offset:17408
    ds_read_b64_tr_b16 a[52:53], v31 offset:16384
    ds_read_b64_tr_b16 a[54:55], v31 offset:17408
    ds_read_b64_tr_b16 a[56:57], v32 offset:16384
    ds_read_b64_tr_b16 a[58:59], v32 offset:17408
    ds_read_b64_tr_b16 a[60:61], v33 offset:16384
    ds_read_b64_tr_b16 a[62:63], v33 offset:17408
    s_add_u32 m0, s71, 98304
    s_mul_i32 s6, s78, 40
    s_waitcnt lgkmcnt(8)
    buffer_load_dwordx4 v11, s[20:23], s6 offen lds
    buffer_load_dwordx4 v44, s[20:23], s6 offen offset:1024 lds
    buffer_load_dwordx4 v45, s[20:23], s6 offen offset:2048 lds
    buffer_load_dwordx4 v46, s[20:23], s6 offen offset:3072 lds
    s_waitcnt vmcnt(8)
    ds_read_b64_tr_b16 a[64:65], v30 offset:32768
    ds_read_b64_tr_b16 a[66:67], v30 offset:33792
    ds_read_b64_tr_b16 a[68:69], v31 offset:32768
    ds_read_b64_tr_b16 a[70:71], v31 offset:33792
    ds_read_b64_tr_b16 a[72:73], v32 offset:32768
    ds_read_b64_tr_b16 a[74:75], v32 offset:33792
    ds_read_b64_tr_b16 a[76:77], v33 offset:32768
    ds_read_b64_tr_b16 a[78:79], v33 offset:33792
    s_add_u32 m0, s71, 114688
    s_mul_i32 s6, s79, 40
    s_waitcnt lgkmcnt(8)
    buffer_load_dwordx4 v11, s[20:23], s6 offen lds
    buffer_load_dwordx4 v44, s[20:23], s6 offen offset:1024 lds
    buffer_load_dwordx4 v45, s[20:23], s6 offen offset:2048 lds
    buffer_load_dwordx4 v46, s[20:23], s6 offen offset:3072 lds
    s_waitcnt vmcnt(8)
    ds_read_b64_tr_b16 a[80:81], v30 offset:49152
    ds_read_b64_tr_b16 a[82:83], v30 offset:50176
    ds_read_b64_tr_b16 a[84:85], v31 offset:49152
    ds_read_b64_tr_b16 a[86:87], v31 offset:50176
    ds_read_b64_tr_b16 a[88:89], v32 offset:49152
    ds_read_b64_tr_b16 a[90:91], v32 offset:50176
    ds_read_b64_tr_b16 a[92:93], v33 offset:49152
    ds_read_b64_tr_b16 a[94:95], v33 offset:50176
    s_add_u32 m0, s71, 131072
    s_mul_i32 s6, s80, 40
    s_waitcnt lgkmcnt(8)
    buffer_load_dwordx4 v11, s[20:23], s6 offen lds
    buffer_load_dwordx4 v44, s[20:23], s6 offen offset:1024 lds
    buffer_load_dwordx4 v45, s[20:23], s6 offen offset:2048 lds
    buffer_load_dwordx4 v46, s[20:23], s6 offen offset:3072 lds
    s_waitcnt vmcnt(8)
    ds_read_b64_tr_b16 a[96:97], v30 offset:0
    ds_read_b64_tr_b16 a[98:99], v30 offset:1024
    ds_read_b64_tr_b16 a[100:101], v31 offset:0
    ds_read_b64_tr_b16 a[102:103], v31 offset:1024
    ds_read_b64_tr_b16 a[104:105], v32 offset:0
    ds_read_b64_tr_b16 a[106:107], v32 offset:1024
    ds_read_b64_tr_b16 a[108:109], v33 offset:0
    ds_read_b64_tr_b16 a[110:111], v33 offset:1024
    s_add_u32 m0, s71, 147456
    s_mul_i32 s6, s81, 40
    s_waitcnt lgkmcnt(8)
    buffer_load_dwordx4 v11, s[20:23], s6 offen lds
    buffer_load_dwordx4 v44, s[20:23], s6 offen offset:1024 lds
    buffer_load_dwordx4 v45, s[20:23], s6 offen offset:2048 lds
    buffer_load_dwordx4 v46, s[20:23], s6 offen offset:3072 lds
    s_waitcnt vmcnt(8)
    ds_read_b64_tr_b16 a[112:113], v30 offset:16384
    ds_read_b64_tr_b16 a[114:115], v30 offset:17408
    ds_read_b64_tr_b16 a[116:117], v31 offset:16384
    ds_read_b64_tr_b16 a[118:119], v31 offset:17408
    ds_read_b64_tr_b16 a[120:121], v32 offset:16384
    ds_read_b64_tr_b16 a[122:123], v32 offset:17408
    ds_read_b64_tr_b16 a[124:125], v33 offset:16384
    ds_read_b64_tr_b16 a[126:127], v33 offset:17408
    s_add_u32 m0, s71, 98304
    s_mul_i32 s6, s82, 40
    s_waitcnt lgkmcnt(8)
    buffer_load_dwordx4 v11, s[20:23], s6 offen lds
    buffer_load_dwordx4 v44, s[20:23], s6 offen offset:1024 lds
    buffer_load_dwordx4 v45, s[20:23], s6 offen offset:2048 lds
    buffer_load_dwordx4 v46, s[20:23], s6 offen offset:3072 lds
    s_waitcnt vmcnt(8)
    ds_read_b64_tr_b16 a[128:129], v30 offset:32768
    ds_read_b64_tr_b16 a[130:131], v30 offset:33792
    ds_read_b64_tr_b16 a[132:133], v31 offset:32768
    ds_read_b64_tr_b16 a[134:135], v31 offset:33792
    ds_read_b64_tr_b16 a[136:137], v32 offset:32768
    ds_read_b64_tr_b16 a[138:139], v32 offset:33792
    ds_read_b64_tr_b16 a[140:141], v33 offset:32768
    ds_read_b64_tr_b16 a[142:143], v33 offset:33792
    s_add_u32 m0, s71, 114688
    s_mul_i32 s6, s83, 40
    s_waitcnt lgkmcnt(8)
    buffer_load_dwordx4 v11, s[20:23], s6 offen lds
    buffer_load_dwordx4 v44, s[20:23], s6 offen offset:1024 lds
    buffer_load_dwordx4 v45, s[20:23], s6 offen offset:2048 lds
    buffer_load_dwordx4 v46, s[20:23], s6 offen offset:3072 lds
    s_waitcnt vmcnt(8)
    ds_read_b64_tr_b16 a[144:145], v30 offset:49152
    ds_read_b64_tr_b16 a[146:147], v30 offset:50176
    ds_read_b64_tr_b16 a[148:149], v31 offset:49152
    ds_read_b64_tr_b16 a[150:151], v31 offset:50176
    ds_read_b64_tr_b16 a[152:153], v32 offset:49152
    ds_read_b64_tr_b16 a[154:155], v32 offset:50176
    ds_read_b64_tr_b16 a[156:157], v33 offset:49152
    ds_read_b64_tr_b16 a[158:159], v33 offset:50176
    s_waitcnt vmcnt(4)
    ds_read_b64_tr_b16 a[160:161], v30 offset:0
    ds_read_b64_tr_b16 a[162:163], v30 offset:1024
    ds_read_b64_tr_b16 a[164:165], v31 offset:0
    ds_read_b64_tr_b16 a[166:167], v31 offset:1024
    ds_read_b64_tr_b16 a[168:169], v32 offset:0
    ds_read_b64_tr_b16 a[170:171], v32 offset:1024
    ds_read_b64_tr_b16 a[172:173], v33 offset:0
    ds_read_b64_tr_b16 a[174:175], v33 offset:1024
    s_waitcnt vmcnt(0)
    ds_read_b64_tr_b16 a[176:177], v30 offset:16384
    ds_read_b64_tr_b16 a[178:179], v30 offset:17408
    ds_read_b64_tr_b16 a[180:181], v31 offset:16384
    ds_read_b64_tr_b16 a[182:183], v31 offset:17408
    ds_read_b64_tr_b16 a[184:185], v32 offset:16384
    ds_read_b64_tr_b16 a[186:187], v32 offset:17408
    ds_read_b64_tr_b16 a[188:189], v33 offset:16384
    ds_read_b64_tr_b16 a[190:191], v33 offset:17408
    s_waitcnt vmcnt(0) lgkmcnt(0)
    s_branch L_D_tag
L_D_tag_back:
    v_mov_b32 v40, s48
    s_mov_b32 s49, s48
    s_load_dword s52, s[0:1], s36
    s_load_dword s53, s[0:1], s36 offset:512
    s_load_dword s54, s[0:1], s36 offset:1024
    s_load_dword s55, s[0:1], s36 offset:1536
    s_load_dword s56, s[0:1], s36 offset:2048
    s_load_dword s57, s[0:1], s36 offset:2560
    s_waitcnt lgkmcnt(0)
    v_add_u32 v1, s84, v13
    s_xor_b64 s[52:53], s[52:53], s[48:49]
    s_xor_b64 s[54:55], s[54:55], s[48:49]
    s_or_b64 s[52:53], s[52:53], s[54:55]
    s_xor_b64 s[56:57], s[56:57], s[48:49]
    s_or_b64 s[52:53], s[52:53], s[56:57]
    s_cbranch_scc1 L_D_chk0
L_D_chk0_back:
    s_load_dword s58, s[0:1], s37
    s_load_dword s59, s[0:1], s37 offset:512
    s_load_dword s60, s[0:1], s37 offset:1024
    s_load_dword s61, s[0:1], s37 offset:1536
    s_load_dword s62, s[0:1], s37 offset:2048
    s_load_dword s63, s[0:1], s37 offset:2560
    buffer_load_dwordx4 v[128:131], v1, s[28:31], s72 offen sc1
    buffer_load_dwordx4 v[132:135], v1, s[28:31], s73 offen sc1
    buffer_load_dwordx4 v[136:139], v1, s[28:31], s74 offen sc1
    buffer_load_dwordx4 v[140:143], v1, s[28:31], s75 offen sc1
    buffer_load_dwordx4 v[144:147], v1, s[28:31], s76 offen sc1
    buffer_load_dwordx4 v[148:151], v1, s[28:31], s77 offen sc1
    buffer_load_dwordx4 v[152:155], v1, s[28:31], s78 offen sc1
    buffer_load_dwordx4 v[156:159], v1, s[28:31], s79 offen sc1
    buffer_load_dwordx4 v[160:163], v1, s[28:31], s80 offen sc1
    buffer_load_dwordx4 v[164:167], v1, s[28:31], s81 offen sc1
    s_waitcnt vmcnt(9)
    v_mfma_f32_16x16x32_bf16 v[96:99], a[0:3], v[128:131], 0
    v_mfma_f32_16x16x32_bf16 v[100:103], a[4:7], v[128:131], 0
    buffer_load_dwordx4 v[168:171], v1, s[28:31], s82 offen sc1
    v_mfma_f32_16x16x32_bf16 v[104:107], a[8:11], v[128:131], 0
    v_mfma_f32_16x16x32_bf16 v[108:111], a[12:15], v[128:131], 0
    s_waitcnt lgkmcnt(0)
    s_waitcnt vmcnt(9)
    v_mfma_f32_16x16x32_bf16 v[96:99], a[16:19], v[132:135], v[96:99]
    v_add_u32 v2, s85, v13
    s_xor_b64 s[58:59], s[58:59], s[48:49]
    v_mfma_f32_16x16x32_bf16 v[100:103], a[20:23], v[132:135], v[100:103]
    buffer_load_dwordx4 v[172:175], v1, s[28:31], s83 offen sc1
    s_xor_b64 s[60:61], s[60:61], s[48:49]
    v_mfma_f32_16x16x32_bf16 v[104:107], a[24:27], v[132:135], v[104:107]
    s_or_b64 s[58:59], s[58:59], s[60:61]
    s_xor_b64 s[62:63], s[62:63], s[48:49]
    v_mfma_f32_16x16x32_bf16 v[108:111], a[28:31], v[132:135], v[108:111]
    s_waitcnt vmcnt(9)
    v_mfma_f32_16x16x32_bf16 v[96:99], a[32:35], v[136:139], v[96:99]
    s_or_b64 s[58:59], s[58:59], s[62:63]
    s_cbranch_scc1 L_D_chk1
L_D_chk1_back:
    v_mfma_f32_16x16x32_bf16 v[100:103], a[36:39], v[136:139], v[100:103]
    buffer_load_dwordx4 v[176:179], v2, s[28:31], s72 offen sc1
    s_load_dword s64, s[0:1], s38
    v_mfma_f32_16x16x32_bf16 v[104:107], a[40:43], v[136:139], v[104:107]
    s_load_dword s65, s[0:1], s38 offset:512
    s_load_dword s66, s[0:1], s38 offset:1024
    v_mfma_f32_16x16x32_bf16 v[108:111], a[44:47], v[136:139], v[108:111]
    s_load_dword s67, s[0:1], s38 offset:1536
    s_waitcnt vmcnt(9)
    v_mfma_f32_16x16x32_bf16 v[96:99], a[48:51], v[140:143], v[96:99]
    s_load_dword s68, s[0:1], s38 offset:2048
    s_load_dword s69, s[0:1], s38 offset:2560
    v_mfma_f32_16x16x32_bf16 v[100:103], a[52:55], v[140:143], v[100:103]
    buffer_load_dwordx4 v[180:183], v2, s[28:31], s73 offen sc1
    v_mfma_f32_16x16x32_bf16 v[104:107], a[56:59], v[140:143], v[104:107]
    v_mfma_f32_16x16x32_bf16 v[108:111], a[60:63], v[140:143], v[108:111]
    s_waitcnt vmcnt(9)
    v_mfma_f32_16x16x32_bf16 v[96:99], a[64:67], v[144:147], v[96:99]
    v_mfma_f32_16x16x32_bf16 v[100:103], a[68:71], v[144:147], v[100:103]
    buffer_load_dwordx4 v[184:187], v2, s[28:31], s74 offen sc1
    v_mfma_f32_16x16x32_bf16 v[104:107], a[72:75], v[144:147], v[104:107]
    v_mfma_f32_16x16x32_bf16 v[108:111], a[76:79], v[144:147], v[108:111]
    s_waitcnt vmcnt(9)
    v_mfma_f32_16x16x32_bf16 v[96:99], a[80:83], v[148:151], v[96:99]
    v_mfma_f32_16x16x32_bf16 v[100:103], a[84:87], v[148:151], v[100:103]
    buffer_load_dwordx4 v[188:191], v2, s[28:31], s75 offen sc1
    v_mfma_f32_16x16x32_bf16 v[104:107], a[88:91], v[148:151], v[104:107]
    v_mfma_f32_16x16x32_bf16 v[108:111], a[92:95], v[148:151], v[108:111]
    s_waitcnt vmcnt(9)
    v_mfma_f32_16x16x32_bf16 v[96:99], a[96:99], v[152:155], v[96:99]
    v_mfma_f32_16x16x32_bf16 v[100:103], a[100:103], v[152:155], v[100:103]
    buffer_load_dwordx4 v[192:195], v2, s[28:31], s76 offen sc1
    v_mfma_f32_16x16x32_bf16 v[104:107], a[104:107], v[152:155], v[104:107]
    v_mfma_f32_16x16x32_bf16 v[108:111], a[108:111], v[152:155], v[108:111]
    s_waitcnt vmcnt(9)
    v_mfma_f32_16x16x32_bf16 v[96:99], a[112:115], v[156:159], v[96:99]
    v_mfma_f32_16x16x32_bf16 v[100:103], a[116:119], v[156:159], v[100:103]
    buffer_load_dwordx4 v[196:199], v2, s[28:31], s77 offen sc1
    v_mfma_f32_16x16x32_bf16 v[104:107], a[120:123], v[156:159], v[104:107]
    v_mfma_f32_16x16x32_bf16 v[108:111], a[124:127], v[156:159], v[108:111]
    s_waitcnt vmcnt(9)
    v_mfma_f32_16x16x32_bf16 v[96:99], a[128:131], v[160:163], v[96:99]
    v_mfma_f32_16x16x32_bf16 v[100:103], a[132:135], v[160:163], v[100:103]
    buffer_load_dwordx4 v[200:203], v2, s[28:31], s78 offen sc1
    v_mfma_f32_16x16x32_bf16 v[104:107], a[136:139], v[160:163], v[104:107]
    v_mfma_f32_16x16x32_bf16 v[108:111], a[140:143], v[160:163], v[108:111]
    s_waitcnt vmcnt(9)
    v_mfma_f32_16x16x32_bf16 v[96:99], a[144:147], v[164:167], v[96:99]
    v_mfma_f32_16x16x32_bf16 v[100:103], a[148:151], v[164:167], v[100:103]
    buffer_load_dwordx4 v[204:207], v2, s[28:31], s79 offen sc1
    v_mfma_f32_16x16x32_bf16 v[104:107], a[152:155], v[164:167], v[104:107]
    v_mfma_f32_16x16x32_bf16 v[108:111], a[156:159], v[164:167], v[108:111]
    s_waitcnt vmcnt(9)
    v_mfma_f32_16x16x32_bf16 v[96:99], a[160:163], v[168:171], v[96:99]
    v_mfma_f32_16x16x32_bf16 v[100:103], a[164:167], v[168:171], v[100:103]
    buffer_load_dwordx4 v[208:211], v2, s[28:31], s80 offen sc1
    v_mfma_f32_16x16x32_bf16 v[104:107], a[168:171], v[168:171], v[104:107]
    v_mfma_f32_16x16x32_bf16 v[108:111], a[172:175], v[168:171], v[108:111]
    s_waitcnt vmcnt(9)
    v_mfma_f32_16x16x32_bf16 v[96:99], a[176:179], v[172:175], v[96:99]
    v_mfma_f32_16x16x32_bf16 v[100:103], a[180:183], v[172:175], v[100:103]
    buffer_load_dwordx4 v[212:215], v2, s[28:31], s81 offen sc1
    v_mfma_f32_16x16x32_bf16 v[104:107], a[184:187], v[172:175], v[104:107]
    v_mfma_f32_16x16x32_bf16 v[108:111], a[188:191], v[172:175], v[108:111]
    s_waitcnt vmcnt(9)
    v_mfma_f32_16x16x32_bf16 v[112:115], a[0:3], v[176:179], 0
    v_mfma_f32_16x16x32_bf16 v[116:119], a[4:7], v[176:179], 0
    buffer_load_dwordx4 v[216:219], v2, s[28:31], s82 offen sc1
    v_mfma_f32_16x16x32_bf16 v[120:123], a[8:11], v[176:179], 0
    v_mfma_f32_16x16x32_bf16 v[124:127], a[12:15], v[176:179], 0
    s_waitcnt lgkmcnt(0)
    s_waitcnt vmcnt(9)
    v_mfma_f32_16x16x32_bf16 v[112:115], a[16:19], v[180:183], v[112:115]
    v_add_u32 v3, s86, v13
    s_xor_b64 s[64:65], s[64:65], s[48:49]
    v_mfma_f32_16x16x32_bf16 v[116:119], a[20:23], v[180:183], v[116:119]
    buffer_load_dwordx4 v[220:223], v2, s[28:31], s83 offen sc1
    s_xor_b64 s[66:67], s[66:67], s[48:49]
    v_mfma_f32_16x16x32_bf16 v[120:123], a[24:27], v[180:183], v[120:123]
    s_or_b64 s[64:65], s[64:65], s[66:67]
    s_xor_b64 s[68:69], s[68:69], s[48:49]
    v_mfma_f32_16x16x32_bf16 v[124:127], a[28:31], v[180:183], v[124:127]
    s_waitcnt vmcnt(9)
    v_mfma_f32_16x16x32_bf16 v[112:115], a[32:35], v[184:187], v[112:115]
    s_or_b64 s[64:65], s[64:65], s[68:69]
    s_cbranch_scc1 L_D_chk2
L_D_chk2_back:
    v_mfma_f32_16x16x32_bf16 v[116:119], a[36:39], v[184:187], v[116:119]
    buffer_load_dwordx4 v[224:227], v3, s[28:31], s72 offen sc1
    s_load_dword s52, s[0:1], s39
    v_mfma_f32_16x16x32_bf16 v[120:123], a[40:43], v[184:187], v[120:123]
    s_load_dword s53, s[0:1], s39 offset:512
    s_load_dword s54, s[0:1], s39 offset:1024
    v_mfma_f32_16x16x32_bf16 v[124:127], a[44:47], v[184:187], v[124:127]
    s_load_dword s55, s[0:1], s39 offset:1536
    s_waitcnt vmcnt(9)
    v_mfma_f32_16x16x32_bf16 v[112:115], a[48:51], v[188:191], v[112:115]
    s_load_dword s56, s[0:1], s39 offset:2048
    s_load_dword s57, s[0:1], s39 offset:2560
    v_mfma_f32_16x16x32_bf16 v[116:119], a[52:55], v[188:191], v[116:119]
    buffer_load_dwordx4 v[228:231], v3, s[28:31], s73 offen sc1
    v_mfma_f32_16x16x32_bf16 v[120:123], a[56:59], v[188:191], v[120:123]
    v_mfma_f32_16x16x32_bf16 v[124:127], a[60:63], v[188:191], v[124:127]
    s_waitcnt vmcnt(9)
    v_mfma_f32_16x16x32_bf16 v[112:115], a[64:67], v[192:195], v[112:115]
    v_mfma_f32_16x16x32_bf16 v[116:119], a[68:71], v[192:195], v[116:119]
    buffer_load_dwordx4 v[232:235], v3, s[28:31], s74 offen sc1
    v_mfma_f32_16x16x32_bf16 v[120:123], a[72:75], v[192:195], v[120:123]
    v_mfma_f32_16x16x32_bf16 v[124:127], a[76:79], v[192:195], v[124:127]
    s_waitcnt vmcnt(9)
    v_mfma_f32_16x16x32_bf16 v[112:115], a[80:83], v[196:199], v[112:115]
    ds_write_b64 v34, v[96:97] offset:0
    v_mfma_f32_16x16x32_bf16 v[116:119], a[84:87], v[196:199], v[116:119]
    buffer_load_dwordx4 v[236:239], v3, s[28:31], s75 offen sc1
    v_mfma_f32_16x16x32_bf16 v[120:123], a[88:91], v[196:199], v[120:123]
    ds_write_b64 v34, v[98:99] offset:8
    v_mfma_f32_16x16x32_bf16 v[124:127], a[92:95], v[196:199], v[124:127]
    s_waitcnt vmcnt(9)
    v_mfma_f32_16x16x32_bf16 v[112:115], a[96:99], v[200:203], v[112:115]
    ds_write_b64 v35, v[100:101] offset:0
    v_mfma_f32_16x16x32_bf16 v[116:119], a[100:103], v[200:203], v[116:119]
    buffer_load_dwordx4 v[240:243], v3, s[28:31], s76 offen sc1
    v_mfma_f32_16x16x32_bf16 v[120:123], a[104:107], v[200:203], v[120:123]
    ds_write_b64 v35, v[102:103] offset:8
    v_mfma_f32_16x16x32_bf16 v[124:127], a[108:111], v[200:203], v[124:127]
    s_waitcnt vmcnt(9)
    v_mfma_f32_16x16x32_bf16 v[112:115], a[112:115], v[204:207], v[112:115]
    ds_write_b64 v36, v[104:105] offset:0
    v_mfma_f32_16x16x32_bf16 v[116:119], a[116:119], v[204:207], v[116:119]
    buffer_load_dwordx4 v[244:247], v3, s[28:31], s77 offen sc1
    v_mfma_f32_16x16x32_bf16 v[120:123], a[120:123], v[204:207], v[120:123]
    ds_write_b64 v36, v[106:107] offset:8
    v_mfma_f32_16x16x32_bf16 v[124:127], a[124:127], v[204:207], v[124:127]
    s_waitcnt vmcnt(9)
    v_mfma_f32_16x16x32_bf16 v[112:115], a[128:131], v[208:211], v[112:115]
    ds_write_b64 v37, v[108:109] offset:0
    v_mfma_f32_16x16x32_bf16 v[116:119], a[132:135], v[208:211], v[116:119]
    buffer_load_dwordx4 v[248:251], v3, s[28:31], s78 offen sc1
    v_mfma_f32_16x16x32_bf16 v[120:123], a[136:139], v[208:211], v[120:123]
    ds_write_b64 v37, v[110:111] offset:8
    v_mfma_f32_16x16x32_bf16 v[124:127], a[140:143], v[208:211], v[124:127]
    s_waitcnt vmcnt(9)
    v_mfma_f32_16x16x32_bf16 v[112:115], a[144:147], v[212:215], v[112:115]
    v_mfma_f32_16x16x32_bf16 v[116:119], a[148:151], v[212:215], v[116:119]
    buffer_load_dwordx4 v[252:255], v3, s[28:31], s79 offen sc1
    v_mfma_f32_16x16x32_bf16 v[120:123], a[152:155], v[212:215], v[120:123]
    v_mfma_f32_16x16x32_bf16 v[124:127], a[156:159], v[212:215], v[124:127]
    s_waitcnt vmcnt(9)
    v_mfma_f32_16x16x32_bf16 v[112:115], a[160:163], v[216:219], v[112:115]
    v_mfma_f32_16x16x32_bf16 v[116:119], a[164:167], v[216:219], v[116:119]
    buffer_load_dwordx4 a[192:195], v3, s[28:31], s80 offen sc1
    v_mfma_f32_16x16x32_bf16 v[120:123], a[168:171], v[216:219], v[120:123]
    v_mfma_f32_16x16x32_bf16 v[124:127], a[172:175], v[216:219], v[124:127]
    s_waitcnt vmcnt(9)
    v_mfma_f32_16x16x32_bf16 v[112:115], a[176:179], v[220:223], v[112:115]
    v_mfma_f32_16x16x32_bf16 v[116:119], a[180:183], v[220:223], v[116:119]
    buffer_load_dwordx4 a[196:199], v3, s[28:31], s81 offen sc1
    v_mfma_f32_16x16x32_bf16 v[120:123], a[184:187], v[220:223], v[120:123]
    v_mfma_f32_16x16x32_bf16 v[124:127], a[188:191], v[220:223], v[124:127]
    s_waitcnt vmcnt(9)
    v_mfma_f32_16x16x32_bf16 v[96:99], a[0:3], v[224:227], 0
    v_mfma_f32_16x16x32_bf16 v[100:103], a[4:7], v[224:227], 0
    buffer_load_dwordx4 a[200:203], v3, s[28:31], s82 offen sc1
    v_mfma_f32_16x16x32_bf16 v[104:107], a[8:11], v[224:227], 0
    v_mfma_f32_16x16x32_bf16 v[108:111], a[12:15], v[224:227], 0
    s_waitcnt lgkmcnt(0)
    s_waitcnt vmcnt(9)
    v_mfma_f32_16x16x32_bf16 v[96:99], a[16:19], v[228:231], v[96:99]
    v_add_u32 v4, s87, v13
    s_xor_b64 s[52:53], s[52:53], s[48:49]
    v_mfma_f32_16x16x32_bf16 v[100:103], a[20:23], v[228:231], v[100:103]
    buffer_load_dwordx4 a[204:207], v3, s[28:31], s83 offen sc1
    s_xor_b64 s[54:55], s[54:55], s[48:49]
    v_mfma_f32_16x16x32_bf16 v[104:107], a[24:27], v[228:231], v[104:107]
    s_or_b64 s[52:53], s[52:53], s[54:55]
    s_xor_b64 s[56:57], s[56:57], s[48:49]
    v_mfma_f32_16x16x32_bf16 v[108:111], a[28:31], v[228:231], v[108:111]
    s_waitcnt vmcnt(9)
    v_mfma_f32_16x16x32_bf16 v[96:99], a[32:35], v[232:235], v[96:99]
    s_or_b64 s[52:53], s[52:53], s[56:57]
    s_cbranch_scc1 L_D_chk3
L_D_chk3_back:
    v_mfma_f32_16x16x32_bf16 v[100:103], a[36:39], v[232:235], v[100:103]
    buffer_load_dwordx4 a[208:211], v4, s[28:31], s72 offen sc1
    s_load_dword s58, s[0:1], s40
    v_mfma_f32_16x16x32_bf16 v[104:107], a[40:43], v[232:235], v[104:107]
    s_load_dword s59, s[0:1], s40 offset:512
    s_load_dword s60, s[0:1], s40 offset:1024
    v_mfma_f32_16x16x32_bf16 v[108:111], a[44:47], v[232:235], v[108:111]
    s_load_dword s61, s[0:1], s40 offset:1536
    s_waitcnt vmcnt(9)
    v_mfma_f32_16x16x32_bf16 v[96:99], a[48:51], v[236:239], v[96:99]
    s_load_dword s62, s[0:1], s40 offset:2048
    s_load_dword s63, s[0:1], s40 offset:2560
    v_mfma_f32_16x16x32_bf16 v[100:103], a[52:55], v[236:239], v[100:103]
    buffer_load_dwordx4 a[212:215], v4, s[28:31], s73 offen sc1
    v_mfma_f32_16x16x32_bf16 v[104:107], a[56:59], v[236:239], v[104:107]
    v_mfma_f32_16x16x32_bf16 v[108:111], a[60:63], v[236:239], v[108:111]
    s_waitcnt vmcnt(9)
    v_mfma_f32_16x16x32_bf16 v[96:99], a[64:67], v[240:243], v[96:99]
    v_mfma_f32_16x16x32_bf16 v[100:103], a[68:71], v[240:243], v[100:103]
    buffer_load_dwordx4 a[216:219], v4, s[28:31], s74 offen sc1
    v_mfma_f32_16x16x32_bf16 v[104:107], a[72:75], v[240:243], v[104:107]
    v_mfma_f32_16x16x32_bf16 v[108:111], a[76:79], v[240:243], v[108:111]
    s_waitcnt vmcnt(9)
    v_mfma_f32_16x16x32_bf16 v[96:99], a[80:83], v[244:247], v[96:99]
    ds_write_b64 v34, v[112:113] offset:16384
    v_mfma_f32_16x16x32_bf16 v[100:103], a[84:87], v[244:247], v[100:103]
    buffer_load_dwordx4 a[220:223], v4, s[28:31], s75 offen sc1
    v_mfma_f32_16x16x32_bf16 v[104:107], a[88:91], v[244:247], v[104:107]
    ds_write_b64 v34, v[114:115] offset:16392
    v_mfma_f32_16x16x32_bf16 v[108:111], a[92:95], v[244:247], v[108:111]
    s_waitcnt vmcnt(9)
    v_mfma_f32_16x16x32_bf16 v[96:99], a[96:99], v[248:251], v[96:99]
    ds_write_b64 v35, v[116:117] offset:16384
    v_mfma_f32_16x16x32_bf16 v[100:103], a[100:103], v[248:251], v[100:103]
    buffer_load_dwordx4 a[224:227], v4, s[28:31], s76 offen sc1
    v_mfma_f32_16x16x32_bf16 v[104:107], a[104:107], v[248:251], v[104:107]
    ds_write_b64 v35, v[118:119] offset:16392
    v_mfma_f32_16x16x32_bf16 v[108:111], a[108:111], v[248:251], v[108:111]
L_D_w1_0:
    s_cbranch_execz L_D_w1_1
    s_waitcnt vmcnt(9)
    v_mfma_f32_16x16x32_bf16 v[96:99], a[112:115], v[252:255], v[96:99]
    ds_write_b64 v36, v[120:121] offset:16384
    v_mfma_f32_16x16x32_bf16 v[100:103], a[116:119], v[252:255], v[100:103]
    buffer_load_dwordx4 a[228:231], v4, s[28:31], s77 offen sc1
    v_mfma_f32_16x16x32_bf16 v[104:107], a[120:123], v[252:255], v[104:107]
    ds_write_b64 v36, v[122:123] offset:16392
    v_mfma_f32_16x16x32_bf16 v[108:111], a[124:127], v[252:255], v[108:111]
L_D_w1_1:
    s_cbranch_execz L_hopped
    s_waitcnt vmcnt(9)
    v_mfma_f32_16x16x32_bf16 v[96:99], a[128:131], a[192:195], v[96:99]
    ds_write_b64 v37, v[124:125] offset:16384
    v_mfma_f32_16x16x32_bf16 v[100:103], a[132:135], a[192:195], v[100:103]
    buffer_load_dwordx4 a[232:235], v4, s[28:31], s78 offen sc1
    v_mfma_f32_16x16x32_bf16 v[104:107], a[136:139], a[192:195], v[104:107]
    ds_write_b64 v37, v[126:127] offset:16392
    v_mfma_f32_16x16x32_bf16 v[108:111], a[140:143], a[192:195], v[108:111]
    s_waitcnt vmcnt(9)
    v_mfma_f32_16x16x32_bf16 v[96:99], a[144:147], a[196:199], v[96:99]
    v_mfma_f32_16x16x32_bf16 v[100:103], a[148:151], a[196:199], v[100:103]
    buffer_load_dwordx4 a[236:239], v4, s[28:31], s79 offen sc1
    v_mfma_f32_16x16x32_bf16 v[104:107], a[152:155], a[196:199], v[104:107]
    s_waitcnt lgkmcnt(0)
    s_barrier
    v_mfma_f32_16x16x32_bf16 v[108:111], a[156:159], a[196:199], v[108:111]
    ds_read_b128 v[64:67], v38 offset:0
    s_waitcnt vmcnt(9)
    v_mfma_f32_16x16x32_bf16 v[96:99], a[160:163], a[200:203], v[96:99]
    ds_read_b128 v[68:71], v38 offset:4096
    ds_read_b128 v[72:75], v38 offset:8192
    v_mfma_f32_16x16x32_bf16 v[100:103], a[164:167], a[200:203], v[100:103]
    buffer_load_dwordx4 a[240:243], v4, s[28:31], s80 offen sc1
    ds_read_b128 v[76:79], v38 offset:12288
    v_mfma_f32_16x16x32_bf16 v[104:107], a[168:171], a[200:203], v[104:107]
    v_mfma_f32_16x16x32_bf16 v[108:111], a[172:175], a[200:203], v[108:111]
    s_waitcnt vmcnt(9)
    v_mfma_f32_16x16x32_bf16 v[96:99], a[176:179], a[204:207], v[96:99]
    v_mfma_f32_16x16x32_bf16 v[100:103], a[180:183], a[204:207], v[100:103]
    buffer_load_dwordx4 a[244:247], v4, s[28:31], s81 offen sc1
    s_waitcnt lgkmcnt(2)
    v_add_f32 v64, v64, v68
    v_mfma_f32_16x16x32_bf16 v[104:107], a[184:187], a[204:207], v[104:107]
    v_add_f32 v65, v65, v69
    v_add_f32 v66, v66, v70
    v_mfma_f32_16x16x32_bf16 v[108:111], a[188:191], a[204:207], v[108:111]
    v_add_f32 v67, v67, v71
    s_waitcnt vmcnt(9)
    v_mfma_f32_16x16x32_bf16 v[112:115], a[0:3], a[208:211], 0
    s_waitcnt lgkmcnt(0)
    v_add_f32 v72, v72, v76
    v_add_f32 v73, v73, v77
    v_mfma_f32_16x16x32_bf16 v[116:119], a[4:7], a[208:211], 0
    buffer_load_dwordx4 a[248:251], v4, s[28:31], s82 offen sc1
    v_add_f32 v74, v74, v78
    v_mfma_f32_16x16x32_bf16 v[120:123], a[8:11], a[208:211], 0
    v_add_f32 v75, v75, v79
    v_add_f32 v64, v64, v72
    v_mfma_f32_16x16x32_bf16 v[124:127], a[12:15], a[208:211], 0
    s_waitcnt lgkmcnt(0)
    s_waitcnt vmcnt(9)
    v_mfma_f32_16x16x32_bf16 v[112:115], a[16:19], a[212:215], v[112:115]
    v_add_u32 v5, s88, v13
    s_xor_b64 s[58:59], s[58:59], s[48:49]
    v_mfma_f32_16x16x32_bf16 v[116:119], a[20:23], a[212:215], v[116:119]
    buffer_load_dwordx4 a[252:255], v4, s[28:31], s83 offen sc1
    s_xor_b64 s[60:61], s[60:61], s[48:49]
    v_mfma_f32_16x16x32_bf16 v[120:123], a[24:27], a[212:215], v[120:123]
    s_or_b64 s[58:59], s[58:59], s[60:61]
    s_xor_b64 s[62:63], s[62:63], s[48:49]
    v_mfma_f32_16x16x32_bf16 v[124:127], a[28:31], a[212:215], v[124:127]
    v_add_f32 v65, v65, v73
    s_waitcnt vmcnt(9)
    v_mfma_f32_16x16x32_bf16 v[112:115], a[32:35], a[216:219], v[112:115]
    s_or_b64 s[58:59], s[58:59], s[62:63]
    s_cbranch_scc1 L_D_chk4
L_D_chk4_back:
    v_mfma_f32_16x16x32_bf16 v[116:119], a[36:39], a[216:219], v[116:119]
    buffer_load_dwordx4 v[128:131], v5, s[28:31], s72 offen sc1
    v_add_f32 v66, v66, v74
    v_mfma_f32_16x16x32_bf16 v[120:123], a[40:43], a[216:219], v[120:123]
    v_add_f32 v67, v67, v75
    v_cvt_pk_bf16_f32 v80, v64, v65
    v_mfma_f32_16x16x32_bf16 v[124:127], a[44:47], a[216:219], v[124:127]
    v_cvt_pk_bf16_f32 v81, v66, v67
    s_waitcnt vmcnt(9)
    v_mfma_f32_16x16x32_bf16 v[112:115], a[48:51], a[220:223], v[112:115]
    ds_read_b128 v[64:67], v38 offset:16384
    ds_read_b128 v[68:71], v38 offset:20480
    v_mfma_f32_16x16x32_bf16 v[116:119], a[52:55], a[220:223], v[116:119]
    buffer_load_dwordx4 v[132:135], v5, s[28:31], s73 offen sc1
    ds_read_b128 v[72:75], v38 offset:24576
    v_mfma_f32_16x16x32_bf16 v[120:123], a[56:59], a[220:223], v[120:123]
    ds_read_b128 v[76:79], v38 offset:28672
    v_mfma_f32_16x16x32_bf16 v[124:127], a[60:63], a[220:223], v[124:127]
    s_waitcnt vmcnt(9)
    v_mfma_f32_16x16x32_bf16 v[112:115], a[64:67], a[224:227], v[112:115]
    v_mfma_f32_16x16x32_bf16 v[116:119], a[68:71], a[224:227], v[116:119]
    buffer_load_dwordx4 v[136:139], v5, s[28:31], s74 offen sc1
    v_mfma_f32_16x16x32_bf16 v[120:123], a[72:75], a[224:227], v[120:123]
    s_waitcnt lgkmcnt(2)
    v_add_f32 v64, v64, v68
    v_add_f32 v65, v65, v69
    v_mfma_f32_16x16x32_bf16 v[124:127], a[76:79], a[224:227], v[124:127]
    v_add_f32 v66, v66, v70
    s_waitcnt vmcnt(9)
    v_mfma_f32_16x16x32_bf16 v[112:115], a[80:83], a[228:231], v[112:115]
    v_add_f32 v67, v67, v71
    s_waitcnt lgkmcnt(0)
    v_add_f32 v72, v72, v76
    v_mfma_f32_16x16x32_bf16 v[116:119], a[84:87], a[228:231], v[116:119]
    buffer_load_dwordx4 v[140:143], v5, s[28:31], s75 offen sc1
    v_add_f32 v73, v73, v77
    v_mfma_f32_16x16x32_bf16 v[120:123], a[88:91], a[228:231], v[120:123]
    v_add_f32 v74, v74, v78
    v_add_f32 v75, v75, v79
    v_mfma_f32_16x16x32_bf16 v[124:127], a[92:95], a[228:231], v[124:127]
    v_add_f32 v64, v64, v72
    s_waitcnt vmcnt(9)
    v_mfma_f32_16x16x32_bf16 v[112:115], a[96:99], a[232:235], v[112:115]
    v_add_f32 v65, v65, v73
    v_add_f32 v66, v66, v74
    v_mfma_f32_16x16x32_bf16 v[116:119], a[100:103], a[232:235], v[116:119]
    buffer_load_dwordx4 v[144:147], v5, s[28:31], s76 offen sc1
    v_add_f32 v67, v67, v75
    v_mfma_f32_16x16x32_bf16 v[120:123], a[104:107], a[232:235], v[120:123]
    v_cvt_pk_bf16_f32 v82, v64, v65
    v_cvt_pk_bf16_f32 v83, v66, v67
    v_mfma_f32_16x16x32_bf16 v[124:127], a[108:111], a[232:235], v[124:127]
    s_waitcnt vmcnt(9)
    v_mfma_f32_16x16x32_bf16 v[112:115], a[112:115], a[236:239], v[112:115]
    ds_write_b64 v34, v[96:97] offset:32768
    v_mfma_f32_16x16x32_bf16 v[116:119], a[116:119], a[236:239], v[116:119]
    buffer_load_dwordx4 v[148:151], v5, s[28:31], s77 offen sc1
    v_mfma_f32_16x16x32_bf16 v[120:123], a[120:123], a[236:239], v[120:123]
    ds_write_b64 v34, v[98:99] offset:32776
    v_mfma_f32_16x16x32_bf16 v[124:127], a[124:127], a[236:239], v[124:127]
    s_waitcnt vmcnt(9)
    v_mfma_f32_16x16x32_bf16 v[112:115], a[128:131], a[240:243], v[112:115]
    ds_write_b64 v35, v[100:101] offset:32768
    v_mfma_f32_16x16x32_bf16 v[116:119], a[132:135], a[240:243], v[116:119]
    buffer_load_dwordx4 v[152:155], v5, s[28:31], s78 offen sc1
    v_mfma_f32_16x16x32_bf16 v[120:123], a[136:139], a[240:243], v[120:123]
    ds_write_b64 v35, v[102:103] offset:32776
    v_mfma_f32_16x16x32_bf16 v[124:127], a[140:143], a[240:243], v[124:127]
    s_waitcnt vmcnt(9)
    v_mfma_f32_16x16x32_bf16 v[112:115], a[144:147], a[244:247], v[112:115]
    ds_write_b64 v36, v[104:105] offset:32768
    v_mfma_f32_16x16x32_bf16 v[116:119], a[148:151], a[244:247], v[116:119]
    buffer_load_dwordx4 v[156:159], v5, s[28:31], s79 offen sc1
    v_mfma_f32_16x16x32_bf16 v[120:123], a[152:155], a[244:247], v[120:123]
    ds_write_b64 v36, v[106:107] offset:32776
    v_mfma_f32_16x16x32_bf16 v[124:127], a[156:159], a[244:247], v[124:127]
    s_waitcnt vmcnt(9)
    v_mfma_f32_16x16x32_bf16 v[112:115], a[160:163], a[248:251], v[112:115]
    ds_write_b64 v37, v[108:109] offset:32768
    v_mfma_f32_16x16x32_bf16 v[116:119], a[164:167], a[248:251], v[116:119]
    buffer_load_dwordx4 v[160:163], v5, s[28:31], s80 offen sc1
    v_mfma_f32_16x16x32_bf16 v[120:123], a[168:171], a[248:251], v[120:123]
    ds_write_b64 v37, v[110:111] offset:32776
    v_mfma_f32_16x16x32_bf16 v[124:127], a[172:175], a[248:251], v[124:127]
    s_waitcnt vmcnt(9)
    v_mfma_f32_16x16x32_bf16 v[112:115], a[176:179], a[252:255], v[112:115]
    v_mfma_f32_16x16x32_bf16 v[116:119], a[180:183], a[252:255], v[116:119]
    buffer_load_dwordx4 v[164:167], v5, s[28:31], s81 offen sc1
    v_mfma_f32_16x16x32_bf16 v[120:123], a[184:187], a[252:255], v[120:123]
    s_waitcnt lgkmcnt(0)
    s_barrier
    v_mfma_f32_16x16x32_bf16 v[124:127], a[188:191], a[252:255], v[124:127]
    ds_read_b128 v[64:67], v38 offset:32768
    s_waitcnt vmcnt(9)
    v_mfma_f32_16x16x32_bf16 v[96:99], a[0:3], v[128:131], 0
    ds_read_b128 v[68:71], v38 offset:36864
    ds_read_b128 v[72:75], v38 offset:40960
    v_mfma_f32_16x16x32_bf16 v[100:103], a[4:7], v[128:131], 0
    buffer_load_dwordx4 v[168:171], v5, s[28:31], s82 offen sc1
    ds_read_b128 v[76:79], v38 offset:45056
    v_mfma_f32_16x16x32_bf16 v[104:107], a[8:11], v[128:131], 0
    v_mfma_f32_16x16x32_bf16 v[108:111], a[12:15], v[128:131], 0
    s_waitcnt vmcnt(9)
    v_mfma_f32_16x16x32_bf16 v[96:99], a[16:19], v[132:135], v[96:99]
    v_mfma_f32_16x16x32_bf16 v[100:103], a[20:23], v[132:135], v[100:103]
    buffer_load_dwordx4 v[172:175], v5, s[28:31], s83 offen sc1
    s_waitcnt lgkmcnt(2)
    v_add_f32 v64, v64, v68
    v_mfma_f32_16x16x32_bf16 v[104:107], a[24:27], v[132:135], v[104:107]
    v_add_f32 v65, v65, v69
    v_add_f32 v66, v66, v70
    v_mfma_f32_16x16x32_bf16 v[108:111], a[28:31], v[132:135], v[108:111]
    v_add_f32 v67, v67, v71
    s_waitcnt vmcnt(9)
    v_mfma_f32_16x16x32_bf16 v[96:99], a[32:35], v[136:139], v[96:99]
    s_waitcnt lgkmcnt(0)
    v_add_f32 v72, v72, v76
    v_add_f32 v73, v73, v77
    v_mfma_f32_16x16x32_bf16 v[100:103], a[36:39], v[136:139], v[100:103]
    v_add_f32 v74, v74, v78
    v_add_f32 v75, v75, v79
    v_mfma_f32_16x16x32_bf16 v[104:107], a[40:43], v[136:139], v[104:107]
    v_add_f32 v64, v64, v72
    v_add_f32 v65, v65, v73
    v_mfma_f32_16x16x32_bf16 v[108:111], a[44:47], v[136:139], v[108:111]
    v_add_f32 v66, v66, v74
    s_waitcnt vmcnt(8)
    v_mfma_f32_16x16x32_bf16 v[96:99], a[48:51], v[140:143], v[96:99]
    v_add_f32 v67, v67, v75
    v_cvt_pk_bf16_f32 v84, v64, v65
    v_mfma_f32_16x16x32_bf16 v[100:103], a[52:55], v[140:143], v[100:103]
    v_cvt_pk_bf16_f32 v85, v66, v67
    v_mfma_f32_16x16x32_bf16 v[104:107], a[56:59], v[140:143], v[104:107]
    ds_write_b64 v34, v[112:113] offset:49152
    v_mfma_f32_16x16x32_bf16 v[108:111], a[60:63], v[140:143], v[108:111]
    buffer_store_dwordx2 v[80:81], v17, s[24:27], s90 offen sc1
    s_waitcnt vmcnt(8)
    v_mfma_f32_16x16x32_bf16 v[96:99], a[64:67], v[144:147], v[96:99]
    ds_write_b64 v34, v[114:115] offset:49160
    v_mfma_f32_16x16x32_bf16 v[100:103], a[68:71], v[144:147], v[100:103]
    ds_write_b64 v35, v[116:117] offset:49152
    v_mfma_f32_16x16x32_bf16 v[104:107], a[72:75], v[144:147], v[104:107]
    ds_write_b64 v35, v[118:119] offset:49160
    v_mfma_f32_16x16x32_bf16 v[108:111], a[76:79], v[144:147], v[108:111]
    buffer_store_dwordx2 v[82:83], v17, s[24:27], s91 offen sc1
    s_waitcnt vmcnt(8)
    v_mfma_f32_16x16x32_bf16 v[96:99], a[80:83], v[148:151], v[96:99]
    ds_write_b64 v36, v[120:121] offset:49152
    v_mfma_f32_16x16x32_bf16 v[100:103], a[84:87], v[148:151], v[100:103]
    ds_write_b64 v36, v[122:123] offset:49160
    v_mfma_f32_16x16x32_bf16 v[104:107], a[88:91], v[148:151], v[104:107]
    ds_write_b64 v37, v[124:125] offset:49152
    v_mfma_f32_16x16x32_bf16 v[108:111], a[92:95], v[148:151], v[108:111]
    buffer_store_dwordx2 v[84:85], v17, s[24:27], s92 offen sc1
    s_waitcnt vmcnt(8)
    v_mfma_f32_16x16x32_bf16 v[96:99], a[96:99], v[152:155], v[96:99]
    ds_write_b64 v37, v[126:127] offset:49160
    v_mfma_f32_16x16x32_bf16 v[100:103], a[100:103], v[152:155], v[100:103]
    v_mfma_f32_16x16x32_bf16 v[104:107], a[104:107], v[152:155], v[104:107]
    v_mfma_f32_16x16x32_bf16 v[108:111], a[108:111], v[152:155], v[108:111]
    s_waitcnt vmcnt(7)
    v_mfma_f32_16x16x32_bf16 v[96:99], a[112:115], v[156:159], v[96:99]
    s_waitcnt lgkmcnt(0)
    s_barrier
    v_mfma_f32_16x16x32_bf16 v[100:103], a[116:119], v[156:159], v[100:103]
    ds_read_b128 v[64:67], v38 offset:49152
    ds_read_b128 v[68:71], v38 offset:53248
    v_mfma_f32_16x16x32_bf16 v[104:107], a[120:123], v[156:159], v[104:107]
    ds_read_b128 v[72:75], v38 offset:57344
    ds_read_b128 v[76:79], v38 offset:61440
    v_mfma_f32_16x16x32_bf16 v[108:111], a[124:127], v[156:159], v[108:111]
    s_waitcnt vmcnt(6)
    v_mfma_f32_16x16x32_bf16 v[96:99], a[128:131], v[160:163], v[96:99]
    v_mfma_f32_16x16x32_bf16 v[100:103], a[132:135], v[160:163], v[100:103]
    v_mfma_f32_16x16x32_bf16 v[104:107], a[136:139], v[160:163], v[104:107]
    s_waitcnt lgkmcnt(2)
    v_add_f32 v64, v64, v68
    v_add_f32 v65, v65, v69
    v_mfma_f32_16x16x32_bf16 v[108:111], a[140:143], v[160:163], v[108:111]
    v_add_f32 v66, v66, v70
    s_waitcnt vmcnt(5)
    v_mfma_f32_16x16x32_bf16 v[96:99], a[144:147], v[164:167], v[96:99]
    v_add_f32 v67, v67, v71
    s_waitcnt lgkmcnt(0)
    v_add_f32 v72, v72, v76
    v_mfma_f32_16x16x32_bf16 v[100:103], a[148:151], v[164:167], v[100:103]
    v_add_f32 v73, v73, v77
    v_add_f32 v74, v74, v78
    v_mfma_f32_16x16x32_bf16 v[104:107], a[152:155], v[164:167], v[104:107]
    v_add_f32 v75, v75, v79
    v_add_f32 v64, v64, v72
    v_mfma_f32_16x16x32_bf16 v[108:111], a[156:159], v[164:167], v[108:111]
    v_add_f32 v65, v65, v73
    s_waitcnt vmcnt(4)
    v_mfma_f32_16x16x32_bf16 v[96:99], a[160:163], v[168:171], v[96:99]
    v_add_f32 v66, v66, v74
    v_add_f32 v67, v67, v75
    s_waitcnt vmcnt(3)
    v_mfma_f32_16x16x32_bf16 v[96:99], a[176:179], v[172:175], v[96:99]
    v_cvt_pk_bf16_f32 v86, v64, v65
    v_cvt_pk_bf16_f32 v87, v66, v67
    v_mfma_f32_16x16x32_bf16 v[100:103], a[164:167], v[168:171], v[100:103]
    buffer_store_dwordx2 v[86:87], v17, s[24:27], s93 offen sc1
    v_mfma_f32_16x16x32_bf16 v[100:103], a[180:183], v[172:175], v[100:103]
    v_mfma_f32_16x16x32_bf16 v[104:107], a[168:171], v[168:171], v[104:107]
    v_mfma_f32_16x16x32_bf16 v[104:107], a[184:187], v[172:175], v[104:107]
    v_mfma_f32_16x16x32_bf16 v[108:111], a[172:175], v[168:171], v[108:111]
    ds_write_b128 v34, v[96:99] offset:0
    v_mfma_f32_16x16x32_bf16 v[108:111], a[188:191], v[172:175], v[108:111]
    s_nop 0
    s_nop 1
    ds_write_b128 v35, v[100:103] offset:0
    s_nop 0
    ds_write_b128 v36, v[104:107] offset:0
    s_nop 1
    ds_write_b128 v37, v[108:111] offset:0
    s_waitcnt lgkmcnt(0)
    s_barrier
    ds_read_b128 v[64:67], v38 offset:0
    ds_read_b128 v[68:71], v38 offset:4096
    ds_read_b128 v[72:75], v38 offset:8192
    ds_read_b128 v[76:79], v38 offset:12288
    s_waitcnt lgkmcnt(2)
    v_add_f32 v64, v64, v68
    v_add_f32 v65, v65, v69
    v_add_f32 v66, v66, v70
    v_add_f32 v67, v67, v71
    s_waitcnt lgkmcnt(0)
    v_add_f32 v72, v72, v76
    v_add_f32 v73, v73, v77
    v_add_f32 v74, v74, v78
    v_add_f32 v75, v75, v79
    v_add_f32 v64, v64, v72
    v_add_f32 v65, v65, v73
    v_add_f32 v66, v66, v74
    v_add_f32 v67, v67, v75
    v_cvt_pk_bf16_f32 v88, v64, v65
    v_cvt_pk_bf16_f32 v89, v66, v67
    buffer_store_dwordx2 v[88:89], v17, s[24:27], s94 offen nt
L_D_end:
    s_endpgm
L_D_tag:
    s_mov_b32 s96, 0
L_D_tag_loop:
    buffer_load_dword v48, v19, s[32:35], 0 offen sc1
    s_add_u32 s96, s96, 1
    s_waitcnt vmcnt(0)
    v_readfirstlane_b32 s48, v48
    s_nop 3
    s_cmp_lg_u32 s48, 0
    s_cbranch_scc1 L_D_tag_back
    s_cmp_lt_u32 s96, 40000
    s_cbranch_scc1 L_D_tag_loop
    s_branch L_D_tag_back
L_D_chk0:
    s_mov_b32 s96, 0
L_D_chk0_loop:
    buffer_load_dword v48, v50, s[28:31], s36 offen sc1
    s_add_u32 s96, s96, 1
    s_waitcnt vmcnt(0)
    v_cmp_ne_u32 vcc, s48, v48
    s_nop 1
    s_cmp_eq_u64 vcc, 0
    s_cbranch_scc1 L_D_chk0_back
    s_cmp_lt_u32 s96, 40000
    s_cbranch_scc1 L_D_chk0_loop
    s_branch L_D_chk0_back
L_D_chk1:
    s_mov_b32 s96, 0
L_D_chk1_loop:
    buffer_load_dword v48, v50, s[28:31], s37 offen sc1
    s_add_u32 s96, s96, 1
    s_waitcnt vmcnt(0)
    v_cmp_ne_u32 vcc, s48, v48
    s_nop 1
    s_cmp_eq_u64 vcc, 0
    s_cbranch_scc1 L_D_chk1_back
    s_cmp_lt_u32 s96, 40000
    s_cbranch_scc1 L_D_chk1_loop
    s_branch L_D_chk1_back
L_D_chk2:
    s_mov_b32 s96, 0
L_D_chk2_loop:
    buffer_load_dword v48, v50, s[28:31], s38 offen sc1
    s_add_u32 s96, s96, 1
    s_waitcnt vmcnt(0)
    v_cmp_ne_u32 vcc, s48, v48
    s_nop 1
    s_cmp_eq_u64 vcc, 0
    s_cbranch_scc1 L_D_chk2_back
    s_cmp_lt_u32 s96, 40000
    s_cbranch_scc1 L_D_chk2_loop
    s_branch L_D_chk2_back
L_D_chk3:
    s_mov_b32 s96, 0
L_D_chk3_loop:
    buffer_load_dword v48, v50, s[28:31], s39 offen sc1
    s_add_u32 s96, s96, 1
    s_waitcnt vmcnt(0)
    v_cmp_ne_u32 vcc, s48, v48
    s_nop 1
    s_cmp_eq_u64 vcc, 0
    s_cbranch_scc1 L_D_chk3_back
    s_cmp_lt_u32 s96, 40000
    s_cbranch_scc1 L_D_chk3_loop
    s_branch L_D_chk3_back
L_D_chk4:
    s_mov_b32 s96, 0
L_D_chk4_loop:
    buffer_load_dword v48, v50, s[28:31], s40 offen sc1
    s_add_u32 s96, s96, 1
    s_waitcnt vmcnt(0)
    v_cmp_ne_u32 vcc, s48, v48
    s_nop 1
    s_cmp_eq_u64 vcc, 0
    s_cbranch_scc1 L_D_chk4_back
    s_cmp_lt_u32 s96, 40000
    s_cbranch_scc1 L_D_chk4_loop
    s_branch L_D_chk4_back
.p2align 6
.type L_table,@object
L_table:
    .long 0x1000, 0x1400, 0x1800, 0x1c00, 0x2000, 0x2400, 0x2800, 0x2c00, 0x0, 0x400, 0x800, 0xc00, 0x18000, 0x144000, 0x3c000, 0xf0000, 0x6c000, 0x0, 0xa000, 0x87000, 0x19000, 0x64000, 0x2d000, 0x0, 0x0, 0x6000, 0x80, 0x3080, 0x100, 0x0, 0x0, 0x0
    .long 0x1000, 0x1400, 0x1800, 0x1c00, 0x2000, 0x2400, 0x2800, 0x2c00, 0x0, 0x400, 0x800, 0xc00, 0x18000, 0x144000, 0x3c000, 0xf0000, 0x6c000, 0x0, 0xa000, 0x87000, 0x19000, 0x64000, 0x2d000, 0x0, 0x0, 0x6000, 0x80, 0x3080, 0x100, 0x0, 0x280, 0x0
    .long 0x2000, 0x2400, 0x2800, 0x2c00, 0x0, 0x400, 0x800, 0xc00, 0x1000, 0x1400, 0x1800, 0x1c00, 0x1e0000, 0x180000, 0x21c000, 0x1b0000, 0x258000, 0x0, 0xc8000, 0xa0000, 0xe1000, 0xb4000, 0xfa000, 0x0, 0x9000, 0x6080, 0x9080, 0x6100, 0x9100, 0x0, 0x0, 0x0
    .long 0x2000, 0x2400, 0x2800, 0x2c00, 0x0, 0x400, 0x800, 0xc00, 0x1000, 0x1400, 0x1800, 0x1c00, 0x1e0000, 0x180000, 0x21c000, 0x1b0000, 0x258000, 0x0, 0xc8000, 0xa0000, 0xe1000, 0xb4000, 0xfa000, 0x0, 0x9000, 0x6080, 0x9080, 0x6100, 0x9100, 0x0, 0x280, 0x0
    .long 0x0, 0x400, 0x800, 0xc00, 0x1000, 0x1400, 0x1800, 0x1c00, 0x2000, 0x2400, 0x2800, 0x2c00, 0x318000, 0x444000, 0x33c000, 0x3f0000, 0x36c000, 0x0, 0x14a000, 0x1c7000, 0x159000, 0x1a4000, 0x16d000, 0x0, 0xf000, 0x15000, 0xf080, 0x12080, 0xf100, 0x0, 0x0, 0x0
    .long 0x0, 0x400, 0x800, 0xc00, 0x1000, 0x1400, 0x1800, 0x1c00, 0x2000, 0x2400, 0x2800, 0x2c00, 0x318000, 0x444000, 0x33c000, 0x3f0000, 0x36c000, 0x0, 0x14a000, 0x1c7000, 0x159000, 0x1a4000, 0x16d000, 0x0, 0xf000, 0x15000, 0xf080, 0x12080, 0xf100, 0x0, 0x280, 0x0
    .long 0x1000, 0x1400, 0x1800, 0x1c00, 0x2000, 0x2400, 0x2800, 0x2c00, 0x0, 0x400, 0x800, 0xc00, 0x4e0000, 0x480000, 0x51c000, 0x4b0000, 0x558000, 0x0, 0x208000, 0x1e0000, 0x221000, 0x1f4000, 0x23a000, 0x0, 0x18000, 0x15080, 0x18080, 0x15100, 0x18100, 0x0, 0x0, 0x0
    .long 0x1000, 0x1400, 0x1800, 0x1c00, 0x2000, 0x2400, 0x2800, 0x2c00, 0x0, 0x400, 0x800, 0xc00, 0x4e0000, 0x480000, 0x51c000, 0x4b0000, 0x558000, 0x0, 0x208000, 0x1e0000, 0x221000, 0x1f4000, 0x23a000, 0x0, 0x18000, 0x15080, 0x18080, 0x15100, 0x18100, 0x0, 0x280, 0x0
    .long 0x1800, 0x1c00, 0x2000, 0x2400, 0x2800, 0x2c00, 0x0, 0x400, 0x800, 0xc00, 0x1000, 0x1400, 0x18000, 0x144000, 0x3c000, 0xf0000, 0x6c000, 0x0, 0xa000, 0x87000, 0x19000, 0x64000, 0x2d000, 0x0, 0x0, 0x6000, 0x80, 0x3080, 0x100, 0x0, 0x80, 0x0
    .long 0x1800, 0x1c00, 0x2000, 0x2400, 0x2800, 0x2c00, 0x0, 0x400, 0x800, 0xc00, 0x1000, 0x1400, 0x18000, 0x144000, 0x3c000, 0xf0000, 0x6c000, 0x0, 0xa000, 0x87000, 0x19000, 0x64000, 0x2d000, 0x0, 0x0, 0x6000, 0x80, 0x3080, 0x100, 0x0, 0x300, 0x0
    .long 0x2800, 0x2c00, 0x0, 0x400, 0x800, 0xc00, 0x1000, 0x1400, 0x1800, 0x1c00, 0x2000, 0x2400, 0x1e0000, 0x180000, 0x21c000, 0x1b0000, 0x258000, 0x0, 0xc8000, 0xa0000, 0xe1000, 0xb4000, 0xfa000, 0x0, 0x9000, 0x6080, 0x9080, 0x6100, 0x9100, 0x0, 0x80, 0x0
    .long 0x2800, 0x2c00, 0x0, 0x400, 0x800, 0xc00, 0x1000, 0x1400, 0x1800, 0x1c00, 0x2000, 0x2400, 0x1e0000, 0x180000, 0x21c000, 0x1b0000, 0x258000, 0x0, 0xc8000, 0xa0000, 0xe1000, 0xb4000, 0xfa000, 0x0, 0x9000, 0x6080, 0x9080, 0x6100, 0x9100, 0x0, 0x300, 0x0
    .long 0x800, 0xc00, 0x1000, 0x1400, 0x1800, 0x1c00, 0x2000, 0x2400, 0x2800, 0x2c00, 0x0, 0x400, 0x318000, 0x444000, 0x33c000, 0x3f0000, 0x36c000, 0x0, 0x14a000, 0x1c7000, 0x159000, 0x1a4000, 0x16d000, 0x0, 0xf000, 0x15000, 0xf080, 0x12080, 0xf100, 0x0, 0x80, 0x0
    .long 0x800, 0xc00, 0x1000, 0x1400, 0x1800, 0x1c00, 0x2000, 0x2400, 0x2800, 0x2c00, 0x0, 0x400, 0x318000, 0x444000, 0x33c000, 0x3f0000, 0x36c000, 0x0, 0x14a000, 0x1c7000, 0x159000, 0x1a4000, 0x16d000, 0x0, 0xf000, 0x15000, 0xf080, 0x12080, 0xf100, 0x0, 0x300, 0x0
    .long 0x1800, 0x1c00, 0x2000, 0x2400, 0x2800, 0x2c00, 0x0, 0x400, 0x800, 0xc00, 0x1000, 0x1400, 0x4e0000, 0x480000, 0x51c000, 0x4b0000, 0x558000, 0x0, 0x208000, 0x1e0000, 0x221000, 0x1f4000, 0x23a000, 0x0, 0x18000, 0x15080, 0x18080, 0x15100, 0x18100, 0x0, 0x80, 0x0
    .long 0x1800, 0x1c00, 0x2000, 0x2400, 0x2800, 0x2c00, 0x0, 0x400, 0x800, 0xc00, 0x1000, 0x1400, 0x4e0000, 0x480000, 0x51c000, 0x4b0000, 0x558000, 0x0, 0x208000, 0x1e0000, 0x221000, 0x1f4000, 0x23a000, 0x0, 0x18000, 0x15080, 0x18080, 0x15100, 0x18100, 0x0, 0x300, 0x0
    .long 0x2400, 0x2800, 0x2c00, 0x0, 0x400, 0x800, 0xc00, 0x1000, 0x1400, 0x1800, 0x1c00, 0x2000, 0x18000, 0x144000, 0x3c000, 0xf0000, 0x6c000, 0x0, 0xa000, 0x87000, 0x19000, 0x64000, 0x2d000, 0x0, 0x0, 0x6000, 0x80, 0x3080, 0x100, 0x0, 0x100, 0x0
    .long 0x2400, 0x2800, 0x2c00, 0x0, 0x400, 0x800, 0xc00, 0x1000, 0x1400, 0x1800, 0x1c00, 0x2000, 0x18000, 0x144000, 0x3c000, 0xf0000, 0x6c000, 0x0, 0xa000, 0x87000, 0x19000, 0x64000, 0x2d000, 0x0, 0x0, 0x6000, 0x80, 0x3080, 0x100, 0x0, 0x380, 0x0
    .long 0x400, 0x800, 0xc00, 0x1000, 0x1400, 0x1800, 0x1c00, 0x2000, 0x2400, 0x2800, 0x2c00, 0x0, 0x1e0000, 0x180000, 0x21c000, 0x1b0000, 0x258000, 0x0, 0xc8000, 0xa0000, 0xe1000, 0xb4000, 0xfa000, 0x0, 0x9000, 0x6080, 0x9080, 0x6100, 0x9100, 0x0, 0x100, 0x0
    .long 0x400, 0x800, 0xc00, 0x1000, 0x1400, 0x1800, 0x1c00, 0x2000, 0x2400, 0x2800, 0x2c00, 0x0, 0x1e0000, 0x180000, 0x21c000, 0x1b0000, 0x258000, 0x0, 0xc8000, 0xa0000, 0xe1000, 0xb4000, 0xfa000, 0x0, 0x9000, 0x6080, 0x9080, 0x6100, 0x9100, 0x0, 0x380, 0x0
    .long 0x1400, 0x1800, 0x1c00, 0x2000, 0x2400, 0x2800, 0x2c00, 0x0, 0x400, 0x800, 0xc00, 0x1000, 0x318000, 0x444000, 0x33c000, 0x3f0000, 0x36c000, 0x0, 0x14a000, 0x1c7000, 0x159000, 0x1a4000, 0x16d000, 0x0, 0xf000, 0x15000, 0xf080, 0x12080, 0xf100, 0x0, 0x100, 0x0
    .long 0x1400, 0x1800, 0x1c00, 0x2000, 0x2400, 0x2800, 0x2c00, 0x0, 0x400, 0x800, 0xc00, 0x1000, 0x318000, 0x444000, 0x33c000, 0x3f0000, 0x36c000, 0x0, 0x14a000, 0x1c7000, 0x159000, 0x1a4000, 0x16d000, 0x0, 0xf000, 0x15000, 0xf080, 0x12080, 0xf100, 0x0, 0x380, 0x0
    .long 0x2400, 0x2800, 0x2c00, 0x0, 0x400, 0x800, 0xc00, 0x1000, 0x1400, 0x1800, 0x1c00, 0x2000, 0x4e0000, 0x480000, 0x51c000, 0x4b0000, 0x558000, 0x0, 0x208000, 0x1e0000, 0x221000, 0x1f4000, 0x23a000, 0x0, 0x18000, 0x15080, 0x18080, 0x15100, 0x18100, 0x0, 0x100, 0x0
    .long 0x2400, 0x2800, 0x2c00, 0x0, 0x400, 0x800, 0xc00, 0x1000, 0x1400, 0x1800, 0x1c00, 0x2000, 0x4e0000, 0x480000, 0x51c000, 0x4b0000, 0x558000, 0x0, 0x208000, 0x1e0000, 0x221000, 0x1f4000, 0x23a000, 0x0, 0x18000, 0x15080, 0x18080, 0x15100, 0x18100, 0x0, 0x380, 0x0
    .long 0x2c00, 0x0, 0x400, 0x800, 0xc00, 0x1000, 0x1400, 0x1800, 0x1c00, 0x2000, 0x2400, 0x2800, 0x18000, 0x144000, 0x3c000, 0xf0000, 0x6c000, 0x0, 0xa000, 0x87000, 0x19000, 0x64000, 0x2d000, 0x0, 0x0, 0x6000, 0x80, 0x3080, 0x100, 0x0, 0x180, 0x0
    .long 0x2c00, 0x0, 0x400, 0x800, 0xc00, 0x1000, 0x1400, 0x1800, 0x1c00, 0x2000, 0x2400, 0x2800, 0x18000, 0x144000, 0x3c000, 0xf0000, 0x6c000, 0x0, 0xa000, 0x87000, 0x19000, 0x64000, 0x2d000, 0x0, 0x0, 0x6000, 0x80, 0x3080, 0x100, 0x0, 0x400, 0x0
    .long 0xc00, 0x1000, 0x1400, 0x1800, 0x1c00, 0x2000, 0x2400, 0x2800, 0x2c00, 0x0, 0x400, 0x800, 0x1e0000, 0x180000, 0x21c000, 0x1b0000, 0x258000, 0x0, 0xc8000, 0xa0000, 0xe1000, 0xb4000, 0xfa000, 0x0, 0x9000, 0x6080, 0x9080, 0x6100, 0x9100, 0x0, 0x180, 0x0
    .long 0xc00, 0x1000, 0x1400, 0x1800, 0x1c00, 0x2000, 0x2400, 0x2800, 0x2c00, 0x0, 0x400, 0x800, 0x1e0000, 0x180000, 0x21c000, 0x1b0000, 0x258000, 0x0, 0xc8000, 0xa0000, 0xe1000, 0xb4000, 0xfa000, 0x0, 0x9000, 0x6080, 0x9080, 0x6100, 0x9100, 0x0, 0x400, 0x0
    .long 0x1c00, 0x2000, 0x2400, 0x2800, 0x2c00, 0x0, 0x400, 0x800, 0xc00, 0x1000, 0x1400, 0x1800, 0x318000, 0x444000, 0x33c000, 0x3f0000, 0x36c000, 0x0, 0x14a000, 0x1c7000, 0x159000, 0x1a4000, 0x16d000, 0x0, 0xf000, 0x15000, 0xf080, 0x12080, 0xf100, 0x0, 0x180, 0x0
    .long 0x1c00, 0x2000, 0x2400, 0x2800, 0x2c00, 0x0, 0x400, 0x800, 0xc00, 0x1000, 0x1400, 0x1800, 0x318000, 0x444000, 0x33c000, 0x3f0000, 0x36c000, 0x0, 0x14a000, 0x1c7000, 0x159000, 0x1a4000, 0x16d000, 0x0, 0xf000, 0x15000, 0xf080, 0x12080, 0xf100, 0x0, 0x400, 0x0
    .long 0x2c00, 0x0, 0x400, 0x800, 0xc00, 0x1000, 0x1400, 0x1800, 0x1c00, 0x2000, 0x2400, 0x2800, 0x4e0000, 0x480000, 0x51c000, 0x4b0000, 0x558000, 0x0, 0x208000, 0x1e0000, 0x221000, 0x1f4000, 0x23a000, 0x0, 0x18000, 0x15080, 0x18080, 0x15100, 0x18100, 0x0, 0x180, 0x0
    .long 0x2c00, 0x0, 0x400, 0x800, 0xc00, 0x1000, 0x1400, 0x1800, 0x1c00, 0x2000, 0x2400, 0x2800, 0x4e0000, 0x480000, 0x51c000, 0x4b0000, 0x558000, 0x0, 0x208000, 0x1e0000, 0x221000, 0x1f4000, 0x23a000, 0x0, 0x18000, 0x15080, 0x18080, 0x15100, 0x18100, 0x0, 0x400, 0x0
    .long 0x800, 0xc00, 0x1000, 0x1400, 0x1800, 0x1c00, 0x2000, 0x2400, 0x2800, 0x2c00, 0x0, 0x400, 0x18000, 0x144000, 0x3c000, 0xf0000, 0x6c000, 0x0, 0xa000, 0x87000, 0x19000, 0x64000, 0x2d000, 0x0, 0x0, 0x6000, 0x80, 0x3080, 0x100, 0x0, 0x200, 0x0
    .long 0x800, 0xc00, 0x1000, 0x1400, 0x1800, 0x1c00, 0x2000, 0x2400, 0x2800, 0x2c00, 0x0, 0x400, 0x18000, 0x144000, 0x3c000, 0xf0000, 0x6c000, 0x0, 0xa000, 0x87000, 0x19000, 0x64000, 0x2d000, 0x0, 0x0, 0x6000, 0x80, 0x3080, 0x100, 0x0, 0x480, 0x0
    .long 0x1800, 0x1c00, 0x2000, 0x2400, 0x2800, 0x2c00, 0x0, 0x400, 0x800, 0xc00, 0x1000, 0x1400, 0x1e0000, 0x180000, 0x21c000, 0x1b0000, 0x258000, 0x0, 0xc8000, 0xa0000, 0xe1000, 0xb4000, 0xfa000, 0x0, 0x9000, 0x6080, 0x9080, 0x6100, 0x9100, 0x0, 0x200, 0x0
    .long 0x1800, 0x1c00, 0x2000, 0x2400, 0x2800, 0x2c00, 0x0, 0x400, 0x800, 0xc00, 0x1000, 0x1400, 0x1e0000, 0x180000, 0x21c000, 0x1b0000, 0x258000, 0x0, 0xc8000, 0xa0000, 0xe1000, 0xb4000, 0xfa000, 0x0, 0x9000, 0x6080, 0x9080, 0x6100, 0x9100, 0x0, 0x480, 0x0
    .long 0x2800, 0x2c00, 0x0, 0x400, 0x800, 0xc00, 0x1000, 0x1400, 0x1800, 0x1c00, 0x2000, 0x2400, 0x318000, 0x444000, 0x33c000, 0x3f0000, 0x36c000, 0x0, 0x14a000, 0x1c7000, 0x159000, 0x1a4000, 0x16d000, 0x0, 0xf000, 0x15000, 0xf080, 0x12080, 0xf100, 0x0, 0x200, 0x0
    .long 0x2800, 0x2c00, 0x0, 0x400, 0x800, 0xc00, 0x1000, 0x1400, 0x1800, 0x1c00, 0x2000, 0x2400, 0x318000, 0x444000, 0x33c000, 0x3f0000, 0x36c000, 0x0, 0x14a000, 0x1c7000, 0x159000, 0x1a4000, 0x16d000, 0x0, 0xf000, 0x15000, 0xf080, 0x12080, 0xf100, 0x0, 0x480, 0x0
    .long 0x800, 0xc00, 0x1000, 0x1400, 0x1800, 0x1c00, 0x2000, 0x2400, 0x2800, 0x2c00, 0x0, 0x400, 0x4e0000, 0x480000, 0x51c000, 0x4b0000, 0x558000, 0x0, 0x208000, 0x1e0000, 0x221000, 0x1f4000, 0x23a000, 0x0, 0x18000, 0x15080, 0x18080, 0x15100, 0x18100, 0x0, 0x200, 0x0
    .long 0x800, 0xc00, 0x1000, 0x1400, 0x1800, 0x1c00, 0x2000, 0x2400, 0x2800, 0x2c00, 0x0, 0x400, 0x4e0000, 0x480000, 0x51c000, 0x4b0000, 0x558000, 0x0, 0x208000, 0x1e0000, 0x221000, 0x1f4000, 0x23a000, 0x0, 0x18000, 0x15080, 0x18080, 0x15100, 0x18100, 0x0, 0x480, 0x0
    .long 0x1800, 0x1c00, 0x2000, 0x2400, 0x2800, 0x2c00, 0x0, 0x400, 0x800, 0xc00, 0x1000, 0x1400, 0x24000, 0x150000, 0x48000, 0xfc000, 0x78000, 0x0, 0xf000, 0x8c000, 0x1e000, 0x69000, 0x32000, 0x0, 0x0, 0x6000, 0x80, 0x3080, 0x100, 0x0, 0x0, 0x0
    .long 0x1800, 0x1c00, 0x2000, 0x2400, 0x2800, 0x2c00, 0x0, 0x400, 0x800, 0xc00, 0x1000, 0x1400, 0x24000, 0x150000, 0x48000, 0xfc000, 0x78000, 0x0, 0xf000, 0x8c000, 0x1e000, 0x69000, 0x32000, 0x0, 0x0, 0x6000, 0x80, 0x3080, 0x100, 0x0, 0x280, 0x0
    .long 0x2800, 0x2c00, 0x0, 0x400, 0x800, 0xc00, 0x1000, 0x1400, 0x1800, 0x1c00, 0x2000, 0x2400, 0x1ec000, 0x18c000, 0x294000, 0x1bc000, 0x2c4000, 0x0, 0xcd000, 0xa5000, 0x113000, 0xb9000, 0x127000, 0x0, 0x9000, 0x6080, 0xc080, 0x6100, 0xc100, 0x0, 0x0, 0x0
    .long 0x2800, 0x2c00, 0x0, 0x400, 0x800, 0xc00, 0x1000, 0x1400, 0x1800, 0x1c00, 0x2000, 0x2400, 0x1ec000, 0x18c000, 0x294000, 0x1bc000, 0x2c4000, 0x0, 0xcd000, 0xa5000, 0x113000, 0xb9000, 0x127000, 0x0, 0x9000, 0x6080, 0xc080, 0x6100, 0xc100, 0x0, 0x280, 0x0
    .long 0x800, 0xc00, 0x1000, 0x1400, 0x1800, 0x1c00, 0x2000, 0x2400, 0x2800, 0x2c00, 0x0, 0x400, 0x324000, 0x450000, 0x348000, 0x3fc000, 0x378000, 0x0, 0x14f000, 0x1cc000, 0x15e000, 0x1a9000, 0x172000, 0x0, 0xf000, 0x15000, 0xf080, 0x12080, 0xf100, 0x0, 0x0, 0x0
    .long 0x800, 0xc00, 0x1000, 0x1400, 0x1800, 0x1c00, 0x2000, 0x2400, 0x2800, 0x2c00, 0x0, 0x400, 0x324000, 0x450000, 0x348000, 0x3fc000, 0x378000, 0x0, 0x14f000, 0x1cc000, 0x15e000, 0x1a9000, 0x172000, 0x0, 0xf000, 0x15000, 0xf080, 0x12080, 0xf100, 0x0, 0x280, 0x0
    .long 0x1800, 0x1c00, 0x2000, 0x2400, 0x2800, 0x2c00, 0x0, 0x400, 0x800, 0xc00, 0x1000, 0x1400, 0x4ec000, 0x48c000, 0x594000, 0x4bc000, 0x5c4000, 0x0, 0x20d000, 0x1e5000, 0x253000, 0x1f9000, 0x267000, 0x0, 0x18000, 0x15080, 0x1b080, 0x15100, 0x1b100, 0x0, 0x0, 0x0
    .long 0x1800, 0x1c00, 0x2000, 0x2400, 0x2800, 0x2c00, 0x0, 0x400, 0x800, 0xc00, 0x1000, 0x1400, 0x4ec000, 0x48c000, 0x594000, 0x4bc000, 0x5c4000, 0x0, 0x20d000, 0x1e5000, 0x253000, 0x1f9000, 0x267000, 0x0, 0x18000, 0x15080, 0x1b080, 0x15100, 0x1b100, 0x0, 0x280, 0x0
    .long 0x1c00, 0x2000, 0x2400, 0x2800, 0x2c00, 0x0, 0x400, 0x800, 0xc00, 0x1000, 0x1400, 0x1800, 0x0, 0xc0000, 0xd8000, 0x60000, 0x0, 0x0, 0x0, 0x50000, 0x5a000, 0x28000, 0x0, 0x0, 0x0, 0x3000, 0x3080, 0x100, 0x0, 0x0, 0x180, 0x0
    .long 0x1c00, 0x2000, 0x2400, 0x2800, 0x2c00, 0x0, 0x400, 0x800, 0xc00, 0x1000, 0x1400, 0x1800, 0x0, 0xc0000, 0xd8000, 0x60000, 0x0, 0x0, 0x0, 0x50000, 0x5a000, 0x28000, 0x0, 0x0, 0x0, 0x3000, 0x3080, 0x100, 0x0, 0x0, 0x400, 0x0
    .long 0x2c00, 0x0, 0x400, 0x800, 0xc00, 0x1000, 0x1400, 0x1800, 0x1c00, 0x2000, 0x2400, 0x2800, 0x1c8000, 0x288000, 0x2b8000, 0x24c000, 0x0, 0x0, 0xbe000, 0x10e000, 0x122000, 0xf5000, 0x0, 0x0, 0x9000, 0xc000, 0xc080, 0x9100, 0x0, 0x0, 0x180, 0x0
    .long 0x2c00, 0x0, 0x400, 0x800, 0xc00, 0x1000, 0x1400, 0x1800, 0x1c00, 0x2000, 0x2400, 0x2800, 0x1c8000, 0x288000, 0x2b8000, 0x24c000, 0x0, 0x0, 0xbe000, 0x10e000, 0x122000, 0xf5000, 0x0, 0x0, 0x9000, 0xc000, 0xc080, 0x9100, 0x0, 0x0, 0x400, 0x0
    .long 0xc00, 0x1000, 0x1400, 0x1800, 0x1c00, 0x2000, 0x2400, 0x2800, 0x2c00, 0x0, 0x400, 0x800, 0x300000, 0x3c0000, 0x3d8000, 0x360000, 0x0, 0x0, 0x140000, 0x190000, 0x19a000, 0x168000, 0x0, 0x0, 0xf000, 0x12000, 0x12080, 0xf100, 0x0, 0x0, 0x180, 0x0
    .long 0xc00, 0x1000, 0x1400, 0x1800, 0x1c00, 0x2000, 0x2400, 0x2800, 0x2c00, 0x0, 0x400, 0x800, 0x300000, 0x3c0000, 0x3d8000, 0x360000, 0x0, 0x0, 0x140000, 0x190000, 0x19a000, 0x168000, 0x0, 0x0, 0xf000, 0x12000, 0x12080, 0xf100, 0x0, 0x0, 0x400, 0x0
    .long 0x1c00, 0x2000, 0x2400, 0x2800, 0x2c00, 0x0, 0x400, 0x800, 0xc00, 0x1000, 0x1400, 0x1800, 0x4c8000, 0x588000, 0x5b8000, 0x54c000, 0x0, 0x0, 0x1fe000, 0x24e000, 0x262000, 0x235000, 0x0, 0x0, 0x18000, 0x1b000, 0x1b080, 0x18100, 0x0, 0x0, 0x180, 0x0
    .long 0x1c00, 0x2000, 0x2400, 0x2800, 0x2c00, 0x0, 0x400, 0x800, 0xc00, 0x1000, 0x1400, 0x1800, 0x4c8000, 0x588000, 0x5b8000, 0x54c000, 0x0, 0x0, 0x1fe000, 0x24e000, 0x262000, 0x235000, 0x0, 0x0, 0x18000, 0x1b000, 0x1b080, 0x18100, 0x0, 0x0, 0x400, 0x0
    .long 0x2800, 0x2c00, 0x0, 0x400, 0x800, 0xc00, 0x1000, 0x1400, 0x1800, 0x1c00, 0x2000, 0x2400, 0x0, 0xc0000, 0xd8000, 0x60000, 0x0, 0x0, 0x0, 0x50000, 0x5a000, 0x28000, 0x0, 0x0, 0x0, 0x3000, 0x3080, 0x100, 0x0, 0x0, 0x200, 0x0
    .long 0x2800, 0x2c00, 0x0, 0x400, 0x800, 0xc00, 0x1000, 0x1400, 0x1800, 0x1c00, 0x2000, 0x2400, 0x0, 0xc0000, 0xd8000, 0x60000, 0x0, 0x0, 0x0, 0x50000, 0x5a000, 0x28000, 0x0, 0x0, 0x0, 0x3000, 0x3080, 0x100, 0x0, 0x0, 0x480, 0x0
    .long 0x800, 0xc00, 0x1000, 0x1400, 0x1800, 0x1c00, 0x2000, 0x2400, 0x2800, 0x2c00, 0x0, 0x400, 0x1c8000, 0x288000, 0x2b8000, 0x24c000, 0x0, 0x0, 0xbe000, 0x10e000, 0x122000, 0xf5000, 0x0, 0x0, 0x9000, 0xc000, 0xc080, 0x9100, 0x0, 0x0, 0x200, 0x0
    .long 0x800, 0xc00, 0x1000, 0x1400, 0x1800, 0x1c00, 0x2000, 0x2400, 0x2800, 0x2c00, 0x0, 0x400, 0x1c8000, 0x288000, 0x2b8000, 0x24c000, 0x0, 0x0, 0xbe000, 0x10e000, 0x122000, 0xf5000, 0x0, 0x0, 0x9000, 0xc000, 0xc080, 0x9100, 0x0, 0x0, 0x480, 0x0
    .long 0x1800, 0x1c00, 0x2000, 0x2400, 0x2800, 0x2c00, 0x0, 0x400, 0x800, 0xc00, 0x1000, 0x1400, 0x300000, 0x3c0000, 0x3d8000, 0x360000, 0x0, 0x0, 0x140000, 0x190000, 0x19a000, 0x168000, 0x0, 0x0, 0xf000, 0x12000, 0x12080, 0xf100, 0x0, 0x0, 0x200, 0x0
    .long 0x1800, 0x1c00, 0x2000, 0x2400, 0x2800, 0x2c00, 0x0, 0x400, 0x800, 0xc00, 0x1000, 0x1400, 0x300000, 0x3c0000, 0x3d8000, 0x360000, 0x0, 0x0, 0x140000, 0x190000, 0x19a000, 0x168000, 0x0, 0x0, 0xf000, 0x12000, 0x12080, 0xf100, 0x0, 0x0, 0x480, 0x0
    .long 0x2800, 0x2c00, 0x0, 0x400, 0x800, 0xc00, 0x1000, 0x1400, 0x1800, 0x1c00, 0x2000, 0x2400, 0x4c8000, 0x588000, 0x5b8000, 0x54c000, 0x0, 0x0, 0x1fe000, 0x24e000, 0x262000, 0x235000, 0x0, 0x0, 0x18000, 0x1b000, 0x1b080, 0x18100, 0x0, 0x0, 0x200, 0x0
    .long 0x2800, 0x2c00, 0x0, 0x400, 0x800, 0xc00, 0x1000, 0x1400, 0x1800, 0x1c00, 0x2000, 0x2400, 0x4c8000, 0x588000, 0x5b8000, 0x54c000, 0x0, 0x0, 0x1fe000, 0x24e000, 0x262000, 0x235000, 0x0, 0x0, 0x18000, 0x1b000, 0x1b080, 0x18100, 0x0, 0x0, 0x480, 0x0
    .long 0x2400, 0x2800, 0x2c00, 0x0, 0x400, 0x800, 0xc00, 0x1000, 0x1400, 0x1800, 0x1c00, 0x2000, 0xc000, 0x174000, 0xe4000, 0x12c000, 0x0, 0x0, 0x5000, 0x9b000, 0x5f000, 0x7d000, 0x0, 0x0, 0x0, 0x6080, 0x3080, 0x3180, 0x0, 0x0, 0x180, 0x0
    .long 0x2400, 0x2800, 0x2c00, 0x0, 0x400, 0x800, 0xc00, 0x1000, 0x1400, 0x1800, 0x1c00, 0x2000, 0xc000, 0x174000, 0xe4000, 0x12c000, 0x0, 0x0, 0x5000, 0x9b000, 0x5f000, 0x7d000, 0x0, 0x0, 0x0, 0x6080, 0x3080, 0x3180, 0x0, 0x0, 0x400, 0x0
    .long 0x400, 0x800, 0xc00, 0x1000, 0x1400, 0x1800, 0x1c00, 0x2000, 0x2400, 0x2800, 0x2c00, 0x0, 0x1d4000, 0x204000, 0x1a4000, 0x2e8000, 0x0, 0x0, 0xc3000, 0xd7000, 0xaf000, 0x136000, 0x0, 0x0, 0x9000, 0x9080, 0x6100, 0xc100, 0x0, 0x0, 0x180, 0x0
    .long 0x400, 0x800, 0xc00, 0x1000, 0x1400, 0x1800, 0x1c00, 0x2000, 0x2400, 0x2800, 0x2c00, 0x0, 0x1d4000, 0x204000, 0x1a4000, 0x2e8000, 0x0, 0x0, 0xc3000, 0xd7000, 0xaf000, 0x136000, 0x0, 0x0, 0x9000, 0x9080, 0x6100, 0xc100, 0x0, 0x0, 0x400, 0x0
    .long 0x1400, 0x1800, 0x1c00, 0x2000, 0x2400, 0x2800, 0x2c00, 0x0, 0x400, 0x800, 0xc00, 0x1000, 0x30c000, 0x474000, 0x3e4000, 0x42c000, 0x0, 0x0, 0x145000, 0x1db000, 0x19f000, 0x1bd000, 0x0, 0x0, 0xf000, 0x15080, 0x12080, 0x12180, 0x0, 0x0, 0x180, 0x0
    .long 0x1400, 0x1800, 0x1c00, 0x2000, 0x2400, 0x2800, 0x2c00, 0x0, 0x400, 0x800, 0xc00, 0x1000, 0x30c000, 0x474000, 0x3e4000, 0x42c000, 0x0, 0x0, 0x145000, 0x1db000, 0x19f000, 0x1bd000, 0x0, 0x0, 0xf000, 0x15080, 0x12080, 0x12180, 0x0, 0x0, 0x400, 0x0
    .long 0x2400, 0x2800, 0x2c00, 0x0, 0x400, 0x800, 0xc00, 0x1000, 0x1400, 0x1800, 0x1c00, 0x2000, 0x4d4000, 0x504000, 0x4a4000, 0x5e8000, 0x0, 0x0, 0x203000, 0x217000, 0x1ef000, 0x276000, 0x0, 0x0, 0x18000, 0x18080, 0x15100, 0x1b100, 0x0, 0x0, 0x180, 0x0
    .long 0x2400, 0x2800, 0x2c00, 0x0, 0x400, 0x800, 0xc00, 0x1000, 0x1400, 0x1800, 0x1c00, 0x2000, 0x4d4000, 0x504000, 0x4a4000, 0x5e8000, 0x0, 0x0, 0x203000, 0x217000, 0x1ef000, 0x276000, 0x0, 0x0, 0x18000, 0x18080, 0x15100, 0x1b100, 0x0, 0x0, 0x400, 0x0
    .long 0x0, 0x400, 0x800, 0xc00, 0x1000, 0x1400, 0x1800, 0x1c00, 0x2000, 0x2400, 0x2800, 0x2c00, 0xc000, 0x174000, 0xe4000, 0x12c000, 0x0, 0x0, 0x5000, 0x9b000, 0x5f000, 0x7d000, 0x0, 0x0, 0x0, 0x6080, 0x3080, 0x3180, 0x0, 0x0, 0x200, 0x0
    .long 0x0, 0x400, 0x800, 0xc00, 0x1000, 0x1400, 0x1800, 0x1c00, 0x2000, 0x2400, 0x2800, 0x2c00, 0xc000, 0x174000, 0xe4000, 0x12c000, 0x0, 0x0, 0x5000, 0x9b000, 0x5f000, 0x7d000, 0x0, 0x0, 0x0, 0x6080, 0x3080, 0x3180, 0x0, 0x0, 0x480, 0x0
    .long 0x1000, 0x1400, 0x1800, 0x1c00, 0x2000, 0x2400, 0x2800, 0x2c00, 0x0, 0x400, 0x800, 0xc00, 0x1d4000, 0x204000, 0x1a4000, 0x2e8000, 0x0, 0x0, 0xc3000, 0xd7000, 0xaf000, 0x136000, 0x0, 0x0, 0x9000, 0x9080, 0x6100, 0xc100, 0x0, 0x0, 0x200, 0x0
    .long 0x1000, 0x1400, 0x1800, 0x1c00, 0x2000, 0x2400, 0x2800, 0x2c00, 0x0, 0x400, 0x800, 0xc00, 0x1d4000, 0x204000, 0x1a4000, 0x2e8000, 0x0, 0x0, 0xc3000, 0xd7000, 0xaf000, 0x136000, 0x0, 0x0, 0x9000, 0x9080, 0x6100, 0xc100, 0x0, 0x0, 0x480, 0x0
    .long 0x2000, 0x2400, 0x2800, 0x2c00, 0x0, 0x400, 0x800, 0xc00, 0x1000, 0x1400, 0x1800, 0x1c00, 0x30c000, 0x474000, 0x3e4000, 0x42c000, 0x0, 0x0, 0x145000, 0x1db000, 0x19f000, 0x1bd000, 0x0, 0x0, 0xf000, 0x15080, 0x12080, 0x12180, 0x0, 0x0, 0x200, 0x0
    .long 0x2000, 0x2400, 0x2800, 0x2c00, 0x0, 0x400, 0x800, 0xc00, 0x1000, 0x1400, 0x1800, 0x1c00, 0x30c000, 0x474000, 0x3e4000, 0x42c000, 0x0, 0x0, 0x145000, 0x1db000, 0x19f000, 0x1bd000, 0x0, 0x0, 0xf000, 0x15080, 0x12080, 0x12180, 0x0, 0x0, 0x480, 0x0
    .long 0x0, 0x400, 0x800, 0xc00, 0x1000, 0x1400, 0x1800, 0x1c00, 0x2000, 0x2400, 0x2800, 0x2c00, 0x4d4000, 0x504000, 0x4a4000, 0x5e8000, 0x0, 0x0, 0x203000, 0x217000, 0x1ef000, 0x276000, 0x0, 0x0, 0x18000, 0x18080, 0x15100, 0x1b100, 0x0, 0x0, 0x200, 0x0
    .long 0x0, 0x400, 0x800, 0xc00, 0x1000, 0x1400, 0x1800, 0x1c00, 0x2000, 0x2400, 0x2800, 0x2c00, 0x4d4000, 0x504000, 0x4a4000, 0x5e8000, 0x0, 0x0, 0x203000, 0x217000, 0x1ef000, 0x276000, 0x0, 0x0, 0x18000, 0x18080, 0x15100, 0x1b100, 0x0, 0x0, 0x480, 0x0
    .long 0x1c00, 0x2000, 0x2400, 0x2800, 0x2c00, 0x0, 0x400, 0x800, 0xc00, 0x1000, 0x1400, 0x1800, 0xb4000, 0x30000, 0x120000, 0x138000, 0x0, 0x0, 0x4b000, 0x14000, 0x78000, 0x82000, 0x0, 0x0, 0x3000, 0x80, 0x3100, 0x3180, 0x0, 0x0, 0x180, 0x0
    .long 0x1c00, 0x2000, 0x2400, 0x2800, 0x2c00, 0x0, 0x400, 0x800, 0xc00, 0x1000, 0x1400, 0x1800, 0xb4000, 0x30000, 0x120000, 0x138000, 0x0, 0x0, 0x4b000, 0x14000, 0x78000, 0x82000, 0x0, 0x0, 0x3000, 0x80, 0x3100, 0x3180, 0x0, 0x0, 0x400, 0x0
    .long 0x2c00, 0x0, 0x400, 0x800, 0xc00, 0x1000, 0x1400, 0x1800, 0x1c00, 0x2000, 0x2400, 0x2800, 0x27c000, 0x210000, 0x240000, 0x2f4000, 0x0, 0x0, 0x109000, 0xdc000, 0xf0000, 0x13b000, 0x0, 0x0, 0xc000, 0x9080, 0x9100, 0xc100, 0x0, 0x0, 0x180, 0x0
    .long 0x2c00, 0x0, 0x400, 0x800, 0xc00, 0x1000, 0x1400, 0x1800, 0x1c00, 0x2000, 0x2400, 0x2800, 0x27c000, 0x210000, 0x240000, 0x2f4000, 0x0, 0x0, 0x109000, 0xdc000, 0xf0000, 0x13b000, 0x0, 0x0, 0xc000, 0x9080, 0x9100, 0xc100, 0x0, 0x0, 0x400, 0x0
    .long 0xc00, 0x1000, 0x1400, 0x1800, 0x1c00, 0x2000, 0x2400, 0x2800, 0x2c00, 0x0, 0x400, 0x800, 0x3b4000, 0x330000, 0x420000, 0x438000, 0x0, 0x0, 0x18b000, 0x154000, 0x1b8000, 0x1c2000, 0x0, 0x0, 0x12000, 0xf080, 0x12100, 0x12180, 0x0, 0x0, 0x180, 0x0
    .long 0xc00, 0x1000, 0x1400, 0x1800, 0x1c00, 0x2000, 0x2400, 0x2800, 0x2c00, 0x0, 0x400, 0x800, 0x3b4000, 0x330000, 0x420000, 0x438000, 0x0, 0x0, 0x18b000, 0x154000, 0x1b8000, 0x1c2000, 0x0, 0x0, 0x12000, 0xf080, 0x12100, 0x12180, 0x0, 0x0, 0x400, 0x0
    .long 0x1c00, 0x2000, 0x2400, 0x2800, 0x2c00, 0x0, 0x400, 0x800, 0xc00, 0x1000, 0x1400, 0x1800, 0x57c000, 0x510000, 0x540000, 0x5f4000, 0x0, 0x0, 0x249000, 0x21c000, 0x230000, 0x27b000, 0x0, 0x0, 0x1b000, 0x18080, 0x18100, 0x1b100, 0x0, 0x0, 0x180, 0x0
    .long 0x1c00, 0x2000, 0x2400, 0x2800, 0x2c00, 0x0, 0x400, 0x800, 0xc00, 0x1000, 0x1400, 0x1800, 0x57c000, 0x510000, 0x540000, 0x5f4000, 0x0, 0x0, 0x249000, 0x21c000, 0x230000, 0x27b000, 0x0, 0x0, 0x1b000, 0x18080, 0x18100, 0x1b100, 0x0, 0x0, 0x400, 0x0
    .long 0x2800, 0x2c00, 0x0, 0x400, 0x800, 0xc00, 0x1000, 0x1400, 0x1800, 0x1c00, 0x2000, 0x2400, 0xb4000, 0x30000, 0x120000, 0x138000, 0x0, 0x0, 0x4b000, 0x14000, 0x78000, 0x82000, 0x0, 0x0, 0x3000, 0x80, 0x3100, 0x3180, 0x0, 0x0, 0x200, 0x0
    .long 0x2800, 0x2c00, 0x0, 0x400, 0x800, 0xc00, 0x1000, 0x1400, 0x1800, 0x1c00, 0x2000, 0x2400, 0xb4000, 0x30000, 0x120000, 0x138000, 0x0, 0x0, 0x4b000, 0x14000, 0x78000, 0x82000, 0x0, 0x0, 0x3000, 0x80, 0x3100, 0x3180, 0x0, 0x0, 0x480, 0x0
    .long 0x800, 0xc00, 0x1000, 0x1400, 0x1800, 0x1c00, 0x2000, 0x2400, 0x2800, 0x2c00, 0x0, 0x400, 0x27c000, 0x210000, 0x240000, 0x2f4000, 0x0, 0x0, 0x109000, 0xdc000, 0xf0000, 0x13b000, 0x0, 0x0, 0xc000, 0x9080, 0x9100, 0xc100, 0x0, 0x0, 0x200, 0x0
    .long 0x800, 0xc00, 0x1000, 0x1400, 0x1800, 0x1c00, 0x2000, 0x2400, 0x2800, 0x2c00, 0x0, 0x400, 0x27c000, 0x210000, 0x240000, 0x2f4000, 0x0, 0x0, 0x109000, 0xdc000, 0xf0000, 0x13b000, 0x0, 0x0, 0xc000, 0x9080, 0x9100, 0xc100, 0x0, 0x0, 0x480, 0x0
    .long 0x1800, 0x1c00, 0x2000, 0x2400, 0x2800, 0x2c00, 0x0, 0x400, 0x800, 0xc00, 0x1000, 0x1400, 0x3b4000, 0x330000, 0x420000, 0x438000, 0x0, 0x0, 0x18b000, 0x154000, 0x1b8000, 0x1c2000, 0x0, 0x0, 0x12000, 0xf080, 0x12100, 0x12180, 0x0, 0x0, 0x200, 0x0
    .long 0x1800, 0x1c00, 0x2000, 0x2400, 0x2800, 0x2c00, 0x0, 0x400, 0x800, 0xc00, 0x1000, 0x1400, 0x3b4000, 0x330000, 0x420000, 0x438000, 0x0, 0x0, 0x18b000, 0x154000, 0x1b8000, 0x1c2000, 0x0, 0x0, 0x12000, 0xf080, 0x12100, 0x12180, 0x0, 0x0, 0x480, 0x0
    .long 0x2800, 0x2c00, 0x0, 0x400, 0x800, 0xc00, 0x1000, 0x1400, 0x1800, 0x1c00, 0x2000, 0x2400, 0x57c000, 0x510000, 0x540000, 0x5f4000, 0x0, 0x0, 0x249000, 0x21c000, 0x230000, 0x27b000, 0x0, 0x0, 0x1b000, 0x18080, 0x18100, 0x1b100, 0x0, 0x0, 0x200, 0x0
    .long 0x2800, 0x2c00, 0x0, 0x400, 0x800, 0xc00, 0x1000, 0x1400, 0x1800, 0x1c00, 0x2000, 0x2400, 0x57c000, 0x510000, 0x540000, 0x5f4000, 0x0, 0x0, 0x249000, 0x21c000, 0x230000, 0x27b000, 0x0, 0x0, 0x1b000, 0x18080, 0x18100, 0x1b100, 0x0, 0x0, 0x480, 0x0
    .long 0x0, 0x400, 0x800, 0xc00, 0x1000, 0x1400, 0x1800, 0x1c00, 0x2000, 0x2400, 0x2800, 0x2c00, 0x0, 0xb4000, 0x174000, 0xd8000, 0x120000, 0x12c000, 0x0, 0x4b000, 0x9b000, 0x5a000, 0x78000, 0x7d000, 0x0, 0x3000, 0x6080, 0x3080, 0x3100, 0x3180, 0x0, 0x0
    .long 0x0, 0x400, 0x800, 0xc00, 0x1000, 0x1400, 0x1800, 0x1c00, 0x2000, 0x2400, 0x2800, 0x2c00, 0x0, 0xb4000, 0x174000, 0xd8000, 0x120000, 0x12c000, 0x0, 0x4b000, 0x9b000, 0x5a000, 0x78000, 0x7d000, 0x0, 0x3000, 0x6080, 0x3080, 0x3100, 0x3180, 0x280, 0x0
    .long 0x1000, 0x1400, 0x1800, 0x1c00, 0x2000, 0x2400, 0x2800, 0x2c00, 0x0, 0x400, 0x800, 0xc00, 0x1c8000, 0x27c000, 0x204000, 0x2b8000, 0x240000, 0x2e8000, 0xbe000, 0x109000, 0xd7000, 0x122000, 0xf0000, 0x136000, 0x9000, 0xc000, 0x9080, 0xc080, 0x9100, 0xc100, 0x0, 0x0
    .long 0x1000, 0x1400, 0x1800, 0x1c00, 0x2000, 0x2400, 0x2800, 0x2c00, 0x0, 0x400, 0x800, 0xc00, 0x1c8000, 0x27c000, 0x204000, 0x2b8000, 0x240000, 0x2e8000, 0xbe000, 0x109000, 0xd7000, 0x122000, 0xf0000, 0x136000, 0x9000, 0xc000, 0x9080, 0xc080, 0x9100, 0xc100, 0x280, 0x0
    .long 0x2000, 0x2400, 0x2800, 0x2c00, 0x0, 0x400, 0x800, 0xc00, 0x1000, 0x1400, 0x1800, 0x1c00, 0x300000, 0x3b4000, 0x474000, 0x3d8000, 0x420000, 0x42c000, 0x140000, 0x18b000, 0x1db000, 0x19a000, 0x1b8000, 0x1bd000, 0xf000, 0x12000, 0x15080, 0x12080, 0x12100, 0x12180, 0x0, 0x0
    .long 0x2000, 0x2400, 0x2800, 0x2c00, 0x0, 0x400, 0x800, 0xc00, 0x1000, 0x1400, 0x1800, 0x1c00, 0x300000, 0x3b4000, 0x474000, 0x3d8000, 0x420000, 0x42c000, 0x140000, 0x18b000, 0x1db000, 0x19a000, 0x1b8000, 0x1bd000, 0xf000, 0x12000, 0x15080, 0x12080, 0x12100, 0x12180, 0x280, 0x0
    .long 0x0, 0x400, 0x800, 0xc00, 0x1000, 0x1400, 0x1800, 0x1c00, 0x2000, 0x2400, 0x2800, 0x2c00, 0x4c8000, 0x57c000, 0x504000, 0x5b8000, 0x540000, 0x5e8000, 0x1fe000, 0x249000, 0x217000, 0x262000, 0x230000, 0x276000, 0x18000, 0x1b000, 0x18080, 0x1b080, 0x18100, 0x1b100, 0x0, 0x0
    .long 0x0, 0x400, 0x800, 0xc00, 0x1000, 0x1400, 0x1800, 0x1c00, 0x2000, 0x2400, 0x2800, 0x2c00, 0x4c8000, 0x57c000, 0x504000, 0x5b8000, 0x540000, 0x5e8000, 0x1fe000, 0x249000, 0x217000, 0x262000, 0x230000, 0x276000, 0x18000, 0x1b000, 0x18080, 0x1b080, 0x18100, 0x1b100, 0x280, 0x0
    .long 0x800, 0xc00, 0x1000, 0x1400, 0x1800, 0x1c00, 0x2000, 0x2400, 0x2800, 0x2c00, 0x0, 0x400, 0x0, 0xb4000, 0x174000, 0xd8000, 0x120000, 0x12c000, 0x0, 0x4b000, 0x9b000, 0x5a000, 0x78000, 0x7d000, 0x0, 0x3000, 0x6080, 0x3080, 0x3100, 0x3180, 0x80, 0x0
    .long 0x800, 0xc00, 0x1000, 0x1400, 0x1800, 0x1c00, 0x2000, 0x2400, 0x2800, 0x2c00, 0x0, 0x400, 0x0, 0xb4000, 0x174000, 0xd8000, 0x120000, 0x12c000, 0x0, 0x4b000, 0x9b000, 0x5a000, 0x78000, 0x7d000, 0x0, 0x3000, 0x6080, 0x3080, 0x3100, 0x3180, 0x300, 0x0
    .long 0x1800, 0x1c00, 0x2000, 0x2400, 0x2800, 0x2c00, 0x0, 0x400, 0x800, 0xc00, 0x1000, 0x1400, 0x1c8000, 0x27c000, 0x204000, 0x2b8000, 0x240000, 0x2e8000, 0xbe000, 0x109000, 0xd7000, 0x122000, 0xf0000, 0x136000, 0x9000, 0xc000, 0x9080, 0xc080, 0x9100, 0xc100, 0x80, 0x0
    .long 0x1800, 0x1c00, 0x2000, 0x2400, 0x2800, 0x2c00, 0x0, 0x400, 0x800, 0xc00, 0x1000, 0x1400, 0x1c8000, 0x27c000, 0x204000, 0x2b8000, 0x240000, 0x2e8000, 0xbe000, 0x109000, 0xd7000, 0x122000, 0xf0000, 0x136000, 0x9000, 0xc000, 0x9080, 0xc080, 0x9100, 0xc100, 0x300, 0x0
    .long 0x2800, 0x2c00, 0x0, 0x400, 0x800, 0xc00, 0x1000, 0x1400, 0x1800, 0x1c00, 0x2000, 0x2400, 0x300000, 0x3b4000, 0x474000, 0x3d8000, 0x420000, 0x42c000, 0x140000, 0x18b000, 0x1db000, 0x19a000, 0x1b8000, 0x1bd000, 0xf000, 0x12000, 0x15080, 0x12080, 0x12100, 0x12180, 0x80, 0x0
    .long 0x2800, 0x2c00, 0x0, 0x400, 0x800, 0xc00, 0x1000, 0x1400, 0x1800, 0x1c00, 0x2000, 0x2400, 0x300000, 0x3b4000, 0x474000, 0x3d8000, 0x420000, 0x42c000, 0x140000, 0x18b000, 0x1db000, 0x19a000, 0x1b8000, 0x1bd000, 0xf000, 0x12000, 0x15080, 0x12080, 0x12100, 0x12180, 0x300, 0x0
    .long 0x800, 0xc00, 0x1000, 0x1400, 0x1800, 0x1c00, 0x2000, 0x2400, 0x2800, 0x2c00, 0x0, 0x400, 0x4c8000, 0x57c000, 0x504000, 0x5b8000, 0x540000, 0x5e8000, 0x1fe000, 0x249000, 0x217000, 0x262000, 0x230000, 0x276000, 0x18000, 0x1b000, 0x18080, 0x1b080, 0x18100, 0x1b100, 0x80, 0x0
    .long 0x800, 0xc00, 0x1000, 0x1400, 0x1800, 0x1c00, 0x2000, 0x2400, 0x2800, 0x2c00, 0x0, 0x400, 0x4c8000, 0x57c000, 0x504000, 0x5b8000, 0x540000, 0x5e8000, 0x1fe000, 0x249000, 0x217000, 0x262000, 0x230000, 0x276000, 0x18000, 0x1b000, 0x18080, 0x1b080, 0x18100, 0x1b100, 0x300, 0x0
    .long 0x1400, 0x1800, 0x1c00, 0x2000, 0x2400, 0x2800, 0x2c00, 0x0, 0x400, 0x800, 0xc00, 0x1000, 0x0, 0xb4000, 0x174000, 0xd8000, 0x120000, 0x12c000, 0x0, 0x4b000, 0x9b000, 0x5a000, 0x78000, 0x7d000, 0x0, 0x3000, 0x6080, 0x3080, 0x3100, 0x3180, 0x100, 0x0
    .long 0x1400, 0x1800, 0x1c00, 0x2000, 0x2400, 0x2800, 0x2c00, 0x0, 0x400, 0x800, 0xc00, 0x1000, 0x0, 0xb4000, 0x174000, 0xd8000, 0x120000, 0x12c000, 0x0, 0x4b000, 0x9b000, 0x5a000, 0x78000, 0x7d000, 0x0, 0x3000, 0x6080, 0x3080, 0x3100, 0x3180, 0x380, 0x0
    .long 0x2400, 0x2800, 0x2c00, 0x0, 0x400, 0x800, 0xc00, 0x1000, 0x1400, 0x1800, 0x1c00, 0x2000, 0x1c8000, 0x27c000, 0x204000, 0x2b8000, 0x240000, 0x2e8000, 0xbe000, 0x109000, 0xd7000, 0x122000, 0xf0000, 0x136000, 0x9000, 0xc000, 0x9080, 0xc080, 0x9100, 0xc100, 0x100, 0x0
    .long 0x2400, 0x2800, 0x2c00, 0x0, 0x400, 0x800, 0xc00, 0x1000, 0x1400, 0x1800, 0x1c00, 0x2000, 0x1c8000, 0x27c000, 0x204000, 0x2b8000, 0x240000, 0x2e8000, 0xbe000, 0x109000, 0xd7000, 0x122000, 0xf0000, 0x136000, 0x9000, 0xc000, 0x9080, 0xc080, 0x9100, 0xc100, 0x380, 0x0
    .long 0x400, 0x800, 0xc00, 0x1000, 0x1400, 0x1800, 0x1c00, 0x2000, 0x2400, 0x2800, 0x2c00, 0x0, 0x300000, 0x3b4000, 0x474000, 0x3d8000, 0x420000, 0x42c000, 0x140000, 0x18b000, 0x1db000, 0x19a000, 0x1b8000, 0x1bd000, 0xf000, 0x12000, 0x15080, 0x12080, 0x12100, 0x12180, 0x100, 0x0
    .long 0x400, 0x800, 0xc00, 0x1000, 0x1400, 0x1800, 0x1c00, 0x2000, 0x2400, 0x2800, 0x2c00, 0x0, 0x300000, 0x3b4000, 0x474000, 0x3d8000, 0x420000, 0x42c000, 0x140000, 0x18b000, 0x1db000, 0x19a000, 0x1b8000, 0x1bd000, 0xf000, 0x12000, 0x15080, 0x12080, 0x12100, 0x12180, 0x380, 0x0
    .long 0x1400, 0x1800, 0x1c00, 0x2000, 0x2400, 0x2800, 0x2c00, 0x0, 0x400, 0x800, 0xc00, 0x1000, 0x4c8000, 0x57c000, 0x504000, 0x5b8000, 0x540000, 0x5e8000, 0x1fe000, 0x249000, 0x217000, 0x262000, 0x230000, 0x276000, 0x18000, 0x1b000, 0x18080, 0x1b080, 0x18100, 0x1b100, 0x100, 0x0
    .long 0x1400, 0x1800, 0x1c00, 0x2000, 0x2400, 0x2800, 0x2c00, 0x0, 0x400, 0x800, 0xc00, 0x1000, 0x4c8000, 0x57c000, 0x504000, 0x5b8000, 0x540000, 0x5e8000, 0x1fe000, 0x249000, 0x217000, 0x262000, 0x230000, 0x276000, 0x18000, 0x1b000, 0x18080, 0x1b080, 0x18100, 0x1b100, 0x380, 0x0
    .long 0x1c00, 0x2000, 0x2400, 0x2800, 0x2c00, 0x0, 0x400, 0x800, 0xc00, 0x1000, 0x1400, 0x1800, 0xc000, 0xc0000, 0x30000, 0xe4000, 0x60000, 0x138000, 0x5000, 0x50000, 0x14000, 0x5f000, 0x28000, 0x82000, 0x0, 0x3000, 0x80, 0x3080, 0x100, 0x3180, 0x100, 0x0
    .long 0x1c00, 0x2000, 0x2400, 0x2800, 0x2c00, 0x0, 0x400, 0x800, 0xc00, 0x1000, 0x1400, 0x1800, 0xc000, 0xc0000, 0x30000, 0xe4000, 0x60000, 0x138000, 0x5000, 0x50000, 0x14000, 0x5f000, 0x28000, 0x82000, 0x0, 0x3000, 0x80, 0x3080, 0x100, 0x3180, 0x380, 0x0
    .long 0x2c00, 0x0, 0x400, 0x800, 0xc00, 0x1000, 0x1400, 0x1800, 0x1c00, 0x2000, 0x2400, 0x2800, 0x1d4000, 0x288000, 0x210000, 0x1a4000, 0x24c000, 0x2f4000, 0xc3000, 0x10e000, 0xdc000, 0xaf000, 0xf5000, 0x13b000, 0x9000, 0xc000, 0x9080, 0x6100, 0x9100, 0xc100, 0x100, 0x0
    .long 0x2c00, 0x0, 0x400, 0x800, 0xc00, 0x1000, 0x1400, 0x1800, 0x1c00, 0x2000, 0x2400, 0x2800, 0x1d4000, 0x288000, 0x210000, 0x1a4000, 0x24c000, 0x2f4000, 0xc3000, 0x10e000, 0xdc000, 0xaf000, 0xf5000, 0x13b000, 0x9000, 0xc000, 0x9080, 0x6100, 0x9100, 0xc100, 0x380, 0x0
    .long 0xc00, 0x1000, 0x1400, 0x1800, 0x1c00, 0x2000, 0x2400, 0x2800, 0x2c00, 0x0, 0x400, 0x800, 0x30c000, 0x3c0000, 0x330000, 0x3e4000, 0x360000, 0x438000, 0x145000, 0x190000, 0x154000, 0x19f000, 0x168000, 0x1c2000, 0xf000, 0x12000, 0xf080, 0x12080, 0xf100, 0x12180, 0x100, 0x0
    .long 0xc00, 0x1000, 0x1400, 0x1800, 0x1c00, 0x2000, 0x2400, 0x2800, 0x2c00, 0x0, 0x400, 0x800, 0x30c000, 0x3c0000, 0x330000, 0x3e4000, 0x360000, 0x438000, 0x145000, 0x190000, 0x154000, 0x19f000, 0x168000, 0x1c2000, 0xf000, 0x12000, 0xf080, 0x12080, 0xf100, 0x12180, 0x380, 0x0
    .long 0x1c00, 0x2000, 0x2400, 0x2800, 0x2c00, 0x0, 0x400, 0x800, 0xc00, 0x1000, 0x1400, 0x1800, 0x4d4000, 0x588000, 0x510000, 0x4a4000, 0x54c000, 0x5f4000, 0x203000, 0x24e000, 0x21c000, 0x1ef000, 0x235000, 0x27b000, 0x18000, 0x1b000, 0x18080, 0x15100, 0x18100, 0x1b100, 0x100, 0x0
    .long 0x1c00, 0x2000, 0x2400, 0x2800, 0x2c00, 0x0, 0x400, 0x800, 0xc00, 0x1000, 0x1400, 0x1800, 0x4d4000, 0x588000, 0x510000, 0x4a4000, 0x54c000, 0x5f4000, 0x203000, 0x24e000, 0x21c000, 0x1ef000, 0x235000, 0x27b000, 0x18000, 0x1b000, 0x18080, 0x15100, 0x18100, 0x1b100, 0x380, 0x0
    .long 0x800, 0xc00, 0x1000, 0x1400, 0x1800, 0x1c00, 0x2000, 0x2400, 0x2800, 0x2c00, 0x0, 0x400, 0xc000, 0xc0000, 0x30000, 0xe4000, 0x60000, 0x138000, 0x5000, 0x50000, 0x14000, 0x5f000, 0x28000, 0x82000, 0x0, 0x3000, 0x80, 0x3080, 0x100, 0x3180, 0x0, 0x0
    .long 0x800, 0xc00, 0x1000, 0x1400, 0x1800, 0x1c00, 0x2000, 0x2400, 0x2800, 0x2c00, 0x0, 0x400, 0xc000, 0xc0000, 0x30000, 0xe4000, 0x60000, 0x138000, 0x5000, 0x50000, 0x14000, 0x5f000, 0x28000, 0x82000, 0x0, 0x3000, 0x80, 0x3080, 0x100, 0x3180, 0x280, 0x0
    .long 0x1800, 0x1c00, 0x2000, 0x2400, 0x2800, 0x2c00, 0x0, 0x400, 0x800, 0xc00, 0x1000, 0x1400, 0x1d4000, 0x288000, 0x210000, 0x1a4000, 0x24c000, 0x2f4000, 0xc3000, 0x10e000, 0xdc000, 0xaf000, 0xf5000, 0x13b000, 0x9000, 0xc000, 0x9080, 0x6100, 0x9100, 0xc100, 0x0, 0x0
    .long 0x1800, 0x1c00, 0x2000, 0x2400, 0x2800, 0x2c00, 0x0, 0x400, 0x800, 0xc00, 0x1000, 0x1400, 0x1d4000, 0x288000, 0x210000, 0x1a4000, 0x24c000, 0x2f4000, 0xc3000, 0x10e000, 0xdc000, 0xaf000, 0xf5000, 0x13b000, 0x9000, 0xc000, 0x9080, 0x6100, 0x9100, 0xc100, 0x280, 0x0
    .long 0x2800, 0x2c00, 0x0, 0x400, 0x800, 0xc00, 0x1000, 0x1400, 0x1800, 0x1c00, 0x2000, 0x2400, 0x30c000, 0x3c0000, 0x330000, 0x3e4000, 0x360000, 0x438000, 0x145000, 0x190000, 0x154000, 0x19f000, 0x168000, 0x1c2000, 0xf000, 0x12000, 0xf080, 0x12080, 0xf100, 0x12180, 0x0, 0x0
    .long 0x2800, 0x2c00, 0x0, 0x400, 0x800, 0xc00, 0x1000, 0x1400, 0x1800, 0x1c00, 0x2000, 0x2400, 0x30c000, 0x3c0000, 0x330000, 0x3e4000, 0x360000, 0x438000, 0x145000, 0x190000, 0x154000, 0x19f000, 0x168000, 0x1c2000, 0xf000, 0x12000, 0xf080, 0x12080, 0xf100, 0x12180, 0x280, 0x0
    .long 0x800, 0xc00, 0x1000, 0x1400, 0x1800, 0x1c00, 0x2000, 0x2400, 0x2800, 0x2c00, 0x0, 0x400, 0x4d4000, 0x588000, 0x510000, 0x4a4000, 0x54c000, 0x5f4000, 0x203000, 0x24e000, 0x21c000, 0x1ef000, 0x235000, 0x27b000, 0x18000, 0x1b000, 0x18080, 0x15100, 0x18100, 0x1b100, 0x0, 0x0
    .long 0x800, 0xc00, 0x1000, 0x1400, 0x1800, 0x1c00, 0x2000, 0x2400, 0x2800, 0x2c00, 0x0, 0x400, 0x4d4000, 0x588000, 0x510000, 0x4a4000, 0x54c000, 0x5f4000, 0x203000, 0x24e000, 0x21c000, 0x1ef000, 0x235000, 0x27b000, 0x18000, 0x1b000, 0x18080, 0x15100, 0x18100, 0x1b100, 0x280, 0x0
    .long 0x1000, 0x1400, 0x1800, 0x1c00, 0x2000, 0x2400, 0x2800, 0x2c00, 0x0, 0x400, 0x800, 0xc00, 0xc000, 0xc0000, 0x30000, 0xe4000, 0x60000, 0x138000, 0x5000, 0x50000, 0x14000, 0x5f000, 0x28000, 0x82000, 0x0, 0x3000, 0x80, 0x3080, 0x100, 0x3180, 0x80, 0x0
    .long 0x1000, 0x1400, 0x1800, 0x1c00, 0x2000, 0x2400, 0x2800, 0x2c00, 0x0, 0x400, 0x800, 0xc00, 0xc000, 0xc0000, 0x30000, 0xe4000, 0x60000, 0x138000, 0x5000, 0x50000, 0x14000, 0x5f000, 0x28000, 0x82000, 0x0, 0x3000, 0x80, 0x3080, 0x100, 0x3180, 0x300, 0x0
    .long 0x2000, 0x2400, 0x2800, 0x2c00, 0x0, 0x400, 0x800, 0xc00, 0x1000, 0x1400, 0x1800, 0x1c00, 0x1d4000, 0x288000, 0x210000, 0x1a4000, 0x24c000, 0x2f4000, 0xc3000, 0x10e000, 0xdc000, 0xaf000, 0xf5000, 0x13b000, 0x9000, 0xc000, 0x9080, 0x6100, 0x9100, 0xc100, 0x80, 0x0
    .long 0x2000, 0x2400, 0x2800, 0x2c00, 0x0, 0x400, 0x800, 0xc00, 0x1000, 0x1400, 0x1800, 0x1c00, 0x1d4000, 0x288000, 0x210000, 0x1a4000, 0x24c000, 0x2f4000, 0xc3000, 0x10e000, 0xdc000, 0xaf000, 0xf5000, 0x13b000, 0x9000, 0xc000, 0x9080, 0x6100, 0x9100, 0xc100, 0x300, 0x0
    .long 0x0, 0x400, 0x800, 0xc00, 0x1000, 0x1400, 0x1800, 0x1c00, 0x2000, 0x2400, 0x2800, 0x2c00, 0x30c000, 0x3c0000, 0x330000, 0x3e4000, 0x360000, 0x438000, 0x145000, 0x190000, 0x154000, 0x19f000, 0x168000, 0x1c2000, 0xf000, 0x12000, 0xf080, 0x12080, 0xf100, 0x12180, 0x80, 0x0
    .long 0x0, 0x400, 0x800, 0xc00, 0x1000, 0x1400, 0x1800, 0x1c00, 0x2000, 0x2400, 0x2800, 0x2c00, 0x30c000, 0x3c0000, 0x330000, 0x3e4000, 0x360000, 0x438000, 0x145000, 0x190000, 0x154000, 0x19f000, 0x168000, 0x1c2000, 0xf000, 0x12000, 0xf080, 0x12080, 0xf100, 0x12180, 0x300, 0x0
    .long 0x1000, 0x1400, 0x1800, 0x1c00, 0x2000, 0x2400, 0x2800, 0x2c00, 0x0, 0x400, 0x800, 0xc00, 0x4d4000, 0x588000, 0x510000, 0x4a4000, 0x54c000, 0x5f4000, 0x203000, 0x24e000, 0x21c000, 0x1ef000, 0x235000, 0x27b000, 0x18000, 0x1b000, 0x18080, 0x15100, 0x18100, 0x1b100, 0x80, 0x0
    .long 0x1000, 0x1400, 0x1800, 0x1c00, 0x2000, 0x2400, 0x2800, 0x2c00, 0x0, 0x400, 0x800, 0xc00, 0x4d4000, 0x588000, 0x510000, 0x4a4000, 0x54c000, 0x5f4000, 0x203000, 0x24e000, 0x21c000, 0x1ef000, 0x235000, 0x27b000, 0x18000, 0x1b000, 0x18080, 0x15100, 0x18100, 0x1b100, 0x300, 0x0
    .long 0x2000, 0x2400, 0x2800, 0x2c00, 0x0, 0x400, 0x800, 0xc00, 0x1000, 0x1400, 0x1800, 0x1c00, 0x24000, 0x150000, 0x48000, 0xfc000, 0x78000, 0x0, 0xf000, 0x8c000, 0x1e000, 0x69000, 0x32000, 0x0, 0x0, 0x6000, 0x80, 0x3080, 0x100, 0x0, 0x80, 0x0
    .long 0x2000, 0x2400, 0x2800, 0x2c00, 0x0, 0x400, 0x800, 0xc00, 0x1000, 0x1400, 0x1800, 0x1c00, 0x24000, 0x150000, 0x48000, 0xfc000, 0x78000, 0x0, 0xf000, 0x8c000, 0x1e000, 0x69000, 0x32000, 0x0, 0x0, 0x6000, 0x80, 0x3080, 0x100, 0x0, 0x300, 0x0
    .long 0x0, 0x400, 0x800, 0xc00, 0x1000, 0x1400, 0x1800, 0x1c00, 0x2000, 0x2400, 0x2800, 0x2c00, 0x1ec000, 0x18c000, 0x294000, 0x1bc000, 0x2c4000, 0x0, 0xcd000, 0xa5000, 0x113000, 0xb9000, 0x127000, 0x0, 0x9000, 0x6080, 0xc080, 0x6100, 0xc100, 0x0, 0x80, 0x0
    .long 0x0, 0x400, 0x800, 0xc00, 0x1000, 0x1400, 0x1800, 0x1c00, 0x2000, 0x2400, 0x2800, 0x2c00, 0x1ec000, 0x18c000, 0x294000, 0x1bc000, 0x2c4000, 0x0, 0xcd000, 0xa5000, 0x113000, 0xb9000, 0x127000, 0x0, 0x9000, 0x6080, 0xc080, 0x6100, 0xc100, 0x0, 0x300, 0x0
    .long 0x1000, 0x1400, 0x1800, 0x1c00, 0x2000, 0x2400, 0x2800, 0x2c00, 0x0, 0x400, 0x800, 0xc00, 0x324000, 0x450000, 0x348000, 0x3fc000, 0x378000, 0x0, 0x14f000, 0x1cc000, 0x15e000, 0x1a9000, 0x172000, 0x0, 0xf000, 0x15000, 0xf080, 0x12080, 0xf100, 0x0, 0x80, 0x0
    .long 0x1000, 0x1400, 0x1800, 0x1c00, 0x2000, 0x2400, 0x2800, 0x2c00, 0x0, 0x400, 0x800, 0xc00, 0x324000, 0x450000, 0x348000, 0x3fc000, 0x378000, 0x0, 0x14f000, 0x1cc000, 0x15e000, 0x1a9000, 0x172000, 0x0, 0xf000, 0x15000, 0xf080, 0x12080, 0xf100, 0x0, 0x300, 0x0
    .long 0x2000, 0x2400, 0x2800, 0x2c00, 0x0, 0x400, 0x800, 0xc00, 0x1000, 0x1400, 0x1800, 0x1c00, 0x4ec000, 0x48c000, 0x594000, 0x4bc000, 0x5c4000, 0x0, 0x20d000, 0x1e5000, 0x253000, 0x1f9000, 0x267000, 0x0, 0x18000, 0x15080, 0x1b080, 0x15100, 0x1b100, 0x0, 0x80, 0x0
    .long 0x2000, 0x2400, 0x2800, 0x2c00, 0x0, 0x400, 0x800, 0xc00, 0x1000, 0x1400, 0x1800, 0x1c00, 0x4ec000, 0x48c000, 0x594000, 0x4bc000, 0x5c4000, 0x0, 0x20d000, 0x1e5000, 0x253000, 0x1f9000, 0x267000, 0x0, 0x18000, 0x15080, 0x1b080, 0x15100, 0x1b100, 0x0, 0x300, 0x0
    .long 0x2c00, 0x0, 0x400, 0x800, 0xc00, 0x1000, 0x1400, 0x1800, 0x1c00, 0x2000, 0x2400, 0x2800, 0x24000, 0x150000, 0x48000, 0xfc000, 0x78000, 0x0, 0xf000, 0x8c000, 0x1e000, 0x69000, 0x32000, 0x0, 0x0, 0x6000, 0x80, 0x3080, 0x100, 0x0, 0x100, 0x0
    .long 0x2c00, 0x0, 0x400, 0x800, 0xc00, 0x1000, 0x1400, 0x1800, 0x1c00, 0x2000, 0x2400, 0x2800, 0x24000, 0x150000, 0x48000, 0xfc000, 0x78000, 0x0, 0xf000, 0x8c000, 0x1e000, 0x69000, 0x32000, 0x0, 0x0, 0x6000, 0x80, 0x3080, 0x100, 0x0, 0x380, 0x0
    .long 0xc00, 0x1000, 0x1400, 0x1800, 0x1c00, 0x2000, 0x2400, 0x2800, 0x2c00, 0x0, 0x400, 0x800, 0x1ec000, 0x18c000, 0x294000, 0x1bc000, 0x2c4000, 0x0, 0xcd000, 0xa5000, 0x113000, 0xb9000, 0x127000, 0x0, 0x9000, 0x6080, 0xc080, 0x6100, 0xc100, 0x0, 0x100, 0x0
    .long 0xc00, 0x1000, 0x1400, 0x1800, 0x1c00, 0x2000, 0x2400, 0x2800, 0x2c00, 0x0, 0x400, 0x800, 0x1ec000, 0x18c000, 0x294000, 0x1bc000, 0x2c4000, 0x0, 0xcd000, 0xa5000, 0x113000, 0xb9000, 0x127000, 0x0, 0x9000, 0x6080, 0xc080, 0x6100, 0xc100, 0x0, 0x380, 0x0
    .long 0x1c00, 0x2000, 0x2400, 0x2800, 0x2c00, 0x0, 0x400, 0x800, 0xc00, 0x1000, 0x1400, 0x1800, 0x324000, 0x450000, 0x348000, 0x3fc000, 0x378000, 0x0, 0x14f000, 0x1cc000, 0x15e000, 0x1a9000, 0x172000, 0x0, 0xf000, 0x15000, 0xf080, 0x12080, 0xf100, 0x0, 0x100, 0x0
    .long 0x1c00, 0x2000, 0x2400, 0x2800, 0x2c00, 0x0, 0x400, 0x800, 0xc00, 0x1000, 0x1400, 0x1800, 0x324000, 0x450000, 0x348000, 0x3fc000, 0x378000, 0x0, 0x14f000, 0x1cc000, 0x15e000, 0x1a9000, 0x172000, 0x0, 0xf000, 0x15000, 0xf080, 0x12080, 0xf100, 0x0, 0x380, 0x0
    .long 0x2c00, 0x0, 0x400, 0x800, 0xc00, 0x1000, 0x1400, 0x1800, 0x1c00, 0x2000, 0x2400, 0x2800, 0x4ec000, 0x48c000, 0x594000, 0x4bc000, 0x5c4000, 0x0, 0x20d000, 0x1e5000, 0x253000, 0x1f9000, 0x267000, 0x0, 0x18000, 0x15080, 0x1b080, 0x15100, 0x1b100, 0x0, 0x100, 0x0
    .long 0x2c00, 0x0, 0x400, 0x800, 0xc00, 0x1000, 0x1400, 0x1800, 0x1c00, 0x2000, 0x2400, 0x2800, 0x4ec000, 0x48c000, 0x594000, 0x4bc000, 0x5c4000, 0x0, 0x20d000, 0x1e5000, 0x253000, 0x1f9000, 0x267000, 0x0, 0x18000, 0x15080, 0x1b080, 0x15100, 0x1b100, 0x0, 0x380, 0x0
    .long 0x400, 0x800, 0xc00, 0x1000, 0x1400, 0x1800, 0x1c00, 0x2000, 0x2400, 0x2800, 0x2c00, 0x0, 0x24000, 0x150000, 0x48000, 0xfc000, 0x78000, 0x0, 0xf000, 0x8c000, 0x1e000, 0x69000, 0x32000, 0x0, 0x0, 0x6000, 0x80, 0x3080, 0x100, 0x0, 0x180, 0x0
    .long 0x400, 0x800, 0xc00, 0x1000, 0x1400, 0x1800, 0x1c00, 0x2000, 0x2400, 0x2800, 0x2c00, 0x0, 0x24000, 0x150000, 0x48000, 0xfc000, 0x78000, 0x0, 0xf000, 0x8c000, 0x1e000, 0x69000, 0x32000, 0x0, 0x0, 0x6000, 0x80, 0x3080, 0x100, 0x0, 0x400, 0x0
    .long 0x1400, 0x1800, 0x1c00, 0x2000, 0x2400, 0x2800, 0x2c00, 0x0, 0x400, 0x800, 0xc00, 0x1000, 0x1ec000, 0x18c000, 0x294000, 0x1bc000, 0x2c4000, 0x0, 0xcd000, 0xa5000, 0x113000, 0xb9000, 0x127000, 0x0, 0x9000, 0x6080, 0xc080, 0x6100, 0xc100, 0x0, 0x180, 0x0
    .long 0x1400, 0x1800, 0x1c00, 0x2000, 0x2400, 0x2800, 0x2c00, 0x0, 0x400, 0x800, 0xc00, 0x1000, 0x1ec000, 0x18c000, 0x294000, 0x1bc000, 0x2c4000, 0x0, 0xcd000, 0xa5000, 0x113000, 0xb9000, 0x127000, 0x0, 0x9000, 0x6080, 0xc080, 0x6100, 0xc100, 0x0, 0x400, 0x0
    .long 0x2400, 0x2800, 0x2c00, 0x0, 0x400, 0x800, 0xc00, 0x1000, 0x1400, 0x1800, 0x1c00, 0x2000, 0x324000, 0x450000, 0x348000, 0x3fc000, 0x378000, 0x0, 0x14f000, 0x1cc000, 0x15e000, 0x1a9000, 0x172000, 0x0, 0xf000, 0x15000, 0xf080, 0x12080, 0xf100, 0x0, 0x180, 0x0
    .long 0x2400, 0x2800, 0x2c00, 0x0, 0x400, 0x800, 0xc00, 0x1000, 0x1400, 0x1800, 0x1c00, 0x2000, 0x324000, 0x450000, 0x348000, 0x3fc000, 0x378000, 0x0, 0x14f000, 0x1cc000, 0x15e000, 0x1a9000, 0x172000, 0x0, 0xf000, 0x15000, 0xf080, 0x12080, 0xf100, 0x0, 0x400, 0x0
    .long 0x400, 0x800, 0xc00, 0x1000, 0x1400, 0x1800, 0x1c00, 0x2000, 0x2400, 0x2800, 0x2c00, 0x0, 0x4ec000, 0x48c000, 0x594000, 0x4bc000, 0x5c4000, 0x0, 0x20d000, 0x1e5000, 0x253000, 0x1f9000, 0x267000, 0x0, 0x18000, 0x15080, 0x1b080, 0x15100, 0x1b100, 0x0, 0x180, 0x0
    .long 0x400, 0x800, 0xc00, 0x1000, 0x1400, 0x1800, 0x1c00, 0x2000, 0x2400, 0x2800, 0x2c00, 0x0, 0x4ec000, 0x48c000, 0x594000, 0x4bc000, 0x5c4000, 0x0, 0x20d000, 0x1e5000, 0x253000, 0x1f9000, 0x267000, 0x0, 0x18000, 0x15080, 0x1b080, 0x15100, 0x1b100, 0x0, 0x400, 0x0
    .long 0x1000, 0x1400, 0x1800, 0x1c00, 0x2000, 0x2400, 0x2800, 0x2c00, 0x0, 0x400, 0x800, 0xc00, 0x24000, 0x150000, 0x48000, 0xfc000, 0x78000, 0x0, 0xf000, 0x8c000, 0x1e000, 0x69000, 0x32000, 0x0, 0x0, 0x6000, 0x80, 0x3080, 0x100, 0x0, 0x200, 0x0
    .long 0x1000, 0x1400, 0x1800, 0x1c00, 0x2000, 0x2400, 0x2800, 0x2c00, 0x0, 0x400, 0x800, 0xc00, 0x24000, 0x150000, 0x48000, 0xfc000, 0x78000, 0x0, 0xf000, 0x8c000, 0x1e000, 0x69000, 0x32000, 0x0, 0x0, 0x6000, 0x80, 0x3080, 0x100, 0x0, 0x480, 0x0
    .long 0x2000, 0x2400, 0x2800, 0x2c00, 0x0, 0x400, 0x800, 0xc00, 0x1000, 0x1400, 0x1800, 0x1c00, 0x1ec000, 0x18c000, 0x294000, 0x1bc000, 0x2c4000, 0x0, 0xcd000, 0xa5000, 0x113000, 0xb9000, 0x127000, 0x0, 0x9000, 0x6080, 0xc080, 0x6100, 0xc100, 0x0, 0x200, 0x0
    .long 0x2000, 0x2400, 0x2800, 0x2c00, 0x0, 0x400, 0x800, 0xc00, 0x1000, 0x1400, 0x1800, 0x1c00, 0x1ec000, 0x18c000, 0x294000, 0x1bc000, 0x2c4000, 0x0, 0xcd000, 0xa5000, 0x113000, 0xb9000, 0x127000, 0x0, 0x9000, 0x6080, 0xc080, 0x6100, 0xc100, 0x0, 0x480, 0x0
    .long 0x0, 0x400, 0x800, 0xc00, 0x1000, 0x1400, 0x1800, 0x1c00, 0x2000, 0x2400, 0x2800, 0x2c00, 0x324000, 0x450000, 0x348000, 0x3fc000, 0x378000, 0x0, 0x14f000, 0x1cc000, 0x15e000, 0x1a9000, 0x172000, 0x0, 0xf000, 0x15000, 0xf080, 0x12080, 0xf100, 0x0, 0x200, 0x0
    .long 0x0, 0x400, 0x800, 0xc00, 0x1000, 0x1400, 0x1800, 0x1c00, 0x2000, 0x2400, 0x2800, 0x2c00, 0x324000, 0x450000, 0x348000, 0x3fc000, 0x378000, 0x0, 0x14f000, 0x1cc000, 0x15e000, 0x1a9000, 0x172000, 0x0, 0xf000, 0x15000, 0xf080, 0x12080, 0xf100, 0x0, 0x480, 0x0
    .long 0x1000, 0x1400, 0x1800, 0x1c00, 0x2000, 0x2400, 0x2800, 0x2c00, 0x0, 0x400, 0x800, 0xc00, 0x4ec000, 0x48c000, 0x594000, 0x4bc000, 0x5c4000, 0x0, 0x20d000, 0x1e5000, 0x253000, 0x1f9000, 0x267000, 0x0, 0x18000, 0x15080, 0x1b080, 0x15100, 0x1b100, 0x0, 0x200, 0x0
    .long 0x1000, 0x1400, 0x1800, 0x1c00, 0x2000, 0x2400, 0x2800, 0x2c00, 0x0, 0x400, 0x800, 0xc00, 0x4ec000, 0x48c000, 0x594000, 0x4bc000, 0x5c4000, 0x0, 0x20d000, 0x1e5000, 0x253000, 0x1f9000, 0x267000, 0x0, 0x18000, 0x15080, 0x1b080, 0x15100, 0x1b100, 0x0, 0x480, 0x0
    .long 0x2000, 0x2400, 0x2800, 0x2c00, 0x0, 0x400, 0x800, 0xc00, 0x1000, 0x1400, 0x1800, 0x1c00, 0x9c000, 0x15c000, 0x54000, 0x108000, 0x84000, 0x0, 0x41000, 0x91000, 0x23000, 0x6e000, 0x37000, 0x0, 0x3000, 0x6000, 0x80, 0x3080, 0x100, 0x0, 0x0, 0x0
    .long 0x2000, 0x2400, 0x2800, 0x2c00, 0x0, 0x400, 0x800, 0xc00, 0x1000, 0x1400, 0x1800, 0x1c00, 0x9c000, 0x15c000, 0x54000, 0x108000, 0x84000, 0x0, 0x41000, 0x91000, 0x23000, 0x6e000, 0x37000, 0x0, 0x3000, 0x6000, 0x80, 0x3080, 0x100, 0x0, 0x280, 0x0
    .long 0x0, 0x400, 0x800, 0xc00, 0x1000, 0x1400, 0x1800, 0x1c00, 0x2000, 0x2400, 0x2800, 0x2c00, 0x264000, 0x198000, 0x2a0000, 0x228000, 0x2d0000, 0x0, 0xff000, 0xaa000, 0x118000, 0xe6000, 0x12c000, 0x0, 0xc000, 0x6080, 0xc080, 0x9100, 0xc100, 0x0, 0x0, 0x0
    .long 0x0, 0x400, 0x800, 0xc00, 0x1000, 0x1400, 0x1800, 0x1c00, 0x2000, 0x2400, 0x2800, 0x2c00, 0x264000, 0x198000, 0x2a0000, 0x228000, 0x2d0000, 0x0, 0xff000, 0xaa000, 0x118000, 0xe6000, 0x12c000, 0x0, 0xc000, 0x6080, 0xc080, 0x9100, 0xc100, 0x0, 0x280, 0x0
    .long 0x1000, 0x1400, 0x1800, 0x1c00, 0x2000, 0x2400, 0x2800, 0x2c00, 0x0, 0x400, 0x800, 0xc00, 0x39c000, 0x45c000, 0x354000, 0x408000, 0x384000, 0x0, 0x181000, 0x1d1000, 0x163000, 0x1ae000, 0x177000, 0x0, 0x12000, 0x15000, 0xf080, 0x12080, 0xf100, 0x0, 0x0, 0x0
    .long 0x1000, 0x1400, 0x1800, 0x1c00, 0x2000, 0x2400, 0x2800, 0x2c00, 0x0, 0x400, 0x800, 0xc00, 0x39c000, 0x45c000, 0x354000, 0x408000, 0x384000, 0x0, 0x181000, 0x1d1000, 0x163000, 0x1ae000, 0x177000, 0x0, 0x12000, 0x15000, 0xf080, 0x12080, 0xf100, 0x0, 0x280, 0x0
    .long 0x2000, 0x2400, 0x2800, 0x2c00, 0x0, 0x400, 0x800, 0xc00, 0x1000, 0x1400, 0x1800, 0x1c00, 0x564000, 0x498000, 0x5a0000, 0x528000, 0x5d0000, 0x0, 0x23f000, 0x1ea000, 0x258000, 0x226000, 0x26c000, 0x0, 0x1b000, 0x15080, 0x1b080, 0x18100, 0x1b100, 0x0, 0x0, 0x0
    .long 0x2000, 0x2400, 0x2800, 0x2c00, 0x0, 0x400, 0x800, 0xc00, 0x1000, 0x1400, 0x1800, 0x1c00, 0x564000, 0x498000, 0x5a0000, 0x528000, 0x5d0000, 0x0, 0x23f000, 0x1ea000, 0x258000, 0x226000, 0x26c000, 0x0, 0x1b000, 0x15080, 0x1b080, 0x18100, 0x1b100, 0x0, 0x280, 0x0
    .long 0x2800, 0x2c00, 0x0, 0x400, 0x800, 0xc00, 0x1000, 0x1400, 0x1800, 0x1c00, 0x2000, 0x2400, 0x9c000, 0x15c000, 0x54000, 0x108000, 0x84000, 0x0, 0x41000, 0x91000, 0x23000, 0x6e000, 0x37000, 0x0, 0x3000, 0x6000, 0x80, 0x3080, 0x100, 0x0, 0x80, 0x0
    .long 0x2800, 0x2c00, 0x0, 0x400, 0x800, 0xc00, 0x1000, 0x1400, 0x1800, 0x1c00, 0x2000, 0x2400, 0x9c000, 0x15c000, 0x54000, 0x108000, 0x84000, 0x0, 0x41000, 0x91000, 0x23000, 0x6e000, 0x37000, 0x0, 0x3000, 0x6000, 0x80, 0x3080, 0x100, 0x0, 0x300, 0x0
    .long 0x800, 0xc00, 0x1000, 0x1400, 0x1800, 0x1c00, 0x2000, 0x2400, 0x2800, 0x2c00, 0x0, 0x400, 0x264000, 0x198000, 0x2a0000, 0x228000, 0x2d0000, 0x0, 0xff000, 0xaa000, 0x118000, 0xe6000, 0x12c000, 0x0, 0xc000, 0x6080, 0xc080, 0x9100, 0xc100, 0x0, 0x80, 0x0
    .long 0x800, 0xc00, 0x1000, 0x1400, 0x1800, 0x1c00, 0x2000, 0x2400, 0x2800, 0x2c00, 0x0, 0x400, 0x264000, 0x198000, 0x2a0000, 0x228000, 0x2d0000, 0x0, 0xff000, 0xaa000, 0x118000, 0xe6000, 0x12c000, 0x0, 0xc000, 0x6080, 0xc080, 0x9100, 0xc100, 0x0, 0x300, 0x0
    .long 0x1800, 0x1c00, 0x2000, 0x2400, 0x2800, 0x2c00, 0x0, 0x400, 0x800, 0xc00, 0x1000, 0x1400, 0x39c000, 0x45c000, 0x354000, 0x408000, 0x384000, 0x0, 0x181000, 0x1d1000, 0x163000, 0x1ae000, 0x177000, 0x0, 0x12000, 0x15000, 0xf080, 0x12080, 0xf100, 0x0, 0x80, 0x0
    .long 0x1800, 0x1c00, 0x2000, 0x2400, 0x2800, 0x2c00, 0x0, 0x400, 0x800, 0xc00, 0x1000, 0x1400, 0x39c000, 0x45c000, 0x354000, 0x408000, 0x384000, 0x0, 0x181000, 0x1d1000, 0x163000, 0x1ae000, 0x177000, 0x0, 0x12000, 0x15000, 0xf080, 0x12080, 0xf100, 0x0, 0x300, 0x0
    .long 0x2800, 0x2c00, 0x0, 0x400, 0x800, 0xc00, 0x1000, 0x1400, 0x1800, 0x1c00, 0x2000, 0x2400, 0x564000, 0x498000, 0x5a0000, 0x528000, 0x5d0000, 0x0, 0x23f000, 0x1ea000, 0x258000, 0x226000, 0x26c000, 0x0, 0x1b000, 0x15080, 0x1b080, 0x18100, 0x1b100, 0x0, 0x80, 0x0
    .long 0x2800, 0x2c00, 0x0, 0x400, 0x800, 0xc00, 0x1000, 0x1400, 0x1800, 0x1c00, 0x2000, 0x2400, 0x564000, 0x498000, 0x5a0000, 0x528000, 0x5d0000, 0x0, 0x23f000, 0x1ea000, 0x258000, 0x226000, 0x26c000, 0x0, 0x1b000, 0x15080, 0x1b080, 0x18100, 0x1b100, 0x0, 0x300, 0x0
    .long 0x400, 0x800, 0xc00, 0x1000, 0x1400, 0x1800, 0x1c00, 0x2000, 0x2400, 0x2800, 0x2c00, 0x0, 0x9c000, 0x15c000, 0x54000, 0x108000, 0x84000, 0x0, 0x41000, 0x91000, 0x23000, 0x6e000, 0x37000, 0x0, 0x3000, 0x6000, 0x80, 0x3080, 0x100, 0x0, 0x100, 0x0
    .long 0x400, 0x800, 0xc00, 0x1000, 0x1400, 0x1800, 0x1c00, 0x2000, 0x2400, 0x2800, 0x2c00, 0x0, 0x9c000, 0x15c000, 0x54000, 0x108000, 0x84000, 0x0, 0x41000, 0x91000, 0x23000, 0x6e000, 0x37000, 0x0, 0x3000, 0x6000, 0x80, 0x3080, 0x100, 0x0, 0x380, 0x0
    .long 0x1400, 0x1800, 0x1c00, 0x2000, 0x2400, 0x2800, 0x2c00, 0x0, 0x400, 0x800, 0xc00, 0x1000, 0x264000, 0x198000, 0x2a0000, 0x228000, 0x2d0000, 0x0, 0xff000, 0xaa000, 0x118000, 0xe6000, 0x12c000, 0x0, 0xc000, 0x6080, 0xc080, 0x9100, 0xc100, 0x0, 0x100, 0x0
    .long 0x1400, 0x1800, 0x1c00, 0x2000, 0x2400, 0x2800, 0x2c00, 0x0, 0x400, 0x800, 0xc00, 0x1000, 0x264000, 0x198000, 0x2a0000, 0x228000, 0x2d0000, 0x0, 0xff000, 0xaa000, 0x118000, 0xe6000, 0x12c000, 0x0, 0xc000, 0x6080, 0xc080, 0x9100, 0xc100, 0x0, 0x380, 0x0
    .long 0x2400, 0x2800, 0x2c00, 0x0, 0x400, 0x800, 0xc00, 0x1000, 0x1400, 0x1800, 0x1c00, 0x2000, 0x39c000, 0x45c000, 0x354000, 0x408000, 0x384000, 0x0, 0x181000, 0x1d1000, 0x163000, 0x1ae000, 0x177000, 0x0, 0x12000, 0x15000, 0xf080, 0x12080, 0xf100, 0x0, 0x100, 0x0
    .long 0x2400, 0x2800, 0x2c00, 0x0, 0x400, 0x800, 0xc00, 0x1000, 0x1400, 0x1800, 0x1c00, 0x2000, 0x39c000, 0x45c000, 0x354000, 0x408000, 0x384000, 0x0, 0x181000, 0x1d1000, 0x163000, 0x1ae000, 0x177000, 0x0, 0x12000, 0x15000, 0xf080, 0x12080, 0xf100, 0x0, 0x380, 0x0
    .long 0x400, 0x800, 0xc00, 0x1000, 0x1400, 0x1800, 0x1c00, 0x2000, 0x2400, 0x2800, 0x2c00, 0x0, 0x564000, 0x498000, 0x5a0000, 0x528000, 0x5d0000, 0x0, 0x23f000, 0x1ea000, 0x258000, 0x226000, 0x26c000, 0x0, 0x1b000, 0x15080, 0x1b080, 0x18100, 0x1b100, 0x0, 0x100, 0x0
    .long 0x400, 0x800, 0xc00, 0x1000, 0x1400, 0x1800, 0x1c00, 0x2000, 0x2400, 0x2800, 0x2c00, 0x0, 0x564000, 0x498000, 0x5a0000, 0x528000, 0x5d0000, 0x0, 0x23f000, 0x1ea000, 0x258000, 0x226000, 0x26c000, 0x0, 0x1b000, 0x15080, 0x1b080, 0x18100, 0x1b100, 0x0, 0x380, 0x0
    .long 0xc00, 0x1000, 0x1400, 0x1800, 0x1c00, 0x2000, 0x2400, 0x2800, 0x2c00, 0x0, 0x400, 0x800, 0x9c000, 0x15c000, 0x54000, 0x108000, 0x84000, 0x0, 0x41000, 0x91000, 0x23000, 0x6e000, 0x37000, 0x0, 0x3000, 0x6000, 0x80, 0x3080, 0x100, 0x0, 0x180, 0x0
    .long 0xc00, 0x1000, 0x1400, 0x1800, 0x1c00, 0x2000, 0x2400, 0x2800, 0x2c00, 0x0, 0x400, 0x800, 0x9c000, 0x15c000, 0x54000, 0x108000, 0x84000, 0x0, 0x41000, 0x91000, 0x23000, 0x6e000, 0x37000, 0x0, 0x3000, 0x6000, 0x80, 0x3080, 0x100, 0x0, 0x400, 0x0
    .long 0x1c00, 0x2000, 0x2400, 0x2800, 0x2c00, 0x0, 0x400, 0x800, 0xc00, 0x1000, 0x1400, 0x1800, 0x264000, 0x198000, 0x2a0000, 0x228000, 0x2d0000, 0x0, 0xff000, 0xaa000, 0x118000, 0xe6000, 0x12c000, 0x0, 0xc000, 0x6080, 0xc080, 0x9100, 0xc100, 0x0, 0x180, 0x0
    .long 0x1c00, 0x2000, 0x2400, 0x2800, 0x2c00, 0x0, 0x400, 0x800, 0xc00, 0x1000, 0x1400, 0x1800, 0x264000, 0x198000, 0x2a0000, 0x228000, 0x2d0000, 0x0, 0xff000, 0xaa000, 0x118000, 0xe6000, 0x12c000, 0x0, 0xc000, 0x6080, 0xc080, 0x9100, 0xc100, 0x0, 0x400, 0x0
    .long 0x2c00, 0x0, 0x400, 0x800, 0xc00, 0x1000, 0x1400, 0x1800, 0x1c00, 0x2000, 0x2400, 0x2800, 0x39c000, 0x45c000, 0x354000, 0x408000, 0x384000, 0x0, 0x181000, 0x1d1000, 0x163000, 0x1ae000, 0x177000, 0x0, 0x12000, 0x15000, 0xf080, 0x12080, 0xf100, 0x0, 0x180, 0x0
    .long 0x2c00, 0x0, 0x400, 0x800, 0xc00, 0x1000, 0x1400, 0x1800, 0x1c00, 0x2000, 0x2400, 0x2800, 0x39c000, 0x45c000, 0x354000, 0x408000, 0x384000, 0x0, 0x181000, 0x1d1000, 0x163000, 0x1ae000, 0x177000, 0x0, 0x12000, 0x15000, 0xf080, 0x12080, 0xf100, 0x0, 0x400, 0x0
    .long 0xc00, 0x1000, 0x1400, 0x1800, 0x1c00, 0x2000, 0x2400, 0x2800, 0x2c00, 0x0, 0x400, 0x800, 0x564000, 0x498000, 0x5a0000, 0x528000, 0x5d0000, 0x0, 0x23f000, 0x1ea000, 0x258000, 0x226000, 0x26c000, 0x0, 0x1b000, 0x15080, 0x1b080, 0x18100, 0x1b100, 0x0, 0x180, 0x0
    .long 0xc00, 0x1000, 0x1400, 0x1800, 0x1c00, 0x2000, 0x2400, 0x2800, 0x2c00, 0x0, 0x400, 0x800, 0x564000, 0x498000, 0x5a0000, 0x528000, 0x5d0000, 0x0, 0x23f000, 0x1ea000, 0x258000, 0x226000, 0x26c000, 0x0, 0x1b000, 0x15080, 0x1b080, 0x18100, 0x1b100, 0x0, 0x400, 0x0
    .long 0x1800, 0x1c00, 0x2000, 0x2400, 0x2800, 0x2c00, 0x0, 0x400, 0x800, 0xc00, 0x1000, 0x1400, 0x9c000, 0x15c000, 0x54000, 0x108000, 0x84000, 0x0, 0x41000, 0x91000, 0x23000, 0x6e000, 0x37000, 0x0, 0x3000, 0x6000, 0x80, 0x3080, 0x100, 0x0, 0x200, 0x0
    .long 0x1800, 0x1c00, 0x2000, 0x2400, 0x2800, 0x2c00, 0x0, 0x400, 0x800, 0xc00, 0x1000, 0x1400, 0x9c000, 0x15c000, 0x54000, 0x108000, 0x84000, 0x0, 0x41000, 0x91000, 0x23000, 0x6e000, 0x37000, 0x0, 0x3000, 0x6000, 0x80, 0x3080, 0x100, 0x0, 0x480, 0x0
    .long 0x2800, 0x2c00, 0x0, 0x400, 0x800, 0xc00, 0x1000, 0x1400, 0x1800, 0x1c00, 0x2000, 0x2400, 0x264000, 0x198000, 0x2a0000, 0x228000, 0x2d0000, 0x0, 0xff000, 0xaa000, 0x118000, 0xe6000, 0x12c000, 0x0, 0xc000, 0x6080, 0xc080, 0x9100, 0xc100, 0x0, 0x200, 0x0
    .long 0x2800, 0x2c00, 0x0, 0x400, 0x800, 0xc00, 0x1000, 0x1400, 0x1800, 0x1c00, 0x2000, 0x2400, 0x264000, 0x198000, 0x2a0000, 0x228000, 0x2d0000, 0x0, 0xff000, 0xaa000, 0x118000, 0xe6000, 0x12c000, 0x0, 0xc000, 0x6080, 0xc080, 0x9100, 0xc100, 0x0, 0x480, 0x0
    .long 0x800, 0xc00, 0x1000, 0x1400, 0x1800, 0x1c00, 0x2000, 0x2400, 0x2800, 0x2c00, 0x0, 0x400, 0x39c000, 0x45c000, 0x354000, 0x408000, 0x384000, 0x0, 0x181000, 0x1d1000, 0x163000, 0x1ae000, 0x177000, 0x0, 0x12000, 0x15000, 0xf080, 0x12080, 0xf100, 0x0, 0x200, 0x0
    .long 0x800, 0xc00, 0x1000, 0x1400, 0x1800, 0x1c00, 0x2000, 0x2400, 0x2800, 0x2c00, 0x0, 0x400, 0x39c000, 0x45c000, 0x354000, 0x408000, 0x384000, 0x0, 0x181000, 0x1d1000, 0x163000, 0x1ae000, 0x177000, 0x0, 0x12000, 0x15000, 0xf080, 0x12080, 0xf100, 0x0, 0x480, 0x0
    .long 0x1800, 0x1c00, 0x2000, 0x2400, 0x2800, 0x2c00, 0x0, 0x400, 0x800, 0xc00, 0x1000, 0x1400, 0x564000, 0x498000, 0x5a0000, 0x528000, 0x5d0000, 0x0, 0x23f000, 0x1ea000, 0x258000, 0x226000, 0x26c000, 0x0, 0x1b000, 0x15080, 0x1b080, 0x18100, 0x1b100, 0x0, 0x200, 0x0
    .long 0x1800, 0x1c00, 0x2000, 0x2400, 0x2800, 0x2c00, 0x0, 0x400, 0x800, 0xc00, 0x1000, 0x1400, 0x564000, 0x498000, 0x5a0000, 0x528000, 0x5d0000, 0x0, 0x23f000, 0x1ea000, 0x258000, 0x226000, 0x26c000, 0x0, 0x1b000, 0x15080, 0x1b080, 0x18100, 0x1b100, 0x0, 0x480, 0x0
    .long 0x2800, 0x2c00, 0x0, 0x400, 0x800, 0xc00, 0x1000, 0x1400, 0x1800, 0x1c00, 0x2000, 0x2400, 0xa8000, 0x168000, 0xcc000, 0x114000, 0x90000, 0x0, 0x46000, 0x96000, 0x55000, 0x73000, 0x3c000, 0x0, 0x3000, 0x6000, 0x3080, 0x3100, 0x100, 0x0, 0x0, 0x0
    .long 0x2800, 0x2c00, 0x0, 0x400, 0x800, 0xc00, 0x1000, 0x1400, 0x1800, 0x1c00, 0x2000, 0x2400, 0xa8000, 0x168000, 0xcc000, 0x114000, 0x90000, 0x0, 0x46000, 0x96000, 0x55000, 0x73000, 0x3c000, 0x0, 0x3000, 0x6000, 0x3080, 0x3100, 0x100, 0x0, 0x280, 0x0
    .long 0x800, 0xc00, 0x1000, 0x1400, 0x1800, 0x1c00, 0x2000, 0x2400, 0x2800, 0x2c00, 0x0, 0x400, 0x270000, 0x1f8000, 0x2ac000, 0x234000, 0x2dc000, 0x0, 0x104000, 0xd2000, 0x11d000, 0xeb000, 0x131000, 0x0, 0xc000, 0x9080, 0xc080, 0x9100, 0xc100, 0x0, 0x0, 0x0
    .long 0x800, 0xc00, 0x1000, 0x1400, 0x1800, 0x1c00, 0x2000, 0x2400, 0x2800, 0x2c00, 0x0, 0x400, 0x270000, 0x1f8000, 0x2ac000, 0x234000, 0x2dc000, 0x0, 0x104000, 0xd2000, 0x11d000, 0xeb000, 0x131000, 0x0, 0xc000, 0x9080, 0xc080, 0x9100, 0xc100, 0x0, 0x280, 0x0
    .long 0x1800, 0x1c00, 0x2000, 0x2400, 0x2800, 0x2c00, 0x0, 0x400, 0x800, 0xc00, 0x1000, 0x1400, 0x3a8000, 0x468000, 0x3cc000, 0x414000, 0x390000, 0x0, 0x186000, 0x1d6000, 0x195000, 0x1b3000, 0x17c000, 0x0, 0x12000, 0x15000, 0x12080, 0x12100, 0xf100, 0x0, 0x0, 0x0
    .long 0x1800, 0x1c00, 0x2000, 0x2400, 0x2800, 0x2c00, 0x0, 0x400, 0x800, 0xc00, 0x1000, 0x1400, 0x3a8000, 0x468000, 0x3cc000, 0x414000, 0x390000, 0x0, 0x186000, 0x1d6000, 0x195000, 0x1b3000, 0x17c000, 0x0, 0x12000, 0x15000, 0x12080, 0x12100, 0xf100, 0x0, 0x280, 0x0
    .long 0x2800, 0x2c00, 0x0, 0x400, 0x800, 0xc00, 0x1000, 0x1400, 0x1800, 0x1c00, 0x2000, 0x2400, 0x570000, 0x4f8000, 0x5ac000, 0x534000, 0x5dc000, 0x0, 0x244000, 0x212000, 0x25d000, 0x22b000, 0x271000, 0x0, 0x1b000, 0x18080, 0x1b080, 0x18100, 0x1b100, 0x0, 0x0, 0x0
    .long 0x2800, 0x2c00, 0x0, 0x400, 0x800, 0xc00, 0x1000, 0x1400, 0x1800, 0x1c00, 0x2000, 0x2400, 0x570000, 0x4f8000, 0x5ac000, 0x534000, 0x5dc000, 0x0, 0x244000, 0x212000, 0x25d000, 0x22b000, 0x271000, 0x0, 0x1b000, 0x18080, 0x1b080, 0x18100, 0x1b100, 0x0, 0x280, 0x0
    .long 0x0, 0x400, 0x800, 0xc00, 0x1000, 0x1400, 0x1800, 0x1c00, 0x2000, 0x2400, 0x2800, 0x2c00, 0xa8000, 0x168000, 0xcc000, 0x114000, 0x90000, 0x0, 0x46000, 0x96000, 0x55000, 0x73000, 0x3c000, 0x0, 0x3000, 0x6000, 0x3080, 0x3100, 0x100, 0x0, 0x80, 0x0
    .long 0x0, 0x400, 0x800, 0xc00, 0x1000, 0x1400, 0x1800, 0x1c00, 0x2000, 0x2400, 0x2800, 0x2c00, 0xa8000, 0x168000, 0xcc000, 0x114000, 0x90000, 0x0, 0x46000, 0x96000, 0x55000, 0x73000, 0x3c000, 0x0, 0x3000, 0x6000, 0x3080, 0x3100, 0x100, 0x0, 0x300, 0x0
    .long 0x1000, 0x1400, 0x1800, 0x1c00, 0x2000, 0x2400, 0x2800, 0x2c00, 0x0, 0x400, 0x800, 0xc00, 0x270000, 0x1f8000, 0x2ac000, 0x234000, 0x2dc000, 0x0, 0x104000, 0xd2000, 0x11d000, 0xeb000, 0x131000, 0x0, 0xc000, 0x9080, 0xc080, 0x9100, 0xc100, 0x0, 0x80, 0x0
    .long 0x1000, 0x1400, 0x1800, 0x1c00, 0x2000, 0x2400, 0x2800, 0x2c00, 0x0, 0x400, 0x800, 0xc00, 0x270000, 0x1f8000, 0x2ac000, 0x234000, 0x2dc000, 0x0, 0x104000, 0xd2000, 0x11d000, 0xeb000, 0x131000, 0x0, 0xc000, 0x9080, 0xc080, 0x9100, 0xc100, 0x0, 0x300, 0x0
    .long 0x2000, 0x2400, 0x2800, 0x2c00, 0x0, 0x400, 0x800, 0xc00, 0x1000, 0x1400, 0x1800, 0x1c00, 0x3a8000, 0x468000, 0x3cc000, 0x414000, 0x390000, 0x0, 0x186000, 0x1d6000, 0x195000, 0x1b3000, 0x17c000, 0x0, 0x12000, 0x15000, 0x12080, 0x12100, 0xf100, 0x0, 0x80, 0x0
    .long 0x2000, 0x2400, 0x2800, 0x2c00, 0x0, 0x400, 0x800, 0xc00, 0x1000, 0x1400, 0x1800, 0x1c00, 0x3a8000, 0x468000, 0x3cc000, 0x414000, 0x390000, 0x0, 0x186000, 0x1d6000, 0x195000, 0x1b3000, 0x17c000, 0x0, 0x12000, 0x15000, 0x12080, 0x12100, 0xf100, 0x0, 0x300, 0x0
    .long 0x0, 0x400, 0x800, 0xc00, 0x1000, 0x1400, 0x1800, 0x1c00, 0x2000, 0x2400, 0x2800, 0x2c00, 0x570000, 0x4f8000, 0x5ac000, 0x534000, 0x5dc000, 0x0, 0x244000, 0x212000, 0x25d000, 0x22b000, 0x271000, 0x0, 0x1b000, 0x18080, 0x1b080, 0x18100, 0x1b100, 0x0, 0x80, 0x0
    .long 0x0, 0x400, 0x800, 0xc00, 0x1000, 0x1400, 0x1800, 0x1c00, 0x2000, 0x2400, 0x2800, 0x2c00, 0x570000, 0x4f8000, 0x5ac000, 0x534000, 0x5dc000, 0x0, 0x244000, 0x212000, 0x25d000, 0x22b000, 0x271000, 0x0, 0x1b000, 0x18080, 0x1b080, 0x18100, 0x1b100, 0x0, 0x300, 0x0
    .long 0xc00, 0x1000, 0x1400, 0x1800, 0x1c00, 0x2000, 0x2400, 0x2800, 0x2c00, 0x0, 0x400, 0x800, 0xa8000, 0x168000, 0xcc000, 0x114000, 0x90000, 0x0, 0x46000, 0x96000, 0x55000, 0x73000, 0x3c000, 0x0, 0x3000, 0x6000, 0x3080, 0x3100, 0x100, 0x0, 0x100, 0x0
    .long 0xc00, 0x1000, 0x1400, 0x1800, 0x1c00, 0x2000, 0x2400, 0x2800, 0x2c00, 0x0, 0x400, 0x800, 0xa8000, 0x168000, 0xcc000, 0x114000, 0x90000, 0x0, 0x46000, 0x96000, 0x55000, 0x73000, 0x3c000, 0x0, 0x3000, 0x6000, 0x3080, 0x3100, 0x100, 0x0, 0x380, 0x0
    .long 0x1c00, 0x2000, 0x2400, 0x2800, 0x2c00, 0x0, 0x400, 0x800, 0xc00, 0x1000, 0x1400, 0x1800, 0x270000, 0x1f8000, 0x2ac000, 0x234000, 0x2dc000, 0x0, 0x104000, 0xd2000, 0x11d000, 0xeb000, 0x131000, 0x0, 0xc000, 0x9080, 0xc080, 0x9100, 0xc100, 0x0, 0x100, 0x0
    .long 0x1c00, 0x2000, 0x2400, 0x2800, 0x2c00, 0x0, 0x400, 0x800, 0xc00, 0x1000, 0x1400, 0x1800, 0x270000, 0x1f8000, 0x2ac000, 0x234000, 0x2dc000, 0x0, 0x104000, 0xd2000, 0x11d000, 0xeb000, 0x131000, 0x0, 0xc000, 0x9080, 0xc080, 0x9100, 0xc100, 0x0, 0x380, 0x0
    .long 0x2c00, 0x0, 0x400, 0x800, 0xc00, 0x1000, 0x1400, 0x1800, 0x1c00, 0x2000, 0x2400, 0x2800, 0x3a8000, 0x468000, 0x3cc000, 0x414000, 0x390000, 0x0, 0x186000, 0x1d6000, 0x195000, 0x1b3000, 0x17c000, 0x0, 0x12000, 0x15000, 0x12080, 0x12100, 0xf100, 0x0, 0x100, 0x0
    .long 0x2c00, 0x0, 0x400, 0x800, 0xc00, 0x1000, 0x1400, 0x1800, 0x1c00, 0x2000, 0x2400, 0x2800, 0x3a8000, 0x468000, 0x3cc000, 0x414000, 0x390000, 0x0, 0x186000, 0x1d6000, 0x195000, 0x1b3000, 0x17c000, 0x0, 0x12000, 0x15000, 0x12080, 0x12100, 0xf100, 0x0, 0x380, 0x0
    .long 0xc00, 0x1000, 0x1400, 0x1800, 0x1c00, 0x2000, 0x2400, 0x2800, 0x2c00, 0x0, 0x400, 0x800, 0x570000, 0x4f8000, 0x5ac000, 0x534000, 0x5dc000, 0x0, 0x244000, 0x212000, 0x25d000, 0x22b000, 0x271000, 0x0, 0x1b000, 0x18080, 0x1b080, 0x18100, 0x1b100, 0x0, 0x100, 0x0
    .long 0xc00, 0x1000, 0x1400, 0x1800, 0x1c00, 0x2000, 0x2400, 0x2800, 0x2c00, 0x0, 0x400, 0x800, 0x570000, 0x4f8000, 0x5ac000, 0x534000, 0x5dc000, 0x0, 0x244000, 0x212000, 0x25d000, 0x22b000, 0x271000, 0x0, 0x1b000, 0x18080, 0x1b080, 0x18100, 0x1b100, 0x0, 0x380, 0x0
    .long 0x1400, 0x1800, 0x1c00, 0x2000, 0x2400, 0x2800, 0x2c00, 0x0, 0x400, 0x800, 0xc00, 0x1000, 0xa8000, 0x168000, 0xcc000, 0x114000, 0x90000, 0x0, 0x46000, 0x96000, 0x55000, 0x73000, 0x3c000, 0x0, 0x3000, 0x6000, 0x3080, 0x3100, 0x100, 0x0, 0x180, 0x0
    .long 0x1400, 0x1800, 0x1c00, 0x2000, 0x2400, 0x2800, 0x2c00, 0x0, 0x400, 0x800, 0xc00, 0x1000, 0xa8000, 0x168000, 0xcc000, 0x114000, 0x90000, 0x0, 0x46000, 0x96000, 0x55000, 0x73000, 0x3c000, 0x0, 0x3000, 0x6000, 0x3080, 0x3100, 0x100, 0x0, 0x400, 0x0
    .long 0x2400, 0x2800, 0x2c00, 0x0, 0x400, 0x800, 0xc00, 0x1000, 0x1400, 0x1800, 0x1c00, 0x2000, 0x270000, 0x1f8000, 0x2ac000, 0x234000, 0x2dc000, 0x0, 0x104000, 0xd2000, 0x11d000, 0xeb000, 0x131000, 0x0, 0xc000, 0x9080, 0xc080, 0x9100, 0xc100, 0x0, 0x180, 0x0
    .long 0x2400, 0x2800, 0x2c00, 0x0, 0x400, 0x800, 0xc00, 0x1000, 0x1400, 0x1800, 0x1c00, 0x2000, 0x270000, 0x1f8000, 0x2ac000, 0x234000, 0x2dc000, 0x0, 0x104000, 0xd2000, 0x11d000, 0xeb000, 0x131000, 0x0, 0xc000, 0x9080, 0xc080, 0x9100, 0xc100, 0x0, 0x400, 0x0
    .long 0x400, 0x800, 0xc00, 0x1000, 0x1400, 0x1800, 0x1c00, 0x2000, 0x2400, 0x2800, 0x2c00, 0x0, 0x3a8000, 0x468000, 0x3cc000, 0x414000, 0x390000, 0x0, 0x186000, 0x1d6000, 0x195000, 0x1b3000, 0x17c000, 0x0, 0x12000, 0x15000, 0x12080, 0x12100, 0xf100, 0x0, 0x180, 0x0
    .long 0x400, 0x800, 0xc00, 0x1000, 0x1400, 0x1800, 0x1c00, 0x2000, 0x2400, 0x2800, 0x2c00, 0x0, 0x3a8000, 0x468000, 0x3cc000, 0x414000, 0x390000, 0x0, 0x186000, 0x1d6000, 0x195000, 0x1b3000, 0x17c000, 0x0, 0x12000, 0x15000, 0x12080, 0x12100, 0xf100, 0x0, 0x400, 0x0
    .long 0x1400, 0x1800, 0x1c00, 0x2000, 0x2400, 0x2800, 0x2c00, 0x0, 0x400, 0x800, 0xc00, 0x1000, 0x570000, 0x4f8000, 0x5ac000, 0x534000, 0x5dc000, 0x0, 0x244000, 0x212000, 0x25d000, 0x22b000, 0x271000, 0x0, 0x1b000, 0x18080, 0x1b080, 0x18100, 0x1b100, 0x0, 0x180, 0x0
    .long 0x1400, 0x1800, 0x1c00, 0x2000, 0x2400, 0x2800, 0x2c00, 0x0, 0x400, 0x800, 0xc00, 0x1000, 0x570000, 0x4f8000, 0x5ac000, 0x534000, 0x5dc000, 0x0, 0x244000, 0x212000, 0x25d000, 0x22b000, 0x271000, 0x0, 0x1b000, 0x18080, 0x1b080, 0x18100, 0x1b100, 0x0, 0x400, 0x0
    .long 0x2000, 0x2400, 0x2800, 0x2c00, 0x0, 0x400, 0x800, 0xc00, 0x1000, 0x1400, 0x1800, 0x1c00, 0xa8000, 0x168000, 0xcc000, 0x114000, 0x90000, 0x0, 0x46000, 0x96000, 0x55000, 0x73000, 0x3c000, 0x0, 0x3000, 0x6000, 0x3080, 0x3100, 0x100, 0x0, 0x200, 0x0
    .long 0x2000, 0x2400, 0x2800, 0x2c00, 0x0, 0x400, 0x800, 0xc00, 0x1000, 0x1400, 0x1800, 0x1c00, 0xa8000, 0x168000, 0xcc000, 0x114000, 0x90000, 0x0, 0x46000, 0x96000, 0x55000, 0x73000, 0x3c000, 0x0, 0x3000, 0x6000, 0x3080, 0x3100, 0x100, 0x0, 0x480, 0x0
    .long 0x0, 0x400, 0x800, 0xc00, 0x1000, 0x1400, 0x1800, 0x1c00, 0x2000, 0x2400, 0x2800, 0x2c00, 0x270000, 0x1f8000, 0x2ac000, 0x234000, 0x2dc000, 0x0, 0x104000, 0xd2000, 0x11d000, 0xeb000, 0x131000, 0x0, 0xc000, 0x9080, 0xc080, 0x9100, 0xc100, 0x0, 0x200, 0x0
    .long 0x0, 0x400, 0x800, 0xc00, 0x1000, 0x1400, 0x1800, 0x1c00, 0x2000, 0x2400, 0x2800, 0x2c00, 0x270000, 0x1f8000, 0x2ac000, 0x234000, 0x2dc000, 0x0, 0x104000, 0xd2000, 0x11d000, 0xeb000, 0x131000, 0x0, 0xc000, 0x9080, 0xc080, 0x9100, 0xc100, 0x0, 0x480, 0x0
    .long 0x1000, 0x1400, 0x1800, 0x1c00, 0x2000, 0x2400, 0x2800, 0x2c00, 0x0, 0x400, 0x800, 0xc00, 0x3a8000, 0x468000, 0x3cc000, 0x414000, 0x390000, 0x0, 0x186000, 0x1d6000, 0x195000, 0x1b3000, 0x17c000, 0x0, 0x12000, 0x15000, 0x12080, 0x12100, 0xf100, 0x0, 0x200, 0x0
    .long 0x1000, 0x1400, 0x1800, 0x1c00, 0x2000, 0x2400, 0x2800, 0x2c00, 0x0, 0x400, 0x800, 0xc00, 0x3a8000, 0x468000, 0x3cc000, 0x414000, 0x390000, 0x0, 0x186000, 0x1d6000, 0x195000, 0x1b3000, 0x17c000, 0x0, 0x12000, 0x15000, 0x12080, 0x12100, 0xf100, 0x0, 0x480, 0x0
    .long 0x2000, 0x2400, 0x2800, 0x2c00, 0x0, 0x400, 0x800, 0xc00, 0x1000, 0x1400, 0x1800, 0x1c00, 0x570000, 0x4f8000, 0x5ac000, 0x534000, 0x5dc000, 0x0, 0x244000, 0x212000, 0x25d000, 0x22b000, 0x271000, 0x0, 0x1b000, 0x18080, 0x1b080, 0x18100, 0x1b100, 0x0, 0x200, 0x0
    .long 0x2000, 0x2400, 0x2800, 0x2c00, 0x0, 0x400, 0x800, 0xc00, 0x1000, 0x1400, 0x1800, 0x1c00, 0x570000, 0x4f8000, 0x5ac000, 0x534000, 0x5dc000, 0x0, 0x244000, 0x212000, 0x25d000, 0x22b000, 0x271000, 0x0, 0x1b000, 0x18080, 0x1b080, 0x18100, 0x1b100, 0x0, 0x480, 0x0
.size L_table, 32768
.section .rodata,"a"
.p2align 6
.amdhsa_kernel standalone__glu_gated_reglu__prompt_kernel
  .amdhsa_next_free_vgpr 512
  .amdhsa_next_free_sgpr 102
  .amdhsa_accum_offset 256
  .amdhsa_group_segment_fixed_size 0
  .amdhsa_kernarg_size 56
  .amdhsa_user_sgpr_count 2
  .amdhsa_user_sgpr_kernarg_segment_ptr 1
  .amdhsa_system_sgpr_workgroup_id_x 1
  .amdhsa_float_denorm_mode_32 3
.end_amdhsa_kernel
```
